```python
import torch

def _softmax(x, axis=-1):
    return torch.softmax(x, dim=axis)
def _gelu(x):
    return torch.nn.functional.gelu(x, approximate="tanh")
def _silu(x):
    return torch.nn.functional.silu(x)
def _sigmoid(x):
    return torch.sigmoid(x)
def _layernorm(x, axis=-1, eps=1e-5):
    m = x.mean(dim=axis, keepdim=True)
    v = x.var(dim=axis, keepdim=True, unbiased=False)
    return (x - m) / torch.sqrt(v + eps)
def _scatter_add(tgt, idx, src, axis=0):
    return tgt.clone().index_add_(axis, idx, src)
def _segment_sum(src, seg, n):
    out = torch.zeros((n,) + src.shape[1:], dtype=src.dtype)
    return out.index_add_(0, seg, src)
def _pad(x, pw):
    flat = tuple(v for pair in reversed(pw) for v in pair)
    return torch.nn.functional.pad(x, flat)

kernel_name = 'recurrent_scan__mha_block_cached__mixer_s_mlp__prompt'

def setup_inputs():

    _w = (lambda a: (lambda t: t.to(torch.bfloat16) if t.is_floating_point() else t)(torch.as_tensor(a)))
    def _A_setup():
        B, Sq, D = 1, 2048, 512
        H, Sk, Dh = 32, 2048, 128
        return {
            "x": _w((lambda *s: torch.randn(*s, dtype=torch.bfloat16) * 0.05)(B, Sq, D)),
            "k_cache": _w((lambda *s: torch.randn(*s, dtype=torch.bfloat16) * 0.8)(B, H, Sk, Dh)),
            "v_cache": _w((lambda *s: torch.randn(*s, dtype=torch.bfloat16) * 0.8)(B, H, Sk, Dh)),
            "wq": _w((lambda *s: torch.randn(*s, dtype=torch.bfloat16) * 0.8)(D, H * Dh) * (D ** -0.5)),
            "wo": _w((lambda *s: torch.randn(*s, dtype=torch.bfloat16) * 0.8)(H * Dh, D) * ((H * Dh) ** -0.5)),
        }
    _A_in = _A_setup()

    def _B_setup():
        B, S, D, F = 1, 2048, 512, 1792
        return {
            "x":  _w((lambda *s: torch.randn(*s, dtype=torch.bfloat16) * 0.05)(B, S, D)),
            "w1": _w((lambda *s: torch.randn(*s, dtype=torch.bfloat16) * 3.2)(D, D) * (D ** -0.5)),
            "w2": _w((lambda *s: torch.randn(*s, dtype=torch.bfloat16) * 3.2)(D, D) * (D ** -0.5)),
            "w3": _w((lambda *s: torch.randn(*s, dtype=torch.bfloat16) * 3.2)(D, F) * (D ** -0.5)),
            "w4": _w((lambda *s: torch.randn(*s, dtype=torch.bfloat16) * 3.2)(F, D) * (F ** -0.5)),
        }
    _B_in = _B_setup()

    return {
        "A_x": _A_in["x"],
        "A_k_cache": _A_in["k_cache"],
        "A_v_cache": _A_in["v_cache"],
        "A_wq": _A_in["wq"],
        "A_wo": _A_in["wo"],
        "B_x": _B_in["x"],
        "B_w1": _B_in["w1"],
        "B_w2": _B_in["w2"],
        "B_w3": _B_in["w3"],
        "B_w4": _B_in["w4"],
    }

def reference(A_x, A_k_cache, A_v_cache, A_wq, A_wo, B_x, B_w1, B_w2, B_w3, B_w4):
    def _A_ref(x, k_cache, v_cache, wq, wo):
        B, Sq, D = x.shape
        H, Dh = 32, 128
        q = (lambda x, *d: x.permute(*d))((x @ wq).reshape(B, Sq, H, Dh), 0, 2, 1, 3)
        scores = torch.einsum("bhqd,bhkd->bhqk", q, k_cache) * (Dh ** -0.5)
        p = _softmax(scores, axis=-1)
        o = torch.einsum("bhqk,bhkd->bhqd", p, v_cache)
        return (lambda x, *d: x.permute(*d))(o, 0, 2, 1, 3).reshape(B, Sq, H * Dh) @ wo

    def _B_ref(x, w1, w2, w3, w4):
        B, S, D = x.shape
        h = _gelu(_layernorm(x, axis=-1) @ w1)
        c = D // 4
        g0 = _pad(h[:, :, 0*c:1*c], ((0, 0), (1, 0), (0, 0)))[:, :S, :]
        g1 = _pad(h[:, :, 1*c:2*c], ((0, 0), (0, 1), (0, 0)))[:, 1:, :]
        g2 = _pad(h[:, :, 2*c:3*c], ((0, 0), (2, 0), (0, 0)))[:, :S, :]
        g3 = _pad(h[:, :, 3*c:   ], ((0, 0), (0, 2), (0, 0)))[:, 2:, :]
        hs = torch.concatenate([g0, g1, g2, g3], axis=-1) @ w2
        x1 = x + hs
        h2 = _gelu(_layernorm(x1, axis=-1) @ w3) @ w4
        return x1 + h2

    x = A_x
    xn = _layernorm(x, axis=-1)
    s = _A_ref(xn, A_k_cache, A_v_cache, A_wq, A_wo)
    g = _silu(_B_ref(xn, B_w1, B_w2, B_w3, B_w4))
    return x + s * g
```

```asm
; @launch kernel=a_kernel grid=(256,1,1) block=(256,1,1) lds=163840
; @launch kernel=final_kernel grid=(256,1,1) block=(256,1,1) lds=131072
.amdgcn_target "amdgcn-amd-amdhsa--gfx950"
.text
.globl a_kernel
.p2align 8
.type a_kernel,@function
a_kernel:
    s_cmp_ge_u32 s2, 256
    s_cbranch_scc1 L_a_end
    s_load_dwordx2 s[16:17], s[0:1], 0
    s_load_dwordx2 s[44:45], s[0:1], 48
    s_load_dwordx2 s[12:13], s[0:1], 24
    s_load_dwordx2 s[4:5], s[0:1], 8
    s_load_dwordx2 s[8:9], s[0:1], 16
    s_load_dwordx2 s[48:49], s[0:1], 56
    s_load_dwordx2 s[20:21], s[0:1], 96
    s_load_dwordx2 s[56:57], s[0:1], 88
    s_load_dwordx2 s[92:93], s[0:1], 72
    s_load_dwordx2 s[94:95], s[0:1], 32
    v_lshrrev_b32 v1, 6, v0
    s_and_b32 s35, s2, 7
    v_readfirstlane_b32 s24, v1
    s_lshr_b32 s36, s2, 3
    s_and_b32 s25, s36, 3
    s_lshl_b32 s35, s35, 2
    s_add_u32 s25, s25, s35
    s_lshr_b32 s26, s2, 5
    s_bfe_u32 s41, s25, 0x10002
    s_lshr_b32 s42, s25, 3
    s_lshl_b32 s42, s42, 2
    s_and_b32 s35, s25, 3
    s_or_b32 s42, s42, s35
    s_lshl_b32 s35, s26, 4
    s_lshl_b32 s36, s24, 2
    s_add_u32 s35, s35, s36
    s_lshl_b32 s36, s41, 1
    s_add_u32 s43, s35, s36
    s_add_u32 s60, s35, 2
    s_sub_u32 s60, s60, s36
    s_lshl_b32 s61, s43, 14
    s_lshl_b32 s62, s60, 14
    v_and_b32 v1, 63, v0
    v_lshlrev_b32 v14, 4, v1
    v_and_b32 v2, 15, v1
    v_lshrrev_b32 v5, 4, v1
    v_lshrrev_b32 v8, 3, v1
    v_and_b32 v9, 7, v1
    v_xor_b32 v9, v9, v8
    v_lshlrev_b32 v9, 4, v9
    v_lshl_add_u32 v3, v8, 10, v9
    v_lshrrev_b32 v8, 2, v1
    v_lshlrev_b32 v8, 10, v8
    v_and_b32 v9, 3, v1
    v_lshrrev_b32 v4, 5, v1
    v_lshlrev_b32 v4, 1, v4
    v_xor_b32 v4, v4, v9
    v_lshl_add_u32 v6, v4, 4, v8
    v_bfe_u32 v4, v1, 4, 1
    v_lshlrev_b32 v4, 1, v4
    v_xor_b32 v4, v4, v9
    v_lshl_add_u32 v15, v4, 4, v8
    s_waitcnt lgkmcnt(0)
    s_mov_b32 s18, 0x200000
    s_mov_b32 s19, 0x20000
    s_lshl_b32 s35, s25, 8
    s_add_u32 s12, s12, s35
    s_addc_u32 s13, s13, 0
    s_sub_u32 s14, 0x400000, s35
    s_mov_b32 s15, 0x20000
    s_lshl_b32 s35, s42, 6
    s_add_u32 s44, s44, s35
    s_addc_u32 s45, s45, 0
    s_sub_u32 s46, 0x80000, s35
    s_mov_b32 s47, 0x20000
    s_add_u32 s48, s48, s35
    s_addc_u32 s49, s49, 0
    s_sub_u32 s50, 0x80000, s35
    s_mov_b32 s51, 0x20000
    s_lshl_b32 s65, s24, 13
    s_add_u32 s65, s65, 131072
    s_add_u32 m0, s65, 0
    s_lshl_b32 s35, s24, 17
    s_add_u32 s35, s35, 0
    buffer_load_dwordx4 v6, s[44:47], s35 offen offset:0 lds
    s_add_u32 m0, s65, 0
    s_lshl_b32 s35, s24, 17
    s_add_u32 s35, s35, 15360
    buffer_load_dwordx4 v6, s[44:47], s35 offen offset:1024 lds
    s_add_u32 m0, s65, 0
    s_lshl_b32 s35, s24, 17
    s_add_u32 s35, s35, 30720
    buffer_load_dwordx4 v6, s[44:47], s35 offen offset:2048 lds
    s_add_u32 m0, s65, 0
    s_lshl_b32 s35, s24, 17
    s_add_u32 s35, s35, 46080
    buffer_load_dwordx4 v6, s[44:47], s35 offen offset:3072 lds
    s_add_u32 m0, s65, 4096
    s_lshl_b32 s35, s24, 17
    s_add_u32 s35, s35, 65536
    buffer_load_dwordx4 v6, s[44:47], s35 offen offset:0 lds
    s_add_u32 m0, s65, 4096
    s_lshl_b32 s35, s24, 17
    s_add_u32 s35, s35, 80896
    buffer_load_dwordx4 v6, s[44:47], s35 offen offset:1024 lds
    s_add_u32 m0, s65, 4096
    s_lshl_b32 s35, s24, 17
    s_add_u32 s35, s35, 96256
    buffer_load_dwordx4 v6, s[44:47], s35 offen offset:2048 lds
    s_add_u32 m0, s65, 4096
    s_lshl_b32 s35, s24, 17
    s_add_u32 s35, s35, 111616
    buffer_load_dwordx4 v6, s[44:47], s35 offen offset:3072 lds
    s_lshl_b32 s35, s24, 12
    s_mov_b32 s33, s35
    s_add_u32 s34, s35, 65536
    s_add_u32 m0, s33, 0
    s_add_u32 s35, s61, 0
    buffer_load_dwordx4 v3, s[16:19], s35 offen offset:0 lds
    s_add_u32 m0, s33, 0
    s_add_u32 s35, s61, 7168
    buffer_load_dwordx4 v3, s[16:19], s35 offen offset:1024 lds
    s_add_u32 m0, s33, 0
    s_add_u32 s35, s61, 14336
    buffer_load_dwordx4 v3, s[16:19], s35 offen offset:2048 lds
    s_add_u32 m0, s33, 0
    s_add_u32 s35, s61, 21504
    buffer_load_dwordx4 v3, s[16:19], s35 offen offset:3072 lds
    s_add_u32 m0, s33, 16384
    s_add_u32 s35, s61, 128
    buffer_load_dwordx4 v3, s[16:19], s35 offen offset:0 lds
    s_add_u32 m0, s33, 16384
    s_add_u32 s35, s61, 7296
    buffer_load_dwordx4 v3, s[16:19], s35 offen offset:1024 lds
    s_add_u32 m0, s33, 16384
    s_add_u32 s35, s61, 14464
    buffer_load_dwordx4 v3, s[16:19], s35 offen offset:2048 lds
    s_add_u32 m0, s33, 16384
    s_add_u32 s35, s61, 21632
    buffer_load_dwordx4 v3, s[16:19], s35 offen offset:3072 lds
    s_add_u32 m0, s34, 0
    s_add_u32 s35, s61, 256
    buffer_load_dwordx4 v3, s[16:19], s35 offen offset:0 lds
    s_add_u32 m0, s34, 0
    s_add_u32 s35, s61, 7424
    buffer_load_dwordx4 v3, s[16:19], s35 offen offset:1024 lds
    s_add_u32 m0, s34, 0
    s_add_u32 s35, s61, 14592
    buffer_load_dwordx4 v3, s[16:19], s35 offen offset:2048 lds
    s_add_u32 m0, s34, 0
    s_add_u32 s35, s61, 21760
    buffer_load_dwordx4 v3, s[16:19], s35 offen offset:3072 lds
    s_add_u32 m0, s33, 32768
    s_add_u32 s35, s61, 384
    buffer_load_dwordx4 v3, s[16:19], s35 offen offset:0 lds
    s_add_u32 m0, s33, 32768
    s_add_u32 s35, s61, 7552
    buffer_load_dwordx4 v3, s[16:19], s35 offen offset:1024 lds
    s_add_u32 m0, s33, 32768
    s_add_u32 s35, s61, 14720
    buffer_load_dwordx4 v3, s[16:19], s35 offen offset:2048 lds
    s_add_u32 m0, s33, 32768
    s_add_u32 s35, s61, 21888
    buffer_load_dwordx4 v3, s[16:19], s35 offen offset:3072 lds
    v_bfe_u32 v4, v1, 1, 4
    v_lshlrev_b32 v4, 13, v4
    v_and_b32 v7, 1, v1
    v_lshl_add_u32 v4, v7, 7, v4
    s_lshl_b32 s35, s26, 2
    s_add_u32 s35, s35, s24
    s_lshl_b32 s35, s35, 17
    buffer_load_dword v226, v4, s[12:15], s35 offen
    s_getpc_b64 s[88:89]
L_pc1:
    s_sub_u32 s88, s88, L_pc1 - a_kernel
    s_subb_u32 s89, s89, 0
    s_lshr_b32 s35, s2, 3
    s_lshl_b32 s35, s35, 2
    s_add_u32 s35, s35, s24
    s_mul_i32 s35, s35, 6
    v_lshrrev_b32 v4, 4, v14
    v_min_u32 v4, 5, v4
    v_add_u32 v4, s35, v4
    v_min_u32 v4, ((L_final_kernel_end - a_kernel) >> 7) - 1, v4
    v_lshlrev_b32 v4, 7, v4
    global_load_dword v224, v4, s[88:89]
    v_and_b32 v1, 63, v0
    v_xor_b32 v4, v5, v2
    v_lshlrev_b32 v4, 4, v4
    v_lshl_add_u32 v4, v2, 8, v4
    s_lshl_b32 s63, s24, 6
    v_xor_b32 v4, s63, v4
    v_xor_b32 v238, 0, v4
    v_xor_b32 v239, 64, v4
    v_xor_b32 v240, 128, v4
    v_xor_b32 v241, 192, v4
    v_lshrrev_b32 v8, 2, v1
    v_and_b32 v8, 3, v8
    v_lshl_add_u32 v7, v5, 2, v8
    v_and_b32 v9, 3, v1
    v_and_b32 v4, 7, v7
    v_lshlrev_b32 v10, 8, v7
    v_lshl_add_u32 v11, v4, 5, v10
    v_lshl_add_u32 v11, v9, 3, v11
    v_add_u32 v11, 65536, v11
    v_xor_b32 v242, 0, v11
    v_xor_b32 v243, 32, v11
    v_xor_b32 v244, 64, v11
    v_xor_b32 v245, 96, v11
    v_xor_b32 v246, 128, v11
    v_xor_b32 v247, 160, v11
    v_xor_b32 v248, 192, v11
    v_xor_b32 v249, 224, v11
    v_lshl_add_u32 v10, v5, 3, v8
    v_lshlrev_b32 v12, 1, v4
    v_xor_b32 v12, v12, v9
    v_lshlrev_b32 v12, 4, v12
    v_lshl_add_u32 v12, v10, 8, v12
    v_xor_b32 v12, s63, v12
    v_xor_b32 v208, 0, v12
    v_add_u32 v212, 65536, v208
    v_xor_b32 v209, 64, v12
    v_add_u32 v213, 65536, v209
    v_xor_b32 v210, 128, v12
    v_add_u32 v214, 65536, v210
    v_xor_b32 v211, 192, v12
    v_add_u32 v215, 65536, v211
    v_and_b32 v12, 1, v5
    v_lshlrev_b32 v12, 5, v12
    v_lshl_add_u32 v12, v9, 3, v12
    v_add_u32 v12, 131072, v12
    v_lshl_add_u32 v222, v10, 6, v12
    v_xor_b32 v223, 32, v222
    v_lshl_add_u32 v228, v7, 6, v12
    v_add_u32 v8, 0, v5
    v_xor_b32 v8, v8, v2
    v_lshlrev_b32 v8, 4, v8
    v_lshl_add_u32 v250, v5, 8, v8
    v_add_u32 v8, 4, v5
    v_xor_b32 v8, v8, v2
    v_lshlrev_b32 v8, 4, v8
    v_lshl_add_u32 v251, v5, 8, v8
    v_add_u32 v8, 8, v5
    v_xor_b32 v8, v8, v2
    v_lshlrev_b32 v8, 4, v8
    v_lshl_add_u32 v252, v5, 8, v8
    v_add_u32 v8, 12, v5
    v_xor_b32 v8, v8, v2
    v_lshlrev_b32 v8, 4, v8
    v_lshl_add_u32 v253, v5, 8, v8
    v_add_u32 v8, 0, v5
    v_lshlrev_b32 v8, 1, v8
    v_xor_b32 v8, v8, v2
    v_lshlrev_b32 v8, 4, v8
    v_lshl_add_u32 v254, v5, 8, v8
    v_lshl_add_u32 v216, v5, 13, v8
    v_add_u32 v8, 4, v5
    v_lshlrev_b32 v8, 1, v8
    v_xor_b32 v8, v8, v2
    v_lshlrev_b32 v8, 4, v8
    v_lshl_add_u32 v255, v5, 8, v8
    v_lshl_add_u32 v217, v5, 13, v8
    s_lshl_b32 s35, s25, 19
    s_add_u32 s4, s4, s35
    s_addc_u32 s5, s5, 0
    s_mov_b32 s6, 0x80000
    s_mov_b32 s7, 0x20000
    s_add_u32 s8, s8, s35
    s_addc_u32 s9, s9, 0
    s_mov_b32 s10, 0x80000
    s_mov_b32 s11, 0x20000
    s_add_u32 s52, s20, 4194304
    s_addc_u32 s53, s21, 0
    s_mov_b32 s54, 0x200000
    s_mov_b32 s55, 0x20000
    s_mov_b32 s22, 0x2c00000
    s_mov_b32 s23, 0x20000
    s_mov_b32 s58, 0x100
    s_mov_b32 s59, 0x20000
    s_lshl_b32 s35, s24, 12
    s_mov_b32 s28, s35
    s_mov_b32 s29, s35
    s_lshl_b32 s38, s24, 17
    s_mov_b32 s32, 0x46000000
    v_mov_b32 v229, s32
    s_mov_b32 s40, 0x3e0293ee
    v_min_u32 v4, 2, v1
    v_add_u32 v4, s26, v4
    v_max_u32 v4, 1, v4
    v_min_u32 v4, 8, v4
    v_subrev_u32 v4, 1, v4
    v_and_b32 v8, 3, v4
    v_lshlrev_b32 v8, 6, v8
    v_lshrrev_b32 v4, 2, v4
    v_lshl_add_u32 v227, v4, 2, v8
    s_and_b32 s67, s26, 3
    s_lshl_b32 s67, s67, 6
    s_lshr_b32 s68, s26, 2
    s_lshl_b32 s68, s68, 2
    s_add_u32 s67, s67, s68
    v_mov_b32 v10, 0x3f803f80
    v_mov_b32 v11, 0x3f803f80
    v_mov_b32 v12, 0x3f803f80
    v_mov_b32 v13, 0x3f803f80
    v_and_b32 v8, 7, v2
    v_xor_b32 v8, v8, v5
    v_lshlrev_b32 v8, 4, v8
    v_lshl_add_u32 v8, v2, 7, v8
    v_add_u32 v4, s33, v8
    v_xor_b32 v5, 64, v4
    v_add_u32 v6, 65536, v4
    v_add_u32 v7, 65536, v5
    s_waitcnt vmcnt(14)
    ds_read_b128 a[0:3], v4 offset:0
    ds_read_b128 a[4:7], v4 offset:2048
    ds_read_b128 a[16:19], v5 offset:0
    ds_read_b128 a[20:23], v5 offset:2048
    s_barrier
    ds_read_b64_tr_b16 a[128:129], v222 offset:0
    ds_read_b64_tr_b16 a[130:131], v222 offset:256
    ds_read_b64_tr_b16 a[132:133], v223 offset:0
    ds_read_b64_tr_b16 a[134:135], v223 offset:256
    ds_read_b64_tr_b16 a[136:137], v222 offset:2048
    ds_read_b64_tr_b16 a[138:139], v222 offset:2304
    ds_read_b64_tr_b16 a[140:141], v223 offset:2048
    ds_read_b64_tr_b16 a[142:143], v223 offset:2304
    s_waitcnt vmcnt(10)
    ds_read_b128 a[32:35], v4 offset:16384
    ds_read_b128 a[36:39], v4 offset:18432
    ds_read_b128 a[48:51], v5 offset:16384
    ds_read_b128 a[52:55], v5 offset:18432
    s_waitcnt lgkmcnt(12)
    v_mfma_f32_16x16x32_bf16 v[40:43], v[10:13], a[0:3], 0
    v_mfma_f32_16x16x32_bf16 v[48:51], a[0:3], a[0:3], 0
    v_mfma_f32_16x16x32_bf16 v[44:47], v[10:13], a[4:7], 0
    v_mfma_f32_16x16x32_bf16 v[52:55], a[4:7], a[4:7], 0
    s_waitcnt lgkmcnt(10)
    v_mfma_f32_16x16x32_bf16 v[16:19], a[128:131], a[0:3], 0
    v_mfma_f32_16x16x32_bf16 v[24:27], a[128:131], a[4:7], 0
    s_add_u32 m0, s34, 16384
    s_add_u32 s35, s61, 512
    buffer_load_dwordx4 v3, s[16:19], s35 offen offset:0 lds
    v_mfma_f32_16x16x32_bf16 v[32:35], a[128:131], v[10:13], 0
    ds_read_b64_tr_b16 a[144:145], v222 offset:4096
    ds_read_b64_tr_b16 a[146:147], v222 offset:4352
    s_waitcnt lgkmcnt(10)
    v_mfma_f32_16x16x32_bf16 v[20:23], a[132:135], a[0:3], 0
    v_mfma_f32_16x16x32_bf16 v[28:31], a[132:135], a[4:7], 0
    s_add_u32 m0, s34, 16384
    s_add_u32 s35, s61, 7680
    buffer_load_dwordx4 v3, s[16:19], s35 offen offset:1024 lds
    v_mfma_f32_16x16x32_bf16 v[36:39], a[132:135], v[10:13], 0
    ds_read_b64_tr_b16 a[148:149], v223 offset:4096
    ds_read_b64_tr_b16 a[150:151], v223 offset:4352
    v_mfma_f32_16x16x32_bf16 v[40:43], v[10:13], a[16:19], v[40:43]
    v_mfma_f32_16x16x32_bf16 v[48:51], a[16:19], a[16:19], v[48:51]
    v_mfma_f32_16x16x32_bf16 v[44:47], v[10:13], a[20:23], v[44:47]
    v_mfma_f32_16x16x32_bf16 v[52:55], a[20:23], a[20:23], v[52:55]
    s_waitcnt lgkmcnt(10)
    v_mfma_f32_16x16x32_bf16 v[16:19], a[136:139], a[16:19], v[16:19]
    v_mfma_f32_16x16x32_bf16 v[24:27], a[136:139], a[20:23], v[24:27]
    s_add_u32 m0, s34, 16384
    s_add_u32 s35, s61, 14848
    buffer_load_dwordx4 v3, s[16:19], s35 offen offset:2048 lds
    v_mfma_f32_16x16x32_bf16 v[32:35], a[136:139], v[10:13], v[32:35]
    ds_read_b64_tr_b16 a[152:153], v222 offset:6144
    ds_read_b64_tr_b16 a[154:155], v222 offset:6400
    s_waitcnt lgkmcnt(10)
    v_mfma_f32_16x16x32_bf16 v[20:23], a[140:143], a[16:19], v[20:23]
    v_mfma_f32_16x16x32_bf16 v[28:31], a[140:143], a[20:23], v[28:31]
    s_add_u32 m0, s34, 16384
    s_add_u32 s35, s61, 22016
    buffer_load_dwordx4 v3, s[16:19], s35 offen offset:3072 lds
    v_mfma_f32_16x16x32_bf16 v[36:39], a[140:143], v[10:13], v[36:39]
    ds_read_b64_tr_b16 a[156:157], v223 offset:6144
    ds_read_b64_tr_b16 a[158:159], v223 offset:6400
    s_waitcnt vmcnt(10)
    ds_read_b128 a[64:67], v6 offset:0
    ds_read_b128 a[68:71], v6 offset:2048
    ds_read_b128 a[80:83], v7 offset:0
    ds_read_b128 a[84:87], v7 offset:2048
    s_waitcnt lgkmcnt(12)
    v_mfma_f32_16x16x32_bf16 v[40:43], v[10:13], a[32:35], v[40:43]
    v_mfma_f32_16x16x32_bf16 v[48:51], a[32:35], a[32:35], v[48:51]
    v_mfma_f32_16x16x32_bf16 v[44:47], v[10:13], a[36:39], v[44:47]
    v_mfma_f32_16x16x32_bf16 v[52:55], a[36:39], a[36:39], v[52:55]
    s_waitcnt lgkmcnt(10)
    v_mfma_f32_16x16x32_bf16 v[16:19], a[144:147], a[32:35], v[16:19]
    v_mfma_f32_16x16x32_bf16 v[24:27], a[144:147], a[36:39], v[24:27]
    s_add_u32 m0, s34, 32768
    s_add_u32 s35, s61, 640
    buffer_load_dwordx4 v3, s[16:19], s35 offen offset:0 lds
    v_mfma_f32_16x16x32_bf16 v[32:35], a[144:147], v[10:13], v[32:35]
    ds_read_b64_tr_b16 a[128:129], v222 offset:8192
    ds_read_b64_tr_b16 a[130:131], v222 offset:8448
    s_waitcnt lgkmcnt(10)
    v_mfma_f32_16x16x32_bf16 v[20:23], a[148:151], a[32:35], v[20:23]
    v_mfma_f32_16x16x32_bf16 v[28:31], a[148:151], a[36:39], v[28:31]
    s_add_u32 m0, s34, 32768
    s_add_u32 s35, s61, 7808
    buffer_load_dwordx4 v3, s[16:19], s35 offen offset:1024 lds
    v_mfma_f32_16x16x32_bf16 v[36:39], a[148:151], v[10:13], v[36:39]
    ds_read_b64_tr_b16 a[132:133], v223 offset:8192
    ds_read_b64_tr_b16 a[134:135], v223 offset:8448
    v_mfma_f32_16x16x32_bf16 v[40:43], v[10:13], a[48:51], v[40:43]
    v_mfma_f32_16x16x32_bf16 v[48:51], a[48:51], a[48:51], v[48:51]
    v_mfma_f32_16x16x32_bf16 v[44:47], v[10:13], a[52:55], v[44:47]
    v_mfma_f32_16x16x32_bf16 v[52:55], a[52:55], a[52:55], v[52:55]
    s_waitcnt lgkmcnt(10)
    v_mfma_f32_16x16x32_bf16 v[16:19], a[152:155], a[48:51], v[16:19]
    v_mfma_f32_16x16x32_bf16 v[24:27], a[152:155], a[52:55], v[24:27]
    s_add_u32 m0, s34, 32768
    s_add_u32 s35, s61, 14976
    buffer_load_dwordx4 v3, s[16:19], s35 offen offset:2048 lds
    v_mfma_f32_16x16x32_bf16 v[32:35], a[152:155], v[10:13], v[32:35]
    ds_read_b64_tr_b16 a[136:137], v222 offset:10240
    ds_read_b64_tr_b16 a[138:139], v222 offset:10496
    s_waitcnt lgkmcnt(10)
    v_mfma_f32_16x16x32_bf16 v[20:23], a[156:159], a[48:51], v[20:23]
    v_mfma_f32_16x16x32_bf16 v[28:31], a[156:159], a[52:55], v[28:31]
    s_add_u32 m0, s34, 32768
    s_add_u32 s35, s61, 22144
    buffer_load_dwordx4 v3, s[16:19], s35 offen offset:3072 lds
    v_mfma_f32_16x16x32_bf16 v[36:39], a[156:159], v[10:13], v[36:39]
    ds_read_b64_tr_b16 a[140:141], v223 offset:10240
    ds_read_b64_tr_b16 a[142:143], v223 offset:10496
    s_waitcnt vmcnt(10)
    ds_read_b128 a[96:99], v4 offset:32768
    ds_read_b128 a[100:103], v4 offset:34816
    ds_read_b128 a[112:115], v5 offset:32768
    ds_read_b128 a[116:119], v5 offset:34816
    s_waitcnt lgkmcnt(12)
    v_mfma_f32_16x16x32_bf16 v[40:43], v[10:13], a[64:67], v[40:43]
    v_mfma_f32_16x16x32_bf16 v[48:51], a[64:67], a[64:67], v[48:51]
    v_mfma_f32_16x16x32_bf16 v[44:47], v[10:13], a[68:71], v[44:47]
    v_mfma_f32_16x16x32_bf16 v[52:55], a[68:71], a[68:71], v[52:55]
    s_waitcnt lgkmcnt(10)
    v_mfma_f32_16x16x32_bf16 v[16:19], a[128:131], a[64:67], v[16:19]
    v_mfma_f32_16x16x32_bf16 v[24:27], a[128:131], a[68:71], v[24:27]
    s_add_u32 m0, s33, 49152
    s_add_u32 s35, s61, 768
    buffer_load_dwordx4 v3, s[16:19], s35 offen offset:0 lds
    v_mfma_f32_16x16x32_bf16 v[32:35], a[128:131], v[10:13], v[32:35]
    ds_read_b64_tr_b16 a[144:145], v222 offset:12288
    ds_read_b64_tr_b16 a[146:147], v222 offset:12544
    s_waitcnt lgkmcnt(10)
    v_mfma_f32_16x16x32_bf16 v[20:23], a[132:135], a[64:67], v[20:23]
    v_mfma_f32_16x16x32_bf16 v[28:31], a[132:135], a[68:71], v[28:31]
    s_add_u32 m0, s33, 49152
    s_add_u32 s35, s61, 7936
    buffer_load_dwordx4 v3, s[16:19], s35 offen offset:1024 lds
    v_mfma_f32_16x16x32_bf16 v[36:39], a[132:135], v[10:13], v[36:39]
    ds_read_b64_tr_b16 a[148:149], v223 offset:12288
    ds_read_b64_tr_b16 a[150:151], v223 offset:12544
    v_mfma_f32_16x16x32_bf16 v[40:43], v[10:13], a[80:83], v[40:43]
    v_mfma_f32_16x16x32_bf16 v[48:51], a[80:83], a[80:83], v[48:51]
    v_mfma_f32_16x16x32_bf16 v[44:47], v[10:13], a[84:87], v[44:47]
    v_mfma_f32_16x16x32_bf16 v[52:55], a[84:87], a[84:87], v[52:55]
    s_waitcnt lgkmcnt(10)
    v_mfma_f32_16x16x32_bf16 v[16:19], a[136:139], a[80:83], v[16:19]
    v_mfma_f32_16x16x32_bf16 v[24:27], a[136:139], a[84:87], v[24:27]
    s_add_u32 m0, s33, 49152
    s_add_u32 s35, s61, 15104
    buffer_load_dwordx4 v3, s[16:19], s35 offen offset:2048 lds
    v_mfma_f32_16x16x32_bf16 v[32:35], a[136:139], v[10:13], v[32:35]
    ds_read_b64_tr_b16 a[152:153], v222 offset:14336
    ds_read_b64_tr_b16 a[154:155], v222 offset:14592
    s_waitcnt lgkmcnt(10)
    v_mfma_f32_16x16x32_bf16 v[20:23], a[140:143], a[80:83], v[20:23]
    v_mfma_f32_16x16x32_bf16 v[28:31], a[140:143], a[84:87], v[28:31]
    s_add_u32 m0, s33, 49152
    s_add_u32 s35, s61, 22272
    buffer_load_dwordx4 v3, s[16:19], s35 offen offset:3072 lds
    v_mfma_f32_16x16x32_bf16 v[36:39], a[140:143], v[10:13], v[36:39]
    ds_read_b64_tr_b16 a[156:157], v223 offset:14336
    ds_read_b64_tr_b16 a[158:159], v223 offset:14592
    s_waitcnt vmcnt(8)
    ds_read_b128 a[192:195], v6 offset:16384
    ds_read_b128 a[196:199], v6 offset:18432
    ds_read_b128 a[208:211], v7 offset:16384
    ds_read_b128 a[212:215], v7 offset:18432
    s_waitcnt lgkmcnt(12)
    v_mfma_f32_16x16x32_bf16 v[40:43], v[10:13], a[96:99], v[40:43]
    v_mfma_f32_16x16x32_bf16 v[48:51], a[96:99], a[96:99], v[48:51]
    v_mfma_f32_16x16x32_bf16 v[44:47], v[10:13], a[100:103], v[44:47]
    v_mfma_f32_16x16x32_bf16 v[52:55], a[100:103], a[100:103], v[52:55]
    s_waitcnt lgkmcnt(10)
    v_mfma_f32_16x16x32_bf16 v[16:19], a[144:147], a[96:99], v[16:19]
    v_mfma_f32_16x16x32_bf16 v[24:27], a[144:147], a[100:103], v[24:27]
    s_add_u32 m0, s34, 49152
    s_add_u32 s35, s61, 896
    buffer_load_dwordx4 v3, s[16:19], s35 offen offset:0 lds
    v_mfma_f32_16x16x32_bf16 v[32:35], a[144:147], v[10:13], v[32:35]
    ds_read_b64_tr_b16 a[128:129], v222 offset:16384
    ds_read_b64_tr_b16 a[130:131], v222 offset:16640
    s_waitcnt lgkmcnt(10)
    v_mfma_f32_16x16x32_bf16 v[20:23], a[148:151], a[96:99], v[20:23]
    v_mfma_f32_16x16x32_bf16 v[28:31], a[148:151], a[100:103], v[28:31]
    s_add_u32 m0, s34, 49152
    s_add_u32 s35, s61, 8064
    buffer_load_dwordx4 v3, s[16:19], s35 offen offset:1024 lds
    v_mfma_f32_16x16x32_bf16 v[36:39], a[148:151], v[10:13], v[36:39]
    ds_read_b64_tr_b16 a[132:133], v223 offset:16384
    ds_read_b64_tr_b16 a[134:135], v223 offset:16640
    v_mfma_f32_16x16x32_bf16 v[40:43], v[10:13], a[112:115], v[40:43]
    v_mfma_f32_16x16x32_bf16 v[48:51], a[112:115], a[112:115], v[48:51]
    v_mfma_f32_16x16x32_bf16 v[44:47], v[10:13], a[116:119], v[44:47]
    v_mfma_f32_16x16x32_bf16 v[52:55], a[116:119], a[116:119], v[52:55]
    s_waitcnt lgkmcnt(10)
    v_mfma_f32_16x16x32_bf16 v[16:19], a[152:155], a[112:115], v[16:19]
    v_mfma_f32_16x16x32_bf16 v[24:27], a[152:155], a[116:119], v[24:27]
    s_add_u32 m0, s34, 49152
    s_add_u32 s35, s61, 15232
    buffer_load_dwordx4 v3, s[16:19], s35 offen offset:2048 lds
    v_mfma_f32_16x16x32_bf16 v[32:35], a[152:155], v[10:13], v[32:35]
    ds_read_b64_tr_b16 a[136:137], v222 offset:18432
    ds_read_b64_tr_b16 a[138:139], v222 offset:18688
    s_waitcnt lgkmcnt(10)
    v_mfma_f32_16x16x32_bf16 v[20:23], a[156:159], a[112:115], v[20:23]
    v_mfma_f32_16x16x32_bf16 v[28:31], a[156:159], a[116:119], v[28:31]
    s_add_u32 m0, s34, 49152
    s_add_u32 s35, s61, 22400
    buffer_load_dwordx4 v3, s[16:19], s35 offen offset:3072 lds
    v_mfma_f32_16x16x32_bf16 v[36:39], a[156:159], v[10:13], v[36:39]
    ds_read_b64_tr_b16 a[140:141], v223 offset:18432
    ds_read_b64_tr_b16 a[142:143], v223 offset:18688
    s_waitcnt vmcnt(8)
    ds_read_b128 a[224:227], v6 offset:32768
    ds_read_b128 a[228:231], v6 offset:34816
    ds_read_b128 a[240:243], v7 offset:32768
    ds_read_b128 a[244:247], v7 offset:34816
    s_waitcnt lgkmcnt(12)
    v_mfma_f32_16x16x32_bf16 v[40:43], v[10:13], a[192:195], v[40:43]
    v_mfma_f32_16x16x32_bf16 v[48:51], a[192:195], a[192:195], v[48:51]
    v_mfma_f32_16x16x32_bf16 v[44:47], v[10:13], a[196:199], v[44:47]
    v_mfma_f32_16x16x32_bf16 v[52:55], a[196:199], a[196:199], v[52:55]
    s_waitcnt lgkmcnt(10)
    v_mfma_f32_16x16x32_bf16 v[16:19], a[128:131], a[192:195], v[16:19]
    v_mfma_f32_16x16x32_bf16 v[24:27], a[128:131], a[196:199], v[24:27]
    s_add_u32 m0, s33, 0
    s_add_u32 s35, s62, 0
    buffer_load_dwordx4 v3, s[16:19], s35 offen offset:0 lds
    s_add_u32 m0, s33, 0
    s_add_u32 s35, s62, 7168
    buffer_load_dwordx4 v3, s[16:19], s35 offen offset:1024 lds
    v_mfma_f32_16x16x32_bf16 v[32:35], a[128:131], v[10:13], v[32:35]
    ds_read_b64_tr_b16 a[144:145], v222 offset:20480
    ds_read_b64_tr_b16 a[146:147], v222 offset:20736
    s_waitcnt lgkmcnt(10)
    v_mfma_f32_16x16x32_bf16 v[20:23], a[132:135], a[192:195], v[20:23]
    v_mfma_f32_16x16x32_bf16 v[28:31], a[132:135], a[196:199], v[28:31]
    s_add_u32 m0, s33, 0
    s_add_u32 s35, s62, 14336
    buffer_load_dwordx4 v3, s[16:19], s35 offen offset:2048 lds
    s_add_u32 m0, s33, 0
    s_add_u32 s35, s62, 21504
    buffer_load_dwordx4 v3, s[16:19], s35 offen offset:3072 lds
    v_mfma_f32_16x16x32_bf16 v[36:39], a[132:135], v[10:13], v[36:39]
    ds_read_b64_tr_b16 a[148:149], v223 offset:20480
    ds_read_b64_tr_b16 a[150:151], v223 offset:20736
    v_mfma_f32_16x16x32_bf16 v[40:43], v[10:13], a[208:211], v[40:43]
    v_mfma_f32_16x16x32_bf16 v[48:51], a[208:211], a[208:211], v[48:51]
    v_mfma_f32_16x16x32_bf16 v[44:47], v[10:13], a[212:215], v[44:47]
    v_mfma_f32_16x16x32_bf16 v[52:55], a[212:215], a[212:215], v[52:55]
    s_waitcnt lgkmcnt(10)
    v_mfma_f32_16x16x32_bf16 v[16:19], a[136:139], a[208:211], v[16:19]
    v_mfma_f32_16x16x32_bf16 v[24:27], a[136:139], a[212:215], v[24:27]
    s_add_u32 m0, s33, 16384
    s_add_u32 s35, s62, 128
    buffer_load_dwordx4 v3, s[16:19], s35 offen offset:0 lds
    s_add_u32 m0, s33, 16384
    s_add_u32 s35, s62, 7296
    buffer_load_dwordx4 v3, s[16:19], s35 offen offset:1024 lds
    v_mfma_f32_16x16x32_bf16 v[32:35], a[136:139], v[10:13], v[32:35]
    ds_read_b64_tr_b16 a[152:153], v222 offset:22528
    ds_read_b64_tr_b16 a[154:155], v222 offset:22784
    s_waitcnt lgkmcnt(10)
    v_mfma_f32_16x16x32_bf16 v[20:23], a[140:143], a[208:211], v[20:23]
    v_mfma_f32_16x16x32_bf16 v[28:31], a[140:143], a[212:215], v[28:31]
    s_add_u32 m0, s33, 16384
    s_add_u32 s35, s62, 14464
    buffer_load_dwordx4 v3, s[16:19], s35 offen offset:2048 lds
    s_add_u32 m0, s33, 16384
    s_add_u32 s35, s62, 21632
    buffer_load_dwordx4 v3, s[16:19], s35 offen offset:3072 lds
    v_mfma_f32_16x16x32_bf16 v[36:39], a[140:143], v[10:13], v[36:39]
    ds_read_b64_tr_b16 a[156:157], v223 offset:22528
    ds_read_b64_tr_b16 a[158:159], v223 offset:22784
    s_waitcnt vmcnt(12)
    ds_read_b128 v[144:147], v4 offset:49152
    ds_read_b128 v[148:151], v4 offset:51200
    ds_read_b128 v[160:163], v5 offset:49152
    ds_read_b128 v[164:167], v5 offset:51200
    s_waitcnt lgkmcnt(12)
    v_mfma_f32_16x16x32_bf16 v[40:43], v[10:13], a[224:227], v[40:43]
    v_mfma_f32_16x16x32_bf16 v[48:51], a[224:227], a[224:227], v[48:51]
    v_mfma_f32_16x16x32_bf16 v[44:47], v[10:13], a[228:231], v[44:47]
    v_mfma_f32_16x16x32_bf16 v[52:55], a[228:231], a[228:231], v[52:55]
    s_waitcnt lgkmcnt(10)
    v_mfma_f32_16x16x32_bf16 v[16:19], a[144:147], a[224:227], v[16:19]
    v_mfma_f32_16x16x32_bf16 v[24:27], a[144:147], a[228:231], v[24:27]
    s_add_u32 m0, s34, 0
    s_add_u32 s35, s62, 256
    buffer_load_dwordx4 v3, s[16:19], s35 offen offset:0 lds
    s_add_u32 m0, s34, 0
    s_add_u32 s35, s62, 7424
    buffer_load_dwordx4 v3, s[16:19], s35 offen offset:1024 lds
    v_mfma_f32_16x16x32_bf16 v[32:35], a[144:147], v[10:13], v[32:35]
    ds_read_b64_tr_b16 a[128:129], v222 offset:24576
    ds_read_b64_tr_b16 a[130:131], v222 offset:24832
    s_waitcnt lgkmcnt(10)
    v_mfma_f32_16x16x32_bf16 v[20:23], a[148:151], a[224:227], v[20:23]
    v_mfma_f32_16x16x32_bf16 v[28:31], a[148:151], a[228:231], v[28:31]
    s_add_u32 m0, s34, 0
    s_add_u32 s35, s62, 14592
    buffer_load_dwordx4 v3, s[16:19], s35 offen offset:2048 lds
    s_add_u32 m0, s34, 0
    s_add_u32 s35, s62, 21760
    buffer_load_dwordx4 v3, s[16:19], s35 offen offset:3072 lds
    v_mfma_f32_16x16x32_bf16 v[36:39], a[148:151], v[10:13], v[36:39]
    ds_read_b64_tr_b16 a[132:133], v223 offset:24576
    ds_read_b64_tr_b16 a[134:135], v223 offset:24832
    v_mfma_f32_16x16x32_bf16 v[40:43], v[10:13], a[240:243], v[40:43]
    v_mfma_f32_16x16x32_bf16 v[48:51], a[240:243], a[240:243], v[48:51]
    v_mfma_f32_16x16x32_bf16 v[44:47], v[10:13], a[244:247], v[44:47]
    v_mfma_f32_16x16x32_bf16 v[52:55], a[244:247], a[244:247], v[52:55]
    s_waitcnt lgkmcnt(10)
    v_mfma_f32_16x16x32_bf16 v[16:19], a[152:155], a[240:243], v[16:19]
    v_mfma_f32_16x16x32_bf16 v[24:27], a[152:155], a[244:247], v[24:27]
    s_add_u32 m0, s33, 32768
    s_add_u32 s35, s62, 384
    buffer_load_dwordx4 v3, s[16:19], s35 offen offset:0 lds
    s_add_u32 m0, s33, 32768
    s_add_u32 s35, s62, 7552
    buffer_load_dwordx4 v3, s[16:19], s35 offen offset:1024 lds
    v_mfma_f32_16x16x32_bf16 v[32:35], a[152:155], v[10:13], v[32:35]
    ds_read_b64_tr_b16 a[136:137], v222 offset:26624
    ds_read_b64_tr_b16 a[138:139], v222 offset:26880
    s_waitcnt lgkmcnt(10)
    v_mfma_f32_16x16x32_bf16 v[20:23], a[156:159], a[240:243], v[20:23]
    v_mfma_f32_16x16x32_bf16 v[28:31], a[156:159], a[244:247], v[28:31]
    s_add_u32 m0, s33, 32768
    s_add_u32 s35, s62, 14720
    buffer_load_dwordx4 v3, s[16:19], s35 offen offset:2048 lds
    s_add_u32 m0, s33, 32768
    s_add_u32 s35, s62, 21888
    buffer_load_dwordx4 v3, s[16:19], s35 offen offset:3072 lds
    v_mfma_f32_16x16x32_bf16 v[36:39], a[156:159], v[10:13], v[36:39]
    ds_read_b64_tr_b16 a[140:141], v223 offset:26624
    ds_read_b64_tr_b16 a[142:143], v223 offset:26880
    s_waitcnt vmcnt(16)
    ds_read_b128 v[176:179], v6 offset:49152
    ds_read_b128 v[180:183], v6 offset:51200
    ds_read_b128 v[192:195], v7 offset:49152
    ds_read_b128 v[196:199], v7 offset:51200
    s_waitcnt lgkmcnt(12)
    v_mfma_f32_16x16x32_bf16 v[40:43], v[10:13], v[144:147], v[40:43]
    v_mfma_f32_16x16x32_bf16 v[48:51], v[144:147], v[144:147], v[48:51]
    v_mfma_f32_16x16x32_bf16 v[44:47], v[10:13], v[148:151], v[44:47]
    v_mfma_f32_16x16x32_bf16 v[52:55], v[148:151], v[148:151], v[52:55]
    s_waitcnt lgkmcnt(10)
    v_mfma_f32_16x16x32_bf16 v[16:19], a[128:131], v[144:147], v[16:19]
    v_mfma_f32_16x16x32_bf16 v[24:27], a[128:131], v[148:151], v[24:27]
    s_add_u32 m0, s34, 16384
    s_add_u32 s35, s62, 512
    buffer_load_dwordx4 v3, s[16:19], s35 offen offset:0 lds
    s_add_u32 m0, s34, 16384
    s_add_u32 s35, s62, 7680
    buffer_load_dwordx4 v3, s[16:19], s35 offen offset:1024 lds
    v_mfma_f32_16x16x32_bf16 v[32:35], a[128:131], v[10:13], v[32:35]
    ds_read_b64_tr_b16 a[144:145], v222 offset:28672
    ds_read_b64_tr_b16 a[146:147], v222 offset:28928
    s_waitcnt lgkmcnt(10)
    v_mfma_f32_16x16x32_bf16 v[20:23], a[132:135], v[144:147], v[20:23]
    v_mfma_f32_16x16x32_bf16 v[28:31], a[132:135], v[148:151], v[28:31]
    s_add_u32 m0, s34, 16384
    s_add_u32 s35, s62, 14848
    buffer_load_dwordx4 v3, s[16:19], s35 offen offset:2048 lds
    s_add_u32 m0, s34, 16384
    s_add_u32 s35, s62, 22016
    buffer_load_dwordx4 v3, s[16:19], s35 offen offset:3072 lds
    v_mfma_f32_16x16x32_bf16 v[36:39], a[132:135], v[10:13], v[36:39]
    ds_read_b64_tr_b16 a[148:149], v223 offset:28672
    ds_read_b64_tr_b16 a[150:151], v223 offset:28928
    v_mfma_f32_16x16x32_bf16 v[40:43], v[10:13], v[160:163], v[40:43]
    v_mfma_f32_16x16x32_bf16 v[48:51], v[160:163], v[160:163], v[48:51]
    v_mfma_f32_16x16x32_bf16 v[44:47], v[10:13], v[164:167], v[44:47]
    v_mfma_f32_16x16x32_bf16 v[52:55], v[164:167], v[164:167], v[52:55]
    s_waitcnt lgkmcnt(10)
    v_mfma_f32_16x16x32_bf16 v[16:19], a[136:139], v[160:163], v[16:19]
    v_mfma_f32_16x16x32_bf16 v[24:27], a[136:139], v[164:167], v[24:27]
    s_add_u32 m0, s34, 32768
    s_add_u32 s35, s62, 640
    buffer_load_dwordx4 v3, s[16:19], s35 offen offset:0 lds
    s_add_u32 m0, s34, 32768
    s_add_u32 s35, s62, 7808
    buffer_load_dwordx4 v3, s[16:19], s35 offen offset:1024 lds
    v_mfma_f32_16x16x32_bf16 v[32:35], a[136:139], v[10:13], v[32:35]
    ds_read_b64_tr_b16 a[152:153], v222 offset:30720
    ds_read_b64_tr_b16 a[154:155], v222 offset:30976
    s_waitcnt lgkmcnt(10)
    v_mfma_f32_16x16x32_bf16 v[20:23], a[140:143], v[160:163], v[20:23]
    v_mfma_f32_16x16x32_bf16 v[28:31], a[140:143], v[164:167], v[28:31]
    s_add_u32 m0, s34, 32768
    s_add_u32 s35, s62, 14976
    buffer_load_dwordx4 v3, s[16:19], s35 offen offset:2048 lds
    s_add_u32 m0, s34, 32768
    s_add_u32 s35, s62, 22144
    buffer_load_dwordx4 v3, s[16:19], s35 offen offset:3072 lds
    v_mfma_f32_16x16x32_bf16 v[36:39], a[140:143], v[10:13], v[36:39]
    ds_read_b64_tr_b16 a[156:157], v223 offset:30720
    ds_read_b64_tr_b16 a[158:159], v223 offset:30976
    s_waitcnt lgkmcnt(8)
    v_mfma_f32_16x16x32_bf16 v[40:43], v[10:13], v[176:179], v[40:43]
    v_mfma_f32_16x16x32_bf16 v[48:51], v[176:179], v[176:179], v[48:51]
    v_mfma_f32_16x16x32_bf16 v[44:47], v[10:13], v[180:183], v[44:47]
    v_mfma_f32_16x16x32_bf16 v[52:55], v[180:183], v[180:183], v[52:55]
    s_waitcnt lgkmcnt(6)
    v_mfma_f32_16x16x32_bf16 v[16:19], a[144:147], v[176:179], v[16:19]
    v_mfma_f32_16x16x32_bf16 v[24:27], a[144:147], v[180:183], v[24:27]
    s_add_u32 m0, s33, 49152
    s_add_u32 s35, s62, 768
    buffer_load_dwordx4 v3, s[16:19], s35 offen offset:0 lds
    s_add_u32 m0, s33, 49152
    s_add_u32 s35, s62, 7936
    buffer_load_dwordx4 v3, s[16:19], s35 offen offset:1024 lds
    v_mfma_f32_16x16x32_bf16 v[32:35], a[144:147], v[10:13], v[32:35]
    s_waitcnt lgkmcnt(4)
    v_mfma_f32_16x16x32_bf16 v[20:23], a[148:151], v[176:179], v[20:23]
    v_mfma_f32_16x16x32_bf16 v[28:31], a[148:151], v[180:183], v[28:31]
    s_add_u32 m0, s33, 49152
    s_add_u32 s35, s62, 15104
    buffer_load_dwordx4 v3, s[16:19], s35 offen offset:2048 lds
    s_add_u32 m0, s33, 49152
    s_add_u32 s35, s62, 22272
    buffer_load_dwordx4 v3, s[16:19], s35 offen offset:3072 lds
    v_mfma_f32_16x16x32_bf16 v[36:39], a[148:151], v[10:13], v[36:39]
    v_mfma_f32_16x16x32_bf16 v[40:43], v[10:13], v[192:195], v[40:43]
    v_mfma_f32_16x16x32_bf16 v[48:51], v[192:195], v[192:195], v[48:51]
    v_mfma_f32_16x16x32_bf16 v[44:47], v[10:13], v[196:199], v[44:47]
    v_mfma_f32_16x16x32_bf16 v[52:55], v[196:199], v[196:199], v[52:55]
    s_waitcnt lgkmcnt(2)
    v_mfma_f32_16x16x32_bf16 v[16:19], a[152:155], v[192:195], v[16:19]
    v_mfma_f32_16x16x32_bf16 v[24:27], a[152:155], v[196:199], v[24:27]
    s_add_u32 m0, s34, 49152
    s_add_u32 s35, s62, 896
    buffer_load_dwordx4 v3, s[16:19], s35 offen offset:0 lds
    s_add_u32 m0, s34, 49152
    s_add_u32 s35, s62, 8064
    buffer_load_dwordx4 v3, s[16:19], s35 offen offset:1024 lds
    v_mfma_f32_16x16x32_bf16 v[32:35], a[152:155], v[10:13], v[32:35]
    s_waitcnt lgkmcnt(0)
    v_mfma_f32_16x16x32_bf16 v[20:23], a[156:159], v[192:195], v[20:23]
    v_mfma_f32_16x16x32_bf16 v[28:31], a[156:159], v[196:199], v[28:31]
    s_add_u32 m0, s34, 49152
    s_add_u32 s35, s62, 15232
    buffer_load_dwordx4 v3, s[16:19], s35 offen offset:2048 lds
    s_add_u32 m0, s34, 49152
    s_add_u32 s35, s62, 22400
    buffer_load_dwordx4 v3, s[16:19], s35 offen offset:3072 lds
    v_mfma_f32_16x16x32_bf16 v[36:39], a[156:159], v[10:13], v[36:39]
    s_waitcnt vmcnt(28)
    ds_read_b128 a[8:11], v4 offset:0
    ds_read_b128 a[12:15], v4 offset:2048
    ds_read_b128 a[24:27], v5 offset:0
    ds_read_b128 a[28:31], v5 offset:2048
    s_waitcnt vmcnt(24)
    ds_read_b128 a[40:43], v4 offset:16384
    ds_read_b128 a[44:47], v4 offset:18432
    ds_read_b128 a[56:59], v5 offset:16384
    ds_read_b128 a[60:63], v5 offset:18432
    s_waitcnt lgkmcnt(4)
    s_add_u32 m0, s33, 0
    s_add_u32 s35, s38, 0
    buffer_load_dwordx4 v216, s[12:15], s35 offen offset:0 lds
    s_add_u32 m0, s33, 0
    s_add_u32 s35, s38, 31744
    buffer_load_dwordx4 v216, s[12:15], s35 offen offset:1024 lds
    s_add_u32 m0, s33, 0
    s_add_u32 s35, s38, 63488
    buffer_load_dwordx4 v217, s[12:15], s35 offen offset:2048 lds
    s_add_u32 m0, s33, 0
    s_add_u32 s35, s38, 95232
    buffer_load_dwordx4 v217, s[12:15], s35 offen offset:3072 lds
    s_waitcnt lgkmcnt(0)
    s_add_u32 m0, s33, 16384
    s_add_u32 s35, s38, 524288
    buffer_load_dwordx4 v216, s[12:15], s35 offen offset:0 lds
    s_add_u32 m0, s33, 16384
    s_add_u32 s35, s38, 556032
    buffer_load_dwordx4 v216, s[12:15], s35 offen offset:1024 lds
    s_add_u32 m0, s33, 16384
    s_add_u32 s35, s38, 587776
    buffer_load_dwordx4 v217, s[12:15], s35 offen offset:2048 lds
    s_add_u32 m0, s33, 16384
    s_add_u32 s35, s38, 619520
    buffer_load_dwordx4 v217, s[12:15], s35 offen offset:3072 lds
    s_nop 7
    v_mov_b32 v8, 0
    s_mov_b32 vcc_lo, 0x100001
    s_mov_b32 vcc_hi, 0x10000100
    v_cndmask_b32 v8, v8, v48, vcc
    s_mov_b32 vcc_lo, 0x200002
    s_mov_b32 vcc_hi, 0x20000200
    v_cndmask_b32 v8, v8, v49, vcc
    s_mov_b32 vcc_lo, 0x400004
    s_mov_b32 vcc_hi, 0x40000400
    v_cndmask_b32 v8, v8, v50, vcc
    s_mov_b32 vcc_lo, 0x800008
    s_mov_b32 vcc_hi, 0x80000800
    v_cndmask_b32 v8, v8, v51, vcc
    v_mov_b32 v9, v8
    s_nop 1
    v_permlane16_swap_b32 v8, v9
    s_nop 0
    v_add_f32 v8, v8, v9
    v_mov_b32 v9, v8
    s_nop 1
    v_permlane32_swap_b32 v8, v9
    s_nop 0
    v_add_f32 v8, v8, v9
    v_mul_f32 v230, 0xbb000000, v40
    v_mul_f32 v8, 0x3b000000, v8
    v_fma_f32 v8, -v230, v230, v8
    v_max_f32 v8, 0, v8
    v_add_f32 v9, 0x3727c5ac, v8
    v_rsq_f32 v234, v9
    s_nop 0
    v_mul_f32 v8, v8, v234
    v_mul_f32 v8, v8, v234
    v_add_f32 v8, 0x3727c5ac, v8
    v_rsq_f32 v8, v8
    s_nop 0
    v_mul_f32 v60, v8, v234
    v_mul_f32 v90, v60, v60
    v_rcp_f32 v92, v60
    v_mul_f32 v90, v90, v60
    v_mul_f32 v88, 0xc0135761, v60
    v_mul_f32 v90, 0xbdd2d3e8, v90
    v_mov_b32 v8, 0
    s_mov_b32 vcc_lo, 0x100001
    s_mov_b32 vcc_hi, 0x10000100
    v_cndmask_b32 v8, v8, v52, vcc
    s_mov_b32 vcc_lo, 0x200002
    s_mov_b32 vcc_hi, 0x20000200
    v_cndmask_b32 v8, v8, v53, vcc
    s_mov_b32 vcc_lo, 0x400004
    s_mov_b32 vcc_hi, 0x40000400
    v_cndmask_b32 v8, v8, v54, vcc
    s_mov_b32 vcc_lo, 0x800008
    s_mov_b32 vcc_hi, 0x80000800
    v_cndmask_b32 v8, v8, v55, vcc
    v_mov_b32 v9, v8
    s_nop 1
    v_permlane16_swap_b32 v8, v9
    s_nop 0
    v_add_f32 v8, v8, v9
    v_mov_b32 v9, v8
    s_nop 1
    v_permlane32_swap_b32 v8, v9
    s_nop 0
    v_add_f32 v8, v8, v9
    v_mul_f32 v231, 0xbb000000, v44
    v_mul_f32 v8, 0x3b000000, v8
    v_fma_f32 v8, -v231, v231, v8
    v_max_f32 v8, 0, v8
    v_add_f32 v9, 0x3727c5ac, v8
    v_rsq_f32 v235, v9
    s_nop 0
    v_mul_f32 v8, v8, v235
    v_mul_f32 v8, v8, v235
    v_add_f32 v8, 0x3727c5ac, v8
    v_rsq_f32 v8, v8
    s_nop 0
    v_mul_f32 v61, v8, v235
    v_mul_f32 v58, v61, v61
    v_rcp_f32 v62, v61
    v_mul_f32 v58, v58, v61
    v_mul_f32 v56, 0xc0135761, v61
    v_mul_f32 v58, 0xbdd2d3e8, v58
    v_lshrrev_b32 v8, 1, v14
    s_lshl_b32 s35, s43, 7
    s_add_u32 s35, s35, 37224448
    v_mov_b32 v94, v230
    v_mov_b32 v95, v234
    v_mov_b32 v96, v231
    v_mov_b32 v97, v235
    s_mov_b64 exec, 0xffff
    buffer_store_dwordx2 v[94:95], v8, s[20:23], s35 offen offset:0 sc1
    buffer_store_dwordx2 v[96:97], v8, s[20:23], s35 offen offset:128 sc1
    s_mov_b64 exec, -1
    v_pk_fma_f32 v[16:17], v[94:95], v[32:33], v[16:17] op_sel:[0,0,0] op_sel_hi:[0,1,1]
    v_pk_fma_f32 v[18:19], v[94:95], v[34:35], v[18:19] op_sel:[0,0,0] op_sel_hi:[0,1,1]
    v_pk_fma_f32 v[20:21], v[94:95], v[36:37], v[20:21] op_sel:[0,0,0] op_sel_hi:[0,1,1]
    v_pk_fma_f32 v[22:23], v[94:95], v[38:39], v[22:23] op_sel:[0,0,0] op_sel_hi:[0,1,1]
    v_pk_fma_f32 v[24:25], v[96:97], v[32:33], v[24:25] op_sel:[0,0,0] op_sel_hi:[0,1,1]
    v_pk_fma_f32 v[26:27], v[96:97], v[34:35], v[26:27] op_sel:[0,0,0] op_sel_hi:[0,1,1]
    v_pk_fma_f32 v[28:29], v[96:97], v[36:37], v[28:29] op_sel:[0,0,0] op_sel_hi:[0,1,1]
    v_pk_fma_f32 v[30:31], v[96:97], v[38:39], v[30:31] op_sel:[0,0,0] op_sel_hi:[0,1,1]
    v_pk_mul_f32 v[64:65], v[16:17], v[16:17] op_sel:[0,0] op_sel_hi:[1,1]
    v_pk_mul_f32 v[66:67], v[18:19], v[18:19] op_sel:[0,0] op_sel_hi:[1,1]
    v_pk_mul_f32 v[68:69], v[20:21], v[20:21] op_sel:[0,0] op_sel_hi:[1,1]
    v_pk_mul_f32 v[70:71], v[22:23], v[22:23] op_sel:[0,0] op_sel_hi:[1,1]
    v_pk_mul_f32 v[72:73], v[24:25], v[24:25] op_sel:[0,0] op_sel_hi:[1,1]
    v_pk_mul_f32 v[74:75], v[26:27], v[26:27] op_sel:[0,0] op_sel_hi:[1,1]
    v_pk_mul_f32 v[76:77], v[28:29], v[28:29] op_sel:[0,0] op_sel_hi:[1,1]
    v_pk_mul_f32 v[78:79], v[30:31], v[30:31] op_sel:[0,0] op_sel_hi:[1,1]
    v_pk_fma_f32 v[64:65], v[64:65], v[90:91], v[88:89] op_sel:[0,0,0] op_sel_hi:[1,0,0]
    v_pk_fma_f32 v[66:67], v[66:67], v[90:91], v[88:89] op_sel:[0,0,0] op_sel_hi:[1,0,0]
    v_pk_fma_f32 v[68:69], v[68:69], v[90:91], v[88:89] op_sel:[0,0,0] op_sel_hi:[1,0,0]
    v_pk_fma_f32 v[70:71], v[70:71], v[90:91], v[88:89] op_sel:[0,0,0] op_sel_hi:[1,0,0]
    v_pk_fma_f32 v[72:73], v[72:73], v[58:59], v[56:57] op_sel:[0,0,0] op_sel_hi:[1,0,0]
    v_pk_fma_f32 v[74:75], v[74:75], v[58:59], v[56:57] op_sel:[0,0,0] op_sel_hi:[1,0,0]
    v_pk_fma_f32 v[76:77], v[76:77], v[58:59], v[56:57] op_sel:[0,0,0] op_sel_hi:[1,0,0]
    v_pk_fma_f32 v[78:79], v[78:79], v[58:59], v[56:57] op_sel:[0,0,0] op_sel_hi:[1,0,0]
    v_pk_mul_f32 v[64:65], v[64:65], v[16:17] op_sel:[0,0] op_sel_hi:[1,1]
    v_pk_mul_f32 v[66:67], v[66:67], v[18:19] op_sel:[0,0] op_sel_hi:[1,1]
    v_pk_mul_f32 v[68:69], v[68:69], v[20:21] op_sel:[0,0] op_sel_hi:[1,1]
    v_pk_mul_f32 v[70:71], v[70:71], v[22:23] op_sel:[0,0] op_sel_hi:[1,1]
    v_pk_mul_f32 v[72:73], v[72:73], v[24:25] op_sel:[0,0] op_sel_hi:[1,1]
    v_pk_mul_f32 v[74:75], v[74:75], v[26:27] op_sel:[0,0] op_sel_hi:[1,1]
    v_pk_mul_f32 v[76:77], v[76:77], v[28:29] op_sel:[0,0] op_sel_hi:[1,1]
    v_pk_mul_f32 v[78:79], v[78:79], v[30:31] op_sel:[0,0] op_sel_hi:[1,1]
    v_exp_f32 v64, v64
    v_exp_f32 v66, v66
    v_exp_f32 v68, v68
    v_exp_f32 v70, v70
    v_exp_f32 v72, v72
    v_exp_f32 v74, v74
    v_exp_f32 v76, v76
    v_exp_f32 v78, v78
    v_exp_f32 v65, v65
    v_exp_f32 v67, v67
    v_exp_f32 v69, v69
    v_exp_f32 v71, v71
    v_exp_f32 v73, v73
    v_exp_f32 v75, v75
    v_exp_f32 v77, v77
    v_exp_f32 v79, v79
    v_pk_fma_f32 v[64:65], v[64:65], v[92:93], v[92:93] op_sel:[0,0,0] op_sel_hi:[1,0,0]
    v_pk_fma_f32 v[66:67], v[66:67], v[92:93], v[92:93] op_sel:[0,0,0] op_sel_hi:[1,0,0]
    v_pk_fma_f32 v[68:69], v[68:69], v[92:93], v[92:93] op_sel:[0,0,0] op_sel_hi:[1,0,0]
    v_pk_fma_f32 v[70:71], v[70:71], v[92:93], v[92:93] op_sel:[0,0,0] op_sel_hi:[1,0,0]
    v_pk_fma_f32 v[72:73], v[72:73], v[62:63], v[62:63] op_sel:[0,0,0] op_sel_hi:[1,0,0]
    v_pk_fma_f32 v[74:75], v[74:75], v[62:63], v[62:63] op_sel:[0,0,0] op_sel_hi:[1,0,0]
    v_pk_fma_f32 v[76:77], v[76:77], v[62:63], v[62:63] op_sel:[0,0,0] op_sel_hi:[1,0,0]
    v_pk_fma_f32 v[78:79], v[78:79], v[62:63], v[62:63] op_sel:[0,0,0] op_sel_hi:[1,0,0]
    v_rcp_f32 v64, v64
    v_rcp_f32 v66, v66
    v_rcp_f32 v68, v68
    v_rcp_f32 v70, v70
    v_rcp_f32 v72, v72
    v_rcp_f32 v74, v74
    v_rcp_f32 v76, v76
    v_rcp_f32 v78, v78
    v_rcp_f32 v65, v65
    v_rcp_f32 v67, v67
    v_rcp_f32 v69, v69
    v_rcp_f32 v71, v71
    v_rcp_f32 v73, v73
    v_rcp_f32 v75, v75
    v_rcp_f32 v77, v77
    v_rcp_f32 v79, v79
    v_pk_mul_f32 v[16:17], v[16:17], v[64:65] op_sel:[0,0] op_sel_hi:[1,1]
    v_pk_mul_f32 v[18:19], v[18:19], v[66:67] op_sel:[0,0] op_sel_hi:[1,1]
    v_pk_mul_f32 v[20:21], v[20:21], v[68:69] op_sel:[0,0] op_sel_hi:[1,1]
    v_pk_mul_f32 v[22:23], v[22:23], v[70:71] op_sel:[0,0] op_sel_hi:[1,1]
    v_pk_mul_f32 v[24:25], v[24:25], v[72:73] op_sel:[0,0] op_sel_hi:[1,1]
    v_pk_mul_f32 v[26:27], v[26:27], v[74:75] op_sel:[0,0] op_sel_hi:[1,1]
    v_pk_mul_f32 v[28:29], v[28:29], v[76:77] op_sel:[0,0] op_sel_hi:[1,1]
    v_pk_mul_f32 v[30:31], v[30:31], v[78:79] op_sel:[0,0] op_sel_hi:[1,1]
    s_lshl_b32 s35, s42, 10
    s_add_u32 s35, s35, s61
    v_cvt_pk_bf16_f32 v80, v16, v17
    v_cvt_pk_bf16_f32 v81, v18, v19
    v_cvt_pk_bf16_f32 v82, v20, v21
    v_cvt_pk_bf16_f32 v83, v22, v23
    buffer_store_dwordx4 v[80:83], v14, s[52:55], s35 offen offset:0 sc1
    s_add_u32 s36, s35, 16384
    v_cvt_pk_bf16_f32 v84, v24, v25
    v_cvt_pk_bf16_f32 v85, v26, v27
    v_cvt_pk_bf16_f32 v86, v28, v29
    v_cvt_pk_bf16_f32 v87, v30, v31
    buffer_store_dwordx4 v[84:87], v14, s[52:55], s36 offen offset:0 sc1
    s_waitcnt vmcnt(32)
    ds_read_b128 a[72:75], v6 offset:0
    ds_read_b128 a[76:79], v6 offset:2048
    ds_read_b128 a[88:91], v7 offset:0
    ds_read_b128 a[92:95], v7 offset:2048
    s_waitcnt vmcnt(28)
    ds_read_b128 a[104:107], v4 offset:32768
    ds_read_b128 a[108:111], v4 offset:34816
    ds_read_b128 a[120:123], v5 offset:32768
    ds_read_b128 a[124:127], v5 offset:34816
    s_waitcnt lgkmcnt(4)
    s_add_u32 m0, s34, 0
    s_add_u32 s35, s38, 1048576
    buffer_load_dwordx4 v216, s[12:15], s35 offen offset:0 lds
    s_add_u32 m0, s34, 0
    s_add_u32 s35, s38, 1080320
    buffer_load_dwordx4 v216, s[12:15], s35 offen offset:1024 lds
    s_add_u32 m0, s34, 0
    s_add_u32 s35, s38, 1112064
    buffer_load_dwordx4 v217, s[12:15], s35 offen offset:2048 lds
    s_add_u32 m0, s34, 0
    s_add_u32 s35, s38, 1143808
    buffer_load_dwordx4 v217, s[12:15], s35 offen offset:3072 lds
    s_waitcnt lgkmcnt(0)
    s_add_u32 m0, s33, 32768
    s_add_u32 s35, s38, 1572864
    buffer_load_dwordx4 v216, s[12:15], s35 offen offset:0 lds
    s_add_u32 m0, s33, 32768
    s_add_u32 s35, s38, 1604608
    buffer_load_dwordx4 v216, s[12:15], s35 offen offset:1024 lds
    s_add_u32 m0, s33, 32768
    s_add_u32 s35, s38, 1636352
    buffer_load_dwordx4 v217, s[12:15], s35 offen offset:2048 lds
    s_add_u32 m0, s33, 32768
    s_add_u32 s35, s38, 1668096
    buffer_load_dwordx4 v217, s[12:15], s35 offen offset:3072 lds
    s_waitcnt vmcnt(16)
    s_barrier
    ds_read_b64_tr_b16 a[128:129], v208 offset:0
    ds_read_b64_tr_b16 a[130:131], v208 offset:1024
    ds_read_b64_tr_b16 a[132:133], v208 offset:8
    ds_read_b64_tr_b16 a[134:135], v208 offset:1032
    ds_read_b64_tr_b16 a[136:137], v209 offset:0
    ds_read_b64_tr_b16 a[138:139], v209 offset:1024
    ds_read_b64_tr_b16 a[140:141], v209 offset:8
    ds_read_b64_tr_b16 a[142:143], v209 offset:1032
    ds_read_b64_tr_b16 a[144:145], v210 offset:0
    ds_read_b64_tr_b16 a[146:147], v210 offset:1024
    ds_read_b64_tr_b16 a[148:149], v210 offset:8
    ds_read_b64_tr_b16 a[150:151], v210 offset:1032
    s_waitcnt lgkmcnt(10)
    v_mfma_f32_16x16x32_bf16 v[16:19], a[128:131], a[0:3], 0
    ds_read_b64_tr_b16 a[152:153], v211 offset:0
    v_mfma_f32_16x16x32_bf16 v[48:51], a[128:131], a[4:7], 0
    v_mfma_f32_16x16x32_bf16 v[80:83], a[128:131], a[8:11], 0
    ds_read_b64_tr_b16 a[154:155], v211 offset:1024
    v_mfma_f32_16x16x32_bf16 v[112:115], a[128:131], a[12:15], 0
    v_mfma_f32_16x16x32_bf16 v[218:221], a[128:131], v[10:13], 0
    s_waitcnt lgkmcnt(10)
    v_mfma_f32_16x16x32_bf16 v[20:23], a[132:135], a[0:3], 0
    ds_read_b64_tr_b16 a[156:157], v211 offset:8
    v_mfma_f32_16x16x32_bf16 v[52:55], a[132:135], a[4:7], 0
    ds_read_b128 a[200:203], v6 offset:16384
    ds_read_b128 a[204:207], v6 offset:18432
    ds_read_b128 a[216:219], v7 offset:16384
    ds_read_b128 a[220:223], v7 offset:18432
    v_mfma_f32_16x16x32_bf16 v[84:87], a[132:135], a[8:11], 0
    ds_read_b64_tr_b16 a[158:159], v211 offset:1032
    v_mfma_f32_16x16x32_bf16 v[116:119], a[132:135], a[12:15], 0
    v_mfma_f32_16x16x32_bf16 v[222:225], a[132:135], v[10:13], 0
    s_waitcnt lgkmcnt(14)
    v_mfma_f32_16x16x32_bf16 v[24:27], a[136:139], a[0:3], 0
    ds_read_b64_tr_b16 a[160:161], v208 offset:8192
    v_mfma_f32_16x16x32_bf16 v[56:59], a[136:139], a[4:7], 0
    ds_read_b128 a[232:235], v6 offset:32768
    ds_read_b128 a[236:239], v6 offset:34816
    ds_read_b128 a[248:251], v7 offset:32768
    ds_read_b128 a[252:255], v7 offset:34816
    v_mfma_f32_16x16x32_bf16 v[88:91], a[136:139], a[8:11], 0
    ds_read_b64_tr_b16 a[162:163], v208 offset:9216
    v_mfma_f32_16x16x32_bf16 v[120:123], a[136:139], a[12:15], 0
    s_waitcnt lgkmcnt(15)
    v_mfma_f32_16x16x32_bf16 v[28:31], a[140:143], a[0:3], 0
    ds_read_b64_tr_b16 a[164:165], v208 offset:8200
    v_mfma_f32_16x16x32_bf16 v[60:63], a[140:143], a[4:7], 0
    s_waitcnt lgkmcnt(8)
    s_add_u32 m0, s34, 16384
    s_add_u32 s35, s38, 2097152
    buffer_load_dwordx4 v216, s[12:15], s35 offen offset:0 lds
    v_mfma_f32_16x16x32_bf16 v[92:95], a[140:143], a[8:11], 0
    ds_read_b64_tr_b16 a[166:167], v208 offset:9224
    v_mfma_f32_16x16x32_bf16 v[124:127], a[140:143], a[12:15], 0
    s_waitcnt lgkmcnt(15)
    v_mfma_f32_16x16x32_bf16 v[32:35], a[144:147], a[0:3], 0
    ds_read_b64_tr_b16 a[168:169], v209 offset:8192
    v_mfma_f32_16x16x32_bf16 v[64:67], a[144:147], a[4:7], 0
    s_add_u32 m0, s34, 16384
    s_add_u32 s35, s38, 2128896
    buffer_load_dwordx4 v216, s[12:15], s35 offen offset:1024 lds
    v_mfma_f32_16x16x32_bf16 v[96:99], a[144:147], a[8:11], 0
    ds_read_b64_tr_b16 a[170:171], v209 offset:9216
    v_mfma_f32_16x16x32_bf16 v[128:131], a[144:147], a[12:15], 0
    s_waitcnt lgkmcnt(15)
    v_mfma_f32_16x16x32_bf16 v[36:39], a[148:151], a[0:3], 0
    ds_read_b64_tr_b16 a[172:173], v209 offset:8200
    v_mfma_f32_16x16x32_bf16 v[68:71], a[148:151], a[4:7], 0
    s_add_u32 m0, s34, 16384
    s_add_u32 s35, s38, 2160640
    buffer_load_dwordx4 v217, s[12:15], s35 offen offset:2048 lds
    v_mfma_f32_16x16x32_bf16 v[100:103], a[148:151], a[8:11], 0
    ds_read_b64_tr_b16 a[174:175], v209 offset:9224
    v_mfma_f32_16x16x32_bf16 v[132:135], a[148:151], a[12:15], 0
    s_waitcnt lgkmcnt(15)
    v_mfma_f32_16x16x32_bf16 v[40:43], a[152:155], a[0:3], 0
    ds_read_b64_tr_b16 a[128:129], v210 offset:8192
    v_mfma_f32_16x16x32_bf16 v[72:75], a[152:155], a[4:7], 0
    s_add_u32 m0, s34, 16384
    s_add_u32 s35, s38, 2192384
    buffer_load_dwordx4 v217, s[12:15], s35 offen offset:3072 lds
    v_mfma_f32_16x16x32_bf16 v[104:107], a[152:155], a[8:11], 0
    ds_read_b64_tr_b16 a[130:131], v210 offset:9216
    v_mfma_f32_16x16x32_bf16 v[136:139], a[152:155], a[12:15], 0
    s_waitcnt lgkmcnt(14)
    v_mfma_f32_16x16x32_bf16 v[44:47], a[156:159], a[0:3], 0
    ds_read_b64_tr_b16 a[132:133], v210 offset:8200
    v_mfma_f32_16x16x32_bf16 v[76:79], a[156:159], a[4:7], 0
    ds_read_b128 v[152:155], v4 offset:49152
    ds_read_b128 v[156:159], v4 offset:51200
    ds_read_b128 v[168:171], v5 offset:49152
    ds_read_b128 v[172:175], v5 offset:51200
    v_mfma_f32_16x16x32_bf16 v[108:111], a[156:159], a[8:11], 0
    ds_read_b64_tr_b16 a[134:135], v210 offset:9224
    v_mfma_f32_16x16x32_bf16 v[140:143], a[156:159], a[12:15], 0
    s_waitcnt lgkmcnt(14)
    v_mfma_f32_16x16x32_bf16 v[16:19], a[160:163], a[16:19], v[16:19]
    ds_read_b64_tr_b16 a[136:137], v211 offset:8192
    v_mfma_f32_16x16x32_bf16 v[48:51], a[160:163], a[20:23], v[48:51]
    s_waitcnt lgkmcnt(15)
    s_add_u32 m0, s34, 32768
    s_add_u32 s35, s38, 2621440
    buffer_load_dwordx4 v216, s[12:15], s35 offen offset:0 lds
    v_mfma_f32_16x16x32_bf16 v[80:83], a[160:163], a[24:27], v[80:83]
    ds_read_b64_tr_b16 a[138:139], v211 offset:9216
    v_mfma_f32_16x16x32_bf16 v[112:115], a[160:163], a[28:31], v[112:115]
    v_mfma_f32_16x16x32_bf16 v[218:221], a[160:163], v[10:13], v[218:221]
    s_waitcnt lgkmcnt(14)
    v_mfma_f32_16x16x32_bf16 v[20:23], a[164:167], a[16:19], v[20:23]
    ds_read_b64_tr_b16 a[140:141], v211 offset:8200
    v_mfma_f32_16x16x32_bf16 v[52:55], a[164:167], a[20:23], v[52:55]
    s_add_u32 m0, s34, 32768
    s_add_u32 s35, s38, 2653184
    buffer_load_dwordx4 v216, s[12:15], s35 offen offset:1024 lds
    v_mfma_f32_16x16x32_bf16 v[84:87], a[164:167], a[24:27], v[84:87]
    ds_read_b64_tr_b16 a[142:143], v211 offset:9224
    v_mfma_f32_16x16x32_bf16 v[116:119], a[164:167], a[28:31], v[116:119]
    v_mfma_f32_16x16x32_bf16 v[222:225], a[164:167], v[10:13], v[222:225]
    s_waitcnt lgkmcnt(14)
    v_mfma_f32_16x16x32_bf16 v[24:27], a[168:171], a[16:19], v[24:27]
    s_waitcnt vmcnt(14)
    s_barrier
    s_cmp_lg_u32 s24, 0
    s_cbranch_scc1 L_sig1
    s_mov_b64 exec, 1
    v_mov_b32 v8, 1
    v_mov_b32 v9, 0
    buffer_atomic_add v8, v9, s[56:59], s67 offen offset:0 sc1
    s_mov_b64 exec, -1
L_sig1:
    ds_read_b64_tr_b16 a[144:145], v208 offset:16384
    v_mfma_f32_16x16x32_bf16 v[56:59], a[168:171], a[20:23], v[56:59]
    s_add_u32 m0, s34, 32768
    s_add_u32 s35, s38, 2684928
    buffer_load_dwordx4 v217, s[12:15], s35 offen offset:2048 lds
    v_mfma_f32_16x16x32_bf16 v[88:91], a[168:171], a[24:27], v[88:91]
    ds_read_b64_tr_b16 a[146:147], v208 offset:17408
    v_mfma_f32_16x16x32_bf16 v[120:123], a[168:171], a[28:31], v[120:123]
    s_waitcnt lgkmcnt(14)
    v_mfma_f32_16x16x32_bf16 v[28:31], a[172:175], a[16:19], v[28:31]
    ds_read_b64_tr_b16 a[148:149], v208 offset:16392
    v_mfma_f32_16x16x32_bf16 v[60:63], a[172:175], a[20:23], v[60:63]
    s_add_u32 m0, s34, 32768
    s_add_u32 s35, s38, 2716672
    buffer_load_dwordx4 v217, s[12:15], s35 offen offset:3072 lds
    v_mfma_f32_16x16x32_bf16 v[92:95], a[172:175], a[24:27], v[92:95]
    ds_read_b64_tr_b16 a[150:151], v208 offset:17416
    v_mfma_f32_16x16x32_bf16 v[124:127], a[172:175], a[28:31], v[124:127]
    s_waitcnt lgkmcnt(14)
    v_mfma_f32_16x16x32_bf16 v[32:35], a[128:131], a[16:19], v[32:35]
    ds_read_b64_tr_b16 a[152:153], v209 offset:16384
    v_mfma_f32_16x16x32_bf16 v[64:67], a[128:131], a[20:23], v[64:67]
    ds_read_b128 v[184:187], v6 offset:49152
    ds_read_b128 v[188:191], v6 offset:51200
    ds_read_b128 v[200:203], v7 offset:49152
    ds_read_b128 v[204:207], v7 offset:51200
    v_mfma_f32_16x16x32_bf16 v[96:99], a[128:131], a[24:27], v[96:99]
    ds_read_b64_tr_b16 a[154:155], v209 offset:17408
    v_mfma_f32_16x16x32_bf16 v[128:131], a[128:131], a[28:31], v[128:131]
    s_waitcnt lgkmcnt(14)
    v_mfma_f32_16x16x32_bf16 v[36:39], a[132:135], a[16:19], v[36:39]
    ds_read_b64_tr_b16 a[156:157], v209 offset:16392
    v_mfma_f32_16x16x32_bf16 v[68:71], a[132:135], a[20:23], v[68:71]
    s_waitcnt lgkmcnt(15)
    s_add_u32 m0, s33, 49152
    s_add_u32 s35, s38, 3145728
    buffer_load_dwordx4 v216, s[12:15], s35 offen offset:0 lds
    v_mfma_f32_16x16x32_bf16 v[100:103], a[132:135], a[24:27], v[100:103]
    ds_read_b64_tr_b16 a[158:159], v209 offset:17416
    v_mfma_f32_16x16x32_bf16 v[132:135], a[132:135], a[28:31], v[132:135]
    s_waitcnt lgkmcnt(14)
    v_mfma_f32_16x16x32_bf16 v[40:43], a[136:139], a[16:19], v[40:43]
    ds_read_b64_tr_b16 a[160:161], v210 offset:16384
    v_mfma_f32_16x16x32_bf16 v[72:75], a[136:139], a[20:23], v[72:75]
    s_add_u32 m0, s33, 49152
    s_add_u32 s35, s38, 3177472
    buffer_load_dwordx4 v216, s[12:15], s35 offen offset:1024 lds
    v_mfma_f32_16x16x32_bf16 v[104:107], a[136:139], a[24:27], v[104:107]
    ds_read_b64_tr_b16 a[162:163], v210 offset:17408
    v_mfma_f32_16x16x32_bf16 v[136:139], a[136:139], a[28:31], v[136:139]
    s_waitcnt lgkmcnt(14)
    v_mfma_f32_16x16x32_bf16 v[44:47], a[140:143], a[16:19], v[44:47]
    ds_read_b64_tr_b16 a[164:165], v210 offset:16392
    v_mfma_f32_16x16x32_bf16 v[76:79], a[140:143], a[20:23], v[76:79]
    s_add_u32 m0, s33, 49152
    s_add_u32 s35, s38, 3209216
    buffer_load_dwordx4 v217, s[12:15], s35 offen offset:2048 lds
    v_mfma_f32_16x16x32_bf16 v[108:111], a[140:143], a[24:27], v[108:111]
    ds_read_b64_tr_b16 a[166:167], v210 offset:17416
    v_mfma_f32_16x16x32_bf16 v[140:143], a[140:143], a[28:31], v[140:143]
    s_waitcnt lgkmcnt(14)
    v_mfma_f32_16x16x32_bf16 v[16:19], a[144:147], a[32:35], v[16:19]
    ds_read_b64_tr_b16 a[168:169], v211 offset:16384
    v_mfma_f32_16x16x32_bf16 v[48:51], a[144:147], a[36:39], v[48:51]
    s_add_u32 m0, s33, 49152
    s_add_u32 s35, s38, 3240960
    buffer_load_dwordx4 v217, s[12:15], s35 offen offset:3072 lds
    v_mfma_f32_16x16x32_bf16 v[80:83], a[144:147], a[40:43], v[80:83]
    ds_read_b64_tr_b16 a[170:171], v211 offset:17408
    v_mfma_f32_16x16x32_bf16 v[112:115], a[144:147], a[44:47], v[112:115]
    v_mfma_f32_16x16x32_bf16 v[218:221], a[144:147], v[10:13], v[218:221]
    s_waitcnt lgkmcnt(14)
    v_mfma_f32_16x16x32_bf16 v[20:23], a[148:151], a[32:35], v[20:23]
    ds_read_b64_tr_b16 a[172:173], v211 offset:16392
    v_mfma_f32_16x16x32_bf16 v[52:55], a[148:151], a[36:39], v[52:55]
    s_waitcnt lgkmcnt(10)
    s_add_u32 m0, s34, 49152
    s_add_u32 s35, s38, 3670016
    buffer_load_dwordx4 v216, s[12:15], s35 offen offset:0 lds
    v_mfma_f32_16x16x32_bf16 v[84:87], a[148:151], a[40:43], v[84:87]
    ds_read_b64_tr_b16 a[174:175], v211 offset:17416
    v_mfma_f32_16x16x32_bf16 v[116:119], a[148:151], a[44:47], v[116:119]
    v_mfma_f32_16x16x32_bf16 v[222:225], a[148:151], v[10:13], v[222:225]
    s_waitcnt lgkmcnt(10)
    v_mfma_f32_16x16x32_bf16 v[24:27], a[152:155], a[32:35], v[24:27]
    ds_read_b64_tr_b16 a[128:129], v208 offset:24576
    v_mfma_f32_16x16x32_bf16 v[56:59], a[152:155], a[36:39], v[56:59]
    s_add_u32 m0, s34, 49152
    s_add_u32 s35, s38, 3701760
    buffer_load_dwordx4 v216, s[12:15], s35 offen offset:1024 lds
    v_mfma_f32_16x16x32_bf16 v[88:91], a[152:155], a[40:43], v[88:91]
    ds_read_b64_tr_b16 a[130:131], v208 offset:25600
    v_mfma_f32_16x16x32_bf16 v[120:123], a[152:155], a[44:47], v[120:123]
    s_waitcnt lgkmcnt(10)
    v_mfma_f32_16x16x32_bf16 v[28:31], a[156:159], a[32:35], v[28:31]
    ds_read_b64_tr_b16 a[132:133], v208 offset:24584
    v_mfma_f32_16x16x32_bf16 v[60:63], a[156:159], a[36:39], v[60:63]
    s_add_u32 m0, s34, 49152
    s_add_u32 s35, s38, 3733504
    buffer_load_dwordx4 v217, s[12:15], s35 offen offset:2048 lds
    v_mfma_f32_16x16x32_bf16 v[92:95], a[156:159], a[40:43], v[92:95]
    ds_read_b64_tr_b16 a[134:135], v208 offset:25608
    v_mfma_f32_16x16x32_bf16 v[124:127], a[156:159], a[44:47], v[124:127]
    s_waitcnt lgkmcnt(10)
    v_mfma_f32_16x16x32_bf16 v[32:35], a[160:163], a[32:35], v[32:35]
    ds_read_b64_tr_b16 a[136:137], v209 offset:24576
    v_mfma_f32_16x16x32_bf16 v[64:67], a[160:163], a[36:39], v[64:67]
    s_add_u32 m0, s34, 49152
    s_add_u32 s35, s38, 3765248
    buffer_load_dwordx4 v217, s[12:15], s35 offen offset:3072 lds
    v_mfma_f32_16x16x32_bf16 v[96:99], a[160:163], a[40:43], v[96:99]
    ds_read_b64_tr_b16 a[138:139], v209 offset:25600
    v_mfma_f32_16x16x32_bf16 v[128:131], a[160:163], a[44:47], v[128:131]
    s_waitcnt lgkmcnt(10)
    v_mfma_f32_16x16x32_bf16 v[36:39], a[164:167], a[32:35], v[36:39]
    ds_read_b64_tr_b16 a[140:141], v209 offset:24584
    v_mfma_f32_16x16x32_bf16 v[68:71], a[164:167], a[36:39], v[68:71]
    s_add_u32 m0, s65, 0
    s_lshl_b32 s35, s24, 17
    s_add_u32 s35, s35, 0
    buffer_load_dwordx4 v15, s[48:51], s35 offen offset:0 lds
    v_mfma_f32_16x16x32_bf16 v[100:103], a[164:167], a[40:43], v[100:103]
    ds_read_b64_tr_b16 a[142:143], v209 offset:25608
    v_mfma_f32_16x16x32_bf16 v[132:135], a[164:167], a[44:47], v[132:135]
    s_waitcnt lgkmcnt(10)
    v_mfma_f32_16x16x32_bf16 v[40:43], a[168:171], a[32:35], v[40:43]
    ds_read_b64_tr_b16 a[144:145], v210 offset:24576
    v_mfma_f32_16x16x32_bf16 v[72:75], a[168:171], a[36:39], v[72:75]
    s_add_u32 m0, s65, 0
    s_lshl_b32 s35, s24, 17
    s_add_u32 s35, s35, 15360
    buffer_load_dwordx4 v15, s[48:51], s35 offen offset:1024 lds
    v_mfma_f32_16x16x32_bf16 v[104:107], a[168:171], a[40:43], v[104:107]
    ds_read_b64_tr_b16 a[146:147], v210 offset:25600
    v_mfma_f32_16x16x32_bf16 v[136:139], a[168:171], a[44:47], v[136:139]
    s_waitcnt lgkmcnt(10)
    v_mfma_f32_16x16x32_bf16 v[44:47], a[172:175], a[32:35], v[44:47]
    ds_read_b64_tr_b16 a[148:149], v210 offset:24584
    v_mfma_f32_16x16x32_bf16 v[76:79], a[172:175], a[36:39], v[76:79]
    s_add_u32 m0, s65, 0
    s_lshl_b32 s35, s24, 17
    s_add_u32 s35, s35, 30720
    buffer_load_dwordx4 v15, s[48:51], s35 offen offset:2048 lds
    v_mfma_f32_16x16x32_bf16 v[108:111], a[172:175], a[40:43], v[108:111]
    ds_read_b64_tr_b16 a[150:151], v210 offset:25608
    v_mfma_f32_16x16x32_bf16 v[140:143], a[172:175], a[44:47], v[140:143]
    s_waitcnt lgkmcnt(10)
    v_mfma_f32_16x16x32_bf16 v[16:19], a[128:131], a[48:51], v[16:19]
    ds_read_b64_tr_b16 a[152:153], v211 offset:24576
    v_mfma_f32_16x16x32_bf16 v[48:51], a[128:131], a[52:55], v[48:51]
    s_add_u32 m0, s65, 0
    s_lshl_b32 s35, s24, 17
    s_add_u32 s35, s35, 46080
    buffer_load_dwordx4 v15, s[48:51], s35 offen offset:3072 lds
    v_mfma_f32_16x16x32_bf16 v[80:83], a[128:131], a[56:59], v[80:83]
    ds_read_b64_tr_b16 a[154:155], v211 offset:25600
    v_mfma_f32_16x16x32_bf16 v[112:115], a[128:131], a[60:63], v[112:115]
    v_mfma_f32_16x16x32_bf16 v[218:221], a[128:131], v[10:13], v[218:221]
    s_waitcnt lgkmcnt(10)
    v_mfma_f32_16x16x32_bf16 v[20:23], a[132:135], a[48:51], v[20:23]
    ds_read_b64_tr_b16 a[156:157], v211 offset:24584
    v_mfma_f32_16x16x32_bf16 v[52:55], a[132:135], a[52:55], v[52:55]
    s_add_u32 m0, s65, 4096
    s_lshl_b32 s35, s24, 17
    s_add_u32 s35, s35, 65536
    buffer_load_dwordx4 v15, s[48:51], s35 offen offset:0 lds
    v_mfma_f32_16x16x32_bf16 v[84:87], a[132:135], a[56:59], v[84:87]
    ds_read_b64_tr_b16 a[158:159], v211 offset:25608
    v_mfma_f32_16x16x32_bf16 v[116:119], a[132:135], a[60:63], v[116:119]
    v_mfma_f32_16x16x32_bf16 v[222:225], a[132:135], v[10:13], v[222:225]
    s_waitcnt lgkmcnt(10)
    v_mfma_f32_16x16x32_bf16 v[24:27], a[136:139], a[48:51], v[24:27]
    s_waitcnt vmcnt(25)
    s_barrier
    ds_read_b64_tr_b16 a[160:161], v212 offset:0
    v_mfma_f32_16x16x32_bf16 v[56:59], a[136:139], a[52:55], v[56:59]
    s_add_u32 m0, s65, 4096
    s_lshl_b32 s35, s24, 17
    s_add_u32 s35, s35, 80896
    buffer_load_dwordx4 v15, s[48:51], s35 offen offset:1024 lds
    v_mfma_f32_16x16x32_bf16 v[88:91], a[136:139], a[56:59], v[88:91]
    ds_read_b64_tr_b16 a[162:163], v212 offset:1024
    v_mfma_f32_16x16x32_bf16 v[120:123], a[136:139], a[60:63], v[120:123]
    s_waitcnt lgkmcnt(10)
    v_mfma_f32_16x16x32_bf16 v[28:31], a[140:143], a[48:51], v[28:31]
    ds_read_b64_tr_b16 a[164:165], v212 offset:8
    v_mfma_f32_16x16x32_bf16 v[60:63], a[140:143], a[52:55], v[60:63]
    s_add_u32 m0, s33, 0
    s_nop 0
    buffer_load_dwordx4 v250, s[4:7], s28 offen offset:0 lds
    v_mfma_f32_16x16x32_bf16 v[92:95], a[140:143], a[56:59], v[92:95]
    ds_read_b64_tr_b16 a[166:167], v212 offset:1032
    v_mfma_f32_16x16x32_bf16 v[124:127], a[140:143], a[60:63], v[124:127]
    s_waitcnt lgkmcnt(10)
    v_mfma_f32_16x16x32_bf16 v[32:35], a[144:147], a[48:51], v[32:35]
    ds_read_b64_tr_b16 a[168:169], v213 offset:0
    v_mfma_f32_16x16x32_bf16 v[64:67], a[144:147], a[52:55], v[64:67]
    s_add_u32 m0, s65, 4096
    s_lshl_b32 s35, s24, 17
    s_add_u32 s35, s35, 96256
    buffer_load_dwordx4 v15, s[48:51], s35 offen offset:2048 lds
    v_mfma_f32_16x16x32_bf16 v[96:99], a[144:147], a[56:59], v[96:99]
    ds_read_b64_tr_b16 a[170:171], v213 offset:1024
    v_mfma_f32_16x16x32_bf16 v[128:131], a[144:147], a[60:63], v[128:131]
    s_waitcnt lgkmcnt(10)
    v_mfma_f32_16x16x32_bf16 v[36:39], a[148:151], a[48:51], v[36:39]
    ds_read_b64_tr_b16 a[172:173], v213 offset:8
    v_mfma_f32_16x16x32_bf16 v[68:71], a[148:151], a[52:55], v[68:71]
    s_add_u32 m0, s33, 0
    s_nop 0
    buffer_load_dwordx4 v251, s[4:7], s28 offen offset:1024 lds
    v_mfma_f32_16x16x32_bf16 v[100:103], a[148:151], a[56:59], v[100:103]
    ds_read_b64_tr_b16 a[174:175], v213 offset:1032
    v_mfma_f32_16x16x32_bf16 v[132:135], a[148:151], a[60:63], v[132:135]
    s_waitcnt lgkmcnt(10)
    v_mfma_f32_16x16x32_bf16 v[40:43], a[152:155], a[48:51], v[40:43]
    ds_read_b64_tr_b16 a[128:129], v214 offset:0
    v_mfma_f32_16x16x32_bf16 v[72:75], a[152:155], a[52:55], v[72:75]
    s_add_u32 m0, s65, 4096
    s_lshl_b32 s35, s24, 17
    s_add_u32 s35, s35, 111616
    buffer_load_dwordx4 v15, s[48:51], s35 offen offset:3072 lds
    v_mfma_f32_16x16x32_bf16 v[104:107], a[152:155], a[56:59], v[104:107]
    ds_read_b64_tr_b16 a[130:131], v214 offset:1024
    v_mfma_f32_16x16x32_bf16 v[136:139], a[152:155], a[60:63], v[136:139]
    s_waitcnt lgkmcnt(10)
    v_mfma_f32_16x16x32_bf16 v[44:47], a[156:159], a[48:51], v[44:47]
    ds_read_b64_tr_b16 a[132:133], v214 offset:8
    v_mfma_f32_16x16x32_bf16 v[76:79], a[156:159], a[52:55], v[76:79]
    s_add_u32 m0, s33, 0
    s_nop 0
    buffer_load_dwordx4 v252, s[4:7], s28 offen offset:2048 lds
    v_mfma_f32_16x16x32_bf16 v[108:111], a[156:159], a[56:59], v[108:111]
    ds_read_b64_tr_b16 a[134:135], v214 offset:1032
    v_mfma_f32_16x16x32_bf16 v[140:143], a[156:159], a[60:63], v[140:143]
    s_waitcnt lgkmcnt(10)
    v_mfma_f32_16x16x32_bf16 v[16:19], a[160:163], a[64:67], v[16:19]
    ds_read_b64_tr_b16 a[136:137], v215 offset:0
    v_mfma_f32_16x16x32_bf16 v[48:51], a[160:163], a[68:71], v[48:51]
    s_add_u32 m0, s33, 0
    s_nop 0
    buffer_load_dwordx4 v253, s[4:7], s28 offen offset:3072 lds
    s_add_u32 s28, s28, 16384
    v_mfma_f32_16x16x32_bf16 v[80:83], a[160:163], a[72:75], v[80:83]
    ds_read_b64_tr_b16 a[138:139], v215 offset:1024
    v_mfma_f32_16x16x32_bf16 v[112:115], a[160:163], a[76:79], v[112:115]
    v_mfma_f32_16x16x32_bf16 v[218:221], a[160:163], v[10:13], v[218:221]
    s_waitcnt lgkmcnt(10)
    v_mfma_f32_16x16x32_bf16 v[20:23], a[164:167], a[64:67], v[20:23]
    ds_read_b64_tr_b16 a[140:141], v215 offset:8
    v_mfma_f32_16x16x32_bf16 v[52:55], a[164:167], a[68:71], v[52:55]
    v_mfma_f32_16x16x32_bf16 v[84:87], a[164:167], a[72:75], v[84:87]
    ds_read_b64_tr_b16 a[142:143], v215 offset:1032
    v_mfma_f32_16x16x32_bf16 v[116:119], a[164:167], a[76:79], v[116:119]
    v_mfma_f32_16x16x32_bf16 v[222:225], a[164:167], v[10:13], v[222:225]
    s_waitcnt lgkmcnt(10)
    v_mfma_f32_16x16x32_bf16 v[24:27], a[168:171], a[64:67], v[24:27]
    ds_read_b64_tr_b16 a[144:145], v212 offset:8192
    v_mfma_f32_16x16x32_bf16 v[56:59], a[168:171], a[68:71], v[56:59]
    v_mfma_f32_16x16x32_bf16 v[88:91], a[168:171], a[72:75], v[88:91]
    ds_read_b64_tr_b16 a[146:147], v212 offset:9216
    v_mfma_f32_16x16x32_bf16 v[120:123], a[168:171], a[76:79], v[120:123]
    s_waitcnt lgkmcnt(10)
    v_mfma_f32_16x16x32_bf16 v[28:31], a[172:175], a[64:67], v[28:31]
    ds_read_b64_tr_b16 a[148:149], v212 offset:8200
    v_mfma_f32_16x16x32_bf16 v[60:63], a[172:175], a[68:71], v[60:63]
    v_mfma_f32_16x16x32_bf16 v[92:95], a[172:175], a[72:75], v[92:95]
    ds_read_b64_tr_b16 a[150:151], v212 offset:9224
    v_mfma_f32_16x16x32_bf16 v[124:127], a[172:175], a[76:79], v[124:127]
    s_waitcnt lgkmcnt(10)
    v_mfma_f32_16x16x32_bf16 v[32:35], a[128:131], a[64:67], v[32:35]
    ds_read_b64_tr_b16 a[152:153], v213 offset:8192
    v_mfma_f32_16x16x32_bf16 v[64:67], a[128:131], a[68:71], v[64:67]
    v_mfma_f32_16x16x32_bf16 v[96:99], a[128:131], a[72:75], v[96:99]
    ds_read_b64_tr_b16 a[154:155], v213 offset:9216
    v_mfma_f32_16x16x32_bf16 v[128:131], a[128:131], a[76:79], v[128:131]
    s_waitcnt lgkmcnt(10)
    v_mfma_f32_16x16x32_bf16 v[36:39], a[132:135], a[64:67], v[36:39]
    ds_read_b64_tr_b16 a[156:157], v213 offset:8200
    v_mfma_f32_16x16x32_bf16 v[68:71], a[132:135], a[68:71], v[68:71]
    v_mfma_f32_16x16x32_bf16 v[100:103], a[132:135], a[72:75], v[100:103]
    ds_read_b64_tr_b16 a[158:159], v213 offset:9224
    v_mfma_f32_16x16x32_bf16 v[132:135], a[132:135], a[76:79], v[132:135]
    s_waitcnt lgkmcnt(10)
    v_mfma_f32_16x16x32_bf16 v[40:43], a[136:139], a[64:67], v[40:43]
    ds_read_b64_tr_b16 a[160:161], v214 offset:8192
    v_mfma_f32_16x16x32_bf16 v[72:75], a[136:139], a[68:71], v[72:75]
    v_mfma_f32_16x16x32_bf16 v[104:107], a[136:139], a[72:75], v[104:107]
    ds_read_b64_tr_b16 a[162:163], v214 offset:9216
    v_mfma_f32_16x16x32_bf16 v[136:139], a[136:139], a[76:79], v[136:139]
    s_waitcnt lgkmcnt(10)
    v_mfma_f32_16x16x32_bf16 v[44:47], a[140:143], a[64:67], v[44:47]
    ds_read_b64_tr_b16 a[164:165], v214 offset:8200
    v_mfma_f32_16x16x32_bf16 v[76:79], a[140:143], a[68:71], v[76:79]
    v_mfma_f32_16x16x32_bf16 v[108:111], a[140:143], a[72:75], v[108:111]
    ds_read_b64_tr_b16 a[166:167], v214 offset:9224
    v_mfma_f32_16x16x32_bf16 v[140:143], a[140:143], a[76:79], v[140:143]
    s_waitcnt lgkmcnt(10)
    v_mfma_f32_16x16x32_bf16 v[16:19], a[144:147], a[80:83], v[16:19]
    ds_read_b64_tr_b16 a[168:169], v215 offset:8192
    v_mfma_f32_16x16x32_bf16 v[48:51], a[144:147], a[84:87], v[48:51]
    v_mfma_f32_16x16x32_bf16 v[80:83], a[144:147], a[88:91], v[80:83]
    ds_read_b64_tr_b16 a[170:171], v215 offset:9216
    v_mfma_f32_16x16x32_bf16 v[112:115], a[144:147], a[92:95], v[112:115]
    v_mfma_f32_16x16x32_bf16 v[218:221], a[144:147], v[10:13], v[218:221]
    s_waitcnt lgkmcnt(10)
    v_mfma_f32_16x16x32_bf16 v[20:23], a[148:151], a[80:83], v[20:23]
    ds_read_b64_tr_b16 a[172:173], v215 offset:8200
    v_mfma_f32_16x16x32_bf16 v[52:55], a[148:151], a[84:87], v[52:55]
    v_mfma_f32_16x16x32_bf16 v[84:87], a[148:151], a[88:91], v[84:87]
    ds_read_b64_tr_b16 a[174:175], v215 offset:9224
    v_mfma_f32_16x16x32_bf16 v[116:119], a[148:151], a[92:95], v[116:119]
    v_mfma_f32_16x16x32_bf16 v[222:225], a[148:151], v[10:13], v[222:225]
    s_waitcnt lgkmcnt(10)
    v_mfma_f32_16x16x32_bf16 v[24:27], a[152:155], a[80:83], v[24:27]
    s_waitcnt vmcnt(28)
    s_barrier
    ds_read_b64_tr_b16 a[128:129], v208 offset:32768
    v_mfma_f32_16x16x32_bf16 v[56:59], a[152:155], a[84:87], v[56:59]
    s_add_u32 m0, s33, 16384
    s_nop 0
    buffer_load_dwordx4 v250, s[4:7], s28 offen offset:0 lds
    v_mfma_f32_16x16x32_bf16 v[88:91], a[152:155], a[88:91], v[88:91]
    ds_read_b64_tr_b16 a[130:131], v208 offset:33792
    v_mfma_f32_16x16x32_bf16 v[120:123], a[152:155], a[92:95], v[120:123]
    s_waitcnt lgkmcnt(10)
    v_mfma_f32_16x16x32_bf16 v[28:31], a[156:159], a[80:83], v[28:31]
    ds_read_b64_tr_b16 a[132:133], v208 offset:32776
    v_mfma_f32_16x16x32_bf16 v[60:63], a[156:159], a[84:87], v[60:63]
    s_add_u32 m0, s33, 16384
    s_nop 0
    buffer_load_dwordx4 v251, s[4:7], s28 offen offset:1024 lds
    v_mfma_f32_16x16x32_bf16 v[92:95], a[156:159], a[88:91], v[92:95]
    ds_read_b64_tr_b16 a[134:135], v208 offset:33800
    v_mfma_f32_16x16x32_bf16 v[124:127], a[156:159], a[92:95], v[124:127]
    s_waitcnt lgkmcnt(10)
    v_mfma_f32_16x16x32_bf16 v[32:35], a[160:163], a[80:83], v[32:35]
    ds_read_b64_tr_b16 a[136:137], v209 offset:32768
    v_mfma_f32_16x16x32_bf16 v[64:67], a[160:163], a[84:87], v[64:67]
    s_add_u32 m0, s33, 16384
    s_nop 0
    buffer_load_dwordx4 v252, s[4:7], s28 offen offset:2048 lds
    v_mfma_f32_16x16x32_bf16 v[96:99], a[160:163], a[88:91], v[96:99]
    ds_read_b64_tr_b16 a[138:139], v209 offset:33792
    v_mfma_f32_16x16x32_bf16 v[128:131], a[160:163], a[92:95], v[128:131]
    s_waitcnt lgkmcnt(10)
    v_mfma_f32_16x16x32_bf16 v[36:39], a[164:167], a[80:83], v[36:39]
    ds_read_b64_tr_b16 a[140:141], v209 offset:32776
    v_mfma_f32_16x16x32_bf16 v[68:71], a[164:167], a[84:87], v[68:71]
    s_add_u32 m0, s33, 16384
    s_nop 0
    buffer_load_dwordx4 v253, s[4:7], s28 offen offset:3072 lds
    s_add_u32 s28, s28, 16384
    v_mfma_f32_16x16x32_bf16 v[100:103], a[164:167], a[88:91], v[100:103]
    ds_read_b64_tr_b16 a[142:143], v209 offset:33800
    v_mfma_f32_16x16x32_bf16 v[132:135], a[164:167], a[92:95], v[132:135]
    s_waitcnt lgkmcnt(10)
    v_mfma_f32_16x16x32_bf16 v[40:43], a[168:171], a[80:83], v[40:43]
    ds_read_b64_tr_b16 a[144:145], v210 offset:32768
    v_mfma_f32_16x16x32_bf16 v[72:75], a[168:171], a[84:87], v[72:75]
    v_mfma_f32_16x16x32_bf16 v[104:107], a[168:171], a[88:91], v[104:107]
    ds_read_b64_tr_b16 a[146:147], v210 offset:33792
    v_mfma_f32_16x16x32_bf16 v[136:139], a[168:171], a[92:95], v[136:139]
    s_waitcnt lgkmcnt(10)
    v_mfma_f32_16x16x32_bf16 v[44:47], a[172:175], a[80:83], v[44:47]
    ds_read_b64_tr_b16 a[148:149], v210 offset:32776
    v_mfma_f32_16x16x32_bf16 v[76:79], a[172:175], a[84:87], v[76:79]
    v_mfma_f32_16x16x32_bf16 v[108:111], a[172:175], a[88:91], v[108:111]
    ds_read_b64_tr_b16 a[150:151], v210 offset:33800
    v_mfma_f32_16x16x32_bf16 v[140:143], a[172:175], a[92:95], v[140:143]
    s_waitcnt lgkmcnt(10)
    v_mfma_f32_16x16x32_bf16 v[16:19], a[128:131], a[96:99], v[16:19]
    ds_read_b64_tr_b16 a[152:153], v211 offset:32768
    v_mfma_f32_16x16x32_bf16 v[48:51], a[128:131], a[100:103], v[48:51]
    v_mfma_f32_16x16x32_bf16 v[80:83], a[128:131], a[104:107], v[80:83]
    ds_read_b64_tr_b16 a[154:155], v211 offset:33792
    v_mfma_f32_16x16x32_bf16 v[112:115], a[128:131], a[108:111], v[112:115]
    v_mfma_f32_16x16x32_bf16 v[218:221], a[128:131], v[10:13], v[218:221]
    s_waitcnt lgkmcnt(10)
    v_mfma_f32_16x16x32_bf16 v[20:23], a[132:135], a[96:99], v[20:23]
    ds_read_b64_tr_b16 a[156:157], v211 offset:32776
    v_mfma_f32_16x16x32_bf16 v[52:55], a[132:135], a[100:103], v[52:55]
    v_mfma_f32_16x16x32_bf16 v[84:87], a[132:135], a[104:107], v[84:87]
    ds_read_b64_tr_b16 a[158:159], v211 offset:33800
    v_mfma_f32_16x16x32_bf16 v[116:119], a[132:135], a[108:111], v[116:119]
    v_mfma_f32_16x16x32_bf16 v[222:225], a[132:135], v[10:13], v[222:225]
    s_waitcnt lgkmcnt(10)
    v_mfma_f32_16x16x32_bf16 v[24:27], a[136:139], a[96:99], v[24:27]
    ds_read_b64_tr_b16 a[160:161], v208 offset:40960
    v_mfma_f32_16x16x32_bf16 v[56:59], a[136:139], a[100:103], v[56:59]
    v_mfma_f32_16x16x32_bf16 v[88:91], a[136:139], a[104:107], v[88:91]
    ds_read_b64_tr_b16 a[162:163], v208 offset:41984
    v_mfma_f32_16x16x32_bf16 v[120:123], a[136:139], a[108:111], v[120:123]
    s_waitcnt lgkmcnt(10)
    v_mfma_f32_16x16x32_bf16 v[28:31], a[140:143], a[96:99], v[28:31]
    ds_read_b64_tr_b16 a[164:165], v208 offset:40968
    v_mfma_f32_16x16x32_bf16 v[60:63], a[140:143], a[100:103], v[60:63]
    v_mfma_f32_16x16x32_bf16 v[92:95], a[140:143], a[104:107], v[92:95]
    ds_read_b64_tr_b16 a[166:167], v208 offset:41992
    v_mfma_f32_16x16x32_bf16 v[124:127], a[140:143], a[108:111], v[124:127]
    s_waitcnt lgkmcnt(10)
    v_mfma_f32_16x16x32_bf16 v[32:35], a[144:147], a[96:99], v[32:35]
    ds_read_b64_tr_b16 a[168:169], v209 offset:40960
    v_mfma_f32_16x16x32_bf16 v[64:67], a[144:147], a[100:103], v[64:67]
    v_mfma_f32_16x16x32_bf16 v[96:99], a[144:147], a[104:107], v[96:99]
    ds_read_b64_tr_b16 a[170:171], v209 offset:41984
    v_mfma_f32_16x16x32_bf16 v[128:131], a[144:147], a[108:111], v[128:131]
    s_waitcnt lgkmcnt(10)
    v_mfma_f32_16x16x32_bf16 v[36:39], a[148:151], a[96:99], v[36:39]
    ds_read_b64_tr_b16 a[172:173], v209 offset:40968
    v_mfma_f32_16x16x32_bf16 v[68:71], a[148:151], a[100:103], v[68:71]
    v_mfma_f32_16x16x32_bf16 v[100:103], a[148:151], a[104:107], v[100:103]
    ds_read_b64_tr_b16 a[174:175], v209 offset:41992
    v_mfma_f32_16x16x32_bf16 v[132:135], a[148:151], a[108:111], v[132:135]
    s_waitcnt lgkmcnt(10)
    v_mfma_f32_16x16x32_bf16 v[40:43], a[152:155], a[96:99], v[40:43]
    ds_read_b64_tr_b16 a[128:129], v210 offset:40960
    v_mfma_f32_16x16x32_bf16 v[72:75], a[152:155], a[100:103], v[72:75]
    v_mfma_f32_16x16x32_bf16 v[104:107], a[152:155], a[104:107], v[104:107]
    ds_read_b64_tr_b16 a[130:131], v210 offset:41984
    v_mfma_f32_16x16x32_bf16 v[136:139], a[152:155], a[108:111], v[136:139]
    s_waitcnt lgkmcnt(10)
    v_mfma_f32_16x16x32_bf16 v[44:47], a[156:159], a[96:99], v[44:47]
    ds_read_b64_tr_b16 a[132:133], v210 offset:40968
    v_mfma_f32_16x16x32_bf16 v[76:79], a[156:159], a[100:103], v[76:79]
    v_mfma_f32_16x16x32_bf16 v[108:111], a[156:159], a[104:107], v[108:111]
    ds_read_b64_tr_b16 a[134:135], v210 offset:41992
    v_mfma_f32_16x16x32_bf16 v[140:143], a[156:159], a[108:111], v[140:143]
    s_waitcnt lgkmcnt(10)
    v_mfma_f32_16x16x32_bf16 v[16:19], a[160:163], a[112:115], v[16:19]
    ds_read_b64_tr_b16 a[136:137], v211 offset:40960
    v_mfma_f32_16x16x32_bf16 v[48:51], a[160:163], a[116:119], v[48:51]
    v_mfma_f32_16x16x32_bf16 v[80:83], a[160:163], a[120:123], v[80:83]
    ds_read_b64_tr_b16 a[138:139], v211 offset:41984
    v_mfma_f32_16x16x32_bf16 v[112:115], a[160:163], a[124:127], v[112:115]
    v_mfma_f32_16x16x32_bf16 v[218:221], a[160:163], v[10:13], v[218:221]
    s_waitcnt lgkmcnt(10)
    v_mfma_f32_16x16x32_bf16 v[20:23], a[164:167], a[112:115], v[20:23]
    ds_read_b64_tr_b16 a[140:141], v211 offset:40968
    v_mfma_f32_16x16x32_bf16 v[52:55], a[164:167], a[116:119], v[52:55]
    v_mfma_f32_16x16x32_bf16 v[84:87], a[164:167], a[120:123], v[84:87]
    ds_read_b64_tr_b16 a[142:143], v211 offset:41992
    v_mfma_f32_16x16x32_bf16 v[116:119], a[164:167], a[124:127], v[116:119]
    v_mfma_f32_16x16x32_bf16 v[222:225], a[164:167], v[10:13], v[222:225]
    s_waitcnt lgkmcnt(10)
    v_mfma_f32_16x16x32_bf16 v[24:27], a[168:171], a[112:115], v[24:27]
    s_waitcnt vmcnt(28)
    s_barrier
    ds_read_b64_tr_b16 a[144:145], v212 offset:16384
    v_mfma_f32_16x16x32_bf16 v[56:59], a[168:171], a[116:119], v[56:59]
    s_add_u32 m0, s34, 0
    s_nop 0
    buffer_load_dwordx4 v254, s[8:11], s29 offen offset:0 lds
    v_mfma_f32_16x16x32_bf16 v[88:91], a[168:171], a[120:123], v[88:91]
    ds_read_b64_tr_b16 a[146:147], v212 offset:17408
    v_mfma_f32_16x16x32_bf16 v[120:123], a[168:171], a[124:127], v[120:123]
    s_waitcnt lgkmcnt(10)
    v_mfma_f32_16x16x32_bf16 v[28:31], a[172:175], a[112:115], v[28:31]
    ds_read_b64_tr_b16 a[148:149], v212 offset:16392
    v_mfma_f32_16x16x32_bf16 v[60:63], a[172:175], a[116:119], v[60:63]
    s_add_u32 m0, s34, 0
    s_nop 0
    buffer_load_dwordx4 v255, s[8:11], s29 offen offset:1024 lds
    v_mfma_f32_16x16x32_bf16 v[92:95], a[172:175], a[120:123], v[92:95]
    ds_read_b64_tr_b16 a[150:151], v212 offset:17416
    v_mfma_f32_16x16x32_bf16 v[124:127], a[172:175], a[124:127], v[124:127]
    s_waitcnt lgkmcnt(10)
    v_mfma_f32_16x16x32_bf16 v[32:35], a[128:131], a[112:115], v[32:35]
    ds_read_b64_tr_b16 a[152:153], v213 offset:16384
    v_mfma_f32_16x16x32_bf16 v[64:67], a[128:131], a[116:119], v[64:67]
    s_add_u32 m0, s34, 0
    s_nop 0
    buffer_load_dwordx4 v254, s[8:11], s29 offen offset:2048 lds
    v_mfma_f32_16x16x32_bf16 v[96:99], a[128:131], a[120:123], v[96:99]
    ds_read_b64_tr_b16 a[154:155], v213 offset:17408
    v_mfma_f32_16x16x32_bf16 v[128:131], a[128:131], a[124:127], v[128:131]
    s_waitcnt lgkmcnt(10)
    v_mfma_f32_16x16x32_bf16 v[36:39], a[132:135], a[112:115], v[36:39]
    ds_read_b64_tr_b16 a[156:157], v213 offset:16392
    v_mfma_f32_16x16x32_bf16 v[68:71], a[132:135], a[116:119], v[68:71]
    s_add_u32 m0, s34, 0
    s_nop 0
    buffer_load_dwordx4 v255, s[8:11], s29 offen offset:3072 lds
    s_add_u32 s29, s29, 16384
    v_mfma_f32_16x16x32_bf16 v[100:103], a[132:135], a[120:123], v[100:103]
    ds_read_b64_tr_b16 a[158:159], v213 offset:17416
    v_mfma_f32_16x16x32_bf16 v[132:135], a[132:135], a[124:127], v[132:135]
    s_waitcnt lgkmcnt(10)
    v_mfma_f32_16x16x32_bf16 v[40:43], a[136:139], a[112:115], v[40:43]
    ds_read_b64_tr_b16 a[160:161], v214 offset:16384
    v_mfma_f32_16x16x32_bf16 v[72:75], a[136:139], a[116:119], v[72:75]
    v_mfma_f32_16x16x32_bf16 v[104:107], a[136:139], a[120:123], v[104:107]
    ds_read_b64_tr_b16 a[162:163], v214 offset:17408
    v_mfma_f32_16x16x32_bf16 v[136:139], a[136:139], a[124:127], v[136:139]
    s_waitcnt lgkmcnt(10)
    v_mfma_f32_16x16x32_bf16 v[44:47], a[140:143], a[112:115], v[44:47]
    ds_read_b64_tr_b16 a[164:165], v214 offset:16392
    v_mfma_f32_16x16x32_bf16 v[76:79], a[140:143], a[116:119], v[76:79]
    v_mfma_f32_16x16x32_bf16 v[108:111], a[140:143], a[120:123], v[108:111]
    ds_read_b64_tr_b16 a[166:167], v214 offset:17416
    v_mfma_f32_16x16x32_bf16 v[140:143], a[140:143], a[124:127], v[140:143]
    s_waitcnt lgkmcnt(10)
    v_mfma_f32_16x16x32_bf16 v[16:19], a[144:147], a[192:195], v[16:19]
    ds_read_b64_tr_b16 a[168:169], v215 offset:16384
    v_mfma_f32_16x16x32_bf16 v[48:51], a[144:147], a[196:199], v[48:51]
    v_mfma_f32_16x16x32_bf16 v[80:83], a[144:147], a[200:203], v[80:83]
    ds_read_b64_tr_b16 a[170:171], v215 offset:17408
    v_mfma_f32_16x16x32_bf16 v[112:115], a[144:147], a[204:207], v[112:115]
    v_mfma_f32_16x16x32_bf16 v[218:221], a[144:147], v[10:13], v[218:221]
    s_waitcnt lgkmcnt(10)
    v_mfma_f32_16x16x32_bf16 v[20:23], a[148:151], a[192:195], v[20:23]
    ds_read_b64_tr_b16 a[172:173], v215 offset:16392
    v_mfma_f32_16x16x32_bf16 v[52:55], a[148:151], a[196:199], v[52:55]
    v_mfma_f32_16x16x32_bf16 v[84:87], a[148:151], a[200:203], v[84:87]
    ds_read_b64_tr_b16 a[174:175], v215 offset:17416
    v_mfma_f32_16x16x32_bf16 v[116:119], a[148:151], a[204:207], v[116:119]
    v_mfma_f32_16x16x32_bf16 v[222:225], a[148:151], v[10:13], v[222:225]
    s_waitcnt lgkmcnt(10)
    v_mfma_f32_16x16x32_bf16 v[24:27], a[152:155], a[192:195], v[24:27]
    ds_read_b64_tr_b16 a[128:129], v212 offset:24576
    v_mfma_f32_16x16x32_bf16 v[56:59], a[152:155], a[196:199], v[56:59]
    v_mfma_f32_16x16x32_bf16 v[88:91], a[152:155], a[200:203], v[88:91]
    ds_read_b64_tr_b16 a[130:131], v212 offset:25600
    v_mfma_f32_16x16x32_bf16 v[120:123], a[152:155], a[204:207], v[120:123]
    buffer_load_dword v226, v227, s[56:59], 0 offen offset:0 sc1
    s_waitcnt lgkmcnt(10)
    v_mfma_f32_16x16x32_bf16 v[28:31], a[156:159], a[192:195], v[28:31]
    ds_read_b64_tr_b16 a[132:133], v212 offset:24584
    v_mfma_f32_16x16x32_bf16 v[60:63], a[156:159], a[196:199], v[60:63]
    v_mfma_f32_16x16x32_bf16 v[92:95], a[156:159], a[200:203], v[92:95]
    ds_read_b64_tr_b16 a[134:135], v212 offset:25608
    v_mfma_f32_16x16x32_bf16 v[124:127], a[156:159], a[204:207], v[124:127]
    s_waitcnt lgkmcnt(10)
    v_mfma_f32_16x16x32_bf16 v[32:35], a[160:163], a[192:195], v[32:35]
    ds_read_b64_tr_b16 a[136:137], v213 offset:24576
    v_mfma_f32_16x16x32_bf16 v[64:67], a[160:163], a[196:199], v[64:67]
    v_mfma_f32_16x16x32_bf16 v[96:99], a[160:163], a[200:203], v[96:99]
    ds_read_b64_tr_b16 a[138:139], v213 offset:25600
    v_mfma_f32_16x16x32_bf16 v[128:131], a[160:163], a[204:207], v[128:131]
    s_waitcnt lgkmcnt(10)
    v_mfma_f32_16x16x32_bf16 v[36:39], a[164:167], a[192:195], v[36:39]
    ds_read_b64_tr_b16 a[140:141], v213 offset:24584
    v_mfma_f32_16x16x32_bf16 v[68:71], a[164:167], a[196:199], v[68:71]
    v_mfma_f32_16x16x32_bf16 v[100:103], a[164:167], a[200:203], v[100:103]
    ds_read_b64_tr_b16 a[142:143], v213 offset:25608
    v_mfma_f32_16x16x32_bf16 v[132:135], a[164:167], a[204:207], v[132:135]
    s_waitcnt lgkmcnt(10)
    v_mfma_f32_16x16x32_bf16 v[40:43], a[168:171], a[192:195], v[40:43]
    ds_read_b64_tr_b16 a[144:145], v214 offset:24576
    v_mfma_f32_16x16x32_bf16 v[72:75], a[168:171], a[196:199], v[72:75]
    v_mfma_f32_16x16x32_bf16 v[104:107], a[168:171], a[200:203], v[104:107]
    ds_read_b64_tr_b16 a[146:147], v214 offset:25600
    v_mfma_f32_16x16x32_bf16 v[136:139], a[168:171], a[204:207], v[136:139]
    s_waitcnt lgkmcnt(10)
    v_mfma_f32_16x16x32_bf16 v[44:47], a[172:175], a[192:195], v[44:47]
    ds_read_b64_tr_b16 a[148:149], v214 offset:24584
    v_mfma_f32_16x16x32_bf16 v[76:79], a[172:175], a[196:199], v[76:79]
    v_mfma_f32_16x16x32_bf16 v[108:111], a[172:175], a[200:203], v[108:111]
    ds_read_b64_tr_b16 a[150:151], v214 offset:25608
    v_mfma_f32_16x16x32_bf16 v[140:143], a[172:175], a[204:207], v[140:143]
    s_waitcnt lgkmcnt(10)
    v_mfma_f32_16x16x32_bf16 v[16:19], a[128:131], a[208:211], v[16:19]
    ds_read_b64_tr_b16 a[152:153], v215 offset:24576
    v_mfma_f32_16x16x32_bf16 v[48:51], a[128:131], a[212:215], v[48:51]
    v_mfma_f32_16x16x32_bf16 v[80:83], a[128:131], a[216:219], v[80:83]
    ds_read_b64_tr_b16 a[154:155], v215 offset:25600
    v_mfma_f32_16x16x32_bf16 v[112:115], a[128:131], a[220:223], v[112:115]
    v_mfma_f32_16x16x32_bf16 v[218:221], a[128:131], v[10:13], v[218:221]
    s_waitcnt lgkmcnt(10)
    v_mfma_f32_16x16x32_bf16 v[20:23], a[132:135], a[208:211], v[20:23]
    ds_read_b64_tr_b16 a[156:157], v215 offset:24584
    v_mfma_f32_16x16x32_bf16 v[52:55], a[132:135], a[212:215], v[52:55]
    v_mfma_f32_16x16x32_bf16 v[84:87], a[132:135], a[216:219], v[84:87]
    ds_read_b64_tr_b16 a[158:159], v215 offset:25608
    v_mfma_f32_16x16x32_bf16 v[116:119], a[132:135], a[220:223], v[116:119]
    v_mfma_f32_16x16x32_bf16 v[222:225], a[132:135], v[10:13], v[222:225]
    s_waitcnt lgkmcnt(10)
    v_mfma_f32_16x16x32_bf16 v[24:27], a[136:139], a[208:211], v[24:27]
    s_waitcnt vmcnt(0)
    s_cmp_lg_u32 s24, 0
    s_cbranch_scc1 L_p1_ok
    v_cmp_gt_u32 vcc, 32, v226
    s_nop 0
    s_cbranch_vccz L_p1_ok
    s_mov_b32 s66, 20000
L_p1_spin:
    buffer_load_dword v226, v227, s[56:59], 0 offen offset:0 sc1
    s_waitcnt vmcnt(0)
    v_cmp_gt_u32 vcc, 32, v226
    s_nop 0
    s_cbranch_vccz L_p1_ok
    s_sub_u32 s66, s66, 1
    s_cmp_lg_u32 s66, 0
    s_cbranch_scc1 L_p1_spin
L_p1_ok:
    s_barrier
    ds_read_b64_tr_b16 a[160:161], v212 offset:32768
    v_mfma_f32_16x16x32_bf16 v[56:59], a[136:139], a[212:215], v[56:59]
    v_mfma_f32_16x16x32_bf16 v[88:91], a[136:139], a[216:219], v[88:91]
    ds_read_b64_tr_b16 a[162:163], v212 offset:33792
    v_mfma_f32_16x16x32_bf16 v[120:123], a[136:139], a[220:223], v[120:123]
    s_waitcnt lgkmcnt(10)
    v_mfma_f32_16x16x32_bf16 v[28:31], a[140:143], a[208:211], v[28:31]
    ds_read_b64_tr_b16 a[164:165], v212 offset:32776
    v_mfma_f32_16x16x32_bf16 v[60:63], a[140:143], a[212:215], v[60:63]
    v_mfma_f32_16x16x32_bf16 v[92:95], a[140:143], a[216:219], v[92:95]
    ds_read_b64_tr_b16 a[166:167], v212 offset:33800
    v_mfma_f32_16x16x32_bf16 v[124:127], a[140:143], a[220:223], v[124:127]
    s_waitcnt lgkmcnt(10)
    v_mfma_f32_16x16x32_bf16 v[32:35], a[144:147], a[208:211], v[32:35]
    ds_read_b64_tr_b16 a[168:169], v213 offset:32768
    v_mfma_f32_16x16x32_bf16 v[64:67], a[144:147], a[212:215], v[64:67]
    v_mfma_f32_16x16x32_bf16 v[96:99], a[144:147], a[216:219], v[96:99]
    ds_read_b64_tr_b16 a[170:171], v213 offset:33792
    v_mfma_f32_16x16x32_bf16 v[128:131], a[144:147], a[220:223], v[128:131]
    v_lshrrev_b32 v0, 4, v14
    v_and_b32 v1, 15, v0
    v_and_b32 v8, 48, v0
    s_add_u32 s63, s43, 0
    s_lshl_b32 s63, s63, 4
    v_add_u32 v6, s63, v1
    v_subrev_u32 v6, 1, v6
    v_ashrrev_i32 v7, 4, v6
    v_lshlrev_b32 v7, 14, v7
    v_and_b32 v6, 15, v6
    v_add_u32 v6, v6, v8
    v_lshl_add_u32 v2, v6, 4, v7
    s_mov_b32 s64, 0
    buffer_load_dwordx4 a[0:3], v2, s[52:55], s64 offen offset:0 sc1
    s_waitcnt lgkmcnt(10)
    v_mfma_f32_16x16x32_bf16 v[36:39], a[148:151], a[208:211], v[36:39]
    ds_read_b64_tr_b16 a[172:173], v213 offset:32776
    v_mfma_f32_16x16x32_bf16 v[68:71], a[148:151], a[212:215], v[68:71]
    v_mfma_f32_16x16x32_bf16 v[100:103], a[148:151], a[216:219], v[100:103]
    ds_read_b64_tr_b16 a[174:175], v213 offset:33800
    v_mfma_f32_16x16x32_bf16 v[132:135], a[148:151], a[220:223], v[132:135]
    s_add_u32 s63, s43, 1
    s_lshl_b32 s63, s63, 4
    v_add_u32 v6, s63, v1
    v_subrev_u32 v6, 1, v6
    v_ashrrev_i32 v7, 4, v6
    v_lshlrev_b32 v7, 14, v7
    v_and_b32 v6, 15, v6
    v_add_u32 v6, v6, v8
    v_lshl_add_u32 v3, v6, 4, v7
    s_mov_b32 s64, 0
    buffer_load_dwordx4 a[4:7], v3, s[52:55], s64 offen offset:0 sc1
    s_waitcnt lgkmcnt(10)
    v_mfma_f32_16x16x32_bf16 v[40:43], a[152:155], a[208:211], v[40:43]
    ds_read_b64_tr_b16 a[128:129], v214 offset:32768
    v_mfma_f32_16x16x32_bf16 v[72:75], a[152:155], a[212:215], v[72:75]
    v_mfma_f32_16x16x32_bf16 v[104:107], a[152:155], a[216:219], v[104:107]
    ds_read_b64_tr_b16 a[130:131], v214 offset:33792
    v_mfma_f32_16x16x32_bf16 v[136:139], a[152:155], a[220:223], v[136:139]
    s_mov_b32 s64, 0
    buffer_load_dwordx4 a[8:11], v2, s[52:55], s64 offen offset:1024 sc1
    s_waitcnt lgkmcnt(10)
    v_mfma_f32_16x16x32_bf16 v[44:47], a[156:159], a[208:211], v[44:47]
    ds_read_b64_tr_b16 a[132:133], v214 offset:32776
    v_mfma_f32_16x16x32_bf16 v[76:79], a[156:159], a[212:215], v[76:79]
    v_mfma_f32_16x16x32_bf16 v[108:111], a[156:159], a[216:219], v[108:111]
    ds_read_b64_tr_b16 a[134:135], v214 offset:33800
    v_mfma_f32_16x16x32_bf16 v[140:143], a[156:159], a[220:223], v[140:143]
    s_mov_b32 s64, 0
    buffer_load_dwordx4 a[12:15], v3, s[52:55], s64 offen offset:1024 sc1
    s_waitcnt lgkmcnt(10)
    v_mfma_f32_16x16x32_bf16 v[16:19], a[160:163], a[224:227], v[16:19]
    ds_read_b64_tr_b16 a[136:137], v215 offset:32768
    v_mfma_f32_16x16x32_bf16 v[48:51], a[160:163], a[228:231], v[48:51]
    v_mfma_f32_16x16x32_bf16 v[80:83], a[160:163], a[232:235], v[80:83]
    ds_read_b64_tr_b16 a[138:139], v215 offset:33792
    v_mfma_f32_16x16x32_bf16 v[112:115], a[160:163], a[236:239], v[112:115]
    v_mfma_f32_16x16x32_bf16 v[218:221], a[160:163], v[10:13], v[218:221]
    s_waitcnt lgkmcnt(10)
    v_mfma_f32_16x16x32_bf16 v[20:23], a[164:167], a[224:227], v[20:23]
    ds_read_b64_tr_b16 a[140:141], v215 offset:32776
    v_mfma_f32_16x16x32_bf16 v[52:55], a[164:167], a[228:231], v[52:55]
    v_mfma_f32_16x16x32_bf16 v[84:87], a[164:167], a[232:235], v[84:87]
    ds_read_b64_tr_b16 a[142:143], v215 offset:33800
    v_mfma_f32_16x16x32_bf16 v[116:119], a[164:167], a[236:239], v[116:119]
    s_mov_b32 s64, 0
    buffer_load_dwordx4 a[16:19], v2, s[52:55], s64 offen offset:2048 sc1
    v_mfma_f32_16x16x32_bf16 v[222:225], a[164:167], v[10:13], v[222:225]
    s_waitcnt lgkmcnt(10)
    v_mfma_f32_16x16x32_bf16 v[24:27], a[168:171], a[224:227], v[24:27]
    ds_read_b64_tr_b16 a[144:145], v212 offset:40960
    v_mfma_f32_16x16x32_bf16 v[56:59], a[168:171], a[228:231], v[56:59]
    v_mfma_f32_16x16x32_bf16 v[88:91], a[168:171], a[232:235], v[88:91]
    ds_read_b64_tr_b16 a[146:147], v212 offset:41984
    v_mfma_f32_16x16x32_bf16 v[120:123], a[168:171], a[236:239], v[120:123]
    s_mov_b32 s64, 0
    buffer_load_dwordx4 a[20:23], v3, s[52:55], s64 offen offset:2048 sc1
    s_waitcnt lgkmcnt(10)
    v_mfma_f32_16x16x32_bf16 v[28:31], a[172:175], a[224:227], v[28:31]
    ds_read_b64_tr_b16 a[148:149], v212 offset:40968
    v_mfma_f32_16x16x32_bf16 v[60:63], a[172:175], a[228:231], v[60:63]
    v_mfma_f32_16x16x32_bf16 v[92:95], a[172:175], a[232:235], v[92:95]
    ds_read_b64_tr_b16 a[150:151], v212 offset:41992
    v_mfma_f32_16x16x32_bf16 v[124:127], a[172:175], a[236:239], v[124:127]
    s_mov_b32 s64, 0
    buffer_load_dwordx4 a[24:27], v2, s[52:55], s64 offen offset:3072 sc1
    s_waitcnt lgkmcnt(10)
    v_mfma_f32_16x16x32_bf16 v[32:35], a[128:131], a[224:227], v[32:35]
    ds_read_b64_tr_b16 a[152:153], v213 offset:40960
    v_mfma_f32_16x16x32_bf16 v[64:67], a[128:131], a[228:231], v[64:67]
    v_mfma_f32_16x16x32_bf16 v[96:99], a[128:131], a[232:235], v[96:99]
    ds_read_b64_tr_b16 a[154:155], v213 offset:41984
    v_mfma_f32_16x16x32_bf16 v[128:131], a[128:131], a[236:239], v[128:131]
    s_waitcnt lgkmcnt(10)
    v_mfma_f32_16x16x32_bf16 v[36:39], a[132:135], a[224:227], v[36:39]
    ds_read_b64_tr_b16 a[156:157], v213 offset:40968
    v_mfma_f32_16x16x32_bf16 v[68:71], a[132:135], a[228:231], v[68:71]
    v_mfma_f32_16x16x32_bf16 v[100:103], a[132:135], a[232:235], v[100:103]
    ds_read_b64_tr_b16 a[158:159], v213 offset:41992
    v_mfma_f32_16x16x32_bf16 v[132:135], a[132:135], a[236:239], v[132:135]
    s_mov_b32 s64, 0
    buffer_load_dwordx4 a[28:31], v3, s[52:55], s64 offen offset:3072 sc1
    s_waitcnt lgkmcnt(10)
    v_mfma_f32_16x16x32_bf16 v[40:43], a[136:139], a[224:227], v[40:43]
    ds_read_b64_tr_b16 a[160:161], v214 offset:40960
    v_mfma_f32_16x16x32_bf16 v[72:75], a[136:139], a[228:231], v[72:75]
    v_mfma_f32_16x16x32_bf16 v[104:107], a[136:139], a[232:235], v[104:107]
    ds_read_b64_tr_b16 a[162:163], v214 offset:41984
    v_mfma_f32_16x16x32_bf16 v[136:139], a[136:139], a[236:239], v[136:139]
    s_add_u32 s63, s43, 0
    s_lshl_b32 s63, s63, 4
    v_add_u32 v6, s63, v1
    v_add_u32 v6, 1, v6
    v_ashrrev_i32 v7, 4, v6
    v_lshlrev_b32 v7, 14, v7
    v_and_b32 v6, 15, v6
    v_add_u32 v6, v6, v8
    v_lshl_add_u32 v4, v6, 4, v7
    s_mov_b32 s64, 4096
    buffer_load_dwordx4 a[32:35], v4, s[52:55], s64 offen offset:0 sc1
    s_waitcnt lgkmcnt(10)
    v_mfma_f32_16x16x32_bf16 v[44:47], a[140:143], a[224:227], v[44:47]
    ds_read_b64_tr_b16 a[164:165], v214 offset:40968
    v_mfma_f32_16x16x32_bf16 v[76:79], a[140:143], a[228:231], v[76:79]
    v_mfma_f32_16x16x32_bf16 v[108:111], a[140:143], a[232:235], v[108:111]
    ds_read_b64_tr_b16 a[166:167], v214 offset:41992
    v_mfma_f32_16x16x32_bf16 v[140:143], a[140:143], a[236:239], v[140:143]
    s_add_u32 s63, s43, 1
    s_lshl_b32 s63, s63, 4
    v_add_u32 v6, s63, v1
    v_add_u32 v6, 1, v6
    v_ashrrev_i32 v7, 4, v6
    v_lshlrev_b32 v7, 14, v7
    v_and_b32 v6, 15, v6
    v_add_u32 v6, v6, v8
    v_lshl_add_u32 v5, v6, 4, v7
    s_mov_b32 s64, 4096
    buffer_load_dwordx4 a[36:39], v5, s[52:55], s64 offen offset:0 sc1
    s_waitcnt lgkmcnt(10)
    v_mfma_f32_16x16x32_bf16 v[16:19], a[144:147], a[240:243], v[16:19]
    ds_read_b64_tr_b16 a[168:169], v215 offset:40960
    v_mfma_f32_16x16x32_bf16 v[48:51], a[144:147], a[244:247], v[48:51]
    v_mfma_f32_16x16x32_bf16 v[80:83], a[144:147], a[248:251], v[80:83]
    ds_read_b64_tr_b16 a[170:171], v215 offset:41984
    v_mfma_f32_16x16x32_bf16 v[112:115], a[144:147], a[252:255], v[112:115]
    v_mfma_f32_16x16x32_bf16 v[218:221], a[144:147], v[10:13], v[218:221]
    s_waitcnt lgkmcnt(10)
    v_mfma_f32_16x16x32_bf16 v[20:23], a[148:151], a[240:243], v[20:23]
    ds_read_b64_tr_b16 a[172:173], v215 offset:40968
    v_mfma_f32_16x16x32_bf16 v[52:55], a[148:151], a[244:247], v[52:55]
    v_mfma_f32_16x16x32_bf16 v[84:87], a[148:151], a[248:251], v[84:87]
    ds_read_b64_tr_b16 a[174:175], v215 offset:41992
    v_mfma_f32_16x16x32_bf16 v[116:119], a[148:151], a[252:255], v[116:119]
    s_mov_b32 s64, 4096
    buffer_load_dwordx4 a[40:43], v4, s[52:55], s64 offen offset:1024 sc1
    v_mfma_f32_16x16x32_bf16 v[222:225], a[148:151], v[10:13], v[222:225]
    s_waitcnt lgkmcnt(10)
    v_mfma_f32_16x16x32_bf16 v[24:27], a[152:155], a[240:243], v[24:27]
    s_barrier
    ds_read_b64_tr_b16 a[128:129], v208 offset:49152
    v_mfma_f32_16x16x32_bf16 v[56:59], a[152:155], a[244:247], v[56:59]
    v_mfma_f32_16x16x32_bf16 v[88:91], a[152:155], a[248:251], v[88:91]
    ds_read_b64_tr_b16 a[130:131], v208 offset:50176
    v_mfma_f32_16x16x32_bf16 v[120:123], a[152:155], a[252:255], v[120:123]
    s_mov_b32 s64, 4096
    buffer_load_dwordx4 a[44:47], v5, s[52:55], s64 offen offset:1024 sc1
    s_waitcnt lgkmcnt(10)
    v_mfma_f32_16x16x32_bf16 v[28:31], a[156:159], a[240:243], v[28:31]
    ds_read_b64_tr_b16 a[132:133], v208 offset:49160
    v_mfma_f32_16x16x32_bf16 v[60:63], a[156:159], a[244:247], v[60:63]
    v_mfma_f32_16x16x32_bf16 v[92:95], a[156:159], a[248:251], v[92:95]
    ds_read_b64_tr_b16 a[134:135], v208 offset:50184
    v_mfma_f32_16x16x32_bf16 v[124:127], a[156:159], a[252:255], v[124:127]
    s_mov_b32 s64, 4096
    buffer_load_dwordx4 a[48:51], v4, s[52:55], s64 offen offset:2048 sc1
    s_waitcnt lgkmcnt(10)
    v_mfma_f32_16x16x32_bf16 v[32:35], a[160:163], a[240:243], v[32:35]
    ds_read_b64_tr_b16 a[136:137], v209 offset:49152
    v_mfma_f32_16x16x32_bf16 v[64:67], a[160:163], a[244:247], v[64:67]
    v_mfma_f32_16x16x32_bf16 v[96:99], a[160:163], a[248:251], v[96:99]
    ds_read_b64_tr_b16 a[138:139], v209 offset:50176
    v_mfma_f32_16x16x32_bf16 v[128:131], a[160:163], a[252:255], v[128:131]
    s_mov_b32 s64, 4096
    buffer_load_dwordx4 a[52:55], v5, s[52:55], s64 offen offset:2048 sc1
    s_waitcnt lgkmcnt(10)
    v_mfma_f32_16x16x32_bf16 v[36:39], a[164:167], a[240:243], v[36:39]
    ds_read_b64_tr_b16 a[140:141], v209 offset:49160
    v_mfma_f32_16x16x32_bf16 v[68:71], a[164:167], a[244:247], v[68:71]
    v_mfma_f32_16x16x32_bf16 v[100:103], a[164:167], a[248:251], v[100:103]
    ds_read_b64_tr_b16 a[142:143], v209 offset:50184
    v_mfma_f32_16x16x32_bf16 v[132:135], a[164:167], a[252:255], v[132:135]
    s_waitcnt lgkmcnt(10)
    v_mfma_f32_16x16x32_bf16 v[40:43], a[168:171], a[240:243], v[40:43]
    ds_read_b64_tr_b16 a[144:145], v210 offset:49152
    v_mfma_f32_16x16x32_bf16 v[72:75], a[168:171], a[244:247], v[72:75]
    v_mfma_f32_16x16x32_bf16 v[104:107], a[168:171], a[248:251], v[104:107]
    ds_read_b64_tr_b16 a[146:147], v210 offset:50176
    v_mfma_f32_16x16x32_bf16 v[136:139], a[168:171], a[252:255], v[136:139]
    s_mov_b32 s64, 4096
    buffer_load_dwordx4 a[56:59], v4, s[52:55], s64 offen offset:3072 sc1
    s_waitcnt lgkmcnt(10)
    v_mfma_f32_16x16x32_bf16 v[44:47], a[172:175], a[240:243], v[44:47]
    ds_read_b64_tr_b16 a[148:149], v210 offset:49160
    v_mfma_f32_16x16x32_bf16 v[76:79], a[172:175], a[244:247], v[76:79]
    v_mfma_f32_16x16x32_bf16 v[108:111], a[172:175], a[248:251], v[108:111]
    ds_read_b64_tr_b16 a[150:151], v210 offset:50184
    v_mfma_f32_16x16x32_bf16 v[140:143], a[172:175], a[252:255], v[140:143]
    s_mov_b32 s64, 4096
    buffer_load_dwordx4 a[60:63], v5, s[52:55], s64 offen offset:3072 sc1
    s_waitcnt lgkmcnt(10)
    v_mfma_f32_16x16x32_bf16 v[16:19], a[128:131], v[144:147], v[16:19]
    ds_read_b64_tr_b16 a[152:153], v211 offset:49152
    v_mfma_f32_16x16x32_bf16 v[48:51], a[128:131], v[148:151], v[48:51]
    v_mfma_f32_16x16x32_bf16 v[80:83], a[128:131], v[152:155], v[80:83]
    ds_read_b64_tr_b16 a[154:155], v211 offset:50176
    v_mfma_f32_16x16x32_bf16 v[112:115], a[128:131], v[156:159], v[112:115]
    s_add_u32 s63, s43, 0
    s_lshl_b32 s63, s63, 4
    v_add_u32 v6, s63, v1
    v_subrev_u32 v6, 2, v6
    v_ashrrev_i32 v7, 4, v6
    v_lshlrev_b32 v7, 14, v7
    v_and_b32 v6, 15, v6
    v_add_u32 v6, v6, v8
    v_lshl_add_u32 v2, v6, 4, v7
    s_mov_b32 s64, 8192
    buffer_load_dwordx4 a[64:67], v2, s[52:55], s64 offen offset:0 sc1
    v_mfma_f32_16x16x32_bf16 v[218:221], a[128:131], v[10:13], v[218:221]
    s_waitcnt lgkmcnt(10)
    v_mfma_f32_16x16x32_bf16 v[20:23], a[132:135], v[144:147], v[20:23]
    ds_read_b64_tr_b16 a[156:157], v211 offset:49160
    v_mfma_f32_16x16x32_bf16 v[52:55], a[132:135], v[148:151], v[52:55]
    v_mfma_f32_16x16x32_bf16 v[84:87], a[132:135], v[152:155], v[84:87]
    ds_read_b64_tr_b16 a[158:159], v211 offset:50184
    v_mfma_f32_16x16x32_bf16 v[116:119], a[132:135], v[156:159], v[116:119]
    v_mfma_f32_16x16x32_bf16 v[222:225], a[132:135], v[10:13], v[222:225]
    s_waitcnt lgkmcnt(10)
    v_mfma_f32_16x16x32_bf16 v[24:27], a[136:139], v[144:147], v[24:27]
    ds_read_b64_tr_b16 a[160:161], v208 offset:57344
    v_mfma_f32_16x16x32_bf16 v[56:59], a[136:139], v[148:151], v[56:59]
    v_mfma_f32_16x16x32_bf16 v[88:91], a[136:139], v[152:155], v[88:91]
    ds_read_b64_tr_b16 a[162:163], v208 offset:58368
    v_mfma_f32_16x16x32_bf16 v[120:123], a[136:139], v[156:159], v[120:123]
    s_add_u32 s63, s43, 1
    s_lshl_b32 s63, s63, 4
    v_add_u32 v6, s63, v1
    v_subrev_u32 v6, 2, v6
    v_ashrrev_i32 v7, 4, v6
    v_lshlrev_b32 v7, 14, v7
    v_and_b32 v6, 15, v6
    v_add_u32 v6, v6, v8
    v_lshl_add_u32 v3, v6, 4, v7
    s_mov_b32 s64, 8192
    buffer_load_dwordx4 a[68:71], v3, s[52:55], s64 offen offset:0 sc1
    s_waitcnt lgkmcnt(10)
    v_mfma_f32_16x16x32_bf16 v[28:31], a[140:143], v[144:147], v[28:31]
    ds_read_b64_tr_b16 a[164:165], v208 offset:57352
    v_mfma_f32_16x16x32_bf16 v[60:63], a[140:143], v[148:151], v[60:63]
    v_mfma_f32_16x16x32_bf16 v[92:95], a[140:143], v[152:155], v[92:95]
    ds_read_b64_tr_b16 a[166:167], v208 offset:58376
    v_mfma_f32_16x16x32_bf16 v[124:127], a[140:143], v[156:159], v[124:127]
    s_mov_b32 s64, 8192
    buffer_load_dwordx4 a[72:75], v2, s[52:55], s64 offen offset:1024 sc1
    s_waitcnt lgkmcnt(10)
    v_mfma_f32_16x16x32_bf16 v[32:35], a[144:147], v[144:147], v[32:35]
    ds_read_b64_tr_b16 a[168:169], v209 offset:57344
    v_mfma_f32_16x16x32_bf16 v[64:67], a[144:147], v[148:151], v[64:67]
    v_mfma_f32_16x16x32_bf16 v[96:99], a[144:147], v[152:155], v[96:99]
    ds_read_b64_tr_b16 a[170:171], v209 offset:58368
    v_mfma_f32_16x16x32_bf16 v[128:131], a[144:147], v[156:159], v[128:131]
    s_mov_b32 s64, 8192
    buffer_load_dwordx4 a[76:79], v3, s[52:55], s64 offen offset:1024 sc1
    s_waitcnt lgkmcnt(10)
    v_mfma_f32_16x16x32_bf16 v[36:39], a[148:151], v[144:147], v[36:39]
    ds_read_b64_tr_b16 a[172:173], v209 offset:57352
    v_mfma_f32_16x16x32_bf16 v[68:71], a[148:151], v[148:151], v[68:71]
    v_mfma_f32_16x16x32_bf16 v[100:103], a[148:151], v[152:155], v[100:103]
    ds_read_b64_tr_b16 a[174:175], v209 offset:58376
    v_mfma_f32_16x16x32_bf16 v[132:135], a[148:151], v[156:159], v[132:135]
    s_waitcnt lgkmcnt(10)
    v_mfma_f32_16x16x32_bf16 v[40:43], a[152:155], v[144:147], v[40:43]
    ds_read_b64_tr_b16 a[128:129], v210 offset:57344
    v_mfma_f32_16x16x32_bf16 v[72:75], a[152:155], v[148:151], v[72:75]
    v_mfma_f32_16x16x32_bf16 v[104:107], a[152:155], v[152:155], v[104:107]
    ds_read_b64_tr_b16 a[130:131], v210 offset:58368
    v_mfma_f32_16x16x32_bf16 v[136:139], a[152:155], v[156:159], v[136:139]
    s_mov_b32 s64, 8192
    buffer_load_dwordx4 a[80:83], v2, s[52:55], s64 offen offset:2048 sc1
    s_waitcnt lgkmcnt(10)
    v_mfma_f32_16x16x32_bf16 v[44:47], a[156:159], v[144:147], v[44:47]
    ds_read_b64_tr_b16 a[132:133], v210 offset:57352
    v_mfma_f32_16x16x32_bf16 v[76:79], a[156:159], v[148:151], v[76:79]
    v_mfma_f32_16x16x32_bf16 v[108:111], a[156:159], v[152:155], v[108:111]
    ds_read_b64_tr_b16 a[134:135], v210 offset:58376
    v_mfma_f32_16x16x32_bf16 v[140:143], a[156:159], v[156:159], v[140:143]
    s_mov_b32 s64, 8192
    buffer_load_dwordx4 a[84:87], v3, s[52:55], s64 offen offset:2048 sc1
    s_waitcnt lgkmcnt(10)
    v_mfma_f32_16x16x32_bf16 v[16:19], a[160:163], v[160:163], v[16:19]
    ds_read_b64_tr_b16 a[136:137], v211 offset:57344
    v_mfma_f32_16x16x32_bf16 v[48:51], a[160:163], v[164:167], v[48:51]
    v_mfma_f32_16x16x32_bf16 v[80:83], a[160:163], v[168:171], v[80:83]
    ds_read_b64_tr_b16 a[138:139], v211 offset:58368
    v_mfma_f32_16x16x32_bf16 v[112:115], a[160:163], v[172:175], v[112:115]
    s_mov_b32 s64, 8192
    buffer_load_dwordx4 a[88:91], v2, s[52:55], s64 offen offset:3072 sc1
    v_mfma_f32_16x16x32_bf16 v[218:221], a[160:163], v[10:13], v[218:221]
    s_waitcnt lgkmcnt(10)
    v_mfma_f32_16x16x32_bf16 v[20:23], a[164:167], v[160:163], v[20:23]
    ds_read_b64_tr_b16 a[140:141], v211 offset:57352
    v_mfma_f32_16x16x32_bf16 v[52:55], a[164:167], v[164:167], v[52:55]
    v_mfma_f32_16x16x32_bf16 v[84:87], a[164:167], v[168:171], v[84:87]
    ds_read_b64_tr_b16 a[142:143], v211 offset:58376
    v_mfma_f32_16x16x32_bf16 v[116:119], a[164:167], v[172:175], v[116:119]
    s_mov_b32 s64, 8192
    buffer_load_dwordx4 a[92:95], v3, s[52:55], s64 offen offset:3072 sc1
    v_mfma_f32_16x16x32_bf16 v[222:225], a[164:167], v[10:13], v[222:225]
    s_waitcnt lgkmcnt(10)
    v_mfma_f32_16x16x32_bf16 v[24:27], a[168:171], v[160:163], v[24:27]
    s_barrier
    ds_read_b64_tr_b16 a[144:145], v212 offset:49152
    v_mfma_f32_16x16x32_bf16 v[56:59], a[168:171], v[164:167], v[56:59]
    v_mfma_f32_16x16x32_bf16 v[88:91], a[168:171], v[168:171], v[88:91]
    ds_read_b64_tr_b16 a[146:147], v212 offset:50176
    v_mfma_f32_16x16x32_bf16 v[120:123], a[168:171], v[172:175], v[120:123]
    s_waitcnt lgkmcnt(10)
    v_mfma_f32_16x16x32_bf16 v[28:31], a[172:175], v[160:163], v[28:31]
    ds_read_b64_tr_b16 a[148:149], v212 offset:49160
    v_mfma_f32_16x16x32_bf16 v[60:63], a[172:175], v[164:167], v[60:63]
    v_mfma_f32_16x16x32_bf16 v[92:95], a[172:175], v[168:171], v[92:95]
    ds_read_b64_tr_b16 a[150:151], v212 offset:50184
    v_mfma_f32_16x16x32_bf16 v[124:127], a[172:175], v[172:175], v[124:127]
    s_add_u32 s63, s43, 0
    s_lshl_b32 s63, s63, 4
    v_add_u32 v6, s63, v1
    v_add_u32 v6, 2, v6
    v_ashrrev_i32 v7, 4, v6
    v_lshlrev_b32 v7, 14, v7
    v_and_b32 v6, 15, v6
    v_add_u32 v6, v6, v8
    v_lshl_add_u32 v4, v6, 4, v7
    s_mov_b32 s64, 12288
    buffer_load_dwordx4 a[96:99], v4, s[52:55], s64 offen offset:0 sc1
    s_waitcnt lgkmcnt(10)
    v_mfma_f32_16x16x32_bf16 v[32:35], a[128:131], v[160:163], v[32:35]
    ds_read_b64_tr_b16 a[152:153], v213 offset:49152
    v_mfma_f32_16x16x32_bf16 v[64:67], a[128:131], v[164:167], v[64:67]
    v_mfma_f32_16x16x32_bf16 v[96:99], a[128:131], v[168:171], v[96:99]
    ds_read_b64_tr_b16 a[154:155], v213 offset:50176
    v_mfma_f32_16x16x32_bf16 v[128:131], a[128:131], v[172:175], v[128:131]
    s_add_u32 s63, s43, 1
    s_lshl_b32 s63, s63, 4
    v_add_u32 v6, s63, v1
    v_add_u32 v6, 2, v6
    v_ashrrev_i32 v7, 4, v6
    v_lshlrev_b32 v7, 14, v7
    v_and_b32 v6, 15, v6
    v_add_u32 v6, v6, v8
    v_lshl_add_u32 v5, v6, 4, v7
    s_mov_b32 s64, 12288
    buffer_load_dwordx4 a[100:103], v5, s[52:55], s64 offen offset:0 sc1
    s_waitcnt lgkmcnt(10)
    v_mfma_f32_16x16x32_bf16 v[36:39], a[132:135], v[160:163], v[36:39]
    ds_read_b64_tr_b16 a[156:157], v213 offset:49160
    v_mfma_f32_16x16x32_bf16 v[68:71], a[132:135], v[164:167], v[68:71]
    v_mfma_f32_16x16x32_bf16 v[100:103], a[132:135], v[168:171], v[100:103]
    ds_read_b64_tr_b16 a[158:159], v213 offset:50184
    v_mfma_f32_16x16x32_bf16 v[132:135], a[132:135], v[172:175], v[132:135]
    s_mov_b32 s64, 12288
    buffer_load_dwordx4 a[104:107], v4, s[52:55], s64 offen offset:1024 sc1
    s_waitcnt lgkmcnt(10)
    v_mfma_f32_16x16x32_bf16 v[40:43], a[136:139], v[160:163], v[40:43]
    ds_read_b64_tr_b16 a[160:161], v214 offset:49152
    v_mfma_f32_16x16x32_bf16 v[72:75], a[136:139], v[164:167], v[72:75]
    v_mfma_f32_16x16x32_bf16 v[104:107], a[136:139], v[168:171], v[104:107]
    ds_read_b64_tr_b16 a[162:163], v214 offset:50176
    v_mfma_f32_16x16x32_bf16 v[136:139], a[136:139], v[172:175], v[136:139]
    s_waitcnt lgkmcnt(10)
    v_mfma_f32_16x16x32_bf16 v[44:47], a[140:143], v[160:163], v[44:47]
    ds_read_b64_tr_b16 a[164:165], v214 offset:49160
    v_mfma_f32_16x16x32_bf16 v[76:79], a[140:143], v[164:167], v[76:79]
    v_mfma_f32_16x16x32_bf16 v[108:111], a[140:143], v[168:171], v[108:111]
    ds_read_b64_tr_b16 a[166:167], v214 offset:50184
    v_mfma_f32_16x16x32_bf16 v[140:143], a[140:143], v[172:175], v[140:143]
    s_mov_b32 s64, 12288
    buffer_load_dwordx4 a[108:111], v5, s[52:55], s64 offen offset:1024 sc1
    s_waitcnt lgkmcnt(10)
    v_mfma_f32_16x16x32_bf16 v[16:19], a[144:147], v[176:179], v[16:19]
    ds_read_b64_tr_b16 a[168:169], v215 offset:49152
    v_mfma_f32_16x16x32_bf16 v[48:51], a[144:147], v[180:183], v[48:51]
    v_mfma_f32_16x16x32_bf16 v[80:83], a[144:147], v[184:187], v[80:83]
    ds_read_b64_tr_b16 a[170:171], v215 offset:50176
    v_mfma_f32_16x16x32_bf16 v[112:115], a[144:147], v[188:191], v[112:115]
    s_mov_b32 s64, 12288
    buffer_load_dwordx4 a[112:115], v4, s[52:55], s64 offen offset:2048 sc1
    v_mfma_f32_16x16x32_bf16 v[218:221], a[144:147], v[10:13], v[218:221]
    s_waitcnt lgkmcnt(10)
    v_mfma_f32_16x16x32_bf16 v[20:23], a[148:151], v[176:179], v[20:23]
    ds_read_b64_tr_b16 a[172:173], v215 offset:49160
    v_mfma_f32_16x16x32_bf16 v[52:55], a[148:151], v[180:183], v[52:55]
    v_mfma_f32_16x16x32_bf16 v[84:87], a[148:151], v[184:187], v[84:87]
    ds_read_b64_tr_b16 a[174:175], v215 offset:50184
    v_mfma_f32_16x16x32_bf16 v[116:119], a[148:151], v[188:191], v[116:119]
    s_mov_b32 s64, 12288
    buffer_load_dwordx4 a[116:119], v5, s[52:55], s64 offen offset:2048 sc1
    v_mfma_f32_16x16x32_bf16 v[222:225], a[148:151], v[10:13], v[222:225]
    s_waitcnt lgkmcnt(10)
    v_mfma_f32_16x16x32_bf16 v[24:27], a[152:155], v[176:179], v[24:27]
    ds_read_b64_tr_b16 a[128:129], v212 offset:57344
    v_mfma_f32_16x16x32_bf16 v[56:59], a[152:155], v[180:183], v[56:59]
    v_mfma_f32_16x16x32_bf16 v[88:91], a[152:155], v[184:187], v[88:91]
    ds_read_b64_tr_b16 a[130:131], v212 offset:58368
    v_mfma_f32_16x16x32_bf16 v[120:123], a[152:155], v[188:191], v[120:123]
    s_waitcnt lgkmcnt(10)
    v_mfma_f32_16x16x32_bf16 v[28:31], a[156:159], v[176:179], v[28:31]
    ds_read_b64_tr_b16 a[132:133], v212 offset:57352
    v_mfma_f32_16x16x32_bf16 v[60:63], a[156:159], v[180:183], v[60:63]
    v_mfma_f32_16x16x32_bf16 v[92:95], a[156:159], v[184:187], v[92:95]
    ds_read_b64_tr_b16 a[134:135], v212 offset:58376
    v_mfma_f32_16x16x32_bf16 v[124:127], a[156:159], v[188:191], v[124:127]
    s_mov_b32 s64, 12288
    buffer_load_dwordx4 a[120:123], v4, s[52:55], s64 offen offset:3072 sc1
    s_waitcnt lgkmcnt(10)
    v_mfma_f32_16x16x32_bf16 v[32:35], a[160:163], v[176:179], v[32:35]
    ds_read_b64_tr_b16 a[136:137], v213 offset:57344
    v_mfma_f32_16x16x32_bf16 v[64:67], a[160:163], v[180:183], v[64:67]
    v_mfma_f32_16x16x32_bf16 v[96:99], a[160:163], v[184:187], v[96:99]
    ds_read_b64_tr_b16 a[138:139], v213 offset:58368
    v_mfma_f32_16x16x32_bf16 v[128:131], a[160:163], v[188:191], v[128:131]
    s_mov_b32 s64, 12288
    buffer_load_dwordx4 a[124:127], v5, s[52:55], s64 offen offset:3072 sc1
    s_waitcnt lgkmcnt(10)
    v_mfma_f32_16x16x32_bf16 v[36:39], a[164:167], v[176:179], v[36:39]
    ds_read_b64_tr_b16 a[140:141], v213 offset:57352
    v_mfma_f32_16x16x32_bf16 v[68:71], a[164:167], v[180:183], v[68:71]
    v_mfma_f32_16x16x32_bf16 v[100:103], a[164:167], v[184:187], v[100:103]
    ds_read_b64_tr_b16 a[142:143], v213 offset:58376
    v_mfma_f32_16x16x32_bf16 v[132:135], a[164:167], v[188:191], v[132:135]
    v_lshlrev_b32 v6, 10, v1
    v_lshrrev_b32 v7, 1, v8
    v_add_u32 v0, v6, v7
    s_lshl_b32 s63, s42, 6
    s_add_u32 s63, s63, s61
    buffer_load_dwordx2 v[2:3], v0, s[16:19], s63 offen offset:0
    s_waitcnt lgkmcnt(10)
    v_mfma_f32_16x16x32_bf16 v[40:43], a[168:171], v[176:179], v[40:43]
    ds_read_b64_tr_b16 a[144:145], v214 offset:57344
    v_mfma_f32_16x16x32_bf16 v[72:75], a[168:171], v[180:183], v[72:75]
    v_mfma_f32_16x16x32_bf16 v[104:107], a[168:171], v[184:187], v[104:107]
    ds_read_b64_tr_b16 a[146:147], v214 offset:58368
    v_mfma_f32_16x16x32_bf16 v[136:139], a[168:171], v[188:191], v[136:139]
    s_lshl_b32 s63, s42, 6
    s_add_u32 s63, s63, s61
    buffer_load_dwordx2 v[4:5], v0, s[16:19], s63 offen offset:32
    s_waitcnt lgkmcnt(10)
    v_mfma_f32_16x16x32_bf16 v[44:47], a[172:175], v[176:179], v[44:47]
    ds_read_b64_tr_b16 a[148:149], v214 offset:57352
    v_mfma_f32_16x16x32_bf16 v[76:79], a[172:175], v[180:183], v[76:79]
    v_mfma_f32_16x16x32_bf16 v[108:111], a[172:175], v[184:187], v[108:111]
    ds_read_b64_tr_b16 a[150:151], v214 offset:58376
    v_mfma_f32_16x16x32_bf16 v[140:143], a[172:175], v[188:191], v[140:143]
    s_waitcnt lgkmcnt(10)
    v_mfma_f32_16x16x32_bf16 v[16:19], a[128:131], v[192:195], v[16:19]
    ds_read_b64_tr_b16 a[152:153], v215 offset:57344
    v_mfma_f32_16x16x32_bf16 v[48:51], a[128:131], v[196:199], v[48:51]
    v_mfma_f32_16x16x32_bf16 v[80:83], a[128:131], v[200:203], v[80:83]
    ds_read_b64_tr_b16 a[154:155], v215 offset:58368
    v_mfma_f32_16x16x32_bf16 v[112:115], a[128:131], v[204:207], v[112:115]
    s_lshl_b32 s63, s42, 6
    s_add_u32 s63, s63, s61
    s_add_u32 s63, s63, 16384
    buffer_load_dwordx2 v[6:7], v0, s[16:19], s63 offen offset:0
    v_mfma_f32_16x16x32_bf16 v[218:221], a[128:131], v[10:13], v[218:221]
    s_waitcnt lgkmcnt(10)
    v_mfma_f32_16x16x32_bf16 v[20:23], a[132:135], v[192:195], v[20:23]
    ds_read_b64_tr_b16 a[156:157], v215 offset:57352
    v_mfma_f32_16x16x32_bf16 v[52:55], a[132:135], v[196:199], v[52:55]
    v_mfma_f32_16x16x32_bf16 v[84:87], a[132:135], v[200:203], v[84:87]
    ds_read_b64_tr_b16 a[158:159], v215 offset:58376
    v_mfma_f32_16x16x32_bf16 v[116:119], a[132:135], v[204:207], v[116:119]
    s_lshl_b32 s63, s42, 6
    s_add_u32 s63, s63, s61
    s_add_u32 s63, s63, 16384
    buffer_load_dwordx2 v[8:9], v0, s[16:19], s63 offen offset:32
    v_mfma_f32_16x16x32_bf16 v[222:225], a[132:135], v[10:13], v[222:225]
    s_waitcnt lgkmcnt(10)
    v_mfma_f32_16x16x32_bf16 v[24:27], a[136:139], v[192:195], v[24:27]
    v_mfma_f32_16x16x32_bf16 v[56:59], a[136:139], v[196:199], v[56:59]
    v_mfma_f32_16x16x32_bf16 v[88:91], a[136:139], v[200:203], v[88:91]
    v_mfma_f32_16x16x32_bf16 v[120:123], a[136:139], v[204:207], v[120:123]
    v_lshlrev_b32 v1, 3, v1
    s_lshl_b32 s63, s60, 7
    s_add_u32 s63, s63, 37224448
    buffer_load_dwordx2 a[176:177], v1, s[20:23], s63 offen offset:0 sc1
    s_waitcnt lgkmcnt(8)
    v_mfma_f32_16x16x32_bf16 v[28:31], a[140:143], v[192:195], v[28:31]
    v_mfma_f32_16x16x32_bf16 v[60:63], a[140:143], v[196:199], v[60:63]
    v_mfma_f32_16x16x32_bf16 v[92:95], a[140:143], v[200:203], v[92:95]
    v_mfma_f32_16x16x32_bf16 v[124:127], a[140:143], v[204:207], v[124:127]
    s_waitcnt lgkmcnt(6)
    v_mfma_f32_16x16x32_bf16 v[32:35], a[144:147], v[192:195], v[32:35]
    v_mfma_f32_16x16x32_bf16 v[64:67], a[144:147], v[196:199], v[64:67]
    v_mfma_f32_16x16x32_bf16 v[96:99], a[144:147], v[200:203], v[96:99]
    v_mfma_f32_16x16x32_bf16 v[128:131], a[144:147], v[204:207], v[128:131]
    s_lshl_b32 s63, s60, 7
    s_add_u32 s63, s63, 37224448
    buffer_load_dwordx2 a[178:179], v1, s[20:23], s63 offen offset:128 sc1
    s_waitcnt lgkmcnt(4)
    v_mfma_f32_16x16x32_bf16 v[36:39], a[148:151], v[192:195], v[36:39]
    v_mfma_f32_16x16x32_bf16 v[68:71], a[148:151], v[196:199], v[68:71]
    v_mfma_f32_16x16x32_bf16 v[100:103], a[148:151], v[200:203], v[100:103]
    v_mfma_f32_16x16x32_bf16 v[132:135], a[148:151], v[204:207], v[132:135]
    s_waitcnt lgkmcnt(2)
    v_mfma_f32_16x16x32_bf16 v[40:43], a[152:155], v[192:195], v[40:43]
    v_mfma_f32_16x16x32_bf16 v[72:75], a[152:155], v[196:199], v[72:75]
    v_mfma_f32_16x16x32_bf16 v[104:107], a[152:155], v[200:203], v[104:107]
    v_mfma_f32_16x16x32_bf16 v[136:139], a[152:155], v[204:207], v[136:139]
    s_waitcnt lgkmcnt(0)
    v_mfma_f32_16x16x32_bf16 v[44:47], a[156:159], v[192:195], v[44:47]
    v_mfma_f32_16x16x32_bf16 v[76:79], a[156:159], v[196:199], v[76:79]
    v_mfma_f32_16x16x32_bf16 v[108:111], a[156:159], v[200:203], v[108:111]
    v_mfma_f32_16x16x32_bf16 v[140:143], a[156:159], v[204:207], v[140:143]
    v_xor_b32 v1, 32, v228
    s_barrier
    s_lshl_b32 s35, s24, 11
    s_add_u32 s35, s35, 49152
    v_add_u32 v0, s35, v14
    ds_write_b128 v0, v[218:221] offset:0
    ds_write_b128 v0, v[222:225] offset:1024
    ds_read_b64_tr_b16 a[208:209], v228 offset:0
    ds_read_b64_tr_b16 a[210:211], v228 offset:1024
    ds_read_b64_tr_b16 a[212:213], v1 offset:0
    ds_read_b64_tr_b16 a[214:215], v1 offset:1024
    ds_read_b64_tr_b16 a[216:217], v228 offset:2048
    ds_read_b64_tr_b16 a[218:219], v228 offset:3072
    ds_read_b64_tr_b16 a[220:221], v1 offset:2048
    ds_read_b64_tr_b16 a[222:223], v1 offset:3072
    ds_read_b64_tr_b16 a[224:225], v228 offset:4096
    ds_read_b64_tr_b16 a[226:227], v228 offset:5120
    ds_read_b64_tr_b16 a[228:229], v1 offset:4096
    ds_read_b64_tr_b16 a[230:231], v1 offset:5120
    s_waitcnt vmcnt(34)
    s_waitcnt lgkmcnt(10)
    v_mfma_f32_16x16x32_bf16 a[192:195], a[208:211], a[0:3], 0
    v_mfma_f32_16x16x32_bf16 a[200:203], a[208:211], a[4:7], 0
    ds_read_b64_tr_b16 a[232:233], v228 offset:6144
    ds_read_b64_tr_b16 a[234:235], v228 offset:7168
    s_add_u32 m0, s33, 32768
    s_nop 0
    buffer_load_dwordx4 v250, s[4:7], s28 offen offset:0 lds
    s_waitcnt lgkmcnt(10)
    v_mfma_f32_16x16x32_bf16 a[196:199], a[212:215], a[0:3], 0
    v_mfma_f32_16x16x32_bf16 a[204:207], a[212:215], a[4:7], 0
    ds_read_b64_tr_b16 a[236:237], v1 offset:6144
    ds_read_b64_tr_b16 a[238:239], v1 offset:7168
    s_add_u32 m0, s33, 32768
    s_nop 0
    buffer_load_dwordx4 v251, s[4:7], s28 offen offset:1024 lds
    s_waitcnt lgkmcnt(10)
    v_mfma_f32_16x16x32_bf16 a[192:195], a[216:219], a[8:11], a[192:195]
    v_mfma_f32_16x16x32_bf16 a[200:203], a[216:219], a[12:15], a[200:203]
    ds_read_b64_tr_b16 a[240:241], v228 offset:8192
    ds_read_b64_tr_b16 a[242:243], v228 offset:9216
    s_add_u32 m0, s33, 32768
    s_nop 0
    buffer_load_dwordx4 v252, s[4:7], s28 offen offset:2048 lds
    s_waitcnt lgkmcnt(10)
    v_mfma_f32_16x16x32_bf16 a[196:199], a[220:223], a[8:11], a[196:199]
    v_mfma_f32_16x16x32_bf16 a[204:207], a[220:223], a[12:15], a[204:207]
    ds_read_b64_tr_b16 a[244:245], v1 offset:8192
    ds_read_b64_tr_b16 a[246:247], v1 offset:9216
    s_add_u32 m0, s33, 32768
    s_nop 0
    buffer_load_dwordx4 v253, s[4:7], s28 offen offset:3072 lds
    s_add_u32 s28, s28, 16384
    s_waitcnt vmcnt(34)
    s_waitcnt lgkmcnt(10)
    v_mfma_f32_16x16x32_bf16 a[192:195], a[224:227], a[16:19], a[192:195]
    v_mfma_f32_16x16x32_bf16 a[200:203], a[224:227], a[20:23], a[200:203]
    ds_read_b64_tr_b16 a[248:249], v228 offset:10240
    ds_read_b64_tr_b16 a[250:251], v228 offset:11264
    s_add_u32 m0, s34, 16384
    s_nop 0
    buffer_load_dwordx4 v254, s[8:11], s29 offen offset:0 lds
    s_waitcnt lgkmcnt(10)
    v_mfma_f32_16x16x32_bf16 a[196:199], a[228:231], a[16:19], a[196:199]
    v_mfma_f32_16x16x32_bf16 a[204:207], a[228:231], a[20:23], a[204:207]
    ds_read_b64_tr_b16 a[252:253], v1 offset:10240
    ds_read_b64_tr_b16 a[254:255], v1 offset:11264
    s_add_u32 m0, s34, 16384
    s_nop 0
    buffer_load_dwordx4 v255, s[8:11], s29 offen offset:1024 lds
    s_waitcnt lgkmcnt(10)
    v_mfma_f32_16x16x32_bf16 a[192:195], a[232:235], a[24:27], a[192:195]
    v_mfma_f32_16x16x32_bf16 a[200:203], a[232:235], a[28:31], a[200:203]
    ds_read_b64_tr_b16 a[208:209], v228 offset:12288
    ds_read_b64_tr_b16 a[210:211], v228 offset:13312
    s_add_u32 m0, s34, 16384
    s_nop 0
    buffer_load_dwordx4 v254, s[8:11], s29 offen offset:2048 lds
    s_waitcnt lgkmcnt(10)
    v_mfma_f32_16x16x32_bf16 a[196:199], a[236:239], a[24:27], a[196:199]
    v_mfma_f32_16x16x32_bf16 a[204:207], a[236:239], a[28:31], a[204:207]
    ds_read_b64_tr_b16 a[212:213], v1 offset:12288
    ds_read_b64_tr_b16 a[214:215], v1 offset:13312
    s_add_u32 m0, s34, 16384
    s_nop 0
    buffer_load_dwordx4 v255, s[8:11], s29 offen offset:3072 lds
    s_add_u32 s29, s29, 16384
    s_waitcnt vmcnt(34)
    s_waitcnt lgkmcnt(10)
    v_mfma_f32_16x16x32_bf16 a[192:195], a[240:243], a[32:35], a[192:195]
    v_mfma_f32_16x16x32_bf16 a[200:203], a[240:243], a[36:39], a[200:203]
    ds_read_b64_tr_b16 a[216:217], v228 offset:14336
    ds_read_b64_tr_b16 a[218:219], v228 offset:15360
    s_add_u32 m0, s34, 32768
    s_nop 0
    buffer_load_dwordx4 v254, s[8:11], s29 offen offset:0 lds
    s_waitcnt lgkmcnt(10)
    v_mfma_f32_16x16x32_bf16 a[196:199], a[244:247], a[32:35], a[196:199]
    v_mfma_f32_16x16x32_bf16 a[204:207], a[244:247], a[36:39], a[204:207]
    ds_read_b64_tr_b16 a[220:221], v1 offset:14336
    ds_read_b64_tr_b16 a[222:223], v1 offset:15360
    s_add_u32 m0, s34, 32768
    s_nop 0
    buffer_load_dwordx4 v255, s[8:11], s29 offen offset:1024 lds
    s_waitcnt lgkmcnt(10)
    v_mfma_f32_16x16x32_bf16 a[192:195], a[248:251], a[40:43], a[192:195]
    v_mfma_f32_16x16x32_bf16 a[200:203], a[248:251], a[44:47], a[200:203]
    ds_read_b64_tr_b16 a[224:225], v228 offset:16384
    ds_read_b64_tr_b16 a[226:227], v228 offset:17408
    s_add_u32 m0, s34, 32768
    s_nop 0
    buffer_load_dwordx4 v254, s[8:11], s29 offen offset:2048 lds
    s_waitcnt lgkmcnt(10)
    v_mfma_f32_16x16x32_bf16 a[196:199], a[252:255], a[40:43], a[196:199]
    v_mfma_f32_16x16x32_bf16 a[204:207], a[252:255], a[44:47], a[204:207]
    ds_read_b64_tr_b16 a[228:229], v1 offset:16384
    ds_read_b64_tr_b16 a[230:231], v1 offset:17408
    s_add_u32 m0, s34, 32768
    s_nop 0
    buffer_load_dwordx4 v255, s[8:11], s29 offen offset:3072 lds
    s_add_u32 s29, s29, 16384
    s_waitcnt vmcnt(34)
    s_waitcnt lgkmcnt(10)
    v_mfma_f32_16x16x32_bf16 a[192:195], a[208:211], a[48:51], a[192:195]
    v_mfma_f32_16x16x32_bf16 a[200:203], a[208:211], a[52:55], a[200:203]
    ds_read_b64_tr_b16 a[232:233], v228 offset:18432
    ds_read_b64_tr_b16 a[234:235], v228 offset:19456
    s_waitcnt lgkmcnt(10)
    v_mfma_f32_16x16x32_bf16 a[196:199], a[212:215], a[48:51], a[196:199]
    v_mfma_f32_16x16x32_bf16 a[204:207], a[212:215], a[52:55], a[204:207]
    ds_read_b64_tr_b16 a[236:237], v1 offset:18432
    ds_read_b64_tr_b16 a[238:239], v1 offset:19456
    s_waitcnt lgkmcnt(10)
    v_mfma_f32_16x16x32_bf16 a[192:195], a[216:219], a[56:59], a[192:195]
    v_mfma_f32_16x16x32_bf16 a[200:203], a[216:219], a[60:63], a[200:203]
    ds_read_b64_tr_b16 a[240:241], v228 offset:20480
    ds_read_b64_tr_b16 a[242:243], v228 offset:21504
    s_waitcnt lgkmcnt(10)
    v_mfma_f32_16x16x32_bf16 a[196:199], a[220:223], a[56:59], a[196:199]
    v_mfma_f32_16x16x32_bf16 a[204:207], a[220:223], a[60:63], a[204:207]
    ds_read_b64_tr_b16 a[244:245], v1 offset:20480
    ds_read_b64_tr_b16 a[246:247], v1 offset:21504
    s_waitcnt vmcnt(30)
    s_waitcnt lgkmcnt(10)
    v_mfma_f32_16x16x32_bf16 a[192:195], a[224:227], a[64:67], a[192:195]
    v_mfma_f32_16x16x32_bf16 a[200:203], a[224:227], a[68:71], a[200:203]
    ds_read_b64_tr_b16 a[248:249], v228 offset:22528
    ds_read_b64_tr_b16 a[250:251], v228 offset:23552
    s_waitcnt lgkmcnt(10)
    v_mfma_f32_16x16x32_bf16 a[196:199], a[228:231], a[64:67], a[196:199]
    v_mfma_f32_16x16x32_bf16 a[204:207], a[228:231], a[68:71], a[204:207]
    ds_read_b64_tr_b16 a[252:253], v1 offset:22528
    ds_read_b64_tr_b16 a[254:255], v1 offset:23552
    s_waitcnt lgkmcnt(10)
    v_mfma_f32_16x16x32_bf16 a[192:195], a[232:235], a[72:75], a[192:195]
    v_mfma_f32_16x16x32_bf16 a[200:203], a[232:235], a[76:79], a[200:203]
    ds_read_b64_tr_b16 a[208:209], v228 offset:24576
    ds_read_b64_tr_b16 a[210:211], v228 offset:25600
    s_waitcnt lgkmcnt(10)
    v_mfma_f32_16x16x32_bf16 a[196:199], a[236:239], a[72:75], a[196:199]
    v_mfma_f32_16x16x32_bf16 a[204:207], a[236:239], a[76:79], a[204:207]
    ds_read_b64_tr_b16 a[212:213], v1 offset:24576
    ds_read_b64_tr_b16 a[214:215], v1 offset:25600
    s_waitcnt vmcnt(26)
    s_waitcnt lgkmcnt(10)
    v_mfma_f32_16x16x32_bf16 a[192:195], a[240:243], a[80:83], a[192:195]
    v_mfma_f32_16x16x32_bf16 a[200:203], a[240:243], a[84:87], a[200:203]
    ds_read_b64_tr_b16 a[216:217], v228 offset:26624
    ds_read_b64_tr_b16 a[218:219], v228 offset:27648
    s_waitcnt lgkmcnt(10)
    v_mfma_f32_16x16x32_bf16 a[196:199], a[244:247], a[80:83], a[196:199]
    v_mfma_f32_16x16x32_bf16 a[204:207], a[244:247], a[84:87], a[204:207]
    ds_read_b64_tr_b16 a[220:221], v1 offset:26624
    ds_read_b64_tr_b16 a[222:223], v1 offset:27648
    s_waitcnt lgkmcnt(10)
    v_mfma_f32_16x16x32_bf16 a[192:195], a[248:251], a[88:91], a[192:195]
    v_mfma_f32_16x16x32_bf16 a[200:203], a[248:251], a[92:95], a[200:203]
    ds_read_b64_tr_b16 a[224:225], v228 offset:28672
    ds_read_b64_tr_b16 a[226:227], v228 offset:29696
    s_waitcnt lgkmcnt(10)
    v_mfma_f32_16x16x32_bf16 a[196:199], a[252:255], a[88:91], a[196:199]
    v_mfma_f32_16x16x32_bf16 a[204:207], a[252:255], a[92:95], a[204:207]
    ds_read_b64_tr_b16 a[228:229], v1 offset:28672
    ds_read_b64_tr_b16 a[230:231], v1 offset:29696
    s_waitcnt vmcnt(22)
    s_waitcnt lgkmcnt(10)
    v_mfma_f32_16x16x32_bf16 a[192:195], a[208:211], a[96:99], a[192:195]
    v_mfma_f32_16x16x32_bf16 a[200:203], a[208:211], a[100:103], a[200:203]
    ds_read_b64_tr_b16 a[232:233], v228 offset:30720
    ds_read_b64_tr_b16 a[234:235], v228 offset:31744
    s_waitcnt lgkmcnt(10)
    v_mfma_f32_16x16x32_bf16 a[196:199], a[212:215], a[96:99], a[196:199]
    v_mfma_f32_16x16x32_bf16 a[204:207], a[212:215], a[100:103], a[204:207]
    ds_read_b64_tr_b16 a[236:237], v1 offset:30720
    ds_read_b64_tr_b16 a[238:239], v1 offset:31744
    s_waitcnt lgkmcnt(10)
    v_mfma_f32_16x16x32_bf16 a[192:195], a[216:219], a[104:107], a[192:195]
    v_mfma_f32_16x16x32_bf16 a[200:203], a[216:219], a[108:111], a[200:203]
    s_waitcnt lgkmcnt(8)
    v_mfma_f32_16x16x32_bf16 a[196:199], a[220:223], a[104:107], a[196:199]
    v_mfma_f32_16x16x32_bf16 a[204:207], a[220:223], a[108:111], a[204:207]
    s_waitcnt vmcnt(18)
    s_waitcnt lgkmcnt(6)
    v_mfma_f32_16x16x32_bf16 a[192:195], a[224:227], a[112:115], a[192:195]
    v_mfma_f32_16x16x32_bf16 a[200:203], a[224:227], a[116:119], a[200:203]
    s_waitcnt lgkmcnt(4)
    v_mfma_f32_16x16x32_bf16 a[196:199], a[228:231], a[112:115], a[196:199]
    v_mfma_f32_16x16x32_bf16 a[204:207], a[228:231], a[116:119], a[204:207]
    s_waitcnt lgkmcnt(2)
    v_mfma_f32_16x16x32_bf16 a[192:195], a[232:235], a[120:123], a[192:195]
    v_mfma_f32_16x16x32_bf16 a[200:203], a[232:235], a[124:127], a[200:203]
    s_waitcnt lgkmcnt(0)
    v_mfma_f32_16x16x32_bf16 a[196:199], a[236:239], a[120:123], a[196:199]
    v_mfma_f32_16x16x32_bf16 a[204:207], a[236:239], a[124:127], a[204:207]
    s_waitcnt vmcnt(12)
    v_accvgpr_read_b32 v232, a176
    v_accvgpr_read_b32 v236, a177
    v_accvgpr_read_b32 v233, a178
    v_accvgpr_read_b32 v237, a179
    s_lshl_b32 s35, s42, 10
    s_add_u32 s35, s35, s61
    s_add_u32 s35, s35, 6291456
    s_lshl_b32 s36, s42, 14
    s_lshl_b32 s63, s43, 7
    s_add_u32 s36, s36, s63
    s_add_u32 s36, s36, 36700160
    v_accvgpr_read_b32 v208, a192
    v_accvgpr_read_b32 v209, a193
    v_accvgpr_read_b32 v210, a194
    v_accvgpr_read_b32 v211, a195
    v_accvgpr_read_b32 v212, a196
    v_accvgpr_read_b32 v213, a197
    v_accvgpr_read_b32 v214, a198
    v_accvgpr_read_b32 v215, a199
    s_waitcnt lgkmcnt(0)
    v_lshlrev_b32 v0, 16, v2
    v_add_f32 v0, v0, v230
    v_fma_f32 v208, v0, v234, v208
    v_and_b32 v0, 0xffff0000, v2
    v_add_f32 v0, v0, v230
    v_fma_f32 v209, v0, v234, v209
    v_lshlrev_b32 v0, 16, v3
    v_add_f32 v0, v0, v230
    v_fma_f32 v210, v0, v234, v210
    v_and_b32 v0, 0xffff0000, v3
    v_add_f32 v0, v0, v230
    v_fma_f32 v211, v0, v234, v211
    v_lshlrev_b32 v0, 16, v4
    v_add_f32 v0, v0, v230
    v_fma_f32 v212, v0, v234, v212
    v_and_b32 v0, 0xffff0000, v4
    v_add_f32 v0, v0, v230
    v_fma_f32 v213, v0, v234, v213
    v_lshlrev_b32 v0, 16, v5
    v_add_f32 v0, v0, v230
    v_fma_f32 v214, v0, v234, v214
    v_and_b32 v0, 0xffff0000, v5
    v_add_f32 v0, v0, v230
    v_fma_f32 v215, v0, v234, v215
    v_cvt_pk_bf16_f32 v216, v208, v209
    v_cvt_pk_bf16_f32 v217, v210, v211
    v_cvt_pk_bf16_f32 v218, v212, v213
    v_cvt_pk_bf16_f32 v219, v214, v215
    buffer_store_dwordx4 v[216:219], v14, s[20:23], s35 offen sc1
    s_add_u32 s35, s35, 16384
    v_lshlrev_b32 v0, 16, v216
    v_and_b32 v1, 0xffff0000, v216
    v_add_f32 v208, v0, v1
    v_mul_f32 v209, v0, v0
    v_fmac_f32 v209, v1, v1
    v_lshlrev_b32 v0, 16, v217
    v_and_b32 v1, 0xffff0000, v217
    v_add_f32 v208, v208, v0
    v_add_f32 v208, v208, v1
    v_fmac_f32 v209, v0, v0
    v_fmac_f32 v209, v1, v1
    v_lshlrev_b32 v0, 16, v218
    v_and_b32 v1, 0xffff0000, v218
    v_add_f32 v208, v208, v0
    v_add_f32 v208, v208, v1
    v_fmac_f32 v209, v0, v0
    v_fmac_f32 v209, v1, v1
    v_lshlrev_b32 v0, 16, v219
    v_and_b32 v1, 0xffff0000, v219
    v_add_f32 v208, v208, v0
    v_add_f32 v208, v208, v1
    v_fmac_f32 v209, v0, v0
    v_fmac_f32 v209, v1, v1
    v_mov_b32 v0, v208
    s_nop 1
    v_permlane16_swap_b32 v208, v0
    s_nop 0
    v_add_f32 v208, v208, v0
    v_mov_b32 v0, v208
    s_nop 1
    v_permlane32_swap_b32 v208, v0
    s_nop 0
    v_add_f32 v208, v208, v0
    v_mov_b32 v0, v209
    s_nop 1
    v_permlane16_swap_b32 v209, v0
    s_nop 0
    v_add_f32 v209, v209, v0
    v_mov_b32 v0, v209
    s_nop 1
    v_permlane32_swap_b32 v209, v0
    s_nop 0
    v_add_f32 v209, v209, v0
    v_lshrrev_b32 v0, 1, v14
    s_mov_b64 exec, 0xffff
    buffer_store_dwordx2 v[208:209], v0, s[20:23], s36 offen offset:0 sc1
    s_mov_b64 exec, -1
    v_accvgpr_read_b32 v208, a200
    v_accvgpr_read_b32 v209, a201
    v_accvgpr_read_b32 v210, a202
    v_accvgpr_read_b32 v211, a203
    v_accvgpr_read_b32 v212, a204
    v_accvgpr_read_b32 v213, a205
    v_accvgpr_read_b32 v214, a206
    v_accvgpr_read_b32 v215, a207
    v_lshlrev_b32 v0, 16, v6
    v_add_f32 v0, v0, v231
    v_fma_f32 v208, v0, v235, v208
    v_and_b32 v0, 0xffff0000, v6
    v_add_f32 v0, v0, v231
    v_fma_f32 v209, v0, v235, v209
    v_lshlrev_b32 v0, 16, v7
    v_add_f32 v0, v0, v231
    v_fma_f32 v210, v0, v235, v210
    v_and_b32 v0, 0xffff0000, v7
    v_add_f32 v0, v0, v231
    v_fma_f32 v211, v0, v235, v211
    v_lshlrev_b32 v0, 16, v8
    v_add_f32 v0, v0, v231
    v_fma_f32 v212, v0, v235, v212
    v_and_b32 v0, 0xffff0000, v8
    v_add_f32 v0, v0, v231
    v_fma_f32 v213, v0, v235, v213
    v_lshlrev_b32 v0, 16, v9
    v_add_f32 v0, v0, v231
    v_fma_f32 v214, v0, v235, v214
    v_and_b32 v0, 0xffff0000, v9
    v_add_f32 v0, v0, v231
    v_fma_f32 v215, v0, v235, v215
    v_cvt_pk_bf16_f32 v220, v208, v209
    v_cvt_pk_bf16_f32 v221, v210, v211
    v_cvt_pk_bf16_f32 v222, v212, v213
    v_cvt_pk_bf16_f32 v223, v214, v215
    buffer_store_dwordx4 v[220:223], v14, s[20:23], s35 offen sc1
    v_lshlrev_b32 v0, 16, v220
    v_and_b32 v1, 0xffff0000, v220
    v_add_f32 v208, v0, v1
    v_mul_f32 v209, v0, v0
    v_fmac_f32 v209, v1, v1
    v_lshlrev_b32 v0, 16, v221
    v_and_b32 v1, 0xffff0000, v221
    v_add_f32 v208, v208, v0
    v_add_f32 v208, v208, v1
    v_fmac_f32 v209, v0, v0
    v_fmac_f32 v209, v1, v1
    v_lshlrev_b32 v0, 16, v222
    v_and_b32 v1, 0xffff0000, v222
    v_add_f32 v208, v208, v0
    v_add_f32 v208, v208, v1
    v_fmac_f32 v209, v0, v0
    v_fmac_f32 v209, v1, v1
    v_lshlrev_b32 v0, 16, v223
    v_and_b32 v1, 0xffff0000, v223
    v_add_f32 v208, v208, v0
    v_add_f32 v208, v208, v1
    v_fmac_f32 v209, v0, v0
    v_fmac_f32 v209, v1, v1
    v_mov_b32 v0, v208
    s_nop 1
    v_permlane16_swap_b32 v208, v0
    s_nop 0
    v_add_f32 v208, v208, v0
    v_mov_b32 v0, v208
    s_nop 1
    v_permlane32_swap_b32 v208, v0
    s_nop 0
    v_add_f32 v208, v208, v0
    v_mov_b32 v0, v209
    s_nop 1
    v_permlane16_swap_b32 v209, v0
    s_nop 0
    v_add_f32 v209, v209, v0
    v_mov_b32 v0, v209
    s_nop 1
    v_permlane32_swap_b32 v209, v0
    s_nop 0
    v_add_f32 v209, v209, v0
    v_lshrrev_b32 v0, 1, v14
    s_mov_b64 exec, 0xffff
    buffer_store_dwordx2 v[208:209], v0, s[20:23], s36 offen offset:128 sc1
    s_mov_b64 exec, -1
    s_waitcnt vmcnt(55) lgkmcnt(0)
    s_barrier
    ds_read_b128 a[128:131], v238 offset:0
    ds_read_b128 a[132:135], v239 offset:0
    ds_read_b128 a[136:139], v240 offset:0
    ds_read_b128 a[140:143], v241 offset:0
    ds_read_b128 a[144:147], v238 offset:4096
    ds_read_b128 a[148:151], v239 offset:4096
    ds_read_b128 a[152:155], v240 offset:4096
    ds_read_b128 a[156:159], v241 offset:4096
    v_mul_f32 v234, s40, v234
    v_mul_f32 v235, s40, v235
    v_mul_f32 v236, s40, v236
    v_mul_f32 v237, s40, v237
    s_xor_b32 s35, s24, 0
    s_lshl_b32 s35, s35, 11
    s_add_u32 s35, s35, 49152
    v_add_u32 v0, s35, v14
    ds_read_b128 v[208:211], v0 offset:0
    ds_read_b128 v[212:215], v0 offset:1024
    s_xor_b32 s35, s24, 1
    s_lshl_b32 s35, s35, 11
    s_add_u32 s35, s35, 49152
    v_add_u32 v1, s35, v14
    ds_read_b128 v[216:219], v1 offset:0
    ds_read_b128 v[220:223], v1 offset:1024
    s_waitcnt lgkmcnt(0)
    v_pk_fma_f32 v[16:17], v[208:209], v[230:231], v[16:17] op_sel:[0,0,0] op_sel_hi:[1,0,1]
    v_pk_fma_f32 v[18:19], v[210:211], v[230:231], v[18:19] op_sel:[0,0,0] op_sel_hi:[1,0,1]
    v_pk_mul_f32 v[16:17], v[16:17], v[234:235] op_sel:[0,0] op_sel_hi:[1,0]
    v_pk_mul_f32 v[18:19], v[18:19], v[234:235] op_sel:[0,0] op_sel_hi:[1,0]
    v_cvt_pk_bf16_f32 v144, v16, v17
    v_cvt_pk_bf16_f32 v145, v18, v19
    v_pk_fma_f32 v[20:21], v[212:213], v[230:231], v[20:21] op_sel:[0,0,0] op_sel_hi:[1,0,1]
    v_pk_fma_f32 v[22:23], v[214:215], v[230:231], v[22:23] op_sel:[0,0,0] op_sel_hi:[1,0,1]
    v_pk_mul_f32 v[20:21], v[20:21], v[234:235] op_sel:[0,0] op_sel_hi:[1,0]
    v_pk_mul_f32 v[22:23], v[22:23], v[234:235] op_sel:[0,0] op_sel_hi:[1,0]
    v_cvt_pk_bf16_f32 v146, v20, v21
    v_cvt_pk_bf16_f32 v147, v22, v23
    v_pk_fma_f32 v[24:25], v[216:217], v[230:231], v[24:25] op_sel:[0,0,0] op_sel_hi:[1,0,1]
    v_pk_fma_f32 v[26:27], v[218:219], v[230:231], v[26:27] op_sel:[0,0,0] op_sel_hi:[1,0,1]
    v_pk_mul_f32 v[24:25], v[24:25], v[234:235] op_sel:[0,0] op_sel_hi:[1,0]
    v_pk_mul_f32 v[26:27], v[26:27], v[234:235] op_sel:[0,0] op_sel_hi:[1,0]
    v_cvt_pk_bf16_f32 v148, v24, v25
    v_cvt_pk_bf16_f32 v149, v26, v27
    v_pk_fma_f32 v[28:29], v[220:221], v[230:231], v[28:29] op_sel:[0,0,0] op_sel_hi:[1,0,1]
    v_pk_fma_f32 v[30:31], v[222:223], v[230:231], v[30:31] op_sel:[0,0,0] op_sel_hi:[1,0,1]
    v_pk_mul_f32 v[28:29], v[28:29], v[234:235] op_sel:[0,0] op_sel_hi:[1,0]
    v_pk_mul_f32 v[30:31], v[30:31], v[234:235] op_sel:[0,0] op_sel_hi:[1,0]
    v_cvt_pk_bf16_f32 v150, v28, v29
    v_cvt_pk_bf16_f32 v151, v30, v31
    v_pk_fma_f32 v[48:49], v[208:209], v[230:231], v[48:49] op_sel:[0,1,0] op_sel_hi:[1,1,1]
    v_pk_fma_f32 v[50:51], v[210:211], v[230:231], v[50:51] op_sel:[0,1,0] op_sel_hi:[1,1,1]
    v_pk_mul_f32 v[48:49], v[48:49], v[234:235] op_sel:[0,1] op_sel_hi:[1,1]
    v_pk_mul_f32 v[50:51], v[50:51], v[234:235] op_sel:[0,1] op_sel_hi:[1,1]
    v_cvt_pk_bf16_f32 v160, v48, v49
    v_cvt_pk_bf16_f32 v161, v50, v51
    v_pk_fma_f32 v[52:53], v[212:213], v[230:231], v[52:53] op_sel:[0,1,0] op_sel_hi:[1,1,1]
    v_pk_fma_f32 v[54:55], v[214:215], v[230:231], v[54:55] op_sel:[0,1,0] op_sel_hi:[1,1,1]
    v_pk_mul_f32 v[52:53], v[52:53], v[234:235] op_sel:[0,1] op_sel_hi:[1,1]
    v_pk_mul_f32 v[54:55], v[54:55], v[234:235] op_sel:[0,1] op_sel_hi:[1,1]
    v_cvt_pk_bf16_f32 v162, v52, v53
    v_cvt_pk_bf16_f32 v163, v54, v55
    v_pk_fma_f32 v[56:57], v[216:217], v[230:231], v[56:57] op_sel:[0,1,0] op_sel_hi:[1,1,1]
    v_pk_fma_f32 v[58:59], v[218:219], v[230:231], v[58:59] op_sel:[0,1,0] op_sel_hi:[1,1,1]
    v_pk_mul_f32 v[56:57], v[56:57], v[234:235] op_sel:[0,1] op_sel_hi:[1,1]
    v_pk_mul_f32 v[58:59], v[58:59], v[234:235] op_sel:[0,1] op_sel_hi:[1,1]
    v_cvt_pk_bf16_f32 v164, v56, v57
    v_cvt_pk_bf16_f32 v165, v58, v59
    v_pk_fma_f32 v[60:61], v[220:221], v[230:231], v[60:61] op_sel:[0,1,0] op_sel_hi:[1,1,1]
    v_pk_fma_f32 v[62:63], v[222:223], v[230:231], v[62:63] op_sel:[0,1,0] op_sel_hi:[1,1,1]
    v_pk_mul_f32 v[60:61], v[60:61], v[234:235] op_sel:[0,1] op_sel_hi:[1,1]
    v_pk_mul_f32 v[62:63], v[62:63], v[234:235] op_sel:[0,1] op_sel_hi:[1,1]
    v_cvt_pk_bf16_f32 v166, v60, v61
    v_cvt_pk_bf16_f32 v167, v62, v63
    v_pk_fma_f32 v[80:81], v[208:209], v[232:233], v[80:81] op_sel:[0,0,0] op_sel_hi:[1,0,1]
    v_pk_fma_f32 v[82:83], v[210:211], v[232:233], v[82:83] op_sel:[0,0,0] op_sel_hi:[1,0,1]
    v_pk_mul_f32 v[80:81], v[80:81], v[236:237] op_sel:[0,0] op_sel_hi:[1,0]
    v_pk_mul_f32 v[82:83], v[82:83], v[236:237] op_sel:[0,0] op_sel_hi:[1,0]
    v_cvt_pk_bf16_f32 v176, v80, v81
    v_cvt_pk_bf16_f32 v177, v82, v83
    v_pk_fma_f32 v[84:85], v[212:213], v[232:233], v[84:85] op_sel:[0,0,0] op_sel_hi:[1,0,1]
    v_pk_fma_f32 v[86:87], v[214:215], v[232:233], v[86:87] op_sel:[0,0,0] op_sel_hi:[1,0,1]
    v_pk_mul_f32 v[84:85], v[84:85], v[236:237] op_sel:[0,0] op_sel_hi:[1,0]
    v_pk_mul_f32 v[86:87], v[86:87], v[236:237] op_sel:[0,0] op_sel_hi:[1,0]
    v_cvt_pk_bf16_f32 v178, v84, v85
    v_cvt_pk_bf16_f32 v179, v86, v87
    v_pk_fma_f32 v[88:89], v[216:217], v[232:233], v[88:89] op_sel:[0,0,0] op_sel_hi:[1,0,1]
    v_pk_fma_f32 v[90:91], v[218:219], v[232:233], v[90:91] op_sel:[0,0,0] op_sel_hi:[1,0,1]
    v_pk_mul_f32 v[88:89], v[88:89], v[236:237] op_sel:[0,0] op_sel_hi:[1,0]
    v_pk_mul_f32 v[90:91], v[90:91], v[236:237] op_sel:[0,0] op_sel_hi:[1,0]
    v_cvt_pk_bf16_f32 v180, v88, v89
    v_cvt_pk_bf16_f32 v181, v90, v91
    v_pk_fma_f32 v[92:93], v[220:221], v[232:233], v[92:93] op_sel:[0,0,0] op_sel_hi:[1,0,1]
    v_pk_fma_f32 v[94:95], v[222:223], v[232:233], v[94:95] op_sel:[0,0,0] op_sel_hi:[1,0,1]
    v_pk_mul_f32 v[92:93], v[92:93], v[236:237] op_sel:[0,0] op_sel_hi:[1,0]
    v_pk_mul_f32 v[94:95], v[94:95], v[236:237] op_sel:[0,0] op_sel_hi:[1,0]
    v_cvt_pk_bf16_f32 v182, v92, v93
    v_cvt_pk_bf16_f32 v183, v94, v95
    v_pk_fma_f32 v[112:113], v[208:209], v[232:233], v[112:113] op_sel:[0,1,0] op_sel_hi:[1,1,1]
    v_pk_fma_f32 v[114:115], v[210:211], v[232:233], v[114:115] op_sel:[0,1,0] op_sel_hi:[1,1,1]
    v_pk_mul_f32 v[112:113], v[112:113], v[236:237] op_sel:[0,1] op_sel_hi:[1,1]
    v_pk_mul_f32 v[114:115], v[114:115], v[236:237] op_sel:[0,1] op_sel_hi:[1,1]
    v_cvt_pk_bf16_f32 v192, v112, v113
    v_cvt_pk_bf16_f32 v193, v114, v115
    v_pk_fma_f32 v[116:117], v[212:213], v[232:233], v[116:117] op_sel:[0,1,0] op_sel_hi:[1,1,1]
    v_pk_fma_f32 v[118:119], v[214:215], v[232:233], v[118:119] op_sel:[0,1,0] op_sel_hi:[1,1,1]
    v_pk_mul_f32 v[116:117], v[116:117], v[236:237] op_sel:[0,1] op_sel_hi:[1,1]
    v_pk_mul_f32 v[118:119], v[118:119], v[236:237] op_sel:[0,1] op_sel_hi:[1,1]
    v_cvt_pk_bf16_f32 v194, v116, v117
    v_cvt_pk_bf16_f32 v195, v118, v119
    v_pk_fma_f32 v[120:121], v[216:217], v[232:233], v[120:121] op_sel:[0,1,0] op_sel_hi:[1,1,1]
    v_pk_fma_f32 v[122:123], v[218:219], v[232:233], v[122:123] op_sel:[0,1,0] op_sel_hi:[1,1,1]
    v_pk_mul_f32 v[120:121], v[120:121], v[236:237] op_sel:[0,1] op_sel_hi:[1,1]
    v_pk_mul_f32 v[122:123], v[122:123], v[236:237] op_sel:[0,1] op_sel_hi:[1,1]
    v_cvt_pk_bf16_f32 v196, v120, v121
    v_cvt_pk_bf16_f32 v197, v122, v123
    v_pk_fma_f32 v[124:125], v[220:221], v[232:233], v[124:125] op_sel:[0,1,0] op_sel_hi:[1,1,1]
    v_pk_fma_f32 v[126:127], v[222:223], v[232:233], v[126:127] op_sel:[0,1,0] op_sel_hi:[1,1,1]
    v_pk_mul_f32 v[124:125], v[124:125], v[236:237] op_sel:[0,1] op_sel_hi:[1,1]
    v_pk_mul_f32 v[126:127], v[126:127], v[236:237] op_sel:[0,1] op_sel_hi:[1,1]
    v_cvt_pk_bf16_f32 v198, v124, v125
    v_cvt_pk_bf16_f32 v199, v126, v127
    s_xor_b32 s35, s24, 2
    s_lshl_b32 s35, s35, 11
    s_add_u32 s35, s35, 49152
    v_add_u32 v0, s35, v14
    ds_read_b128 v[208:211], v0 offset:0
    ds_read_b128 v[212:215], v0 offset:1024
    s_xor_b32 s35, s24, 3
    s_lshl_b32 s35, s35, 11
    s_add_u32 s35, s35, 49152
    v_add_u32 v1, s35, v14
    ds_read_b128 v[216:219], v1 offset:0
    ds_read_b128 v[220:223], v1 offset:1024
    s_waitcnt lgkmcnt(0)
    v_pk_fma_f32 v[32:33], v[208:209], v[230:231], v[32:33] op_sel:[0,0,0] op_sel_hi:[1,0,1]
    v_pk_fma_f32 v[34:35], v[210:211], v[230:231], v[34:35] op_sel:[0,0,0] op_sel_hi:[1,0,1]
    v_pk_mul_f32 v[32:33], v[32:33], v[234:235] op_sel:[0,0] op_sel_hi:[1,0]
    v_pk_mul_f32 v[34:35], v[34:35], v[234:235] op_sel:[0,0] op_sel_hi:[1,0]
    v_cvt_pk_bf16_f32 v152, v32, v33
    v_cvt_pk_bf16_f32 v153, v34, v35
    v_pk_fma_f32 v[36:37], v[212:213], v[230:231], v[36:37] op_sel:[0,0,0] op_sel_hi:[1,0,1]
    v_pk_fma_f32 v[38:39], v[214:215], v[230:231], v[38:39] op_sel:[0,0,0] op_sel_hi:[1,0,1]
    v_pk_mul_f32 v[36:37], v[36:37], v[234:235] op_sel:[0,0] op_sel_hi:[1,0]
    v_pk_mul_f32 v[38:39], v[38:39], v[234:235] op_sel:[0,0] op_sel_hi:[1,0]
    v_cvt_pk_bf16_f32 v154, v36, v37
    v_cvt_pk_bf16_f32 v155, v38, v39
    v_pk_fma_f32 v[40:41], v[216:217], v[230:231], v[40:41] op_sel:[0,0,0] op_sel_hi:[1,0,1]
    v_pk_fma_f32 v[42:43], v[218:219], v[230:231], v[42:43] op_sel:[0,0,0] op_sel_hi:[1,0,1]
    v_pk_mul_f32 v[40:41], v[40:41], v[234:235] op_sel:[0,0] op_sel_hi:[1,0]
    v_pk_mul_f32 v[42:43], v[42:43], v[234:235] op_sel:[0,0] op_sel_hi:[1,0]
    v_cvt_pk_bf16_f32 v156, v40, v41
    v_cvt_pk_bf16_f32 v157, v42, v43
    v_pk_fma_f32 v[44:45], v[220:221], v[230:231], v[44:45] op_sel:[0,0,0] op_sel_hi:[1,0,1]
    v_pk_fma_f32 v[46:47], v[222:223], v[230:231], v[46:47] op_sel:[0,0,0] op_sel_hi:[1,0,1]
    v_pk_mul_f32 v[44:45], v[44:45], v[234:235] op_sel:[0,0] op_sel_hi:[1,0]
    v_pk_mul_f32 v[46:47], v[46:47], v[234:235] op_sel:[0,0] op_sel_hi:[1,0]
    v_cvt_pk_bf16_f32 v158, v44, v45
    v_cvt_pk_bf16_f32 v159, v46, v47
    v_pk_fma_f32 v[64:65], v[208:209], v[230:231], v[64:65] op_sel:[0,1,0] op_sel_hi:[1,1,1]
    v_pk_fma_f32 v[66:67], v[210:211], v[230:231], v[66:67] op_sel:[0,1,0] op_sel_hi:[1,1,1]
    v_pk_mul_f32 v[64:65], v[64:65], v[234:235] op_sel:[0,1] op_sel_hi:[1,1]
    v_pk_mul_f32 v[66:67], v[66:67], v[234:235] op_sel:[0,1] op_sel_hi:[1,1]
    v_cvt_pk_bf16_f32 v168, v64, v65
    v_cvt_pk_bf16_f32 v169, v66, v67
    v_pk_fma_f32 v[68:69], v[212:213], v[230:231], v[68:69] op_sel:[0,1,0] op_sel_hi:[1,1,1]
    v_pk_fma_f32 v[70:71], v[214:215], v[230:231], v[70:71] op_sel:[0,1,0] op_sel_hi:[1,1,1]
    v_pk_mul_f32 v[68:69], v[68:69], v[234:235] op_sel:[0,1] op_sel_hi:[1,1]
    v_pk_mul_f32 v[70:71], v[70:71], v[234:235] op_sel:[0,1] op_sel_hi:[1,1]
    v_cvt_pk_bf16_f32 v170, v68, v69
    v_cvt_pk_bf16_f32 v171, v70, v71
    v_pk_fma_f32 v[72:73], v[216:217], v[230:231], v[72:73] op_sel:[0,1,0] op_sel_hi:[1,1,1]
    v_pk_fma_f32 v[74:75], v[218:219], v[230:231], v[74:75] op_sel:[0,1,0] op_sel_hi:[1,1,1]
    v_pk_mul_f32 v[72:73], v[72:73], v[234:235] op_sel:[0,1] op_sel_hi:[1,1]
    v_pk_mul_f32 v[74:75], v[74:75], v[234:235] op_sel:[0,1] op_sel_hi:[1,1]
    v_cvt_pk_bf16_f32 v172, v72, v73
    v_cvt_pk_bf16_f32 v173, v74, v75
    v_pk_fma_f32 v[76:77], v[220:221], v[230:231], v[76:77] op_sel:[0,1,0] op_sel_hi:[1,1,1]
    v_pk_fma_f32 v[78:79], v[222:223], v[230:231], v[78:79] op_sel:[0,1,0] op_sel_hi:[1,1,1]
    v_pk_mul_f32 v[76:77], v[76:77], v[234:235] op_sel:[0,1] op_sel_hi:[1,1]
    v_pk_mul_f32 v[78:79], v[78:79], v[234:235] op_sel:[0,1] op_sel_hi:[1,1]
    v_cvt_pk_bf16_f32 v174, v76, v77
    v_cvt_pk_bf16_f32 v175, v78, v79
    v_pk_fma_f32 v[96:97], v[208:209], v[232:233], v[96:97] op_sel:[0,0,0] op_sel_hi:[1,0,1]
    v_pk_fma_f32 v[98:99], v[210:211], v[232:233], v[98:99] op_sel:[0,0,0] op_sel_hi:[1,0,1]
    v_pk_mul_f32 v[96:97], v[96:97], v[236:237] op_sel:[0,0] op_sel_hi:[1,0]
    v_pk_mul_f32 v[98:99], v[98:99], v[236:237] op_sel:[0,0] op_sel_hi:[1,0]
    v_cvt_pk_bf16_f32 v184, v96, v97
    v_cvt_pk_bf16_f32 v185, v98, v99
    v_pk_fma_f32 v[100:101], v[212:213], v[232:233], v[100:101] op_sel:[0,0,0] op_sel_hi:[1,0,1]
    v_pk_fma_f32 v[102:103], v[214:215], v[232:233], v[102:103] op_sel:[0,0,0] op_sel_hi:[1,0,1]
    v_pk_mul_f32 v[100:101], v[100:101], v[236:237] op_sel:[0,0] op_sel_hi:[1,0]
    v_pk_mul_f32 v[102:103], v[102:103], v[236:237] op_sel:[0,0] op_sel_hi:[1,0]
    v_cvt_pk_bf16_f32 v186, v100, v101
    v_cvt_pk_bf16_f32 v187, v102, v103
    v_pk_fma_f32 v[104:105], v[216:217], v[232:233], v[104:105] op_sel:[0,0,0] op_sel_hi:[1,0,1]
    v_pk_fma_f32 v[106:107], v[218:219], v[232:233], v[106:107] op_sel:[0,0,0] op_sel_hi:[1,0,1]
    v_pk_mul_f32 v[104:105], v[104:105], v[236:237] op_sel:[0,0] op_sel_hi:[1,0]
    v_pk_mul_f32 v[106:107], v[106:107], v[236:237] op_sel:[0,0] op_sel_hi:[1,0]
    v_cvt_pk_bf16_f32 v188, v104, v105
    v_cvt_pk_bf16_f32 v189, v106, v107
    v_pk_fma_f32 v[108:109], v[220:221], v[232:233], v[108:109] op_sel:[0,0,0] op_sel_hi:[1,0,1]
    v_pk_fma_f32 v[110:111], v[222:223], v[232:233], v[110:111] op_sel:[0,0,0] op_sel_hi:[1,0,1]
    v_pk_mul_f32 v[108:109], v[108:109], v[236:237] op_sel:[0,0] op_sel_hi:[1,0]
    v_pk_mul_f32 v[110:111], v[110:111], v[236:237] op_sel:[0,0] op_sel_hi:[1,0]
    v_cvt_pk_bf16_f32 v190, v108, v109
    v_cvt_pk_bf16_f32 v191, v110, v111
    v_pk_fma_f32 v[128:129], v[208:209], v[232:233], v[128:129] op_sel:[0,1,0] op_sel_hi:[1,1,1]
    v_pk_fma_f32 v[130:131], v[210:211], v[232:233], v[130:131] op_sel:[0,1,0] op_sel_hi:[1,1,1]
    v_pk_mul_f32 v[128:129], v[128:129], v[236:237] op_sel:[0,1] op_sel_hi:[1,1]
    v_pk_mul_f32 v[130:131], v[130:131], v[236:237] op_sel:[0,1] op_sel_hi:[1,1]
    v_cvt_pk_bf16_f32 v200, v128, v129
    v_cvt_pk_bf16_f32 v201, v130, v131
    v_pk_fma_f32 v[132:133], v[212:213], v[232:233], v[132:133] op_sel:[0,1,0] op_sel_hi:[1,1,1]
    v_pk_fma_f32 v[134:135], v[214:215], v[232:233], v[134:135] op_sel:[0,1,0] op_sel_hi:[1,1,1]
    v_pk_mul_f32 v[132:133], v[132:133], v[236:237] op_sel:[0,1] op_sel_hi:[1,1]
    v_pk_mul_f32 v[134:135], v[134:135], v[236:237] op_sel:[0,1] op_sel_hi:[1,1]
    v_cvt_pk_bf16_f32 v202, v132, v133
    v_cvt_pk_bf16_f32 v203, v134, v135
    v_pk_fma_f32 v[136:137], v[216:217], v[232:233], v[136:137] op_sel:[0,1,0] op_sel_hi:[1,1,1]
    v_pk_fma_f32 v[138:139], v[218:219], v[232:233], v[138:139] op_sel:[0,1,0] op_sel_hi:[1,1,1]
    v_pk_mul_f32 v[136:137], v[136:137], v[236:237] op_sel:[0,1] op_sel_hi:[1,1]
    v_pk_mul_f32 v[138:139], v[138:139], v[236:237] op_sel:[0,1] op_sel_hi:[1,1]
    v_cvt_pk_bf16_f32 v204, v136, v137
    v_cvt_pk_bf16_f32 v205, v138, v139
    v_pk_fma_f32 v[140:141], v[220:221], v[232:233], v[140:141] op_sel:[0,1,0] op_sel_hi:[1,1,1]
    v_pk_fma_f32 v[142:143], v[222:223], v[232:233], v[142:143] op_sel:[0,1,0] op_sel_hi:[1,1,1]
    v_pk_mul_f32 v[140:141], v[140:141], v[236:237] op_sel:[0,1] op_sel_hi:[1,1]
    v_pk_mul_f32 v[142:143], v[142:143], v[236:237] op_sel:[0,1] op_sel_hi:[1,1]
    v_cvt_pk_bf16_f32 v206, v140, v141
    v_cvt_pk_bf16_f32 v207, v142, v143
    s_waitcnt lgkmcnt(0)
    v_mov_b32 v0, 0
    v_mov_b32 v1, 0
    v_mov_b32 v2, 0
    v_mov_b32 v3, 0
    v_mfma_f32_16x16x32_bf16 v[16:19], a[128:131], v[144:147], 0
    v_mfma_f32_16x16x32_bf16 v[16:19], a[132:135], v[148:151], v[16:19]
    v_mfma_f32_16x16x32_bf16 v[16:19], a[136:139], v[152:155], v[16:19]
    v_mfma_f32_16x16x32_bf16 v[16:19], a[140:143], v[156:159], v[16:19]
    v_mfma_f32_32x32x16_bf16 a[0:15], v[0:3], v[0:3], 0
    v_mfma_f32_16x16x32_bf16 v[20:23], a[144:147], v[144:147], 0
    v_mfma_f32_16x16x32_bf16 v[20:23], a[148:151], v[148:151], v[20:23]
    v_mfma_f32_16x16x32_bf16 v[20:23], a[152:155], v[152:155], v[20:23]
    v_mfma_f32_16x16x32_bf16 v[20:23], a[156:159], v[156:159], v[20:23]
    v_mfma_f32_32x32x16_bf16 a[16:31], v[0:3], v[0:3], 0
    v_mfma_f32_16x16x32_bf16 v[24:27], a[128:131], v[160:163], 0
    v_mfma_f32_16x16x32_bf16 v[24:27], a[132:135], v[164:167], v[24:27]
    v_mfma_f32_16x16x32_bf16 v[24:27], a[136:139], v[168:171], v[24:27]
    v_mfma_f32_16x16x32_bf16 v[24:27], a[140:143], v[172:175], v[24:27]
    v_mfma_f32_32x32x16_bf16 a[32:47], v[0:3], v[0:3], 0
    v_mfma_f32_16x16x32_bf16 v[28:31], a[144:147], v[160:163], 0
    v_mfma_f32_16x16x32_bf16 v[28:31], a[148:151], v[164:167], v[28:31]
    v_mfma_f32_16x16x32_bf16 v[28:31], a[152:155], v[168:171], v[28:31]
    v_mfma_f32_16x16x32_bf16 v[28:31], a[156:159], v[172:175], v[28:31]
    v_mfma_f32_32x32x16_bf16 a[48:63], v[0:3], v[0:3], 0
    v_mfma_f32_16x16x32_bf16 v[32:35], a[128:131], v[176:179], 0
    v_mfma_f32_16x16x32_bf16 v[32:35], a[132:135], v[180:183], v[32:35]
    v_mfma_f32_16x16x32_bf16 v[32:35], a[136:139], v[184:187], v[32:35]
    v_mfma_f32_16x16x32_bf16 v[32:35], a[140:143], v[188:191], v[32:35]
    v_mfma_f32_32x32x16_bf16 a[64:79], v[0:3], v[0:3], 0
    v_mfma_f32_16x16x32_bf16 v[36:39], a[144:147], v[176:179], 0
    v_mfma_f32_16x16x32_bf16 v[36:39], a[148:151], v[180:183], v[36:39]
    v_mfma_f32_16x16x32_bf16 v[36:39], a[152:155], v[184:187], v[36:39]
    v_mfma_f32_16x16x32_bf16 v[36:39], a[156:159], v[188:191], v[36:39]
    v_mfma_f32_32x32x16_bf16 a[80:95], v[0:3], v[0:3], 0
    v_mfma_f32_16x16x32_bf16 v[40:43], a[128:131], v[192:195], 0
    v_mfma_f32_16x16x32_bf16 v[40:43], a[132:135], v[196:199], v[40:43]
    v_mfma_f32_16x16x32_bf16 v[40:43], a[136:139], v[200:203], v[40:43]
    v_mfma_f32_16x16x32_bf16 v[40:43], a[140:143], v[204:207], v[40:43]
    v_mfma_f32_32x32x16_bf16 a[96:111], v[0:3], v[0:3], 0
    v_mfma_f32_16x16x32_bf16 v[44:47], a[144:147], v[192:195], 0
    v_mfma_f32_16x16x32_bf16 v[44:47], a[148:151], v[196:199], v[44:47]
    v_mfma_f32_16x16x32_bf16 v[44:47], a[152:155], v[200:203], v[44:47]
    v_mfma_f32_16x16x32_bf16 v[44:47], a[156:159], v[204:207], v[44:47]
    v_mfma_f32_32x32x16_bf16 a[112:127], v[0:3], v[0:3], 0
    ds_read_b128 a[128:131], v238 offset:8192
    ds_read_b128 a[132:135], v239 offset:8192
    ds_read_b128 a[136:139], v240 offset:8192
    ds_read_b128 a[140:143], v241 offset:8192
    ds_read_b128 a[144:147], v238 offset:12288
    ds_read_b128 a[148:151], v239 offset:12288
    ds_read_b128 a[152:155], v240 offset:12288
    ds_read_b128 a[156:159], v241 offset:12288
    v_mov_b32 v224, 0
    v_mov_b32 v225, 0
    v_mov_b32 v226, 0
    v_mov_b32 v227, 0
    s_nop 3
    v_max3_f32 v230, v16, v17, v18
    v_max3_f32 v230, v230, v19, v20
    v_max3_f32 v230, v230, v21, v22
    v_max_f32 v230, v230, v23
    v_mov_b32 v231, v230
    s_nop 1
    v_permlane16_swap_b32 v230, v231
    s_nop 0
    v_max_f32 v230, v230, v231
    v_mov_b32 v231, v230
    s_nop 1
    v_permlane32_swap_b32 v230, v231
    s_nop 0
    v_max_f32 v230, v230, v231
    v_sub_f32 v16, v16, v230
    v_sub_f32 v17, v17, v230
    v_sub_f32 v18, v18, v230
    v_sub_f32 v19, v19, v230
    v_sub_f32 v20, v20, v230
    v_sub_f32 v21, v21, v230
    v_sub_f32 v22, v22, v230
    v_sub_f32 v23, v23, v230
    v_sub_f32 v80, 0, v230
    v_sub_f32 v81, 0, v230
    v_sub_f32 v82, 0, v230
    v_sub_f32 v83, 0, v230
    v_max3_f32 v230, v24, v25, v26
    v_max3_f32 v230, v230, v27, v28
    v_max3_f32 v230, v230, v29, v30
    v_max_f32 v230, v230, v31
    v_mov_b32 v231, v230
    s_nop 1
    v_permlane16_swap_b32 v230, v231
    s_nop 0
    v_max_f32 v230, v230, v231
    v_mov_b32 v231, v230
    s_nop 1
    v_permlane32_swap_b32 v230, v231
    s_nop 0
    v_max_f32 v230, v230, v231
    v_sub_f32 v24, v24, v230
    v_sub_f32 v25, v25, v230
    v_sub_f32 v26, v26, v230
    v_sub_f32 v27, v27, v230
    v_sub_f32 v28, v28, v230
    v_sub_f32 v29, v29, v230
    v_sub_f32 v30, v30, v230
    v_sub_f32 v31, v31, v230
    v_sub_f32 v84, 0, v230
    v_sub_f32 v85, 0, v230
    v_sub_f32 v86, 0, v230
    v_sub_f32 v87, 0, v230
    v_max3_f32 v230, v32, v33, v34
    v_max3_f32 v230, v230, v35, v36
    v_max3_f32 v230, v230, v37, v38
    v_max_f32 v230, v230, v39
    v_mov_b32 v231, v230
    s_nop 1
    v_permlane16_swap_b32 v230, v231
    s_nop 0
    v_max_f32 v230, v230, v231
    v_mov_b32 v231, v230
    s_nop 1
    v_permlane32_swap_b32 v230, v231
    s_nop 0
    v_max_f32 v230, v230, v231
    v_sub_f32 v32, v32, v230
    v_sub_f32 v33, v33, v230
    v_sub_f32 v34, v34, v230
    v_sub_f32 v35, v35, v230
    v_sub_f32 v36, v36, v230
    v_sub_f32 v37, v37, v230
    v_sub_f32 v38, v38, v230
    v_sub_f32 v39, v39, v230
    v_sub_f32 v88, 0, v230
    v_sub_f32 v89, 0, v230
    v_sub_f32 v90, 0, v230
    v_sub_f32 v91, 0, v230
    v_max3_f32 v230, v40, v41, v42
    v_max3_f32 v230, v230, v43, v44
    v_max3_f32 v230, v230, v45, v46
    v_max_f32 v230, v230, v47
    v_mov_b32 v231, v230
    s_nop 1
    v_permlane16_swap_b32 v230, v231
    s_nop 0
    v_max_f32 v230, v230, v231
    v_mov_b32 v231, v230
    s_nop 1
    v_permlane32_swap_b32 v230, v231
    s_nop 0
    v_max_f32 v230, v230, v231
    v_sub_f32 v40, v40, v230
    v_sub_f32 v41, v41, v230
    v_sub_f32 v42, v42, v230
    v_sub_f32 v43, v43, v230
    v_sub_f32 v44, v44, v230
    v_sub_f32 v45, v45, v230
    v_sub_f32 v46, v46, v230
    v_sub_f32 v47, v47, v230
    v_sub_f32 v92, 0, v230
    v_sub_f32 v93, 0, v230
    v_sub_f32 v94, 0, v230
    v_sub_f32 v95, 0, v230
    v_exp_f32 v208, v16
    v_exp_f32 v209, v17
    s_nop 0
    v_cvt_pk_bf16_f32 v96, v208, v209
    v_exp_f32 v210, v18
    v_add_f32 v216, v208, v209
    v_exp_f32 v211, v19
    v_add_f32 v216, v216, v210
    v_cvt_pk_bf16_f32 v97, v210, v211
    v_exp_f32 v212, v20
    v_add_f32 v216, v216, v211
    v_exp_f32 v213, v21
    v_add_f32 v216, v216, v212
    v_cvt_pk_bf16_f32 v98, v212, v213
    v_exp_f32 v214, v22
    v_add_f32 v216, v216, v213
    v_exp_f32 v215, v23
    v_add_f32 v216, v216, v214
    v_cvt_pk_bf16_f32 v99, v214, v215
    v_exp_f32 v208, v24
    v_add_f32 v216, v216, v215
    v_exp_f32 v209, v25
    s_nop 0
    v_cvt_pk_bf16_f32 v100, v208, v209
    v_exp_f32 v210, v26
    v_add_f32 v217, v208, v209
    v_exp_f32 v211, v27
    v_add_f32 v217, v217, v210
    v_cvt_pk_bf16_f32 v101, v210, v211
    v_exp_f32 v212, v28
    v_add_f32 v217, v217, v211
    v_exp_f32 v213, v29
    v_add_f32 v217, v217, v212
    v_cvt_pk_bf16_f32 v102, v212, v213
    v_exp_f32 v214, v30
    v_add_f32 v217, v217, v213
    v_exp_f32 v215, v31
    v_add_f32 v217, v217, v214
    v_cvt_pk_bf16_f32 v103, v214, v215
    v_exp_f32 v208, v32
    v_add_f32 v217, v217, v215
    v_exp_f32 v209, v33
    s_nop 0
    v_cvt_pk_bf16_f32 v104, v208, v209
    v_exp_f32 v210, v34
    v_add_f32 v218, v208, v209
    v_exp_f32 v211, v35
    v_add_f32 v218, v218, v210
    v_cvt_pk_bf16_f32 v105, v210, v211
    v_exp_f32 v212, v36
    v_add_f32 v218, v218, v211
    v_exp_f32 v213, v37
    v_add_f32 v218, v218, v212
    v_cvt_pk_bf16_f32 v106, v212, v213
    v_exp_f32 v214, v38
    v_add_f32 v218, v218, v213
    v_exp_f32 v215, v39
    v_add_f32 v218, v218, v214
    v_cvt_pk_bf16_f32 v107, v214, v215
    v_exp_f32 v208, v40
    v_add_f32 v218, v218, v215
    v_exp_f32 v209, v41
    s_waitcnt vmcnt(0) lgkmcnt(0)
    s_barrier
    s_cmp_lg_u32 s24, 0
    s_cbranch_scc1 L_sig2
    s_mov_b64 exec, 1
    v_mov_b32 v8, 1
    v_mov_b32 v9, 0
    buffer_atomic_add v8, v9, s[56:59], s67 offen offset:32 sc1
    s_mov_b64 exec, -1
L_sig2:
    v_lshrrev_b32 v6, 7, v14
    v_bfe_u32 v7, v14, 4, 3
    v_lshrrev_b32 v8, 1, v6
    v_lshlrev_b32 v8, 1, v8
    v_xor_b32 v8, v8, v7
    v_lshlrev_b32 v8, 4, v8
    v_lshl_add_u32 v9, v6, 10, v8
    s_mov_b32 s50, 1835008
    s_mov_b32 s54, 4194304
    s_lshl_b32 s63, s2, 2
    s_add_u32 s63, s63, s24
    s_mov_b32 s64, 4194304
    s_mov_b32 s86, 4095
    s_mov_b32 s87, 37978112
    s_cmp_lt_u32 s63, 299
    s_cselect_b32 s88, s92, s94
    s_cselect_b32 s89, s93, s95
    s_cselect_b32 s90, 1835008, s64
    s_cselect_b32 s86, 1791, s86
    s_cselect_b32 s87, 37748736, s87
    s_cselect_b32 s64, 0, 299
    s_mov_b32 s91, 0x20000
    s_sub_u32 s63, s63, s64
    s_mul_i32 s69, s63, 6
    s_add_u32 s63, s69, 0
    s_min_u32 s63, s63, s86
    s_and_b32 s64, s63, 7
    s_lshr_b32 s63, s63, 3
    s_lshl_b32 s63, s63, 13
    s_lshl_b32 s64, s64, 7
    s_add_u32 s63, s63, s64
    buffer_load_dwordx4 a[208:211], v9, s[88:91], s63 offen
    s_add_u32 s63, s69, 1
    s_min_u32 s63, s63, s86
    s_and_b32 s64, s63, 7
    s_lshr_b32 s63, s63, 3
    s_lshl_b32 s63, s63, 13
    s_lshl_b32 s64, s64, 7
    s_add_u32 s63, s63, s64
    buffer_load_dwordx4 a[212:215], v9, s[88:91], s63 offen
    s_add_u32 s63, s69, 2
    s_min_u32 s63, s63, s86
    s_and_b32 s64, s63, 7
    s_lshr_b32 s63, s63, 3
    s_lshl_b32 s63, s63, 13
    s_lshl_b32 s64, s64, 7
    s_add_u32 s63, s63, s64
    buffer_load_dwordx4 a[216:219], v9, s[88:91], s63 offen
    s_add_u32 s63, s69, 3
    s_min_u32 s63, s63, s86
    s_and_b32 s64, s63, 7
    s_lshr_b32 s63, s63, 3
    s_lshl_b32 s63, s63, 13
    s_lshl_b32 s64, s64, 7
    s_add_u32 s63, s63, s64
    buffer_load_dwordx4 a[220:223], v9, s[88:91], s63 offen
    s_add_u32 s63, s69, 4
    s_min_u32 s63, s63, s86
    s_and_b32 s64, s63, 7
    s_lshr_b32 s63, s63, 3
    s_lshl_b32 s63, s63, 13
    s_lshl_b32 s64, s64, 7
    s_add_u32 s63, s63, s64
    buffer_load_dwordx4 a[224:227], v9, s[88:91], s63 offen
    s_add_u32 s63, s69, 5
    s_min_u32 s63, s63, s86
    s_and_b32 s64, s63, 7
    s_lshr_b32 s63, s63, 3
    s_lshl_b32 s63, s63, 13
    s_lshl_b32 s64, s64, 7
    s_add_u32 s63, s63, s64
    buffer_load_dwordx4 a[228:231], v9, s[88:91], s63 offen
    s_mov_b32 s27, 7
.p2align 6
L_attn_loop:
    v_mfma_f32_16x16x32_bf16 v[48:51], a[128:131], v[144:147], v[80:83]
    v_cvt_pk_bf16_f32 v108, v208, v209
    v_exp_f32 v210, v42
    v_mfma_f32_16x16x32_bf16 v[48:51], a[132:135], v[148:151], v[48:51]
    ds_read_b64_tr_b16 a[160:161], v242 offset:0
    v_add_f32 v219, v208, v209
    v_mfma_f32_16x16x32_bf16 v[48:51], a[136:139], v[152:155], v[48:51]
    v_exp_f32 v211, v43
    v_mfma_f32_16x16x32_bf16 v[48:51], a[140:143], v[156:159], v[48:51]
    ds_read_b64_tr_b16 a[162:163], v242 offset:4096
    v_add_f32 v219, v219, v210
    v_cvt_pk_bf16_f32 v109, v210, v211
    v_mfma_f32_16x16x32_bf16 v[52:55], a[144:147], v[144:147], v[80:83]
    v_exp_f32 v212, v44
    v_mfma_f32_16x16x32_bf16 v[52:55], a[148:151], v[148:151], v[52:55]
    ds_read_b64_tr_b16 a[164:165], v243 offset:0
    v_add_f32 v219, v219, v211
    v_mfma_f32_16x16x32_bf16 v[52:55], a[152:155], v[152:155], v[52:55]
    v_exp_f32 v213, v45
    v_mfma_f32_16x16x32_bf16 v[52:55], a[156:159], v[156:159], v[52:55]
    ds_read_b64_tr_b16 a[166:167], v243 offset:4096
    v_add_f32 v219, v219, v212
    v_cvt_pk_bf16_f32 v110, v212, v213
    v_mfma_f32_16x16x32_bf16 v[56:59], a[128:131], v[160:163], v[84:87]
    v_exp_f32 v214, v46
    v_mfma_f32_16x16x32_bf16 v[56:59], a[132:135], v[164:167], v[56:59]
    ds_read_b64_tr_b16 a[168:169], v244 offset:0
    v_add_f32 v219, v219, v213
    v_mfma_f32_16x16x32_bf16 v[56:59], a[136:139], v[168:171], v[56:59]
    v_exp_f32 v215, v47
    v_mfma_f32_16x16x32_bf16 v[56:59], a[140:143], v[172:175], v[56:59]
    ds_read_b64_tr_b16 a[170:171], v244 offset:4096
    v_add_f32 v219, v219, v214
    v_cvt_pk_bf16_f32 v111, v214, v215
    v_mfma_f32_16x16x32_bf16 v[60:63], a[144:147], v[160:163], v[84:87]
    v_exp_f32 v208, v48
    v_mfma_f32_16x16x32_bf16 v[60:63], a[148:151], v[164:167], v[60:63]
    ds_read_b64_tr_b16 a[172:173], v245 offset:0
    v_add_f32 v219, v219, v215
    v_mfma_f32_16x16x32_bf16 v[60:63], a[152:155], v[168:171], v[60:63]
    v_exp_f32 v209, v49
    v_max3_f32 v228, v216, v217, v218
    v_mfma_f32_16x16x32_bf16 v[60:63], a[156:159], v[172:175], v[60:63]
    ds_read_b64_tr_b16 a[174:175], v245 offset:4096
    v_cvt_pk_bf16_f32 v112, v208, v209
    v_max_f32 v228, v228, v219
    v_mfma_f32_16x16x32_bf16 v[64:67], a[128:131], v[176:179], v[88:91]
    v_exp_f32 v210, v50
    v_mfma_f32_16x16x32_bf16 v[64:67], a[132:135], v[180:183], v[64:67]
    ds_read_b64_tr_b16 a[176:177], v246 offset:0
    v_add_f32 v220, v208, v209
    v_cmp_nle_f32 vcc, v228, v229
    v_mfma_f32_16x16x32_bf16 v[64:67], a[136:139], v[184:187], v[64:67]
    v_exp_f32 v211, v51
    v_mfma_f32_16x16x32_bf16 v[64:67], a[140:143], v[188:191], v[64:67]
    ds_read_b64_tr_b16 a[178:179], v246 offset:4096
    v_add_f32 v220, v220, v210
    v_cvt_pk_bf16_f32 v113, v210, v211
    v_mfma_f32_16x16x32_bf16 v[68:71], a[144:147], v[176:179], v[88:91]
    v_exp_f32 v212, v52
    v_mfma_f32_16x16x32_bf16 v[68:71], a[148:151], v[180:183], v[68:71]
    ds_read_b64_tr_b16 a[180:181], v247 offset:0
    v_add_f32 v220, v220, v211
    v_mfma_f32_16x16x32_bf16 v[68:71], a[152:155], v[184:187], v[68:71]
    v_exp_f32 v213, v53
    v_mfma_f32_16x16x32_bf16 v[68:71], a[156:159], v[188:191], v[68:71]
    ds_read_b64_tr_b16 a[182:183], v247 offset:4096
    v_add_f32 v220, v220, v212
    v_cvt_pk_bf16_f32 v114, v212, v213
    s_cbranch_vccnz L_tramp_1
L_back_2:
    v_mfma_f32_16x16x32_bf16 v[72:75], a[128:131], v[192:195], v[92:95]
    v_exp_f32 v214, v54
    v_mfma_f32_16x16x32_bf16 v[72:75], a[132:135], v[196:199], v[72:75]
    ds_read_b64_tr_b16 a[184:185], v248 offset:0
    v_add_f32 v220, v220, v213
    v_add_f32 v224, v224, v216
    v_mfma_f32_16x16x32_bf16 v[72:75], a[136:139], v[200:203], v[72:75]
    v_exp_f32 v215, v55
    v_mfma_f32_16x16x32_bf16 v[72:75], a[140:143], v[204:207], v[72:75]
    ds_read_b64_tr_b16 a[186:187], v248 offset:4096
    v_add_f32 v220, v220, v214
    v_cvt_pk_bf16_f32 v115, v214, v215
    v_add_f32 v225, v225, v217
    v_mfma_f32_16x16x32_bf16 v[76:79], a[144:147], v[192:195], v[92:95]
    v_exp_f32 v208, v56
    v_mfma_f32_16x16x32_bf16 v[76:79], a[148:151], v[196:199], v[76:79]
    ds_read_b64_tr_b16 a[188:189], v249 offset:0
    v_add_f32 v220, v220, v215
    v_add_f32 v226, v226, v218
    v_mfma_f32_16x16x32_bf16 v[76:79], a[152:155], v[200:203], v[76:79]
    v_exp_f32 v209, v57
    v_mfma_f32_16x16x32_bf16 v[76:79], a[156:159], v[204:207], v[76:79]
    ds_read_b64_tr_b16 a[190:191], v249 offset:4096
    s_waitcnt lgkmcnt(8)
    v_cvt_pk_bf16_f32 v116, v208, v209
    v_add_f32 v227, v227, v219
    v_mfma_f32_16x16x32_bf16 a[0:3], a[160:163], v[96:99], a[0:3]
    v_exp_f32 v210, v58
    v_mfma_f32_16x16x32_bf16 a[32:35], a[160:163], v[100:103], a[32:35]
    ds_read_b128 a[128:131], v238 offset:16384
    v_add_f32 v221, v208, v209
    v_mfma_f32_16x16x32_bf16 a[64:67], a[160:163], v[104:107], a[64:67]
    v_exp_f32 v211, v59
    v_mfma_f32_16x16x32_bf16 a[96:99], a[160:163], v[108:111], a[96:99]
    ds_read_b128 a[132:135], v239 offset:16384
    v_add_f32 v221, v221, v210
    v_cvt_pk_bf16_f32 v117, v210, v211
    v_mfma_f32_16x16x32_bf16 a[4:7], a[164:167], v[96:99], a[4:7]
    v_exp_f32 v212, v60
    v_mfma_f32_16x16x32_bf16 a[36:39], a[164:167], v[100:103], a[36:39]
    ds_read_b128 a[136:139], v240 offset:16384
    v_add_f32 v221, v221, v211
    v_mfma_f32_16x16x32_bf16 a[68:71], a[164:167], v[104:107], a[68:71]
    v_exp_f32 v213, v61
    v_mfma_f32_16x16x32_bf16 a[100:103], a[164:167], v[108:111], a[100:103]
    ds_read_b128 a[140:143], v241 offset:16384
    v_add_f32 v221, v221, v212
    v_cvt_pk_bf16_f32 v118, v212, v213
    v_mfma_f32_16x16x32_bf16 a[8:11], a[168:171], v[96:99], a[8:11]
    v_exp_f32 v214, v62
    v_mfma_f32_16x16x32_bf16 a[40:43], a[168:171], v[100:103], a[40:43]
    ds_read_b128 a[144:147], v238 offset:20480
    v_add_f32 v221, v221, v213
    v_mfma_f32_16x16x32_bf16 a[72:75], a[168:171], v[104:107], a[72:75]
    v_exp_f32 v215, v63
    v_mfma_f32_16x16x32_bf16 a[104:107], a[168:171], v[108:111], a[104:107]
    ds_read_b128 a[148:151], v239 offset:20480
    v_add_f32 v221, v221, v214
    v_cvt_pk_bf16_f32 v119, v214, v215
    v_mfma_f32_16x16x32_bf16 a[12:15], a[172:175], v[96:99], a[12:15]
    v_exp_f32 v208, v64
    v_mfma_f32_16x16x32_bf16 a[44:47], a[172:175], v[100:103], a[44:47]
    ds_read_b128 a[152:155], v240 offset:20480
    v_add_f32 v221, v221, v215
    v_mfma_f32_16x16x32_bf16 a[76:79], a[172:175], v[104:107], a[76:79]
    v_exp_f32 v209, v65
    v_mfma_f32_16x16x32_bf16 a[108:111], a[172:175], v[108:111], a[108:111]
    ds_read_b128 a[156:159], v241 offset:20480
    s_waitcnt lgkmcnt(8)
    v_cvt_pk_bf16_f32 v120, v208, v209
    v_mfma_f32_16x16x32_bf16 a[16:19], a[176:179], v[96:99], a[16:19]
    s_add_u32 m0, s33, 49152
    v_exp_f32 v210, v66
    v_mfma_f32_16x16x32_bf16 a[48:51], a[176:179], v[100:103], a[48:51]
    buffer_load_dwordx4 v250, s[4:7], s28 offen offset:0 lds
    v_add_f32 v222, v208, v209
    v_mfma_f32_16x16x32_bf16 a[80:83], a[176:179], v[104:107], a[80:83]
    v_exp_f32 v211, v67
    v_mfma_f32_16x16x32_bf16 a[112:115], a[176:179], v[108:111], a[112:115]
    v_add_f32 v222, v222, v210
    v_cvt_pk_bf16_f32 v121, v210, v211
    v_mfma_f32_16x16x32_bf16 a[20:23], a[180:183], v[96:99], a[20:23]
    v_exp_f32 v212, v68
    v_mfma_f32_16x16x32_bf16 a[52:55], a[180:183], v[100:103], a[52:55]
    buffer_load_dwordx4 v251, s[4:7], s28 offen offset:1024 lds
    v_add_f32 v222, v222, v211
    v_mfma_f32_16x16x32_bf16 a[84:87], a[180:183], v[104:107], a[84:87]
    v_exp_f32 v213, v69
    v_mfma_f32_16x16x32_bf16 a[116:119], a[180:183], v[108:111], a[116:119]
    v_add_f32 v222, v222, v212
    v_cvt_pk_bf16_f32 v122, v212, v213
    v_mfma_f32_16x16x32_bf16 a[24:27], a[184:187], v[96:99], a[24:27]
    v_exp_f32 v214, v70
    v_mfma_f32_16x16x32_bf16 a[56:59], a[184:187], v[100:103], a[56:59]
    buffer_load_dwordx4 v252, s[4:7], s28 offen offset:2048 lds
    v_add_f32 v222, v222, v213
    v_mfma_f32_16x16x32_bf16 a[88:91], a[184:187], v[104:107], a[88:91]
    v_exp_f32 v215, v71
    v_mfma_f32_16x16x32_bf16 a[120:123], a[184:187], v[108:111], a[120:123]
    v_add_f32 v222, v222, v214
    v_cvt_pk_bf16_f32 v123, v214, v215
    v_mfma_f32_16x16x32_bf16 a[28:31], a[188:191], v[96:99], a[28:31]
    v_exp_f32 v208, v72
    v_mfma_f32_16x16x32_bf16 a[60:63], a[188:191], v[100:103], a[60:63]
    buffer_load_dwordx4 v253, s[4:7], s28 offen offset:3072 lds
    v_add_f32 v222, v222, v215
    v_mfma_f32_16x16x32_bf16 a[92:95], a[188:191], v[104:107], a[92:95]
    s_add_u32 s28, s28, 16384
    v_exp_f32 v209, v73
    v_mfma_f32_16x16x32_bf16 a[124:127], a[188:191], v[108:111], a[124:127]
    s_waitcnt lgkmcnt(0)
    v_cvt_pk_bf16_f32 v124, v208, v209
    v_mfma_f32_16x16x32_bf16 v[16:19], a[128:131], v[144:147], v[80:83]
    v_exp_f32 v210, v74
    v_mfma_f32_16x16x32_bf16 v[16:19], a[132:135], v[148:151], v[16:19]
    ds_read_b64_tr_b16 a[160:161], v242 offset:8192
    v_add_f32 v223, v208, v209
    v_mfma_f32_16x16x32_bf16 v[16:19], a[136:139], v[152:155], v[16:19]
    v_exp_f32 v211, v75
    v_mfma_f32_16x16x32_bf16 v[16:19], a[140:143], v[156:159], v[16:19]
    ds_read_b64_tr_b16 a[162:163], v242 offset:12288
    v_add_f32 v223, v223, v210
    v_cvt_pk_bf16_f32 v125, v210, v211
    v_mfma_f32_16x16x32_bf16 v[20:23], a[144:147], v[144:147], v[80:83]
    v_exp_f32 v212, v76
    v_mfma_f32_16x16x32_bf16 v[20:23], a[148:151], v[148:151], v[20:23]
    ds_read_b64_tr_b16 a[164:165], v243 offset:8192
    v_add_f32 v223, v223, v211
    v_mfma_f32_16x16x32_bf16 v[20:23], a[152:155], v[152:155], v[20:23]
    v_exp_f32 v213, v77
    v_mfma_f32_16x16x32_bf16 v[20:23], a[156:159], v[156:159], v[20:23]
    ds_read_b64_tr_b16 a[166:167], v243 offset:12288
    v_add_f32 v223, v223, v212
    v_cvt_pk_bf16_f32 v126, v212, v213
    v_mfma_f32_16x16x32_bf16 v[24:27], a[128:131], v[160:163], v[84:87]
    v_exp_f32 v214, v78
    v_mfma_f32_16x16x32_bf16 v[24:27], a[132:135], v[164:167], v[24:27]
    ds_read_b64_tr_b16 a[168:169], v244 offset:8192
    v_add_f32 v223, v223, v213
    v_mfma_f32_16x16x32_bf16 v[24:27], a[136:139], v[168:171], v[24:27]
    v_exp_f32 v215, v79
    v_mfma_f32_16x16x32_bf16 v[24:27], a[140:143], v[172:175], v[24:27]
    ds_read_b64_tr_b16 a[170:171], v244 offset:12288
    v_add_f32 v223, v223, v214
    v_cvt_pk_bf16_f32 v127, v214, v215
    v_mfma_f32_16x16x32_bf16 v[28:31], a[144:147], v[160:163], v[84:87]
    v_exp_f32 v208, v16
    v_mfma_f32_16x16x32_bf16 v[28:31], a[148:151], v[164:167], v[28:31]
    ds_read_b64_tr_b16 a[172:173], v245 offset:8192
    v_add_f32 v223, v223, v215
    v_mfma_f32_16x16x32_bf16 v[28:31], a[152:155], v[168:171], v[28:31]
    v_exp_f32 v209, v17
    v_max3_f32 v228, v220, v221, v222
    v_mfma_f32_16x16x32_bf16 v[28:31], a[156:159], v[172:175], v[28:31]
    ds_read_b64_tr_b16 a[174:175], v245 offset:12288
    v_cvt_pk_bf16_f32 v96, v208, v209
    v_max_f32 v228, v228, v223
    v_mfma_f32_16x16x32_bf16 v[32:35], a[128:131], v[176:179], v[88:91]
    v_exp_f32 v210, v18
    v_mfma_f32_16x16x32_bf16 v[32:35], a[132:135], v[180:183], v[32:35]
    ds_read_b64_tr_b16 a[176:177], v246 offset:8192
    v_add_f32 v216, v208, v209
    v_cmp_nle_f32 vcc, v228, v229
    v_mfma_f32_16x16x32_bf16 v[32:35], a[136:139], v[184:187], v[32:35]
    v_exp_f32 v211, v19
    v_mfma_f32_16x16x32_bf16 v[32:35], a[140:143], v[188:191], v[32:35]
    ds_read_b64_tr_b16 a[178:179], v246 offset:12288
    v_add_f32 v216, v216, v210
    v_cvt_pk_bf16_f32 v97, v210, v211
    v_mfma_f32_16x16x32_bf16 v[36:39], a[144:147], v[176:179], v[88:91]
    v_exp_f32 v212, v20
    v_mfma_f32_16x16x32_bf16 v[36:39], a[148:151], v[180:183], v[36:39]
    ds_read_b64_tr_b16 a[180:181], v247 offset:8192
    v_add_f32 v216, v216, v211
    v_mfma_f32_16x16x32_bf16 v[36:39], a[152:155], v[184:187], v[36:39]
    v_exp_f32 v213, v21
    v_mfma_f32_16x16x32_bf16 v[36:39], a[156:159], v[188:191], v[36:39]
    ds_read_b64_tr_b16 a[182:183], v247 offset:12288
    v_add_f32 v216, v216, v212
    v_cvt_pk_bf16_f32 v98, v212, v213
    s_cbranch_vccnz L_tramp_3
L_back_4:
    v_mfma_f32_16x16x32_bf16 v[40:43], a[128:131], v[192:195], v[92:95]
    v_exp_f32 v214, v22
    v_mfma_f32_16x16x32_bf16 v[40:43], a[132:135], v[196:199], v[40:43]
    ds_read_b64_tr_b16 a[184:185], v248 offset:8192
    v_add_f32 v216, v216, v213
    v_add_f32 v224, v224, v220
    v_mfma_f32_16x16x32_bf16 v[40:43], a[136:139], v[200:203], v[40:43]
    v_exp_f32 v215, v23
    v_mfma_f32_16x16x32_bf16 v[40:43], a[140:143], v[204:207], v[40:43]
    ds_read_b64_tr_b16 a[186:187], v248 offset:12288
    v_add_f32 v216, v216, v214
    v_cvt_pk_bf16_f32 v99, v214, v215
    v_add_f32 v225, v225, v221
    v_mfma_f32_16x16x32_bf16 v[44:47], a[144:147], v[192:195], v[92:95]
    v_exp_f32 v208, v24
    v_mfma_f32_16x16x32_bf16 v[44:47], a[148:151], v[196:199], v[44:47]
    ds_read_b64_tr_b16 a[188:189], v249 offset:8192
    v_add_f32 v216, v216, v215
    v_add_f32 v226, v226, v222
    v_mfma_f32_16x16x32_bf16 v[44:47], a[152:155], v[200:203], v[44:47]
    v_exp_f32 v209, v25
    v_mfma_f32_16x16x32_bf16 v[44:47], a[156:159], v[204:207], v[44:47]
    ds_read_b64_tr_b16 a[190:191], v249 offset:12288
    s_waitcnt lgkmcnt(8)
    v_cvt_pk_bf16_f32 v100, v208, v209
    v_add_f32 v227, v227, v223
    v_mfma_f32_16x16x32_bf16 a[0:3], a[160:163], v[112:115], a[0:3]
    v_exp_f32 v210, v26
    v_mfma_f32_16x16x32_bf16 a[32:35], a[160:163], v[116:119], a[32:35]
    ds_read_b128 a[128:131], v238 offset:24576
    v_add_f32 v217, v208, v209
    v_mfma_f32_16x16x32_bf16 a[64:67], a[160:163], v[120:123], a[64:67]
    v_exp_f32 v211, v27
    v_mfma_f32_16x16x32_bf16 a[96:99], a[160:163], v[124:127], a[96:99]
    ds_read_b128 a[132:135], v239 offset:24576
    v_add_f32 v217, v217, v210
    v_cvt_pk_bf16_f32 v101, v210, v211
    v_mfma_f32_16x16x32_bf16 a[4:7], a[164:167], v[112:115], a[4:7]
    v_exp_f32 v212, v28
    v_mfma_f32_16x16x32_bf16 a[36:39], a[164:167], v[116:119], a[36:39]
    ds_read_b128 a[136:139], v240 offset:24576
    v_add_f32 v217, v217, v211
    v_mfma_f32_16x16x32_bf16 a[68:71], a[164:167], v[120:123], a[68:71]
    v_exp_f32 v213, v29
    v_mfma_f32_16x16x32_bf16 a[100:103], a[164:167], v[124:127], a[100:103]
    ds_read_b128 a[140:143], v241 offset:24576
    v_add_f32 v217, v217, v212
    v_cvt_pk_bf16_f32 v102, v212, v213
    v_mfma_f32_16x16x32_bf16 a[8:11], a[168:171], v[112:115], a[8:11]
    v_exp_f32 v214, v30
    v_mfma_f32_16x16x32_bf16 a[40:43], a[168:171], v[116:119], a[40:43]
    ds_read_b128 a[144:147], v238 offset:28672
    v_add_f32 v217, v217, v213
    v_mfma_f32_16x16x32_bf16 a[72:75], a[168:171], v[120:123], a[72:75]
    v_exp_f32 v215, v31
    v_mfma_f32_16x16x32_bf16 a[104:107], a[168:171], v[124:127], a[104:107]
    ds_read_b128 a[148:151], v239 offset:28672
    v_add_f32 v217, v217, v214
    v_cvt_pk_bf16_f32 v103, v214, v215
    v_mfma_f32_16x16x32_bf16 a[12:15], a[172:175], v[112:115], a[12:15]
    v_exp_f32 v208, v32
    v_mfma_f32_16x16x32_bf16 a[44:47], a[172:175], v[116:119], a[44:47]
    ds_read_b128 a[152:155], v240 offset:28672
    v_add_f32 v217, v217, v215
    v_mfma_f32_16x16x32_bf16 a[76:79], a[172:175], v[120:123], a[76:79]
    v_exp_f32 v209, v33
    v_mfma_f32_16x16x32_bf16 a[108:111], a[172:175], v[124:127], a[108:111]
    ds_read_b128 a[156:159], v241 offset:28672
    s_waitcnt lgkmcnt(8)
    v_cvt_pk_bf16_f32 v104, v208, v209
    v_mfma_f32_16x16x32_bf16 a[16:19], a[176:179], v[112:115], a[16:19]
    s_add_u32 m0, s34, 49152
    v_exp_f32 v210, v34
    v_mfma_f32_16x16x32_bf16 a[48:51], a[176:179], v[116:119], a[48:51]
    buffer_load_dwordx4 v254, s[8:11], s29 offen offset:0 lds
    v_add_f32 v218, v208, v209
    v_mfma_f32_16x16x32_bf16 a[80:83], a[176:179], v[120:123], a[80:83]
    v_exp_f32 v211, v35
    v_mfma_f32_16x16x32_bf16 a[112:115], a[176:179], v[124:127], a[112:115]
    v_add_f32 v218, v218, v210
    v_cvt_pk_bf16_f32 v105, v210, v211
    v_mfma_f32_16x16x32_bf16 a[20:23], a[180:183], v[112:115], a[20:23]
    v_exp_f32 v212, v36
    v_mfma_f32_16x16x32_bf16 a[52:55], a[180:183], v[116:119], a[52:55]
    buffer_load_dwordx4 v255, s[8:11], s29 offen offset:1024 lds
    v_add_f32 v218, v218, v211
    v_mfma_f32_16x16x32_bf16 a[84:87], a[180:183], v[120:123], a[84:87]
    v_exp_f32 v213, v37
    v_mfma_f32_16x16x32_bf16 a[116:119], a[180:183], v[124:127], a[116:119]
    v_add_f32 v218, v218, v212
    v_cvt_pk_bf16_f32 v106, v212, v213
    v_mfma_f32_16x16x32_bf16 a[24:27], a[184:187], v[112:115], a[24:27]
    v_exp_f32 v214, v38
    v_mfma_f32_16x16x32_bf16 a[56:59], a[184:187], v[116:119], a[56:59]
    buffer_load_dwordx4 v254, s[8:11], s29 offen offset:2048 lds
    v_add_f32 v218, v218, v213
    v_mfma_f32_16x16x32_bf16 a[88:91], a[184:187], v[120:123], a[88:91]
    v_exp_f32 v215, v39
    v_mfma_f32_16x16x32_bf16 a[120:123], a[184:187], v[124:127], a[120:123]
    v_add_f32 v218, v218, v214
    v_cvt_pk_bf16_f32 v107, v214, v215
    v_mfma_f32_16x16x32_bf16 a[28:31], a[188:191], v[112:115], a[28:31]
    v_exp_f32 v208, v40
    v_mfma_f32_16x16x32_bf16 a[60:63], a[188:191], v[116:119], a[60:63]
    buffer_load_dwordx4 v255, s[8:11], s29 offen offset:3072 lds
    v_add_f32 v218, v218, v215
    v_mfma_f32_16x16x32_bf16 a[92:95], a[188:191], v[120:123], a[92:95]
    s_add_u32 s29, s29, 16384
    v_exp_f32 v209, v41
    v_mfma_f32_16x16x32_bf16 a[124:127], a[188:191], v[124:127], a[124:127]
    s_waitcnt vmcnt(8) lgkmcnt(0)
    s_barrier
    v_mfma_f32_16x16x32_bf16 v[48:51], a[128:131], v[144:147], v[80:83]
    v_cvt_pk_bf16_f32 v108, v208, v209
    v_exp_f32 v210, v42
    v_mfma_f32_16x16x32_bf16 v[48:51], a[132:135], v[148:151], v[48:51]
    ds_read_b64_tr_b16 a[160:161], v242 offset:16384
    v_add_f32 v219, v208, v209
    v_mfma_f32_16x16x32_bf16 v[48:51], a[136:139], v[152:155], v[48:51]
    v_exp_f32 v211, v43
    v_mfma_f32_16x16x32_bf16 v[48:51], a[140:143], v[156:159], v[48:51]
    ds_read_b64_tr_b16 a[162:163], v242 offset:20480
    v_add_f32 v219, v219, v210
    v_cvt_pk_bf16_f32 v109, v210, v211
    v_mfma_f32_16x16x32_bf16 v[52:55], a[144:147], v[144:147], v[80:83]
    v_exp_f32 v212, v44
    v_mfma_f32_16x16x32_bf16 v[52:55], a[148:151], v[148:151], v[52:55]
    ds_read_b64_tr_b16 a[164:165], v243 offset:16384
    v_add_f32 v219, v219, v211
    v_mfma_f32_16x16x32_bf16 v[52:55], a[152:155], v[152:155], v[52:55]
    v_exp_f32 v213, v45
    v_mfma_f32_16x16x32_bf16 v[52:55], a[156:159], v[156:159], v[52:55]
    ds_read_b64_tr_b16 a[166:167], v243 offset:20480
    v_add_f32 v219, v219, v212
    v_cvt_pk_bf16_f32 v110, v212, v213
    v_mfma_f32_16x16x32_bf16 v[56:59], a[128:131], v[160:163], v[84:87]
    v_exp_f32 v214, v46
    v_mfma_f32_16x16x32_bf16 v[56:59], a[132:135], v[164:167], v[56:59]
    ds_read_b64_tr_b16 a[168:169], v244 offset:16384
    v_add_f32 v219, v219, v213
    v_mfma_f32_16x16x32_bf16 v[56:59], a[136:139], v[168:171], v[56:59]
    v_exp_f32 v215, v47
    v_mfma_f32_16x16x32_bf16 v[56:59], a[140:143], v[172:175], v[56:59]
    ds_read_b64_tr_b16 a[170:171], v244 offset:20480
    v_add_f32 v219, v219, v214
    v_cvt_pk_bf16_f32 v111, v214, v215
    v_mfma_f32_16x16x32_bf16 v[60:63], a[144:147], v[160:163], v[84:87]
    v_exp_f32 v208, v48
    v_mfma_f32_16x16x32_bf16 v[60:63], a[148:151], v[164:167], v[60:63]
    ds_read_b64_tr_b16 a[172:173], v245 offset:16384
    v_add_f32 v219, v219, v215
    v_mfma_f32_16x16x32_bf16 v[60:63], a[152:155], v[168:171], v[60:63]
    v_exp_f32 v209, v49
    v_max3_f32 v228, v216, v217, v218
    v_mfma_f32_16x16x32_bf16 v[60:63], a[156:159], v[172:175], v[60:63]
    ds_read_b64_tr_b16 a[174:175], v245 offset:20480
    v_cvt_pk_bf16_f32 v112, v208, v209
    v_max_f32 v228, v228, v219
    v_mfma_f32_16x16x32_bf16 v[64:67], a[128:131], v[176:179], v[88:91]
    v_exp_f32 v210, v50
    v_mfma_f32_16x16x32_bf16 v[64:67], a[132:135], v[180:183], v[64:67]
    ds_read_b64_tr_b16 a[176:177], v246 offset:16384
    v_add_f32 v220, v208, v209
    v_cmp_nle_f32 vcc, v228, v229
    v_mfma_f32_16x16x32_bf16 v[64:67], a[136:139], v[184:187], v[64:67]
    v_exp_f32 v211, v51
    v_mfma_f32_16x16x32_bf16 v[64:67], a[140:143], v[188:191], v[64:67]
    ds_read_b64_tr_b16 a[178:179], v246 offset:20480
    v_add_f32 v220, v220, v210
    v_cvt_pk_bf16_f32 v113, v210, v211
    v_mfma_f32_16x16x32_bf16 v[68:71], a[144:147], v[176:179], v[88:91]
    v_exp_f32 v212, v52
    v_mfma_f32_16x16x32_bf16 v[68:71], a[148:151], v[180:183], v[68:71]
    ds_read_b64_tr_b16 a[180:181], v247 offset:16384
    v_add_f32 v220, v220, v211
    v_mfma_f32_16x16x32_bf16 v[68:71], a[152:155], v[184:187], v[68:71]
    v_exp_f32 v213, v53
    v_mfma_f32_16x16x32_bf16 v[68:71], a[156:159], v[188:191], v[68:71]
    ds_read_b64_tr_b16 a[182:183], v247 offset:20480
    v_add_f32 v220, v220, v212
    v_cvt_pk_bf16_f32 v114, v212, v213
    s_cbranch_vccnz L_tramp_5
L_back_6:
    v_mfma_f32_16x16x32_bf16 v[72:75], a[128:131], v[192:195], v[92:95]
    v_exp_f32 v214, v54
    v_mfma_f32_16x16x32_bf16 v[72:75], a[132:135], v[196:199], v[72:75]
    ds_read_b64_tr_b16 a[184:185], v248 offset:16384
    v_add_f32 v220, v220, v213
    v_add_f32 v224, v224, v216
    v_mfma_f32_16x16x32_bf16 v[72:75], a[136:139], v[200:203], v[72:75]
    v_exp_f32 v215, v55
    v_mfma_f32_16x16x32_bf16 v[72:75], a[140:143], v[204:207], v[72:75]
    ds_read_b64_tr_b16 a[186:187], v248 offset:20480
    v_add_f32 v220, v220, v214
    v_cvt_pk_bf16_f32 v115, v214, v215
    v_add_f32 v225, v225, v217
    v_mfma_f32_16x16x32_bf16 v[76:79], a[144:147], v[192:195], v[92:95]
    v_exp_f32 v208, v56
    v_mfma_f32_16x16x32_bf16 v[76:79], a[148:151], v[196:199], v[76:79]
    ds_read_b64_tr_b16 a[188:189], v249 offset:16384
    v_add_f32 v220, v220, v215
    v_add_f32 v226, v226, v218
    v_mfma_f32_16x16x32_bf16 v[76:79], a[152:155], v[200:203], v[76:79]
    v_exp_f32 v209, v57
    v_mfma_f32_16x16x32_bf16 v[76:79], a[156:159], v[204:207], v[76:79]
    ds_read_b64_tr_b16 a[190:191], v249 offset:20480
    s_waitcnt lgkmcnt(8)
    v_cvt_pk_bf16_f32 v116, v208, v209
    v_add_f32 v227, v227, v219
    v_mfma_f32_16x16x32_bf16 a[0:3], a[160:163], v[96:99], a[0:3]
    v_exp_f32 v210, v58
    v_mfma_f32_16x16x32_bf16 a[32:35], a[160:163], v[100:103], a[32:35]
    ds_read_b128 a[128:131], v238 offset:32768
    v_add_f32 v221, v208, v209
    v_mfma_f32_16x16x32_bf16 a[64:67], a[160:163], v[104:107], a[64:67]
    v_exp_f32 v211, v59
    v_mfma_f32_16x16x32_bf16 a[96:99], a[160:163], v[108:111], a[96:99]
    ds_read_b128 a[132:135], v239 offset:32768
    v_add_f32 v221, v221, v210
    v_cvt_pk_bf16_f32 v117, v210, v211
    v_mfma_f32_16x16x32_bf16 a[4:7], a[164:167], v[96:99], a[4:7]
    v_exp_f32 v212, v60
    v_mfma_f32_16x16x32_bf16 a[36:39], a[164:167], v[100:103], a[36:39]
    ds_read_b128 a[136:139], v240 offset:32768
    v_add_f32 v221, v221, v211
    v_mfma_f32_16x16x32_bf16 a[68:71], a[164:167], v[104:107], a[68:71]
    v_exp_f32 v213, v61
    v_mfma_f32_16x16x32_bf16 a[100:103], a[164:167], v[108:111], a[100:103]
    ds_read_b128 a[140:143], v241 offset:32768
    v_add_f32 v221, v221, v212
    v_cvt_pk_bf16_f32 v118, v212, v213
    v_mfma_f32_16x16x32_bf16 a[8:11], a[168:171], v[96:99], a[8:11]
    v_exp_f32 v214, v62
    v_mfma_f32_16x16x32_bf16 a[40:43], a[168:171], v[100:103], a[40:43]
    ds_read_b128 a[144:147], v238 offset:36864
    v_add_f32 v221, v221, v213
    v_mfma_f32_16x16x32_bf16 a[72:75], a[168:171], v[104:107], a[72:75]
    v_exp_f32 v215, v63
    v_mfma_f32_16x16x32_bf16 a[104:107], a[168:171], v[108:111], a[104:107]
    ds_read_b128 a[148:151], v239 offset:36864
    v_add_f32 v221, v221, v214
    v_cvt_pk_bf16_f32 v119, v214, v215
    v_mfma_f32_16x16x32_bf16 a[12:15], a[172:175], v[96:99], a[12:15]
    v_exp_f32 v208, v64
    v_mfma_f32_16x16x32_bf16 a[44:47], a[172:175], v[100:103], a[44:47]
    ds_read_b128 a[152:155], v240 offset:36864
    v_add_f32 v221, v221, v215
    v_mfma_f32_16x16x32_bf16 a[76:79], a[172:175], v[104:107], a[76:79]
    v_exp_f32 v209, v65
    v_mfma_f32_16x16x32_bf16 a[108:111], a[172:175], v[108:111], a[108:111]
    ds_read_b128 a[156:159], v241 offset:36864
    s_waitcnt lgkmcnt(8)
    v_cvt_pk_bf16_f32 v120, v208, v209
    v_mfma_f32_16x16x32_bf16 a[16:19], a[176:179], v[96:99], a[16:19]
    s_add_u32 m0, s33, 0
    v_exp_f32 v210, v66
    v_mfma_f32_16x16x32_bf16 a[48:51], a[176:179], v[100:103], a[48:51]
    buffer_load_dwordx4 v250, s[4:7], s28 offen offset:0 lds
    v_add_f32 v222, v208, v209
    v_mfma_f32_16x16x32_bf16 a[80:83], a[176:179], v[104:107], a[80:83]
    v_exp_f32 v211, v67
    v_mfma_f32_16x16x32_bf16 a[112:115], a[176:179], v[108:111], a[112:115]
    v_add_f32 v222, v222, v210
    v_cvt_pk_bf16_f32 v121, v210, v211
    v_mfma_f32_16x16x32_bf16 a[20:23], a[180:183], v[96:99], a[20:23]
    v_exp_f32 v212, v68
    v_mfma_f32_16x16x32_bf16 a[52:55], a[180:183], v[100:103], a[52:55]
    buffer_load_dwordx4 v251, s[4:7], s28 offen offset:1024 lds
    v_add_f32 v222, v222, v211
    v_mfma_f32_16x16x32_bf16 a[84:87], a[180:183], v[104:107], a[84:87]
    v_exp_f32 v213, v69
    v_mfma_f32_16x16x32_bf16 a[116:119], a[180:183], v[108:111], a[116:119]
    v_add_f32 v222, v222, v212
    v_cvt_pk_bf16_f32 v122, v212, v213
    v_mfma_f32_16x16x32_bf16 a[24:27], a[184:187], v[96:99], a[24:27]
    v_exp_f32 v214, v70
    v_mfma_f32_16x16x32_bf16 a[56:59], a[184:187], v[100:103], a[56:59]
    buffer_load_dwordx4 v252, s[4:7], s28 offen offset:2048 lds
    v_add_f32 v222, v222, v213
    v_mfma_f32_16x16x32_bf16 a[88:91], a[184:187], v[104:107], a[88:91]
    v_exp_f32 v215, v71
    v_mfma_f32_16x16x32_bf16 a[120:123], a[184:187], v[108:111], a[120:123]
    v_add_f32 v222, v222, v214
    v_cvt_pk_bf16_f32 v123, v214, v215
    v_mfma_f32_16x16x32_bf16 a[28:31], a[188:191], v[96:99], a[28:31]
    v_exp_f32 v208, v72
    v_mfma_f32_16x16x32_bf16 a[60:63], a[188:191], v[100:103], a[60:63]
    buffer_load_dwordx4 v253, s[4:7], s28 offen offset:3072 lds
    v_add_f32 v222, v222, v215
    v_mfma_f32_16x16x32_bf16 a[92:95], a[188:191], v[104:107], a[92:95]
    s_add_u32 s28, s28, 16384
    v_exp_f32 v209, v73
    v_mfma_f32_16x16x32_bf16 a[124:127], a[188:191], v[108:111], a[124:127]
    s_waitcnt lgkmcnt(0)
    v_cvt_pk_bf16_f32 v124, v208, v209
    v_mfma_f32_16x16x32_bf16 v[16:19], a[128:131], v[144:147], v[80:83]
    v_exp_f32 v210, v74
    v_mfma_f32_16x16x32_bf16 v[16:19], a[132:135], v[148:151], v[16:19]
    ds_read_b64_tr_b16 a[160:161], v242 offset:24576
    v_add_f32 v223, v208, v209
    v_mfma_f32_16x16x32_bf16 v[16:19], a[136:139], v[152:155], v[16:19]
    v_exp_f32 v211, v75
    v_mfma_f32_16x16x32_bf16 v[16:19], a[140:143], v[156:159], v[16:19]
    ds_read_b64_tr_b16 a[162:163], v242 offset:28672
    v_add_f32 v223, v223, v210
    v_cvt_pk_bf16_f32 v125, v210, v211
    v_mfma_f32_16x16x32_bf16 v[20:23], a[144:147], v[144:147], v[80:83]
    v_exp_f32 v212, v76
    v_mfma_f32_16x16x32_bf16 v[20:23], a[148:151], v[148:151], v[20:23]
    ds_read_b64_tr_b16 a[164:165], v243 offset:24576
    v_add_f32 v223, v223, v211
    v_mfma_f32_16x16x32_bf16 v[20:23], a[152:155], v[152:155], v[20:23]
    v_exp_f32 v213, v77
    v_mfma_f32_16x16x32_bf16 v[20:23], a[156:159], v[156:159], v[20:23]
    ds_read_b64_tr_b16 a[166:167], v243 offset:28672
    v_add_f32 v223, v223, v212
    v_cvt_pk_bf16_f32 v126, v212, v213
    v_mfma_f32_16x16x32_bf16 v[24:27], a[128:131], v[160:163], v[84:87]
    v_exp_f32 v214, v78
    v_mfma_f32_16x16x32_bf16 v[24:27], a[132:135], v[164:167], v[24:27]
    ds_read_b64_tr_b16 a[168:169], v244 offset:24576
    v_add_f32 v223, v223, v213
    v_mfma_f32_16x16x32_bf16 v[24:27], a[136:139], v[168:171], v[24:27]
    v_exp_f32 v215, v79
    v_mfma_f32_16x16x32_bf16 v[24:27], a[140:143], v[172:175], v[24:27]
    ds_read_b64_tr_b16 a[170:171], v244 offset:28672
    v_add_f32 v223, v223, v214
    v_cvt_pk_bf16_f32 v127, v214, v215
    v_mfma_f32_16x16x32_bf16 v[28:31], a[144:147], v[160:163], v[84:87]
    v_exp_f32 v208, v16
    v_mfma_f32_16x16x32_bf16 v[28:31], a[148:151], v[164:167], v[28:31]
    ds_read_b64_tr_b16 a[172:173], v245 offset:24576
    v_add_f32 v223, v223, v215
    v_mfma_f32_16x16x32_bf16 v[28:31], a[152:155], v[168:171], v[28:31]
    v_exp_f32 v209, v17
    v_max3_f32 v228, v220, v221, v222
    v_mfma_f32_16x16x32_bf16 v[28:31], a[156:159], v[172:175], v[28:31]
    ds_read_b64_tr_b16 a[174:175], v245 offset:28672
    v_cvt_pk_bf16_f32 v96, v208, v209
    v_max_f32 v228, v228, v223
    v_mfma_f32_16x16x32_bf16 v[32:35], a[128:131], v[176:179], v[88:91]
    v_exp_f32 v210, v18
    v_mfma_f32_16x16x32_bf16 v[32:35], a[132:135], v[180:183], v[32:35]
    ds_read_b64_tr_b16 a[176:177], v246 offset:24576
    v_add_f32 v216, v208, v209
    v_cmp_nle_f32 vcc, v228, v229
    v_mfma_f32_16x16x32_bf16 v[32:35], a[136:139], v[184:187], v[32:35]
    v_exp_f32 v211, v19
    v_mfma_f32_16x16x32_bf16 v[32:35], a[140:143], v[188:191], v[32:35]
    ds_read_b64_tr_b16 a[178:179], v246 offset:28672
    v_add_f32 v216, v216, v210
    v_cvt_pk_bf16_f32 v97, v210, v211
    v_mfma_f32_16x16x32_bf16 v[36:39], a[144:147], v[176:179], v[88:91]
    v_exp_f32 v212, v20
    v_mfma_f32_16x16x32_bf16 v[36:39], a[148:151], v[180:183], v[36:39]
    ds_read_b64_tr_b16 a[180:181], v247 offset:24576
    v_add_f32 v216, v216, v211
    v_mfma_f32_16x16x32_bf16 v[36:39], a[152:155], v[184:187], v[36:39]
    v_exp_f32 v213, v21
    v_mfma_f32_16x16x32_bf16 v[36:39], a[156:159], v[188:191], v[36:39]
    ds_read_b64_tr_b16 a[182:183], v247 offset:28672
    v_add_f32 v216, v216, v212
    v_cvt_pk_bf16_f32 v98, v212, v213
    s_cbranch_vccnz L_tramp_7
L_back_8:
    v_mfma_f32_16x16x32_bf16 v[40:43], a[128:131], v[192:195], v[92:95]
    v_exp_f32 v214, v22
    v_mfma_f32_16x16x32_bf16 v[40:43], a[132:135], v[196:199], v[40:43]
    ds_read_b64_tr_b16 a[184:185], v248 offset:24576
    v_add_f32 v216, v216, v213
    v_add_f32 v224, v224, v220
    v_mfma_f32_16x16x32_bf16 v[40:43], a[136:139], v[200:203], v[40:43]
    v_exp_f32 v215, v23
    v_mfma_f32_16x16x32_bf16 v[40:43], a[140:143], v[204:207], v[40:43]
    ds_read_b64_tr_b16 a[186:187], v248 offset:28672
    v_add_f32 v216, v216, v214
    v_cvt_pk_bf16_f32 v99, v214, v215
    v_add_f32 v225, v225, v221
    v_mfma_f32_16x16x32_bf16 v[44:47], a[144:147], v[192:195], v[92:95]
    v_exp_f32 v208, v24
    v_mfma_f32_16x16x32_bf16 v[44:47], a[148:151], v[196:199], v[44:47]
    ds_read_b64_tr_b16 a[188:189], v249 offset:24576
    v_add_f32 v216, v216, v215
    v_add_f32 v226, v226, v222
    v_mfma_f32_16x16x32_bf16 v[44:47], a[152:155], v[200:203], v[44:47]
    v_exp_f32 v209, v25
    v_mfma_f32_16x16x32_bf16 v[44:47], a[156:159], v[204:207], v[44:47]
    ds_read_b64_tr_b16 a[190:191], v249 offset:28672
    s_waitcnt lgkmcnt(8)
    v_cvt_pk_bf16_f32 v100, v208, v209
    v_add_f32 v227, v227, v223
    v_mfma_f32_16x16x32_bf16 a[0:3], a[160:163], v[112:115], a[0:3]
    v_exp_f32 v210, v26
    v_mfma_f32_16x16x32_bf16 a[32:35], a[160:163], v[116:119], a[32:35]
    ds_read_b128 a[128:131], v238 offset:40960
    v_add_f32 v217, v208, v209
    v_mfma_f32_16x16x32_bf16 a[64:67], a[160:163], v[120:123], a[64:67]
    v_exp_f32 v211, v27
    v_mfma_f32_16x16x32_bf16 a[96:99], a[160:163], v[124:127], a[96:99]
    ds_read_b128 a[132:135], v239 offset:40960
    v_add_f32 v217, v217, v210
    v_cvt_pk_bf16_f32 v101, v210, v211
    v_mfma_f32_16x16x32_bf16 a[4:7], a[164:167], v[112:115], a[4:7]
    v_exp_f32 v212, v28
    v_mfma_f32_16x16x32_bf16 a[36:39], a[164:167], v[116:119], a[36:39]
    ds_read_b128 a[136:139], v240 offset:40960
    v_add_f32 v217, v217, v211
    v_mfma_f32_16x16x32_bf16 a[68:71], a[164:167], v[120:123], a[68:71]
    v_exp_f32 v213, v29
    v_mfma_f32_16x16x32_bf16 a[100:103], a[164:167], v[124:127], a[100:103]
    ds_read_b128 a[140:143], v241 offset:40960
    v_add_f32 v217, v217, v212
    v_cvt_pk_bf16_f32 v102, v212, v213
    v_mfma_f32_16x16x32_bf16 a[8:11], a[168:171], v[112:115], a[8:11]
    v_exp_f32 v214, v30
    v_mfma_f32_16x16x32_bf16 a[40:43], a[168:171], v[116:119], a[40:43]
    ds_read_b128 a[144:147], v238 offset:45056
    v_add_f32 v217, v217, v213
    v_mfma_f32_16x16x32_bf16 a[72:75], a[168:171], v[120:123], a[72:75]
    v_exp_f32 v215, v31
    v_mfma_f32_16x16x32_bf16 a[104:107], a[168:171], v[124:127], a[104:107]
    ds_read_b128 a[148:151], v239 offset:45056
    v_add_f32 v217, v217, v214
    v_cvt_pk_bf16_f32 v103, v214, v215
    v_mfma_f32_16x16x32_bf16 a[12:15], a[172:175], v[112:115], a[12:15]
    v_exp_f32 v208, v32
    v_mfma_f32_16x16x32_bf16 a[44:47], a[172:175], v[116:119], a[44:47]
    ds_read_b128 a[152:155], v240 offset:45056
    v_add_f32 v217, v217, v215
    v_mfma_f32_16x16x32_bf16 a[76:79], a[172:175], v[120:123], a[76:79]
    v_exp_f32 v209, v33
    v_mfma_f32_16x16x32_bf16 a[108:111], a[172:175], v[124:127], a[108:111]
    ds_read_b128 a[156:159], v241 offset:45056
    s_waitcnt lgkmcnt(8)
    v_cvt_pk_bf16_f32 v104, v208, v209
    v_mfma_f32_16x16x32_bf16 a[16:19], a[176:179], v[112:115], a[16:19]
    s_add_u32 m0, s34, 0
    v_exp_f32 v210, v34
    v_mfma_f32_16x16x32_bf16 a[48:51], a[176:179], v[116:119], a[48:51]
    buffer_load_dwordx4 v254, s[8:11], s29 offen offset:0 lds
    v_add_f32 v218, v208, v209
    v_mfma_f32_16x16x32_bf16 a[80:83], a[176:179], v[120:123], a[80:83]
    v_exp_f32 v211, v35
    v_mfma_f32_16x16x32_bf16 a[112:115], a[176:179], v[124:127], a[112:115]
    v_add_f32 v218, v218, v210
    v_cvt_pk_bf16_f32 v105, v210, v211
    v_mfma_f32_16x16x32_bf16 a[20:23], a[180:183], v[112:115], a[20:23]
    v_exp_f32 v212, v36
    v_mfma_f32_16x16x32_bf16 a[52:55], a[180:183], v[116:119], a[52:55]
    buffer_load_dwordx4 v255, s[8:11], s29 offen offset:1024 lds
    v_add_f32 v218, v218, v211
    v_mfma_f32_16x16x32_bf16 a[84:87], a[180:183], v[120:123], a[84:87]
    v_exp_f32 v213, v37
    v_mfma_f32_16x16x32_bf16 a[116:119], a[180:183], v[124:127], a[116:119]
    v_add_f32 v218, v218, v212
    v_cvt_pk_bf16_f32 v106, v212, v213
    v_mfma_f32_16x16x32_bf16 a[24:27], a[184:187], v[112:115], a[24:27]
    v_exp_f32 v214, v38
    v_mfma_f32_16x16x32_bf16 a[56:59], a[184:187], v[116:119], a[56:59]
    buffer_load_dwordx4 v254, s[8:11], s29 offen offset:2048 lds
    v_add_f32 v218, v218, v213
    v_mfma_f32_16x16x32_bf16 a[88:91], a[184:187], v[120:123], a[88:91]
    v_exp_f32 v215, v39
    v_mfma_f32_16x16x32_bf16 a[120:123], a[184:187], v[124:127], a[120:123]
    v_add_f32 v218, v218, v214
    v_cvt_pk_bf16_f32 v107, v214, v215
    v_mfma_f32_16x16x32_bf16 a[28:31], a[188:191], v[112:115], a[28:31]
    v_exp_f32 v208, v40
    v_mfma_f32_16x16x32_bf16 a[60:63], a[188:191], v[116:119], a[60:63]
    buffer_load_dwordx4 v255, s[8:11], s29 offen offset:3072 lds
    v_add_f32 v218, v218, v215
    v_mfma_f32_16x16x32_bf16 a[92:95], a[188:191], v[120:123], a[92:95]
    s_add_u32 s29, s29, 16384
    v_exp_f32 v209, v41
    v_mfma_f32_16x16x32_bf16 a[124:127], a[188:191], v[124:127], a[124:127]
    s_waitcnt vmcnt(8) lgkmcnt(0)
    s_barrier
    v_mfma_f32_16x16x32_bf16 v[48:51], a[128:131], v[144:147], v[80:83]
    v_cvt_pk_bf16_f32 v108, v208, v209
    v_exp_f32 v210, v42
    v_mfma_f32_16x16x32_bf16 v[48:51], a[132:135], v[148:151], v[48:51]
    ds_read_b64_tr_b16 a[160:161], v242 offset:32768
    v_add_f32 v219, v208, v209
    v_mfma_f32_16x16x32_bf16 v[48:51], a[136:139], v[152:155], v[48:51]
    v_exp_f32 v211, v43
    v_mfma_f32_16x16x32_bf16 v[48:51], a[140:143], v[156:159], v[48:51]
    ds_read_b64_tr_b16 a[162:163], v242 offset:36864
    v_add_f32 v219, v219, v210
    v_cvt_pk_bf16_f32 v109, v210, v211
    v_mfma_f32_16x16x32_bf16 v[52:55], a[144:147], v[144:147], v[80:83]
    v_exp_f32 v212, v44
    v_mfma_f32_16x16x32_bf16 v[52:55], a[148:151], v[148:151], v[52:55]
    ds_read_b64_tr_b16 a[164:165], v243 offset:32768
    v_add_f32 v219, v219, v211
    v_mfma_f32_16x16x32_bf16 v[52:55], a[152:155], v[152:155], v[52:55]
    v_exp_f32 v213, v45
    v_mfma_f32_16x16x32_bf16 v[52:55], a[156:159], v[156:159], v[52:55]
    ds_read_b64_tr_b16 a[166:167], v243 offset:36864
    v_add_f32 v219, v219, v212
    v_cvt_pk_bf16_f32 v110, v212, v213
    v_mfma_f32_16x16x32_bf16 v[56:59], a[128:131], v[160:163], v[84:87]
    v_exp_f32 v214, v46
    v_mfma_f32_16x16x32_bf16 v[56:59], a[132:135], v[164:167], v[56:59]
    ds_read_b64_tr_b16 a[168:169], v244 offset:32768
    v_add_f32 v219, v219, v213
    v_mfma_f32_16x16x32_bf16 v[56:59], a[136:139], v[168:171], v[56:59]
    v_exp_f32 v215, v47
    v_mfma_f32_16x16x32_bf16 v[56:59], a[140:143], v[172:175], v[56:59]
    ds_read_b64_tr_b16 a[170:171], v244 offset:36864
    v_add_f32 v219, v219, v214
    v_cvt_pk_bf16_f32 v111, v214, v215
    v_mfma_f32_16x16x32_bf16 v[60:63], a[144:147], v[160:163], v[84:87]
    v_exp_f32 v208, v48
    v_mfma_f32_16x16x32_bf16 v[60:63], a[148:151], v[164:167], v[60:63]
    ds_read_b64_tr_b16 a[172:173], v245 offset:32768
    v_add_f32 v219, v219, v215
    v_mfma_f32_16x16x32_bf16 v[60:63], a[152:155], v[168:171], v[60:63]
    v_exp_f32 v209, v49
    v_max3_f32 v228, v216, v217, v218
    v_mfma_f32_16x16x32_bf16 v[60:63], a[156:159], v[172:175], v[60:63]
    ds_read_b64_tr_b16 a[174:175], v245 offset:36864
    v_cvt_pk_bf16_f32 v112, v208, v209
    v_max_f32 v228, v228, v219
    v_mfma_f32_16x16x32_bf16 v[64:67], a[128:131], v[176:179], v[88:91]
    v_exp_f32 v210, v50
    v_mfma_f32_16x16x32_bf16 v[64:67], a[132:135], v[180:183], v[64:67]
    ds_read_b64_tr_b16 a[176:177], v246 offset:32768
    v_add_f32 v220, v208, v209
    v_cmp_nle_f32 vcc, v228, v229
    v_mfma_f32_16x16x32_bf16 v[64:67], a[136:139], v[184:187], v[64:67]
    v_exp_f32 v211, v51
    v_mfma_f32_16x16x32_bf16 v[64:67], a[140:143], v[188:191], v[64:67]
    ds_read_b64_tr_b16 a[178:179], v246 offset:36864
    v_add_f32 v220, v220, v210
    v_cvt_pk_bf16_f32 v113, v210, v211
    v_mfma_f32_16x16x32_bf16 v[68:71], a[144:147], v[176:179], v[88:91]
    v_exp_f32 v212, v52
    v_mfma_f32_16x16x32_bf16 v[68:71], a[148:151], v[180:183], v[68:71]
    ds_read_b64_tr_b16 a[180:181], v247 offset:32768
    v_add_f32 v220, v220, v211
    v_mfma_f32_16x16x32_bf16 v[68:71], a[152:155], v[184:187], v[68:71]
    v_exp_f32 v213, v53
    v_mfma_f32_16x16x32_bf16 v[68:71], a[156:159], v[188:191], v[68:71]
    ds_read_b64_tr_b16 a[182:183], v247 offset:36864
    v_add_f32 v220, v220, v212
    v_cvt_pk_bf16_f32 v114, v212, v213
    s_cbranch_vccnz L_tramp_9
L_back_10:
    v_mfma_f32_16x16x32_bf16 v[72:75], a[128:131], v[192:195], v[92:95]
    v_exp_f32 v214, v54
    v_mfma_f32_16x16x32_bf16 v[72:75], a[132:135], v[196:199], v[72:75]
    ds_read_b64_tr_b16 a[184:185], v248 offset:32768
    v_add_f32 v220, v220, v213
    v_add_f32 v224, v224, v216
    v_mfma_f32_16x16x32_bf16 v[72:75], a[136:139], v[200:203], v[72:75]
    v_exp_f32 v215, v55
    v_mfma_f32_16x16x32_bf16 v[72:75], a[140:143], v[204:207], v[72:75]
    ds_read_b64_tr_b16 a[186:187], v248 offset:36864
    v_add_f32 v220, v220, v214
    v_cvt_pk_bf16_f32 v115, v214, v215
    v_add_f32 v225, v225, v217
    v_mfma_f32_16x16x32_bf16 v[76:79], a[144:147], v[192:195], v[92:95]
    v_exp_f32 v208, v56
    v_mfma_f32_16x16x32_bf16 v[76:79], a[148:151], v[196:199], v[76:79]
    ds_read_b64_tr_b16 a[188:189], v249 offset:32768
    v_add_f32 v220, v220, v215
    v_add_f32 v226, v226, v218
    v_mfma_f32_16x16x32_bf16 v[76:79], a[152:155], v[200:203], v[76:79]
    v_exp_f32 v209, v57
    v_mfma_f32_16x16x32_bf16 v[76:79], a[156:159], v[204:207], v[76:79]
    ds_read_b64_tr_b16 a[190:191], v249 offset:36864
    s_waitcnt lgkmcnt(8)
    v_cvt_pk_bf16_f32 v116, v208, v209
    v_add_f32 v227, v227, v219
    v_mfma_f32_16x16x32_bf16 a[0:3], a[160:163], v[96:99], a[0:3]
    v_exp_f32 v210, v58
    v_mfma_f32_16x16x32_bf16 a[32:35], a[160:163], v[100:103], a[32:35]
    ds_read_b128 a[128:131], v238 offset:49152
    v_add_f32 v221, v208, v209
    v_mfma_f32_16x16x32_bf16 a[64:67], a[160:163], v[104:107], a[64:67]
    v_exp_f32 v211, v59
    v_mfma_f32_16x16x32_bf16 a[96:99], a[160:163], v[108:111], a[96:99]
    ds_read_b128 a[132:135], v239 offset:49152
    v_add_f32 v221, v221, v210
    v_cvt_pk_bf16_f32 v117, v210, v211
    v_mfma_f32_16x16x32_bf16 a[4:7], a[164:167], v[96:99], a[4:7]
    v_exp_f32 v212, v60
    v_mfma_f32_16x16x32_bf16 a[36:39], a[164:167], v[100:103], a[36:39]
    ds_read_b128 a[136:139], v240 offset:49152
    v_add_f32 v221, v221, v211
    v_mfma_f32_16x16x32_bf16 a[68:71], a[164:167], v[104:107], a[68:71]
    v_exp_f32 v213, v61
    v_mfma_f32_16x16x32_bf16 a[100:103], a[164:167], v[108:111], a[100:103]
    ds_read_b128 a[140:143], v241 offset:49152
    v_add_f32 v221, v221, v212
    v_cvt_pk_bf16_f32 v118, v212, v213
    v_mfma_f32_16x16x32_bf16 a[8:11], a[168:171], v[96:99], a[8:11]
    v_exp_f32 v214, v62
    v_mfma_f32_16x16x32_bf16 a[40:43], a[168:171], v[100:103], a[40:43]
    ds_read_b128 a[144:147], v238 offset:53248
    v_add_f32 v221, v221, v213
    v_mfma_f32_16x16x32_bf16 a[72:75], a[168:171], v[104:107], a[72:75]
    v_exp_f32 v215, v63
    v_mfma_f32_16x16x32_bf16 a[104:107], a[168:171], v[108:111], a[104:107]
    ds_read_b128 a[148:151], v239 offset:53248
    v_add_f32 v221, v221, v214
    v_cvt_pk_bf16_f32 v119, v214, v215
    v_mfma_f32_16x16x32_bf16 a[12:15], a[172:175], v[96:99], a[12:15]
    v_exp_f32 v208, v64
    v_mfma_f32_16x16x32_bf16 a[44:47], a[172:175], v[100:103], a[44:47]
    ds_read_b128 a[152:155], v240 offset:53248
    v_add_f32 v221, v221, v215
    v_mfma_f32_16x16x32_bf16 a[76:79], a[172:175], v[104:107], a[76:79]
    v_exp_f32 v209, v65
    v_mfma_f32_16x16x32_bf16 a[108:111], a[172:175], v[108:111], a[108:111]
    ds_read_b128 a[156:159], v241 offset:53248
    s_waitcnt lgkmcnt(8)
    v_cvt_pk_bf16_f32 v120, v208, v209
    v_mfma_f32_16x16x32_bf16 a[16:19], a[176:179], v[96:99], a[16:19]
    s_add_u32 m0, s33, 16384
    v_exp_f32 v210, v66
    v_mfma_f32_16x16x32_bf16 a[48:51], a[176:179], v[100:103], a[48:51]
    buffer_load_dwordx4 v250, s[4:7], s28 offen offset:0 lds
    v_add_f32 v222, v208, v209
    v_mfma_f32_16x16x32_bf16 a[80:83], a[176:179], v[104:107], a[80:83]
    v_exp_f32 v211, v67
    v_mfma_f32_16x16x32_bf16 a[112:115], a[176:179], v[108:111], a[112:115]
    v_add_f32 v222, v222, v210
    v_cvt_pk_bf16_f32 v121, v210, v211
    v_mfma_f32_16x16x32_bf16 a[20:23], a[180:183], v[96:99], a[20:23]
    v_exp_f32 v212, v68
    v_mfma_f32_16x16x32_bf16 a[52:55], a[180:183], v[100:103], a[52:55]
    buffer_load_dwordx4 v251, s[4:7], s28 offen offset:1024 lds
    v_add_f32 v222, v222, v211
    v_mfma_f32_16x16x32_bf16 a[84:87], a[180:183], v[104:107], a[84:87]
    v_exp_f32 v213, v69
    v_mfma_f32_16x16x32_bf16 a[116:119], a[180:183], v[108:111], a[116:119]
    v_add_f32 v222, v222, v212
    v_cvt_pk_bf16_f32 v122, v212, v213
    v_mfma_f32_16x16x32_bf16 a[24:27], a[184:187], v[96:99], a[24:27]
    v_exp_f32 v214, v70
    v_mfma_f32_16x16x32_bf16 a[56:59], a[184:187], v[100:103], a[56:59]
    buffer_load_dwordx4 v252, s[4:7], s28 offen offset:2048 lds
    v_add_f32 v222, v222, v213
    v_mfma_f32_16x16x32_bf16 a[88:91], a[184:187], v[104:107], a[88:91]
    v_exp_f32 v215, v71
    v_mfma_f32_16x16x32_bf16 a[120:123], a[184:187], v[108:111], a[120:123]
    v_add_f32 v222, v222, v214
    v_cvt_pk_bf16_f32 v123, v214, v215
    v_mfma_f32_16x16x32_bf16 a[28:31], a[188:191], v[96:99], a[28:31]
    v_exp_f32 v208, v72
    v_mfma_f32_16x16x32_bf16 a[60:63], a[188:191], v[100:103], a[60:63]
    buffer_load_dwordx4 v253, s[4:7], s28 offen offset:3072 lds
    v_add_f32 v222, v222, v215
    v_mfma_f32_16x16x32_bf16 a[92:95], a[188:191], v[104:107], a[92:95]
    s_add_u32 s28, s28, 16384
    v_exp_f32 v209, v73
    v_mfma_f32_16x16x32_bf16 a[124:127], a[188:191], v[108:111], a[124:127]
    s_waitcnt lgkmcnt(0)
    v_cvt_pk_bf16_f32 v124, v208, v209
    v_mfma_f32_16x16x32_bf16 v[16:19], a[128:131], v[144:147], v[80:83]
    v_exp_f32 v210, v74
    v_mfma_f32_16x16x32_bf16 v[16:19], a[132:135], v[148:151], v[16:19]
    ds_read_b64_tr_b16 a[160:161], v242 offset:40960
    v_add_f32 v223, v208, v209
    v_mfma_f32_16x16x32_bf16 v[16:19], a[136:139], v[152:155], v[16:19]
    v_exp_f32 v211, v75
    v_mfma_f32_16x16x32_bf16 v[16:19], a[140:143], v[156:159], v[16:19]
    ds_read_b64_tr_b16 a[162:163], v242 offset:45056
    v_add_f32 v223, v223, v210
    v_cvt_pk_bf16_f32 v125, v210, v211
    v_mfma_f32_16x16x32_bf16 v[20:23], a[144:147], v[144:147], v[80:83]
    v_exp_f32 v212, v76
    v_mfma_f32_16x16x32_bf16 v[20:23], a[148:151], v[148:151], v[20:23]
    ds_read_b64_tr_b16 a[164:165], v243 offset:40960
    v_add_f32 v223, v223, v211
    v_mfma_f32_16x16x32_bf16 v[20:23], a[152:155], v[152:155], v[20:23]
    v_exp_f32 v213, v77
    v_mfma_f32_16x16x32_bf16 v[20:23], a[156:159], v[156:159], v[20:23]
    ds_read_b64_tr_b16 a[166:167], v243 offset:45056
    v_add_f32 v223, v223, v212
    v_cvt_pk_bf16_f32 v126, v212, v213
    v_mfma_f32_16x16x32_bf16 v[24:27], a[128:131], v[160:163], v[84:87]
    v_exp_f32 v214, v78
    v_mfma_f32_16x16x32_bf16 v[24:27], a[132:135], v[164:167], v[24:27]
    ds_read_b64_tr_b16 a[168:169], v244 offset:40960
    v_add_f32 v223, v223, v213
    v_mfma_f32_16x16x32_bf16 v[24:27], a[136:139], v[168:171], v[24:27]
    v_exp_f32 v215, v79
    v_mfma_f32_16x16x32_bf16 v[24:27], a[140:143], v[172:175], v[24:27]
    ds_read_b64_tr_b16 a[170:171], v244 offset:45056
    v_add_f32 v223, v223, v214
    v_cvt_pk_bf16_f32 v127, v214, v215
    v_mfma_f32_16x16x32_bf16 v[28:31], a[144:147], v[160:163], v[84:87]
    v_exp_f32 v208, v16
    v_mfma_f32_16x16x32_bf16 v[28:31], a[148:151], v[164:167], v[28:31]
    ds_read_b64_tr_b16 a[172:173], v245 offset:40960
    v_add_f32 v223, v223, v215
    v_mfma_f32_16x16x32_bf16 v[28:31], a[152:155], v[168:171], v[28:31]
    v_exp_f32 v209, v17
    v_max3_f32 v228, v220, v221, v222
    v_mfma_f32_16x16x32_bf16 v[28:31], a[156:159], v[172:175], v[28:31]
    ds_read_b64_tr_b16 a[174:175], v245 offset:45056
    v_cvt_pk_bf16_f32 v96, v208, v209
    v_max_f32 v228, v228, v223
    v_mfma_f32_16x16x32_bf16 v[32:35], a[128:131], v[176:179], v[88:91]
    v_exp_f32 v210, v18
    v_mfma_f32_16x16x32_bf16 v[32:35], a[132:135], v[180:183], v[32:35]
    ds_read_b64_tr_b16 a[176:177], v246 offset:40960
    v_add_f32 v216, v208, v209
    v_cmp_nle_f32 vcc, v228, v229
    v_mfma_f32_16x16x32_bf16 v[32:35], a[136:139], v[184:187], v[32:35]
    v_exp_f32 v211, v19
    v_mfma_f32_16x16x32_bf16 v[32:35], a[140:143], v[188:191], v[32:35]
    ds_read_b64_tr_b16 a[178:179], v246 offset:45056
    v_add_f32 v216, v216, v210
    v_cvt_pk_bf16_f32 v97, v210, v211
    v_mfma_f32_16x16x32_bf16 v[36:39], a[144:147], v[176:179], v[88:91]
    v_exp_f32 v212, v20
    v_mfma_f32_16x16x32_bf16 v[36:39], a[148:151], v[180:183], v[36:39]
    ds_read_b64_tr_b16 a[180:181], v247 offset:40960
    v_add_f32 v216, v216, v211
    v_mfma_f32_16x16x32_bf16 v[36:39], a[152:155], v[184:187], v[36:39]
    v_exp_f32 v213, v21
    v_mfma_f32_16x16x32_bf16 v[36:39], a[156:159], v[188:191], v[36:39]
    ds_read_b64_tr_b16 a[182:183], v247 offset:45056
    v_add_f32 v216, v216, v212
    v_cvt_pk_bf16_f32 v98, v212, v213
    s_cbranch_vccnz L_tramp_11
L_back_12:
    v_mfma_f32_16x16x32_bf16 v[40:43], a[128:131], v[192:195], v[92:95]
    v_exp_f32 v214, v22
    v_mfma_f32_16x16x32_bf16 v[40:43], a[132:135], v[196:199], v[40:43]
    ds_read_b64_tr_b16 a[184:185], v248 offset:40960
    v_add_f32 v216, v216, v213
    v_add_f32 v224, v224, v220
    v_mfma_f32_16x16x32_bf16 v[40:43], a[136:139], v[200:203], v[40:43]
    v_exp_f32 v215, v23
    v_mfma_f32_16x16x32_bf16 v[40:43], a[140:143], v[204:207], v[40:43]
    ds_read_b64_tr_b16 a[186:187], v248 offset:45056
    v_add_f32 v216, v216, v214
    v_cvt_pk_bf16_f32 v99, v214, v215
    v_add_f32 v225, v225, v221
    v_mfma_f32_16x16x32_bf16 v[44:47], a[144:147], v[192:195], v[92:95]
    v_exp_f32 v208, v24
    v_mfma_f32_16x16x32_bf16 v[44:47], a[148:151], v[196:199], v[44:47]
    ds_read_b64_tr_b16 a[188:189], v249 offset:40960
    v_add_f32 v216, v216, v215
    v_add_f32 v226, v226, v222
    v_mfma_f32_16x16x32_bf16 v[44:47], a[152:155], v[200:203], v[44:47]
    v_exp_f32 v209, v25
    v_mfma_f32_16x16x32_bf16 v[44:47], a[156:159], v[204:207], v[44:47]
    ds_read_b64_tr_b16 a[190:191], v249 offset:45056
    s_waitcnt lgkmcnt(8)
    v_cvt_pk_bf16_f32 v100, v208, v209
    v_add_f32 v227, v227, v223
    v_mfma_f32_16x16x32_bf16 a[0:3], a[160:163], v[112:115], a[0:3]
    v_exp_f32 v210, v26
    v_mfma_f32_16x16x32_bf16 a[32:35], a[160:163], v[116:119], a[32:35]
    ds_read_b128 a[128:131], v238 offset:57344
    v_add_f32 v217, v208, v209
    v_mfma_f32_16x16x32_bf16 a[64:67], a[160:163], v[120:123], a[64:67]
    v_exp_f32 v211, v27
    v_mfma_f32_16x16x32_bf16 a[96:99], a[160:163], v[124:127], a[96:99]
    ds_read_b128 a[132:135], v239 offset:57344
    v_add_f32 v217, v217, v210
    v_cvt_pk_bf16_f32 v101, v210, v211
    v_mfma_f32_16x16x32_bf16 a[4:7], a[164:167], v[112:115], a[4:7]
    v_exp_f32 v212, v28
    v_mfma_f32_16x16x32_bf16 a[36:39], a[164:167], v[116:119], a[36:39]
    ds_read_b128 a[136:139], v240 offset:57344
    v_add_f32 v217, v217, v211
    v_mfma_f32_16x16x32_bf16 a[68:71], a[164:167], v[120:123], a[68:71]
    v_exp_f32 v213, v29
    v_mfma_f32_16x16x32_bf16 a[100:103], a[164:167], v[124:127], a[100:103]
    ds_read_b128 a[140:143], v241 offset:57344
    v_add_f32 v217, v217, v212
    v_cvt_pk_bf16_f32 v102, v212, v213
    v_mfma_f32_16x16x32_bf16 a[8:11], a[168:171], v[112:115], a[8:11]
    v_exp_f32 v214, v30
    v_mfma_f32_16x16x32_bf16 a[40:43], a[168:171], v[116:119], a[40:43]
    ds_read_b128 a[144:147], v238 offset:61440
    v_add_f32 v217, v217, v213
    v_mfma_f32_16x16x32_bf16 a[72:75], a[168:171], v[120:123], a[72:75]
    v_exp_f32 v215, v31
    v_mfma_f32_16x16x32_bf16 a[104:107], a[168:171], v[124:127], a[104:107]
    ds_read_b128 a[148:151], v239 offset:61440
    v_add_f32 v217, v217, v214
    v_cvt_pk_bf16_f32 v103, v214, v215
    v_mfma_f32_16x16x32_bf16 a[12:15], a[172:175], v[112:115], a[12:15]
    v_exp_f32 v208, v32
    v_mfma_f32_16x16x32_bf16 a[44:47], a[172:175], v[116:119], a[44:47]
    ds_read_b128 a[152:155], v240 offset:61440
    v_add_f32 v217, v217, v215
    v_mfma_f32_16x16x32_bf16 a[76:79], a[172:175], v[120:123], a[76:79]
    v_exp_f32 v209, v33
    v_mfma_f32_16x16x32_bf16 a[108:111], a[172:175], v[124:127], a[108:111]
    ds_read_b128 a[156:159], v241 offset:61440
    s_waitcnt lgkmcnt(8)
    v_cvt_pk_bf16_f32 v104, v208, v209
    v_mfma_f32_16x16x32_bf16 a[16:19], a[176:179], v[112:115], a[16:19]
    s_add_u32 m0, s34, 16384
    v_exp_f32 v210, v34
    v_mfma_f32_16x16x32_bf16 a[48:51], a[176:179], v[116:119], a[48:51]
    buffer_load_dwordx4 v254, s[8:11], s29 offen offset:0 lds
    v_add_f32 v218, v208, v209
    v_mfma_f32_16x16x32_bf16 a[80:83], a[176:179], v[120:123], a[80:83]
    v_exp_f32 v211, v35
    v_mfma_f32_16x16x32_bf16 a[112:115], a[176:179], v[124:127], a[112:115]
    v_add_f32 v218, v218, v210
    v_cvt_pk_bf16_f32 v105, v210, v211
    v_mfma_f32_16x16x32_bf16 a[20:23], a[180:183], v[112:115], a[20:23]
    v_exp_f32 v212, v36
    v_mfma_f32_16x16x32_bf16 a[52:55], a[180:183], v[116:119], a[52:55]
    buffer_load_dwordx4 v255, s[8:11], s29 offen offset:1024 lds
    v_add_f32 v218, v218, v211
    v_mfma_f32_16x16x32_bf16 a[84:87], a[180:183], v[120:123], a[84:87]
    v_exp_f32 v213, v37
    v_mfma_f32_16x16x32_bf16 a[116:119], a[180:183], v[124:127], a[116:119]
    v_add_f32 v218, v218, v212
    v_cvt_pk_bf16_f32 v106, v212, v213
    v_mfma_f32_16x16x32_bf16 a[24:27], a[184:187], v[112:115], a[24:27]
    v_exp_f32 v214, v38
    v_mfma_f32_16x16x32_bf16 a[56:59], a[184:187], v[116:119], a[56:59]
    buffer_load_dwordx4 v254, s[8:11], s29 offen offset:2048 lds
    v_add_f32 v218, v218, v213
    v_mfma_f32_16x16x32_bf16 a[88:91], a[184:187], v[120:123], a[88:91]
    v_exp_f32 v215, v39
    v_mfma_f32_16x16x32_bf16 a[120:123], a[184:187], v[124:127], a[120:123]
    v_add_f32 v218, v218, v214
    v_cvt_pk_bf16_f32 v107, v214, v215
    v_mfma_f32_16x16x32_bf16 a[28:31], a[188:191], v[112:115], a[28:31]
    v_exp_f32 v208, v40
    v_mfma_f32_16x16x32_bf16 a[60:63], a[188:191], v[116:119], a[60:63]
    buffer_load_dwordx4 v255, s[8:11], s29 offen offset:3072 lds
    v_add_f32 v218, v218, v215
    v_mfma_f32_16x16x32_bf16 a[92:95], a[188:191], v[120:123], a[92:95]
    s_add_u32 s29, s29, 16384
    v_exp_f32 v209, v41
    v_mfma_f32_16x16x32_bf16 a[124:127], a[188:191], v[124:127], a[124:127]
    s_waitcnt vmcnt(8) lgkmcnt(0)
    s_barrier
    v_mfma_f32_16x16x32_bf16 v[48:51], a[128:131], v[144:147], v[80:83]
    v_cvt_pk_bf16_f32 v108, v208, v209
    v_exp_f32 v210, v42
    v_mfma_f32_16x16x32_bf16 v[48:51], a[132:135], v[148:151], v[48:51]
    ds_read_b64_tr_b16 a[160:161], v242 offset:49152
    v_add_f32 v219, v208, v209
    v_mfma_f32_16x16x32_bf16 v[48:51], a[136:139], v[152:155], v[48:51]
    v_exp_f32 v211, v43
    v_mfma_f32_16x16x32_bf16 v[48:51], a[140:143], v[156:159], v[48:51]
    ds_read_b64_tr_b16 a[162:163], v242 offset:53248
    v_add_f32 v219, v219, v210
    v_cvt_pk_bf16_f32 v109, v210, v211
    v_mfma_f32_16x16x32_bf16 v[52:55], a[144:147], v[144:147], v[80:83]
    v_exp_f32 v212, v44
    v_mfma_f32_16x16x32_bf16 v[52:55], a[148:151], v[148:151], v[52:55]
    ds_read_b64_tr_b16 a[164:165], v243 offset:49152
    v_add_f32 v219, v219, v211
    v_mfma_f32_16x16x32_bf16 v[52:55], a[152:155], v[152:155], v[52:55]
    v_exp_f32 v213, v45
    v_mfma_f32_16x16x32_bf16 v[52:55], a[156:159], v[156:159], v[52:55]
    ds_read_b64_tr_b16 a[166:167], v243 offset:53248
    v_add_f32 v219, v219, v212
    v_cvt_pk_bf16_f32 v110, v212, v213
    v_mfma_f32_16x16x32_bf16 v[56:59], a[128:131], v[160:163], v[84:87]
    v_exp_f32 v214, v46
    v_mfma_f32_16x16x32_bf16 v[56:59], a[132:135], v[164:167], v[56:59]
    ds_read_b64_tr_b16 a[168:169], v244 offset:49152
    v_add_f32 v219, v219, v213
    v_mfma_f32_16x16x32_bf16 v[56:59], a[136:139], v[168:171], v[56:59]
    v_exp_f32 v215, v47
    v_mfma_f32_16x16x32_bf16 v[56:59], a[140:143], v[172:175], v[56:59]
    ds_read_b64_tr_b16 a[170:171], v244 offset:53248
    v_add_f32 v219, v219, v214
    v_cvt_pk_bf16_f32 v111, v214, v215
    v_mfma_f32_16x16x32_bf16 v[60:63], a[144:147], v[160:163], v[84:87]
    v_exp_f32 v208, v48
    v_mfma_f32_16x16x32_bf16 v[60:63], a[148:151], v[164:167], v[60:63]
    ds_read_b64_tr_b16 a[172:173], v245 offset:49152
    v_add_f32 v219, v219, v215
    v_mfma_f32_16x16x32_bf16 v[60:63], a[152:155], v[168:171], v[60:63]
    v_exp_f32 v209, v49
    v_max3_f32 v228, v216, v217, v218
    v_mfma_f32_16x16x32_bf16 v[60:63], a[156:159], v[172:175], v[60:63]
    ds_read_b64_tr_b16 a[174:175], v245 offset:53248
    v_cvt_pk_bf16_f32 v112, v208, v209
    v_max_f32 v228, v228, v219
    v_mfma_f32_16x16x32_bf16 v[64:67], a[128:131], v[176:179], v[88:91]
    v_exp_f32 v210, v50
    v_mfma_f32_16x16x32_bf16 v[64:67], a[132:135], v[180:183], v[64:67]
    ds_read_b64_tr_b16 a[176:177], v246 offset:49152
    v_add_f32 v220, v208, v209
    v_cmp_nle_f32 vcc, v228, v229
    v_mfma_f32_16x16x32_bf16 v[64:67], a[136:139], v[184:187], v[64:67]
    v_exp_f32 v211, v51
    v_mfma_f32_16x16x32_bf16 v[64:67], a[140:143], v[188:191], v[64:67]
    ds_read_b64_tr_b16 a[178:179], v246 offset:53248
    v_add_f32 v220, v220, v210
    v_cvt_pk_bf16_f32 v113, v210, v211
    v_mfma_f32_16x16x32_bf16 v[68:71], a[144:147], v[176:179], v[88:91]
    v_exp_f32 v212, v52
    v_mfma_f32_16x16x32_bf16 v[68:71], a[148:151], v[180:183], v[68:71]
    ds_read_b64_tr_b16 a[180:181], v247 offset:49152
    v_add_f32 v220, v220, v211
    v_mfma_f32_16x16x32_bf16 v[68:71], a[152:155], v[184:187], v[68:71]
    v_exp_f32 v213, v53
    v_mfma_f32_16x16x32_bf16 v[68:71], a[156:159], v[188:191], v[68:71]
    ds_read_b64_tr_b16 a[182:183], v247 offset:53248
    v_add_f32 v220, v220, v212
    v_cvt_pk_bf16_f32 v114, v212, v213
    s_cbranch_vccnz L_tramp_13
L_back_14:
    v_mfma_f32_16x16x32_bf16 v[72:75], a[128:131], v[192:195], v[92:95]
    v_exp_f32 v214, v54
    v_mfma_f32_16x16x32_bf16 v[72:75], a[132:135], v[196:199], v[72:75]
    ds_read_b64_tr_b16 a[184:185], v248 offset:49152
    v_add_f32 v220, v220, v213
    v_add_f32 v224, v224, v216
    v_mfma_f32_16x16x32_bf16 v[72:75], a[136:139], v[200:203], v[72:75]
    v_exp_f32 v215, v55
    v_mfma_f32_16x16x32_bf16 v[72:75], a[140:143], v[204:207], v[72:75]
    ds_read_b64_tr_b16 a[186:187], v248 offset:53248
    v_add_f32 v220, v220, v214
    v_cvt_pk_bf16_f32 v115, v214, v215
    v_add_f32 v225, v225, v217
    v_mfma_f32_16x16x32_bf16 v[76:79], a[144:147], v[192:195], v[92:95]
    v_exp_f32 v208, v56
    v_mfma_f32_16x16x32_bf16 v[76:79], a[148:151], v[196:199], v[76:79]
    ds_read_b64_tr_b16 a[188:189], v249 offset:49152
    v_add_f32 v220, v220, v215
    v_add_f32 v226, v226, v218
    v_mfma_f32_16x16x32_bf16 v[76:79], a[152:155], v[200:203], v[76:79]
    v_exp_f32 v209, v57
    v_mfma_f32_16x16x32_bf16 v[76:79], a[156:159], v[204:207], v[76:79]
    ds_read_b64_tr_b16 a[190:191], v249 offset:53248
    s_waitcnt lgkmcnt(8)
    v_cvt_pk_bf16_f32 v116, v208, v209
    v_add_f32 v227, v227, v219
    v_mfma_f32_16x16x32_bf16 a[0:3], a[160:163], v[96:99], a[0:3]
    v_exp_f32 v210, v58
    v_mfma_f32_16x16x32_bf16 a[32:35], a[160:163], v[100:103], a[32:35]
    ds_read_b128 a[128:131], v238 offset:0
    v_add_f32 v221, v208, v209
    v_mfma_f32_16x16x32_bf16 a[64:67], a[160:163], v[104:107], a[64:67]
    v_exp_f32 v211, v59
    v_mfma_f32_16x16x32_bf16 a[96:99], a[160:163], v[108:111], a[96:99]
    ds_read_b128 a[132:135], v239 offset:0
    v_add_f32 v221, v221, v210
    v_cvt_pk_bf16_f32 v117, v210, v211
    v_mfma_f32_16x16x32_bf16 a[4:7], a[164:167], v[96:99], a[4:7]
    v_exp_f32 v212, v60
    v_mfma_f32_16x16x32_bf16 a[36:39], a[164:167], v[100:103], a[36:39]
    ds_read_b128 a[136:139], v240 offset:0
    v_add_f32 v221, v221, v211
    v_mfma_f32_16x16x32_bf16 a[68:71], a[164:167], v[104:107], a[68:71]
    v_exp_f32 v213, v61
    v_mfma_f32_16x16x32_bf16 a[100:103], a[164:167], v[108:111], a[100:103]
    ds_read_b128 a[140:143], v241 offset:0
    v_add_f32 v221, v221, v212
    v_cvt_pk_bf16_f32 v118, v212, v213
    v_mfma_f32_16x16x32_bf16 a[8:11], a[168:171], v[96:99], a[8:11]
    v_exp_f32 v214, v62
    v_mfma_f32_16x16x32_bf16 a[40:43], a[168:171], v[100:103], a[40:43]
    ds_read_b128 a[144:147], v238 offset:4096
    v_add_f32 v221, v221, v213
    v_mfma_f32_16x16x32_bf16 a[72:75], a[168:171], v[104:107], a[72:75]
    v_exp_f32 v215, v63
    v_mfma_f32_16x16x32_bf16 a[104:107], a[168:171], v[108:111], a[104:107]
    ds_read_b128 a[148:151], v239 offset:4096
    v_add_f32 v221, v221, v214
    v_cvt_pk_bf16_f32 v119, v214, v215
    v_mfma_f32_16x16x32_bf16 a[12:15], a[172:175], v[96:99], a[12:15]
    v_exp_f32 v208, v64
    v_mfma_f32_16x16x32_bf16 a[44:47], a[172:175], v[100:103], a[44:47]
    ds_read_b128 a[152:155], v240 offset:4096
    v_add_f32 v221, v221, v215
    v_mfma_f32_16x16x32_bf16 a[76:79], a[172:175], v[104:107], a[76:79]
    v_exp_f32 v209, v65
    v_mfma_f32_16x16x32_bf16 a[108:111], a[172:175], v[108:111], a[108:111]
    ds_read_b128 a[156:159], v241 offset:4096
    s_waitcnt lgkmcnt(8)
    v_cvt_pk_bf16_f32 v120, v208, v209
    v_mfma_f32_16x16x32_bf16 a[16:19], a[176:179], v[96:99], a[16:19]
    s_add_u32 m0, s33, 32768
    v_exp_f32 v210, v66
    v_mfma_f32_16x16x32_bf16 a[48:51], a[176:179], v[100:103], a[48:51]
    buffer_load_dwordx4 v250, s[4:7], s28 offen offset:0 lds
    v_add_f32 v222, v208, v209
    v_mfma_f32_16x16x32_bf16 a[80:83], a[176:179], v[104:107], a[80:83]
    v_exp_f32 v211, v67
    v_mfma_f32_16x16x32_bf16 a[112:115], a[176:179], v[108:111], a[112:115]
    v_add_f32 v222, v222, v210
    v_cvt_pk_bf16_f32 v121, v210, v211
    v_mfma_f32_16x16x32_bf16 a[20:23], a[180:183], v[96:99], a[20:23]
    v_exp_f32 v212, v68
    v_mfma_f32_16x16x32_bf16 a[52:55], a[180:183], v[100:103], a[52:55]
    buffer_load_dwordx4 v251, s[4:7], s28 offen offset:1024 lds
    v_add_f32 v222, v222, v211
    v_mfma_f32_16x16x32_bf16 a[84:87], a[180:183], v[104:107], a[84:87]
    v_exp_f32 v213, v69
    v_mfma_f32_16x16x32_bf16 a[116:119], a[180:183], v[108:111], a[116:119]
    v_add_f32 v222, v222, v212
    v_cvt_pk_bf16_f32 v122, v212, v213
    v_mfma_f32_16x16x32_bf16 a[24:27], a[184:187], v[96:99], a[24:27]
    v_exp_f32 v214, v70
    v_mfma_f32_16x16x32_bf16 a[56:59], a[184:187], v[100:103], a[56:59]
    buffer_load_dwordx4 v252, s[4:7], s28 offen offset:2048 lds
    v_add_f32 v222, v222, v213
    v_mfma_f32_16x16x32_bf16 a[88:91], a[184:187], v[104:107], a[88:91]
    v_exp_f32 v215, v71
    v_mfma_f32_16x16x32_bf16 a[120:123], a[184:187], v[108:111], a[120:123]
    v_add_f32 v222, v222, v214
    v_cvt_pk_bf16_f32 v123, v214, v215
    v_mfma_f32_16x16x32_bf16 a[28:31], a[188:191], v[96:99], a[28:31]
    v_exp_f32 v208, v72
    v_mfma_f32_16x16x32_bf16 a[60:63], a[188:191], v[100:103], a[60:63]
    buffer_load_dwordx4 v253, s[4:7], s28 offen offset:3072 lds
    v_add_f32 v222, v222, v215
    v_mfma_f32_16x16x32_bf16 a[92:95], a[188:191], v[104:107], a[92:95]
    s_add_u32 s28, s28, 16384
    v_exp_f32 v209, v73
    v_mfma_f32_16x16x32_bf16 a[124:127], a[188:191], v[108:111], a[124:127]
    s_waitcnt lgkmcnt(0)
    v_cvt_pk_bf16_f32 v124, v208, v209
    v_mfma_f32_16x16x32_bf16 v[16:19], a[128:131], v[144:147], v[80:83]
    v_exp_f32 v210, v74
    v_mfma_f32_16x16x32_bf16 v[16:19], a[132:135], v[148:151], v[16:19]
    ds_read_b64_tr_b16 a[160:161], v242 offset:57344
    v_add_f32 v223, v208, v209
    v_mfma_f32_16x16x32_bf16 v[16:19], a[136:139], v[152:155], v[16:19]
    v_exp_f32 v211, v75
    v_mfma_f32_16x16x32_bf16 v[16:19], a[140:143], v[156:159], v[16:19]
    ds_read_b64_tr_b16 a[162:163], v242 offset:61440
    v_add_f32 v223, v223, v210
    v_cvt_pk_bf16_f32 v125, v210, v211
    v_mfma_f32_16x16x32_bf16 v[20:23], a[144:147], v[144:147], v[80:83]
    v_exp_f32 v212, v76
    v_mfma_f32_16x16x32_bf16 v[20:23], a[148:151], v[148:151], v[20:23]
    ds_read_b64_tr_b16 a[164:165], v243 offset:57344
    v_add_f32 v223, v223, v211
    v_mfma_f32_16x16x32_bf16 v[20:23], a[152:155], v[152:155], v[20:23]
    v_exp_f32 v213, v77
    v_mfma_f32_16x16x32_bf16 v[20:23], a[156:159], v[156:159], v[20:23]
    ds_read_b64_tr_b16 a[166:167], v243 offset:61440
    v_add_f32 v223, v223, v212
    v_cvt_pk_bf16_f32 v126, v212, v213
    v_mfma_f32_16x16x32_bf16 v[24:27], a[128:131], v[160:163], v[84:87]
    v_exp_f32 v214, v78
    v_mfma_f32_16x16x32_bf16 v[24:27], a[132:135], v[164:167], v[24:27]
    ds_read_b64_tr_b16 a[168:169], v244 offset:57344
    v_add_f32 v223, v223, v213
    v_mfma_f32_16x16x32_bf16 v[24:27], a[136:139], v[168:171], v[24:27]
    v_exp_f32 v215, v79
    v_mfma_f32_16x16x32_bf16 v[24:27], a[140:143], v[172:175], v[24:27]
    ds_read_b64_tr_b16 a[170:171], v244 offset:61440
    v_add_f32 v223, v223, v214
    v_cvt_pk_bf16_f32 v127, v214, v215
    v_mfma_f32_16x16x32_bf16 v[28:31], a[144:147], v[160:163], v[84:87]
    v_exp_f32 v208, v16
    v_mfma_f32_16x16x32_bf16 v[28:31], a[148:151], v[164:167], v[28:31]
    ds_read_b64_tr_b16 a[172:173], v245 offset:57344
    v_add_f32 v223, v223, v215
    v_mfma_f32_16x16x32_bf16 v[28:31], a[152:155], v[168:171], v[28:31]
    v_exp_f32 v209, v17
    v_max3_f32 v228, v220, v221, v222
    v_mfma_f32_16x16x32_bf16 v[28:31], a[156:159], v[172:175], v[28:31]
    ds_read_b64_tr_b16 a[174:175], v245 offset:61440
    v_cvt_pk_bf16_f32 v96, v208, v209
    v_max_f32 v228, v228, v223
    v_mfma_f32_16x16x32_bf16 v[32:35], a[128:131], v[176:179], v[88:91]
    v_exp_f32 v210, v18
    v_mfma_f32_16x16x32_bf16 v[32:35], a[132:135], v[180:183], v[32:35]
    ds_read_b64_tr_b16 a[176:177], v246 offset:57344
    v_add_f32 v216, v208, v209
    v_cmp_nle_f32 vcc, v228, v229
    v_mfma_f32_16x16x32_bf16 v[32:35], a[136:139], v[184:187], v[32:35]
    v_exp_f32 v211, v19
    v_mfma_f32_16x16x32_bf16 v[32:35], a[140:143], v[188:191], v[32:35]
    ds_read_b64_tr_b16 a[178:179], v246 offset:61440
    v_add_f32 v216, v216, v210
    v_cvt_pk_bf16_f32 v97, v210, v211
    v_mfma_f32_16x16x32_bf16 v[36:39], a[144:147], v[176:179], v[88:91]
    v_exp_f32 v212, v20
    v_mfma_f32_16x16x32_bf16 v[36:39], a[148:151], v[180:183], v[36:39]
    ds_read_b64_tr_b16 a[180:181], v247 offset:57344
    v_add_f32 v216, v216, v211
    v_mfma_f32_16x16x32_bf16 v[36:39], a[152:155], v[184:187], v[36:39]
    v_exp_f32 v213, v21
    v_mfma_f32_16x16x32_bf16 v[36:39], a[156:159], v[188:191], v[36:39]
    ds_read_b64_tr_b16 a[182:183], v247 offset:61440
    v_add_f32 v216, v216, v212
    v_cvt_pk_bf16_f32 v98, v212, v213
    s_cbranch_vccnz L_tramp_15
L_back_16:
    v_mfma_f32_16x16x32_bf16 v[40:43], a[128:131], v[192:195], v[92:95]
    v_exp_f32 v214, v22
    v_mfma_f32_16x16x32_bf16 v[40:43], a[132:135], v[196:199], v[40:43]
    ds_read_b64_tr_b16 a[184:185], v248 offset:57344
    v_add_f32 v216, v216, v213
    v_add_f32 v224, v224, v220
    v_mfma_f32_16x16x32_bf16 v[40:43], a[136:139], v[200:203], v[40:43]
    v_exp_f32 v215, v23
    v_mfma_f32_16x16x32_bf16 v[40:43], a[140:143], v[204:207], v[40:43]
    ds_read_b64_tr_b16 a[186:187], v248 offset:61440
    v_add_f32 v216, v216, v214
    v_cvt_pk_bf16_f32 v99, v214, v215
    v_add_f32 v225, v225, v221
    v_mfma_f32_16x16x32_bf16 v[44:47], a[144:147], v[192:195], v[92:95]
    v_exp_f32 v208, v24
    v_mfma_f32_16x16x32_bf16 v[44:47], a[148:151], v[196:199], v[44:47]
    ds_read_b64_tr_b16 a[188:189], v249 offset:57344
    v_add_f32 v216, v216, v215
    v_add_f32 v226, v226, v222
    v_mfma_f32_16x16x32_bf16 v[44:47], a[152:155], v[200:203], v[44:47]
    v_exp_f32 v209, v25
    v_mfma_f32_16x16x32_bf16 v[44:47], a[156:159], v[204:207], v[44:47]
    ds_read_b64_tr_b16 a[190:191], v249 offset:61440
    s_waitcnt lgkmcnt(8)
    v_cvt_pk_bf16_f32 v100, v208, v209
    v_add_f32 v227, v227, v223
    v_mfma_f32_16x16x32_bf16 a[0:3], a[160:163], v[112:115], a[0:3]
    v_exp_f32 v210, v26
    v_mfma_f32_16x16x32_bf16 a[32:35], a[160:163], v[116:119], a[32:35]
    ds_read_b128 a[128:131], v238 offset:8192
    v_add_f32 v217, v208, v209
    v_mfma_f32_16x16x32_bf16 a[64:67], a[160:163], v[120:123], a[64:67]
    v_exp_f32 v211, v27
    v_mfma_f32_16x16x32_bf16 a[96:99], a[160:163], v[124:127], a[96:99]
    ds_read_b128 a[132:135], v239 offset:8192
    v_add_f32 v217, v217, v210
    v_cvt_pk_bf16_f32 v101, v210, v211
    v_mfma_f32_16x16x32_bf16 a[4:7], a[164:167], v[112:115], a[4:7]
    v_exp_f32 v212, v28
    v_mfma_f32_16x16x32_bf16 a[36:39], a[164:167], v[116:119], a[36:39]
    ds_read_b128 a[136:139], v240 offset:8192
    v_add_f32 v217, v217, v211
    v_mfma_f32_16x16x32_bf16 a[68:71], a[164:167], v[120:123], a[68:71]
    v_exp_f32 v213, v29
    v_mfma_f32_16x16x32_bf16 a[100:103], a[164:167], v[124:127], a[100:103]
    ds_read_b128 a[140:143], v241 offset:8192
    v_add_f32 v217, v217, v212
    v_cvt_pk_bf16_f32 v102, v212, v213
    v_mfma_f32_16x16x32_bf16 a[8:11], a[168:171], v[112:115], a[8:11]
    v_exp_f32 v214, v30
    v_mfma_f32_16x16x32_bf16 a[40:43], a[168:171], v[116:119], a[40:43]
    ds_read_b128 a[144:147], v238 offset:12288
    v_add_f32 v217, v217, v213
    v_mfma_f32_16x16x32_bf16 a[72:75], a[168:171], v[120:123], a[72:75]
    v_exp_f32 v215, v31
    v_mfma_f32_16x16x32_bf16 a[104:107], a[168:171], v[124:127], a[104:107]
    ds_read_b128 a[148:151], v239 offset:12288
    v_add_f32 v217, v217, v214
    v_cvt_pk_bf16_f32 v103, v214, v215
    v_mfma_f32_16x16x32_bf16 a[12:15], a[172:175], v[112:115], a[12:15]
    v_exp_f32 v208, v32
    v_mfma_f32_16x16x32_bf16 a[44:47], a[172:175], v[116:119], a[44:47]
    ds_read_b128 a[152:155], v240 offset:12288
    v_add_f32 v217, v217, v215
    v_mfma_f32_16x16x32_bf16 a[76:79], a[172:175], v[120:123], a[76:79]
    v_exp_f32 v209, v33
    v_mfma_f32_16x16x32_bf16 a[108:111], a[172:175], v[124:127], a[108:111]
    ds_read_b128 a[156:159], v241 offset:12288
    s_waitcnt lgkmcnt(8)
    v_cvt_pk_bf16_f32 v104, v208, v209
    v_mfma_f32_16x16x32_bf16 a[16:19], a[176:179], v[112:115], a[16:19]
    s_add_u32 m0, s34, 32768
    v_exp_f32 v210, v34
    v_mfma_f32_16x16x32_bf16 a[48:51], a[176:179], v[116:119], a[48:51]
    buffer_load_dwordx4 v254, s[8:11], s29 offen offset:0 lds
    v_add_f32 v218, v208, v209
    v_mfma_f32_16x16x32_bf16 a[80:83], a[176:179], v[120:123], a[80:83]
    v_exp_f32 v211, v35
    v_mfma_f32_16x16x32_bf16 a[112:115], a[176:179], v[124:127], a[112:115]
    v_add_f32 v218, v218, v210
    v_cvt_pk_bf16_f32 v105, v210, v211
    v_mfma_f32_16x16x32_bf16 a[20:23], a[180:183], v[112:115], a[20:23]
    v_exp_f32 v212, v36
    v_mfma_f32_16x16x32_bf16 a[52:55], a[180:183], v[116:119], a[52:55]
    buffer_load_dwordx4 v255, s[8:11], s29 offen offset:1024 lds
    v_add_f32 v218, v218, v211
    v_mfma_f32_16x16x32_bf16 a[84:87], a[180:183], v[120:123], a[84:87]
    v_exp_f32 v213, v37
    v_mfma_f32_16x16x32_bf16 a[116:119], a[180:183], v[124:127], a[116:119]
    v_add_f32 v218, v218, v212
    v_cvt_pk_bf16_f32 v106, v212, v213
    v_mfma_f32_16x16x32_bf16 a[24:27], a[184:187], v[112:115], a[24:27]
    v_exp_f32 v214, v38
    v_mfma_f32_16x16x32_bf16 a[56:59], a[184:187], v[116:119], a[56:59]
    buffer_load_dwordx4 v254, s[8:11], s29 offen offset:2048 lds
    v_add_f32 v218, v218, v213
    v_mfma_f32_16x16x32_bf16 a[88:91], a[184:187], v[120:123], a[88:91]
    v_exp_f32 v215, v39
    v_mfma_f32_16x16x32_bf16 a[120:123], a[184:187], v[124:127], a[120:123]
    v_add_f32 v218, v218, v214
    v_cvt_pk_bf16_f32 v107, v214, v215
    v_mfma_f32_16x16x32_bf16 a[28:31], a[188:191], v[112:115], a[28:31]
    v_exp_f32 v208, v40
    v_mfma_f32_16x16x32_bf16 a[60:63], a[188:191], v[116:119], a[60:63]
    buffer_load_dwordx4 v255, s[8:11], s29 offen offset:3072 lds
    v_add_f32 v218, v218, v215
    v_mfma_f32_16x16x32_bf16 a[92:95], a[188:191], v[120:123], a[92:95]
    s_add_u32 s29, s29, 16384
    v_exp_f32 v209, v41
    v_mfma_f32_16x16x32_bf16 a[124:127], a[188:191], v[124:127], a[124:127]
    s_waitcnt vmcnt(8) lgkmcnt(0)
    s_barrier
    s_sub_u32 s27, s27, 1
    s_cmp_lg_u32 s27, 0
    s_cbranch_scc1 L_attn_loop
    s_load_dwordx2 s[44:45], s[0:1], 64
    v_lshrrev_b32 v1, 4, v14
    v_and_b32 v2, 15, v1
    v_lshrrev_b32 v5, 4, v1
    v_mul_u32_u24 v9, 3584, v5
    v_add_u32 v8, 0, v5
    v_lshlrev_b32 v8, 1, v8
    v_xor_b32 v8, v8, v2
    v_min_u32 v8, 13, v8
    v_lshlrev_b32 v8, 4, v8
    v_add_u32 v128, v9, v8
    v_add_u32 v8, 4, v5
    v_lshlrev_b32 v8, 1, v8
    v_xor_b32 v8, v8, v2
    v_min_u32 v8, 13, v8
    v_lshlrev_b32 v8, 4, v8
    v_add_u32 v129, v9, v8
    v_mov_b32 v139, s67
    s_waitcnt lgkmcnt(0)
    s_mul_i32 s35, s42, 224
    s_add_u32 s44, s44, s35
    s_addc_u32 s45, s45, 0
    s_sub_u32 s46, 1835008, s35
    s_mov_b32 s47, 0x20000
    s_mul_i32 s38, s24, 57344
    buffer_load_dword v138, v139, s[56:59], 0 offen offset:32 sc1
    s_getpc_b64 s[88:89]
L_pc2:
    s_add_u32 s88, s88, L_j3 - L_pc2
    s_addc_u32 s89, s89, 0
    s_lshr_b32 s35, s2, 3
    s_lshl_b32 s35, s35, 2
    s_add_u32 s35, s35, s24
    s_mul_i32 s35, s35, 2
    v_lshrrev_b32 v2, 4, v14
    v_min_u32 v2, 1, v2
    v_add_u32 v2, s35, v2
    v_min_u32 v2, ((L_final_kernel_end - L_j3) >> 7) - 1, v2
    v_lshlrev_b32 v2, 7, v2
    global_load_dword v142, v2, s[88:89]
    v_mfma_f32_16x16x32_bf16 v[48:51], a[128:131], v[144:147], v[80:83]
    v_cvt_pk_bf16_f32 v108, v208, v209
    v_exp_f32 v210, v42
    v_mfma_f32_16x16x32_bf16 v[48:51], a[132:135], v[148:151], v[48:51]
    ds_read_b64_tr_b16 a[160:161], v242 offset:0
    v_add_f32 v219, v208, v209
    v_mfma_f32_16x16x32_bf16 v[48:51], a[136:139], v[152:155], v[48:51]
    s_add_u32 s63, s69, 0
    s_min_u32 s63, s63, s86
    s_and_b32 s64, s63, 7
    s_lshr_b32 s63, s63, 3
    s_lshl_b32 s63, s63, 10
    s_mul_i32 s64, s64, 754688
    s_add_u32 s63, s63, s64
    s_add_u32 s63, s63, s87
    buffer_store_dwordx4 a[208:211], v14, s[20:23], s63 offen sc1
    v_exp_f32 v211, v43
    v_mfma_f32_16x16x32_bf16 v[48:51], a[140:143], v[156:159], v[48:51]
    ds_read_b64_tr_b16 a[162:163], v242 offset:4096
    v_add_f32 v219, v219, v210
    v_cvt_pk_bf16_f32 v109, v210, v211
    v_mfma_f32_16x16x32_bf16 v[52:55], a[144:147], v[144:147], v[80:83]
    v_exp_f32 v212, v44
    v_mfma_f32_16x16x32_bf16 v[52:55], a[148:151], v[148:151], v[52:55]
    ds_read_b64_tr_b16 a[164:165], v243 offset:0
    v_add_f32 v219, v219, v211
    v_mfma_f32_16x16x32_bf16 v[52:55], a[152:155], v[152:155], v[52:55]
    s_add_u32 s63, s69, 1
    s_min_u32 s63, s63, s86
    s_and_b32 s64, s63, 7
    s_lshr_b32 s63, s63, 3
    s_lshl_b32 s63, s63, 10
    s_mul_i32 s64, s64, 754688
    s_add_u32 s63, s63, s64
    s_add_u32 s63, s63, s87
    buffer_store_dwordx4 a[212:215], v14, s[20:23], s63 offen sc1
    v_exp_f32 v213, v45
    v_mfma_f32_16x16x32_bf16 v[52:55], a[156:159], v[156:159], v[52:55]
    ds_read_b64_tr_b16 a[166:167], v243 offset:4096
    v_add_f32 v219, v219, v212
    v_cvt_pk_bf16_f32 v110, v212, v213
    v_mfma_f32_16x16x32_bf16 v[56:59], a[128:131], v[160:163], v[84:87]
    v_exp_f32 v214, v46
    v_mfma_f32_16x16x32_bf16 v[56:59], a[132:135], v[164:167], v[56:59]
    ds_read_b64_tr_b16 a[168:169], v244 offset:0
    v_add_f32 v219, v219, v213
    v_mfma_f32_16x16x32_bf16 v[56:59], a[136:139], v[168:171], v[56:59]
    s_add_u32 s63, s69, 2
    s_min_u32 s63, s63, s86
    s_and_b32 s64, s63, 7
    s_lshr_b32 s63, s63, 3
    s_lshl_b32 s63, s63, 10
    s_mul_i32 s64, s64, 754688
    s_add_u32 s63, s63, s64
    s_add_u32 s63, s63, s87
    buffer_store_dwordx4 a[216:219], v14, s[20:23], s63 offen sc1
    v_exp_f32 v215, v47
    v_mfma_f32_16x16x32_bf16 v[56:59], a[140:143], v[172:175], v[56:59]
    ds_read_b64_tr_b16 a[170:171], v244 offset:4096
    v_add_f32 v219, v219, v214
    v_cvt_pk_bf16_f32 v111, v214, v215
    v_mfma_f32_16x16x32_bf16 v[60:63], a[144:147], v[160:163], v[84:87]
    v_exp_f32 v208, v48
    v_mfma_f32_16x16x32_bf16 v[60:63], a[148:151], v[164:167], v[60:63]
    ds_read_b64_tr_b16 a[172:173], v245 offset:0
    v_add_f32 v219, v219, v215
    v_mfma_f32_16x16x32_bf16 v[60:63], a[152:155], v[168:171], v[60:63]
    s_add_u32 s63, s69, 3
    s_min_u32 s63, s63, s86
    s_and_b32 s64, s63, 7
    s_lshr_b32 s63, s63, 3
    s_lshl_b32 s63, s63, 10
    s_mul_i32 s64, s64, 754688
    s_add_u32 s63, s63, s64
    s_add_u32 s63, s63, s87
    buffer_store_dwordx4 a[220:223], v14, s[20:23], s63 offen sc1
    v_exp_f32 v209, v49
    v_max3_f32 v228, v216, v217, v218
    v_mfma_f32_16x16x32_bf16 v[60:63], a[156:159], v[172:175], v[60:63]
    ds_read_b64_tr_b16 a[174:175], v245 offset:4096
    v_cvt_pk_bf16_f32 v112, v208, v209
    v_max_f32 v228, v228, v219
    v_mfma_f32_16x16x32_bf16 v[64:67], a[128:131], v[176:179], v[88:91]
    v_exp_f32 v210, v50
    v_mfma_f32_16x16x32_bf16 v[64:67], a[132:135], v[180:183], v[64:67]
    ds_read_b64_tr_b16 a[176:177], v246 offset:0
    v_add_f32 v220, v208, v209
    v_cmp_nle_f32 vcc, v228, v229
    v_mfma_f32_16x16x32_bf16 v[64:67], a[136:139], v[184:187], v[64:67]
    s_add_u32 s63, s69, 4
    s_min_u32 s63, s63, s86
    s_and_b32 s64, s63, 7
    s_lshr_b32 s63, s63, 3
    s_lshl_b32 s63, s63, 10
    s_mul_i32 s64, s64, 754688
    s_add_u32 s63, s63, s64
    s_add_u32 s63, s63, s87
    buffer_store_dwordx4 a[224:227], v14, s[20:23], s63 offen sc1
    v_exp_f32 v211, v51
    v_mfma_f32_16x16x32_bf16 v[64:67], a[140:143], v[188:191], v[64:67]
    ds_read_b64_tr_b16 a[178:179], v246 offset:4096
    v_add_f32 v220, v220, v210
    v_cvt_pk_bf16_f32 v113, v210, v211
    v_mfma_f32_16x16x32_bf16 v[68:71], a[144:147], v[176:179], v[88:91]
    v_exp_f32 v212, v52
    v_mfma_f32_16x16x32_bf16 v[68:71], a[148:151], v[180:183], v[68:71]
    ds_read_b64_tr_b16 a[180:181], v247 offset:0
    v_add_f32 v220, v220, v211
    v_mfma_f32_16x16x32_bf16 v[68:71], a[152:155], v[184:187], v[68:71]
    s_add_u32 s63, s69, 5
    s_min_u32 s63, s63, s86
    s_and_b32 s64, s63, 7
    s_lshr_b32 s63, s63, 3
    s_lshl_b32 s63, s63, 10
    s_mul_i32 s64, s64, 754688
    s_add_u32 s63, s63, s64
    s_add_u32 s63, s63, s87
    buffer_store_dwordx4 a[228:231], v14, s[20:23], s63 offen sc1
    v_exp_f32 v213, v53
    v_mfma_f32_16x16x32_bf16 v[68:71], a[156:159], v[188:191], v[68:71]
    ds_read_b64_tr_b16 a[182:183], v247 offset:4096
    v_add_f32 v220, v220, v212
    v_cvt_pk_bf16_f32 v114, v212, v213
    s_cbranch_vccnz L_tramp_17
L_back_18:
    v_mfma_f32_16x16x32_bf16 v[72:75], a[128:131], v[192:195], v[92:95]
    v_exp_f32 v214, v54
    v_mfma_f32_16x16x32_bf16 v[72:75], a[132:135], v[196:199], v[72:75]
    ds_read_b64_tr_b16 a[184:185], v248 offset:0
    v_add_f32 v220, v220, v213
    v_add_f32 v224, v224, v216
    v_mfma_f32_16x16x32_bf16 v[72:75], a[136:139], v[200:203], v[72:75]
    v_exp_f32 v215, v55
    v_mfma_f32_16x16x32_bf16 v[72:75], a[140:143], v[204:207], v[72:75]
    ds_read_b64_tr_b16 a[186:187], v248 offset:4096
    v_add_f32 v220, v220, v214
    v_cvt_pk_bf16_f32 v115, v214, v215
    v_add_f32 v225, v225, v217
    v_mfma_f32_16x16x32_bf16 v[76:79], a[144:147], v[192:195], v[92:95]
    v_exp_f32 v208, v56
    v_mfma_f32_16x16x32_bf16 v[76:79], a[148:151], v[196:199], v[76:79]
    ds_read_b64_tr_b16 a[188:189], v249 offset:0
    v_add_f32 v220, v220, v215
    v_add_f32 v226, v226, v218
    v_mfma_f32_16x16x32_bf16 v[76:79], a[152:155], v[200:203], v[76:79]
    v_exp_f32 v209, v57
    v_mfma_f32_16x16x32_bf16 v[76:79], a[156:159], v[204:207], v[76:79]
    ds_read_b64_tr_b16 a[190:191], v249 offset:4096
    s_waitcnt lgkmcnt(8)
    v_cvt_pk_bf16_f32 v116, v208, v209
    v_add_f32 v227, v227, v219
    v_mfma_f32_16x16x32_bf16 a[0:3], a[160:163], v[96:99], a[0:3]
    v_exp_f32 v210, v58
    v_mfma_f32_16x16x32_bf16 a[32:35], a[160:163], v[100:103], a[32:35]
    ds_read_b128 a[128:131], v238 offset:16384
    v_add_f32 v221, v208, v209
    v_mfma_f32_16x16x32_bf16 a[64:67], a[160:163], v[104:107], a[64:67]
    v_exp_f32 v211, v59
    v_mfma_f32_16x16x32_bf16 a[96:99], a[160:163], v[108:111], a[96:99]
    ds_read_b128 a[132:135], v239 offset:16384
    v_add_f32 v221, v221, v210
    v_cvt_pk_bf16_f32 v117, v210, v211
    v_mfma_f32_16x16x32_bf16 a[4:7], a[164:167], v[96:99], a[4:7]
    v_exp_f32 v212, v60
    v_mfma_f32_16x16x32_bf16 a[36:39], a[164:167], v[100:103], a[36:39]
    ds_read_b128 a[136:139], v240 offset:16384
    v_add_f32 v221, v221, v211
    v_mfma_f32_16x16x32_bf16 a[68:71], a[164:167], v[104:107], a[68:71]
    v_exp_f32 v213, v61
    v_mfma_f32_16x16x32_bf16 a[100:103], a[164:167], v[108:111], a[100:103]
    ds_read_b128 a[140:143], v241 offset:16384
    v_add_f32 v221, v221, v212
    v_cvt_pk_bf16_f32 v118, v212, v213
    v_mfma_f32_16x16x32_bf16 a[8:11], a[168:171], v[96:99], a[8:11]
    v_exp_f32 v214, v62
    v_mfma_f32_16x16x32_bf16 a[40:43], a[168:171], v[100:103], a[40:43]
    ds_read_b128 a[144:147], v238 offset:20480
    v_add_f32 v221, v221, v213
    v_mfma_f32_16x16x32_bf16 a[72:75], a[168:171], v[104:107], a[72:75]
    v_exp_f32 v215, v63
    v_mfma_f32_16x16x32_bf16 a[104:107], a[168:171], v[108:111], a[104:107]
    ds_read_b128 a[148:151], v239 offset:20480
    v_add_f32 v221, v221, v214
    v_cvt_pk_bf16_f32 v119, v214, v215
    v_mfma_f32_16x16x32_bf16 a[12:15], a[172:175], v[96:99], a[12:15]
    v_exp_f32 v208, v64
    v_mfma_f32_16x16x32_bf16 a[44:47], a[172:175], v[100:103], a[44:47]
    ds_read_b128 a[152:155], v240 offset:20480
    v_add_f32 v221, v221, v215
    v_mfma_f32_16x16x32_bf16 a[76:79], a[172:175], v[104:107], a[76:79]
    v_exp_f32 v209, v65
    v_mfma_f32_16x16x32_bf16 a[108:111], a[172:175], v[108:111], a[108:111]
    ds_read_b128 a[156:159], v241 offset:20480
    s_waitcnt lgkmcnt(8)
    v_cvt_pk_bf16_f32 v120, v208, v209
    v_mfma_f32_16x16x32_bf16 a[16:19], a[176:179], v[96:99], a[16:19]
    s_add_u32 m0, s33, 49152
    v_exp_f32 v210, v66
    v_mfma_f32_16x16x32_bf16 a[48:51], a[176:179], v[100:103], a[48:51]
    buffer_load_dwordx4 v250, s[4:7], s28 offen offset:0 lds
    v_add_f32 v222, v208, v209
    v_mfma_f32_16x16x32_bf16 a[80:83], a[176:179], v[104:107], a[80:83]
    v_exp_f32 v211, v67
    v_mfma_f32_16x16x32_bf16 a[112:115], a[176:179], v[108:111], a[112:115]
    v_add_f32 v222, v222, v210
    v_cvt_pk_bf16_f32 v121, v210, v211
    v_mfma_f32_16x16x32_bf16 a[20:23], a[180:183], v[96:99], a[20:23]
    v_exp_f32 v212, v68
    v_mfma_f32_16x16x32_bf16 a[52:55], a[180:183], v[100:103], a[52:55]
    buffer_load_dwordx4 v251, s[4:7], s28 offen offset:1024 lds
    v_add_f32 v222, v222, v211
    v_mfma_f32_16x16x32_bf16 a[84:87], a[180:183], v[104:107], a[84:87]
    v_exp_f32 v213, v69
    v_mfma_f32_16x16x32_bf16 a[116:119], a[180:183], v[108:111], a[116:119]
    v_add_f32 v222, v222, v212
    v_cvt_pk_bf16_f32 v122, v212, v213
    v_mfma_f32_16x16x32_bf16 a[24:27], a[184:187], v[96:99], a[24:27]
    v_exp_f32 v214, v70
    v_mfma_f32_16x16x32_bf16 a[56:59], a[184:187], v[100:103], a[56:59]
    buffer_load_dwordx4 v252, s[4:7], s28 offen offset:2048 lds
    v_add_f32 v222, v222, v213
    v_mfma_f32_16x16x32_bf16 a[88:91], a[184:187], v[104:107], a[88:91]
    v_exp_f32 v215, v71
    v_mfma_f32_16x16x32_bf16 a[120:123], a[184:187], v[108:111], a[120:123]
    v_add_f32 v222, v222, v214
    v_cvt_pk_bf16_f32 v123, v214, v215
    v_mfma_f32_16x16x32_bf16 a[28:31], a[188:191], v[96:99], a[28:31]
    v_exp_f32 v208, v72
    v_mfma_f32_16x16x32_bf16 a[60:63], a[188:191], v[100:103], a[60:63]
    buffer_load_dwordx4 v253, s[4:7], s28 offen offset:3072 lds
    v_add_f32 v222, v222, v215
    v_mfma_f32_16x16x32_bf16 a[92:95], a[188:191], v[104:107], a[92:95]
    s_add_u32 s28, s28, 16384
    v_exp_f32 v209, v73
    v_mfma_f32_16x16x32_bf16 a[124:127], a[188:191], v[108:111], a[124:127]
    s_waitcnt lgkmcnt(0)
    v_cvt_pk_bf16_f32 v124, v208, v209
    v_mfma_f32_16x16x32_bf16 v[16:19], a[128:131], v[144:147], v[80:83]
    v_exp_f32 v210, v74
    v_mfma_f32_16x16x32_bf16 v[16:19], a[132:135], v[148:151], v[16:19]
    ds_read_b64_tr_b16 a[160:161], v242 offset:8192
    v_add_f32 v223, v208, v209
    v_mfma_f32_16x16x32_bf16 v[16:19], a[136:139], v[152:155], v[16:19]
    v_exp_f32 v211, v75
    v_mfma_f32_16x16x32_bf16 v[16:19], a[140:143], v[156:159], v[16:19]
    ds_read_b64_tr_b16 a[162:163], v242 offset:12288
    v_add_f32 v223, v223, v210
    v_cvt_pk_bf16_f32 v125, v210, v211
    v_mfma_f32_16x16x32_bf16 v[20:23], a[144:147], v[144:147], v[80:83]
    v_exp_f32 v212, v76
    v_mfma_f32_16x16x32_bf16 v[20:23], a[148:151], v[148:151], v[20:23]
    ds_read_b64_tr_b16 a[164:165], v243 offset:8192
    v_add_f32 v223, v223, v211
    v_mfma_f32_16x16x32_bf16 v[20:23], a[152:155], v[152:155], v[20:23]
    v_exp_f32 v213, v77
    v_mfma_f32_16x16x32_bf16 v[20:23], a[156:159], v[156:159], v[20:23]
    ds_read_b64_tr_b16 a[166:167], v243 offset:12288
    v_add_f32 v223, v223, v212
    v_cvt_pk_bf16_f32 v126, v212, v213
    v_mfma_f32_16x16x32_bf16 v[24:27], a[128:131], v[160:163], v[84:87]
    v_exp_f32 v214, v78
    v_mfma_f32_16x16x32_bf16 v[24:27], a[132:135], v[164:167], v[24:27]
    ds_read_b64_tr_b16 a[168:169], v244 offset:8192
    v_add_f32 v223, v223, v213
    v_mfma_f32_16x16x32_bf16 v[24:27], a[136:139], v[168:171], v[24:27]
    v_exp_f32 v215, v79
    v_mfma_f32_16x16x32_bf16 v[24:27], a[140:143], v[172:175], v[24:27]
    ds_read_b64_tr_b16 a[170:171], v244 offset:12288
    v_add_f32 v223, v223, v214
    v_cvt_pk_bf16_f32 v127, v214, v215
    v_mfma_f32_16x16x32_bf16 v[28:31], a[144:147], v[160:163], v[84:87]
    v_exp_f32 v208, v16
    v_mfma_f32_16x16x32_bf16 v[28:31], a[148:151], v[164:167], v[28:31]
    ds_read_b64_tr_b16 a[172:173], v245 offset:8192
    v_add_f32 v223, v223, v215
    v_mfma_f32_16x16x32_bf16 v[28:31], a[152:155], v[168:171], v[28:31]
    v_exp_f32 v209, v17
    v_max3_f32 v228, v220, v221, v222
    v_mfma_f32_16x16x32_bf16 v[28:31], a[156:159], v[172:175], v[28:31]
    ds_read_b64_tr_b16 a[174:175], v245 offset:12288
    v_cvt_pk_bf16_f32 v96, v208, v209
    v_max_f32 v228, v228, v223
    v_mfma_f32_16x16x32_bf16 v[32:35], a[128:131], v[176:179], v[88:91]
    v_exp_f32 v210, v18
    v_mfma_f32_16x16x32_bf16 v[32:35], a[132:135], v[180:183], v[32:35]
    ds_read_b64_tr_b16 a[176:177], v246 offset:8192
    v_add_f32 v216, v208, v209
    v_cmp_nle_f32 vcc, v228, v229
    v_mfma_f32_16x16x32_bf16 v[32:35], a[136:139], v[184:187], v[32:35]
    v_exp_f32 v211, v19
    v_mfma_f32_16x16x32_bf16 v[32:35], a[140:143], v[188:191], v[32:35]
    ds_read_b64_tr_b16 a[178:179], v246 offset:12288
    v_add_f32 v216, v216, v210
    v_cvt_pk_bf16_f32 v97, v210, v211
    v_mfma_f32_16x16x32_bf16 v[36:39], a[144:147], v[176:179], v[88:91]
    v_exp_f32 v212, v20
    v_mfma_f32_16x16x32_bf16 v[36:39], a[148:151], v[180:183], v[36:39]
    ds_read_b64_tr_b16 a[180:181], v247 offset:8192
    v_add_f32 v216, v216, v211
    v_mfma_f32_16x16x32_bf16 v[36:39], a[152:155], v[184:187], v[36:39]
    v_exp_f32 v213, v21
    v_mfma_f32_16x16x32_bf16 v[36:39], a[156:159], v[188:191], v[36:39]
    ds_read_b64_tr_b16 a[182:183], v247 offset:12288
    v_add_f32 v216, v216, v212
    v_cvt_pk_bf16_f32 v98, v212, v213
    s_cbranch_vccnz L_tramp_19
L_back_20:
    v_mfma_f32_16x16x32_bf16 v[40:43], a[128:131], v[192:195], v[92:95]
    v_exp_f32 v214, v22
    v_mfma_f32_16x16x32_bf16 v[40:43], a[132:135], v[196:199], v[40:43]
    ds_read_b64_tr_b16 a[184:185], v248 offset:8192
    v_add_f32 v216, v216, v213
    v_add_f32 v224, v224, v220
    v_mfma_f32_16x16x32_bf16 v[40:43], a[136:139], v[200:203], v[40:43]
    v_exp_f32 v215, v23
    v_mfma_f32_16x16x32_bf16 v[40:43], a[140:143], v[204:207], v[40:43]
    ds_read_b64_tr_b16 a[186:187], v248 offset:12288
    v_add_f32 v216, v216, v214
    v_cvt_pk_bf16_f32 v99, v214, v215
    v_add_f32 v225, v225, v221
    v_mfma_f32_16x16x32_bf16 v[44:47], a[144:147], v[192:195], v[92:95]
    v_exp_f32 v208, v24
    v_mfma_f32_16x16x32_bf16 v[44:47], a[148:151], v[196:199], v[44:47]
    ds_read_b64_tr_b16 a[188:189], v249 offset:8192
    v_add_f32 v216, v216, v215
    v_add_f32 v226, v226, v222
    v_mfma_f32_16x16x32_bf16 v[44:47], a[152:155], v[200:203], v[44:47]
    v_exp_f32 v209, v25
    v_mfma_f32_16x16x32_bf16 v[44:47], a[156:159], v[204:207], v[44:47]
    ds_read_b64_tr_b16 a[190:191], v249 offset:12288
    s_waitcnt lgkmcnt(8)
    v_cvt_pk_bf16_f32 v100, v208, v209
    v_add_f32 v227, v227, v223
    v_mfma_f32_16x16x32_bf16 a[0:3], a[160:163], v[112:115], a[0:3]
    v_exp_f32 v210, v26
    v_mfma_f32_16x16x32_bf16 a[32:35], a[160:163], v[116:119], a[32:35]
    ds_read_b128 a[128:131], v238 offset:24576
    v_add_f32 v217, v208, v209
    v_mfma_f32_16x16x32_bf16 a[64:67], a[160:163], v[120:123], a[64:67]
    v_exp_f32 v211, v27
    v_mfma_f32_16x16x32_bf16 a[96:99], a[160:163], v[124:127], a[96:99]
    ds_read_b128 a[132:135], v239 offset:24576
    v_add_f32 v217, v217, v210
    v_cvt_pk_bf16_f32 v101, v210, v211
    v_mfma_f32_16x16x32_bf16 a[4:7], a[164:167], v[112:115], a[4:7]
    v_exp_f32 v212, v28
    v_mfma_f32_16x16x32_bf16 a[36:39], a[164:167], v[116:119], a[36:39]
    ds_read_b128 a[136:139], v240 offset:24576
    v_add_f32 v217, v217, v211
    v_mfma_f32_16x16x32_bf16 a[68:71], a[164:167], v[120:123], a[68:71]
    v_exp_f32 v213, v29
    v_mfma_f32_16x16x32_bf16 a[100:103], a[164:167], v[124:127], a[100:103]
    ds_read_b128 a[140:143], v241 offset:24576
    v_add_f32 v217, v217, v212
    v_cvt_pk_bf16_f32 v102, v212, v213
    v_mfma_f32_16x16x32_bf16 a[8:11], a[168:171], v[112:115], a[8:11]
    v_exp_f32 v214, v30
    v_mfma_f32_16x16x32_bf16 a[40:43], a[168:171], v[116:119], a[40:43]
    ds_read_b128 a[144:147], v238 offset:28672
    v_add_f32 v217, v217, v213
    v_mfma_f32_16x16x32_bf16 a[72:75], a[168:171], v[120:123], a[72:75]
    v_exp_f32 v215, v31
    v_mfma_f32_16x16x32_bf16 a[104:107], a[168:171], v[124:127], a[104:107]
    ds_read_b128 a[148:151], v239 offset:28672
    v_add_f32 v217, v217, v214
    v_cvt_pk_bf16_f32 v103, v214, v215
    v_mfma_f32_16x16x32_bf16 a[12:15], a[172:175], v[112:115], a[12:15]
    v_exp_f32 v208, v32
    v_mfma_f32_16x16x32_bf16 a[44:47], a[172:175], v[116:119], a[44:47]
    ds_read_b128 a[152:155], v240 offset:28672
    v_add_f32 v217, v217, v215
    v_mfma_f32_16x16x32_bf16 a[76:79], a[172:175], v[120:123], a[76:79]
    v_exp_f32 v209, v33
    v_mfma_f32_16x16x32_bf16 a[108:111], a[172:175], v[124:127], a[108:111]
    ds_read_b128 a[156:159], v241 offset:28672
    s_waitcnt lgkmcnt(8)
    v_cvt_pk_bf16_f32 v104, v208, v209
    v_mfma_f32_16x16x32_bf16 a[16:19], a[176:179], v[112:115], a[16:19]
    s_add_u32 m0, s34, 49152
    v_exp_f32 v210, v34
    v_mfma_f32_16x16x32_bf16 a[48:51], a[176:179], v[116:119], a[48:51]
    buffer_load_dwordx4 v254, s[8:11], s29 offen offset:0 lds
    v_add_f32 v218, v208, v209
    v_mfma_f32_16x16x32_bf16 a[80:83], a[176:179], v[120:123], a[80:83]
    v_exp_f32 v211, v35
    v_mfma_f32_16x16x32_bf16 a[112:115], a[176:179], v[124:127], a[112:115]
    v_add_f32 v218, v218, v210
    v_cvt_pk_bf16_f32 v105, v210, v211
    v_mfma_f32_16x16x32_bf16 a[20:23], a[180:183], v[112:115], a[20:23]
    v_exp_f32 v212, v36
    v_mfma_f32_16x16x32_bf16 a[52:55], a[180:183], v[116:119], a[52:55]
    buffer_load_dwordx4 v255, s[8:11], s29 offen offset:1024 lds
    v_add_f32 v218, v218, v211
    v_mfma_f32_16x16x32_bf16 a[84:87], a[180:183], v[120:123], a[84:87]
    v_exp_f32 v213, v37
    v_mfma_f32_16x16x32_bf16 a[116:119], a[180:183], v[124:127], a[116:119]
    v_add_f32 v218, v218, v212
    v_cvt_pk_bf16_f32 v106, v212, v213
    v_mfma_f32_16x16x32_bf16 a[24:27], a[184:187], v[112:115], a[24:27]
    v_exp_f32 v214, v38
    v_mfma_f32_16x16x32_bf16 a[56:59], a[184:187], v[116:119], a[56:59]
    buffer_load_dwordx4 v254, s[8:11], s29 offen offset:2048 lds
    v_add_f32 v218, v218, v213
    v_mfma_f32_16x16x32_bf16 a[88:91], a[184:187], v[120:123], a[88:91]
    v_exp_f32 v215, v39
    v_mfma_f32_16x16x32_bf16 a[120:123], a[184:187], v[124:127], a[120:123]
    v_add_f32 v218, v218, v214
    v_cvt_pk_bf16_f32 v107, v214, v215
    v_mfma_f32_16x16x32_bf16 a[28:31], a[188:191], v[112:115], a[28:31]
    v_exp_f32 v208, v40
    v_mfma_f32_16x16x32_bf16 a[60:63], a[188:191], v[116:119], a[60:63]
    buffer_load_dwordx4 v255, s[8:11], s29 offen offset:3072 lds
    v_add_f32 v218, v218, v215
    v_mfma_f32_16x16x32_bf16 a[92:95], a[188:191], v[120:123], a[92:95]
    s_waitcnt vmcnt(15)
    s_cmp_lg_u32 s24, 0
    s_cbranch_scc1 L_p2_ok
    v_cmp_gt_u32 vcc, 32, v138
    s_nop 0
    s_cbranch_vccz L_p2_ok
    s_mov_b32 s66, 20000
L_p2_spin:
    buffer_load_dword v138, v139, s[56:59], 0 offen offset:32 sc1
    s_waitcnt vmcnt(0)
    v_cmp_gt_u32 vcc, 32, v138
    s_nop 0
    s_cbranch_vccz L_p2_ok
    s_sub_u32 s66, s66, 1
    s_cmp_lg_u32 s66, 0
    s_cbranch_scc1 L_p2_spin
L_p2_ok:
    s_add_u32 s29, s29, 16384
    v_exp_f32 v209, v41
    v_mfma_f32_16x16x32_bf16 a[124:127], a[188:191], v[124:127], a[124:127]
    s_waitcnt vmcnt(14) lgkmcnt(0)
    s_barrier
    v_mfma_f32_16x16x32_bf16 v[48:51], a[128:131], v[144:147], v[80:83]
    v_cvt_pk_bf16_f32 v108, v208, v209
    v_exp_f32 v210, v42
    v_mfma_f32_16x16x32_bf16 v[48:51], a[132:135], v[148:151], v[48:51]
    ds_read_b64_tr_b16 a[160:161], v242 offset:16384
    v_add_f32 v219, v208, v209
    v_mfma_f32_16x16x32_bf16 v[48:51], a[136:139], v[152:155], v[48:51]
    v_exp_f32 v211, v43
    v_mfma_f32_16x16x32_bf16 v[48:51], a[140:143], v[156:159], v[48:51]
    ds_read_b64_tr_b16 a[162:163], v242 offset:20480
    v_add_f32 v219, v219, v210
    v_cvt_pk_bf16_f32 v109, v210, v211
    v_mfma_f32_16x16x32_bf16 v[52:55], a[144:147], v[144:147], v[80:83]
    v_exp_f32 v212, v44
    v_mfma_f32_16x16x32_bf16 v[52:55], a[148:151], v[148:151], v[52:55]
    ds_read_b64_tr_b16 a[164:165], v243 offset:16384
    v_add_f32 v219, v219, v211
    v_mfma_f32_16x16x32_bf16 v[52:55], a[152:155], v[152:155], v[52:55]
    v_exp_f32 v213, v45
    v_mfma_f32_16x16x32_bf16 v[52:55], a[156:159], v[156:159], v[52:55]
    ds_read_b64_tr_b16 a[166:167], v243 offset:20480
    v_add_f32 v219, v219, v212
    v_cvt_pk_bf16_f32 v110, v212, v213
    v_mfma_f32_16x16x32_bf16 v[56:59], a[128:131], v[160:163], v[84:87]
    v_exp_f32 v214, v46
    v_mfma_f32_16x16x32_bf16 v[56:59], a[132:135], v[164:167], v[56:59]
    ds_read_b64_tr_b16 a[168:169], v244 offset:16384
    v_add_f32 v219, v219, v213
    v_mfma_f32_16x16x32_bf16 v[56:59], a[136:139], v[168:171], v[56:59]
    v_exp_f32 v215, v47
    v_mfma_f32_16x16x32_bf16 v[56:59], a[140:143], v[172:175], v[56:59]
    ds_read_b64_tr_b16 a[170:171], v244 offset:20480
    v_add_f32 v219, v219, v214
    v_cvt_pk_bf16_f32 v111, v214, v215
    v_mfma_f32_16x16x32_bf16 v[60:63], a[144:147], v[160:163], v[84:87]
    v_exp_f32 v208, v48
    v_mfma_f32_16x16x32_bf16 v[60:63], a[148:151], v[164:167], v[60:63]
    ds_read_b64_tr_b16 a[172:173], v245 offset:16384
    v_add_f32 v219, v219, v215
    v_mfma_f32_16x16x32_bf16 v[60:63], a[152:155], v[168:171], v[60:63]
    v_exp_f32 v209, v49
    v_max3_f32 v228, v216, v217, v218
    v_mfma_f32_16x16x32_bf16 v[60:63], a[156:159], v[172:175], v[60:63]
    ds_read_b64_tr_b16 a[174:175], v245 offset:20480
    v_cvt_pk_bf16_f32 v112, v208, v209
    v_max_f32 v228, v228, v219
    v_mfma_f32_16x16x32_bf16 v[64:67], a[128:131], v[176:179], v[88:91]
    v_exp_f32 v210, v50
    v_mfma_f32_16x16x32_bf16 v[64:67], a[132:135], v[180:183], v[64:67]
    ds_read_b64_tr_b16 a[176:177], v246 offset:16384
    v_add_f32 v220, v208, v209
    v_cmp_nle_f32 vcc, v228, v229
    v_mfma_f32_16x16x32_bf16 v[64:67], a[136:139], v[184:187], v[64:67]
    v_exp_f32 v211, v51
    v_mfma_f32_16x16x32_bf16 v[64:67], a[140:143], v[188:191], v[64:67]
    ds_read_b64_tr_b16 a[178:179], v246 offset:20480
    v_add_f32 v220, v220, v210
    v_cvt_pk_bf16_f32 v113, v210, v211
    v_mfma_f32_16x16x32_bf16 v[68:71], a[144:147], v[176:179], v[88:91]
    v_exp_f32 v212, v52
    v_mfma_f32_16x16x32_bf16 v[68:71], a[148:151], v[180:183], v[68:71]
    ds_read_b64_tr_b16 a[180:181], v247 offset:16384
    v_add_f32 v220, v220, v211
    v_mfma_f32_16x16x32_bf16 v[68:71], a[152:155], v[184:187], v[68:71]
    v_exp_f32 v213, v53
    v_mfma_f32_16x16x32_bf16 v[68:71], a[156:159], v[188:191], v[68:71]
    ds_read_b64_tr_b16 a[182:183], v247 offset:20480
    v_add_f32 v220, v220, v212
    v_cvt_pk_bf16_f32 v114, v212, v213
    s_cbranch_vccnz L_tramp_21
L_back_22:
    v_mfma_f32_16x16x32_bf16 v[72:75], a[128:131], v[192:195], v[92:95]
    v_exp_f32 v214, v54
    v_mfma_f32_16x16x32_bf16 v[72:75], a[132:135], v[196:199], v[72:75]
    ds_read_b64_tr_b16 a[184:185], v248 offset:16384
    v_add_f32 v220, v220, v213
    v_add_f32 v224, v224, v216
    v_mfma_f32_16x16x32_bf16 v[72:75], a[136:139], v[200:203], v[72:75]
    v_exp_f32 v215, v55
    v_mfma_f32_16x16x32_bf16 v[72:75], a[140:143], v[204:207], v[72:75]
    ds_read_b64_tr_b16 a[186:187], v248 offset:20480
    v_add_f32 v220, v220, v214
    v_cvt_pk_bf16_f32 v115, v214, v215
    v_add_f32 v225, v225, v217
    v_mfma_f32_16x16x32_bf16 v[76:79], a[144:147], v[192:195], v[92:95]
    v_exp_f32 v208, v56
    v_mfma_f32_16x16x32_bf16 v[76:79], a[148:151], v[196:199], v[76:79]
    ds_read_b64_tr_b16 a[188:189], v249 offset:16384
    v_add_f32 v220, v220, v215
    v_add_f32 v226, v226, v218
    v_mfma_f32_16x16x32_bf16 v[76:79], a[152:155], v[200:203], v[76:79]
    v_exp_f32 v209, v57
    v_mfma_f32_16x16x32_bf16 v[76:79], a[156:159], v[204:207], v[76:79]
    ds_read_b64_tr_b16 a[190:191], v249 offset:20480
    s_waitcnt lgkmcnt(8)
    v_cvt_pk_bf16_f32 v116, v208, v209
    v_add_f32 v227, v227, v219
    v_mfma_f32_16x16x32_bf16 a[0:3], a[160:163], v[96:99], a[0:3]
    v_exp_f32 v210, v58
    v_mfma_f32_16x16x32_bf16 a[32:35], a[160:163], v[100:103], a[32:35]
    ds_read_b128 a[128:131], v238 offset:32768
    v_add_f32 v221, v208, v209
    v_mfma_f32_16x16x32_bf16 a[64:67], a[160:163], v[104:107], a[64:67]
    s_add_u32 s64, s61, 6291456
    buffer_load_dwordx4 a[192:195], v14, s[20:23], s64 offen offset:0 sc1
    v_exp_f32 v211, v59
    v_mfma_f32_16x16x32_bf16 a[96:99], a[160:163], v[108:111], a[96:99]
    ds_read_b128 a[132:135], v239 offset:32768
    v_add_f32 v221, v221, v210
    v_cvt_pk_bf16_f32 v117, v210, v211
    v_mfma_f32_16x16x32_bf16 a[4:7], a[164:167], v[96:99], a[4:7]
    v_exp_f32 v212, v60
    v_mfma_f32_16x16x32_bf16 a[36:39], a[164:167], v[100:103], a[36:39]
    ds_read_b128 a[136:139], v240 offset:32768
    v_add_f32 v221, v221, v211
    v_mfma_f32_16x16x32_bf16 a[68:71], a[164:167], v[104:107], a[68:71]
    s_add_u32 s64, s61, 6307840
    buffer_load_dwordx4 a[196:199], v14, s[20:23], s64 offen offset:0 sc1
    v_exp_f32 v213, v61
    v_mfma_f32_16x16x32_bf16 a[100:103], a[164:167], v[108:111], a[100:103]
    ds_read_b128 a[140:143], v241 offset:32768
    v_add_f32 v221, v221, v212
    v_cvt_pk_bf16_f32 v118, v212, v213
    v_mfma_f32_16x16x32_bf16 a[8:11], a[168:171], v[96:99], a[8:11]
    v_exp_f32 v214, v62
    v_mfma_f32_16x16x32_bf16 a[40:43], a[168:171], v[100:103], a[40:43]
    ds_read_b128 a[144:147], v238 offset:36864
    v_add_f32 v221, v221, v213
    v_mfma_f32_16x16x32_bf16 a[72:75], a[168:171], v[104:107], a[72:75]
    s_add_u32 s64, s61, 6291456
    buffer_load_dwordx4 a[200:203], v14, s[20:23], s64 offen offset:1024 sc1
    v_exp_f32 v215, v63
    v_mfma_f32_16x16x32_bf16 a[104:107], a[168:171], v[108:111], a[104:107]
    ds_read_b128 a[148:151], v239 offset:36864
    v_add_f32 v221, v221, v214
    v_cvt_pk_bf16_f32 v119, v214, v215
    v_mfma_f32_16x16x32_bf16 a[12:15], a[172:175], v[96:99], a[12:15]
    v_exp_f32 v208, v64
    v_mfma_f32_16x16x32_bf16 a[44:47], a[172:175], v[100:103], a[44:47]
    ds_read_b128 a[152:155], v240 offset:36864
    v_add_f32 v221, v221, v215
    v_mfma_f32_16x16x32_bf16 a[76:79], a[172:175], v[104:107], a[76:79]
    s_add_u32 s64, s61, 6307840
    buffer_load_dwordx4 a[204:207], v14, s[20:23], s64 offen offset:1024 sc1
    v_exp_f32 v209, v65
    v_mfma_f32_16x16x32_bf16 a[108:111], a[172:175], v[108:111], a[108:111]
    ds_read_b128 a[156:159], v241 offset:36864
    s_waitcnt lgkmcnt(8)
    v_cvt_pk_bf16_f32 v120, v208, v209
    v_mfma_f32_16x16x32_bf16 a[16:19], a[176:179], v[96:99], a[16:19]
    s_add_u32 m0, s33, 0
    v_exp_f32 v210, v66
    v_mfma_f32_16x16x32_bf16 a[48:51], a[176:179], v[100:103], a[48:51]
    s_add_u32 s35, s38, 0
    buffer_load_dwordx4 v128, s[44:47], s35 offen offset:0 lds
    v_add_f32 v222, v208, v209
    v_mfma_f32_16x16x32_bf16 a[80:83], a[176:179], v[104:107], a[80:83]
    v_exp_f32 v211, v67
    v_mfma_f32_16x16x32_bf16 a[112:115], a[176:179], v[108:111], a[112:115]
    v_add_f32 v222, v222, v210
    v_cvt_pk_bf16_f32 v121, v210, v211
    v_mfma_f32_16x16x32_bf16 a[20:23], a[180:183], v[96:99], a[20:23]
    v_exp_f32 v212, v68
    v_mfma_f32_16x16x32_bf16 a[52:55], a[180:183], v[100:103], a[52:55]
    s_add_u32 s35, s38, 13312
    buffer_load_dwordx4 v129, s[44:47], s35 offen offset:1024 lds
    v_add_f32 v222, v222, v211
    v_mfma_f32_16x16x32_bf16 a[84:87], a[180:183], v[104:107], a[84:87]
    v_exp_f32 v213, v69
    v_mfma_f32_16x16x32_bf16 a[116:119], a[180:183], v[108:111], a[116:119]
    v_add_f32 v222, v222, v212
    v_cvt_pk_bf16_f32 v122, v212, v213
    v_mfma_f32_16x16x32_bf16 a[24:27], a[184:187], v[96:99], a[24:27]
    v_exp_f32 v214, v70
    v_mfma_f32_16x16x32_bf16 a[56:59], a[184:187], v[100:103], a[56:59]
    s_add_u32 s35, s38, 26624
    buffer_load_dwordx4 v128, s[44:47], s35 offen offset:2048 lds
    v_add_f32 v222, v222, v213
    v_mfma_f32_16x16x32_bf16 a[88:91], a[184:187], v[104:107], a[88:91]
    v_exp_f32 v215, v71
    v_mfma_f32_16x16x32_bf16 a[120:123], a[184:187], v[108:111], a[120:123]
    v_add_f32 v222, v222, v214
    v_cvt_pk_bf16_f32 v123, v214, v215
    v_mfma_f32_16x16x32_bf16 a[28:31], a[188:191], v[96:99], a[28:31]
    v_exp_f32 v208, v72
    v_mfma_f32_16x16x32_bf16 a[60:63], a[188:191], v[100:103], a[60:63]
    s_add_u32 s35, s38, 39936
    buffer_load_dwordx4 v129, s[44:47], s35 offen offset:3072 lds
    v_add_f32 v222, v222, v215
    v_mfma_f32_16x16x32_bf16 a[92:95], a[188:191], v[104:107], a[92:95]
    s_add_u32 s28, s28, 16384
    v_exp_f32 v209, v73
    v_mfma_f32_16x16x32_bf16 a[124:127], a[188:191], v[108:111], a[124:127]
    s_waitcnt lgkmcnt(0)
    v_cvt_pk_bf16_f32 v124, v208, v209
    v_mfma_f32_16x16x32_bf16 v[16:19], a[128:131], v[144:147], v[80:83]
    v_exp_f32 v210, v74
    v_mfma_f32_16x16x32_bf16 v[16:19], a[132:135], v[148:151], v[16:19]
    ds_read_b64_tr_b16 a[160:161], v242 offset:24576
    v_add_f32 v223, v208, v209
    v_mfma_f32_16x16x32_bf16 v[16:19], a[136:139], v[152:155], v[16:19]
    v_exp_f32 v211, v75
    v_mfma_f32_16x16x32_bf16 v[16:19], a[140:143], v[156:159], v[16:19]
    ds_read_b64_tr_b16 a[162:163], v242 offset:28672
    v_add_f32 v223, v223, v210
    v_cvt_pk_bf16_f32 v125, v210, v211
    v_mfma_f32_16x16x32_bf16 v[20:23], a[144:147], v[144:147], v[80:83]
    v_exp_f32 v212, v76
    v_mfma_f32_16x16x32_bf16 v[20:23], a[148:151], v[148:151], v[20:23]
    ds_read_b64_tr_b16 a[164:165], v243 offset:24576
    v_add_f32 v223, v223, v211
    v_mfma_f32_16x16x32_bf16 v[20:23], a[152:155], v[152:155], v[20:23]
    v_exp_f32 v213, v77
    v_mfma_f32_16x16x32_bf16 v[20:23], a[156:159], v[156:159], v[20:23]
    ds_read_b64_tr_b16 a[166:167], v243 offset:28672
    v_add_f32 v223, v223, v212
    v_cvt_pk_bf16_f32 v126, v212, v213
    v_mfma_f32_16x16x32_bf16 v[24:27], a[128:131], v[160:163], v[84:87]
    v_exp_f32 v214, v78
    v_mfma_f32_16x16x32_bf16 v[24:27], a[132:135], v[164:167], v[24:27]
    ds_read_b64_tr_b16 a[168:169], v244 offset:24576
    v_add_f32 v223, v223, v213
    v_mfma_f32_16x16x32_bf16 v[24:27], a[136:139], v[168:171], v[24:27]
    v_exp_f32 v215, v79
    v_mfma_f32_16x16x32_bf16 v[24:27], a[140:143], v[172:175], v[24:27]
    ds_read_b64_tr_b16 a[170:171], v244 offset:28672
    v_add_f32 v223, v223, v214
    v_cvt_pk_bf16_f32 v127, v214, v215
    v_mfma_f32_16x16x32_bf16 v[28:31], a[144:147], v[160:163], v[84:87]
    v_exp_f32 v208, v16
    v_mfma_f32_16x16x32_bf16 v[28:31], a[148:151], v[164:167], v[28:31]
    ds_read_b64_tr_b16 a[172:173], v245 offset:24576
    v_add_f32 v223, v223, v215
    v_mfma_f32_16x16x32_bf16 v[28:31], a[152:155], v[168:171], v[28:31]
    v_exp_f32 v209, v17
    v_max3_f32 v228, v220, v221, v222
    v_mfma_f32_16x16x32_bf16 v[28:31], a[156:159], v[172:175], v[28:31]
    ds_read_b64_tr_b16 a[174:175], v245 offset:28672
    v_cvt_pk_bf16_f32 v96, v208, v209
    v_max_f32 v228, v228, v223
    v_mfma_f32_16x16x32_bf16 v[32:35], a[128:131], v[176:179], v[88:91]
    v_exp_f32 v210, v18
    v_mfma_f32_16x16x32_bf16 v[32:35], a[132:135], v[180:183], v[32:35]
    ds_read_b64_tr_b16 a[176:177], v246 offset:24576
    v_add_f32 v216, v208, v209
    v_cmp_nle_f32 vcc, v228, v229
    v_mfma_f32_16x16x32_bf16 v[32:35], a[136:139], v[184:187], v[32:35]
    v_exp_f32 v211, v19
    v_mfma_f32_16x16x32_bf16 v[32:35], a[140:143], v[188:191], v[32:35]
    ds_read_b64_tr_b16 a[178:179], v246 offset:28672
    v_add_f32 v216, v216, v210
    v_cvt_pk_bf16_f32 v97, v210, v211
    v_mfma_f32_16x16x32_bf16 v[36:39], a[144:147], v[176:179], v[88:91]
    v_exp_f32 v212, v20
    v_mfma_f32_16x16x32_bf16 v[36:39], a[148:151], v[180:183], v[36:39]
    ds_read_b64_tr_b16 a[180:181], v247 offset:24576
    v_add_f32 v216, v216, v211
    v_mfma_f32_16x16x32_bf16 v[36:39], a[152:155], v[184:187], v[36:39]
    v_exp_f32 v213, v21
    v_mfma_f32_16x16x32_bf16 v[36:39], a[156:159], v[188:191], v[36:39]
    ds_read_b64_tr_b16 a[182:183], v247 offset:28672
    v_add_f32 v216, v216, v212
    v_cvt_pk_bf16_f32 v98, v212, v213
    s_cbranch_vccnz L_tramp_23
L_back_24:
    v_mfma_f32_16x16x32_bf16 v[40:43], a[128:131], v[192:195], v[92:95]
    v_exp_f32 v214, v22
    v_mfma_f32_16x16x32_bf16 v[40:43], a[132:135], v[196:199], v[40:43]
    ds_read_b64_tr_b16 a[184:185], v248 offset:24576
    v_add_f32 v216, v216, v213
    v_add_f32 v224, v224, v220
    v_mfma_f32_16x16x32_bf16 v[40:43], a[136:139], v[200:203], v[40:43]
    v_exp_f32 v215, v23
    v_mfma_f32_16x16x32_bf16 v[40:43], a[140:143], v[204:207], v[40:43]
    ds_read_b64_tr_b16 a[186:187], v248 offset:28672
    v_add_f32 v216, v216, v214
    v_cvt_pk_bf16_f32 v99, v214, v215
    v_add_f32 v225, v225, v221
    v_mfma_f32_16x16x32_bf16 v[44:47], a[144:147], v[192:195], v[92:95]
    v_exp_f32 v208, v24
    v_mfma_f32_16x16x32_bf16 v[44:47], a[148:151], v[196:199], v[44:47]
    ds_read_b64_tr_b16 a[188:189], v249 offset:24576
    v_add_f32 v216, v216, v215
    v_add_f32 v226, v226, v222
    v_mfma_f32_16x16x32_bf16 v[44:47], a[152:155], v[200:203], v[44:47]
    v_exp_f32 v209, v25
    v_mfma_f32_16x16x32_bf16 v[44:47], a[156:159], v[204:207], v[44:47]
    ds_read_b64_tr_b16 a[190:191], v249 offset:28672
    s_waitcnt lgkmcnt(8)
    v_cvt_pk_bf16_f32 v100, v208, v209
    v_add_f32 v227, v227, v223
    v_mfma_f32_16x16x32_bf16 a[0:3], a[160:163], v[112:115], a[0:3]
    v_exp_f32 v210, v26
    v_mfma_f32_16x16x32_bf16 a[32:35], a[160:163], v[116:119], a[32:35]
    ds_read_b128 a[128:131], v238 offset:40960
    v_add_f32 v217, v208, v209
    v_mfma_f32_16x16x32_bf16 a[64:67], a[160:163], v[120:123], a[64:67]
    s_add_u32 s64, s61, 6291456
    buffer_load_dwordx4 a[208:211], v14, s[20:23], s64 offen offset:2048 sc1
    v_exp_f32 v211, v27
    v_mfma_f32_16x16x32_bf16 a[96:99], a[160:163], v[124:127], a[96:99]
    ds_read_b128 a[132:135], v239 offset:40960
    v_add_f32 v217, v217, v210
    v_cvt_pk_bf16_f32 v101, v210, v211
    v_mfma_f32_16x16x32_bf16 a[4:7], a[164:167], v[112:115], a[4:7]
    v_exp_f32 v212, v28
    v_mfma_f32_16x16x32_bf16 a[36:39], a[164:167], v[116:119], a[36:39]
    ds_read_b128 a[136:139], v240 offset:40960
    v_add_f32 v217, v217, v211
    v_mfma_f32_16x16x32_bf16 a[68:71], a[164:167], v[120:123], a[68:71]
    s_add_u32 s64, s61, 6307840
    buffer_load_dwordx4 a[212:215], v14, s[20:23], s64 offen offset:2048 sc1
    v_exp_f32 v213, v29
    v_mfma_f32_16x16x32_bf16 a[100:103], a[164:167], v[124:127], a[100:103]
    ds_read_b128 a[140:143], v241 offset:40960
    v_add_f32 v217, v217, v212
    v_cvt_pk_bf16_f32 v102, v212, v213
    v_mfma_f32_16x16x32_bf16 a[8:11], a[168:171], v[112:115], a[8:11]
    v_exp_f32 v214, v30
    v_mfma_f32_16x16x32_bf16 a[40:43], a[168:171], v[116:119], a[40:43]
    ds_read_b128 a[144:147], v238 offset:45056
    v_add_f32 v217, v217, v213
    v_mfma_f32_16x16x32_bf16 a[72:75], a[168:171], v[120:123], a[72:75]
    s_add_u32 s64, s61, 6291456
    buffer_load_dwordx4 a[216:219], v14, s[20:23], s64 offen offset:3072 sc1
    v_exp_f32 v215, v31
    v_mfma_f32_16x16x32_bf16 a[104:107], a[168:171], v[124:127], a[104:107]
    ds_read_b128 a[148:151], v239 offset:45056
    v_add_f32 v217, v217, v214
    v_cvt_pk_bf16_f32 v103, v214, v215
    v_mfma_f32_16x16x32_bf16 a[12:15], a[172:175], v[112:115], a[12:15]
    v_exp_f32 v208, v32
    v_mfma_f32_16x16x32_bf16 a[44:47], a[172:175], v[116:119], a[44:47]
    ds_read_b128 a[152:155], v240 offset:45056
    v_add_f32 v217, v217, v215
    v_mfma_f32_16x16x32_bf16 a[76:79], a[172:175], v[120:123], a[76:79]
    s_add_u32 s64, s61, 6307840
    buffer_load_dwordx4 a[220:223], v14, s[20:23], s64 offen offset:3072 sc1
    v_exp_f32 v209, v33
    v_mfma_f32_16x16x32_bf16 a[108:111], a[172:175], v[124:127], a[108:111]
    ds_read_b128 a[156:159], v241 offset:45056
    s_waitcnt lgkmcnt(8)
    v_cvt_pk_bf16_f32 v104, v208, v209
    v_mfma_f32_16x16x32_bf16 a[16:19], a[176:179], v[112:115], a[16:19]
    s_add_u32 m0, s34, 0
    v_exp_f32 v210, v34
    v_mfma_f32_16x16x32_bf16 a[48:51], a[176:179], v[116:119], a[48:51]
    s_add_u32 s35, s38, 229376
    buffer_load_dwordx4 v128, s[44:47], s35 offen offset:0 lds
    v_add_f32 v218, v208, v209
    v_mfma_f32_16x16x32_bf16 a[80:83], a[176:179], v[120:123], a[80:83]
    v_exp_f32 v211, v35
    v_mfma_f32_16x16x32_bf16 a[112:115], a[176:179], v[124:127], a[112:115]
    v_add_f32 v218, v218, v210
    v_cvt_pk_bf16_f32 v105, v210, v211
    v_mfma_f32_16x16x32_bf16 a[20:23], a[180:183], v[112:115], a[20:23]
    v_exp_f32 v212, v36
    v_mfma_f32_16x16x32_bf16 a[52:55], a[180:183], v[116:119], a[52:55]
    s_add_u32 s35, s38, 242688
    buffer_load_dwordx4 v129, s[44:47], s35 offen offset:1024 lds
    v_add_f32 v218, v218, v211
    v_mfma_f32_16x16x32_bf16 a[84:87], a[180:183], v[120:123], a[84:87]
    v_exp_f32 v213, v37
    v_mfma_f32_16x16x32_bf16 a[116:119], a[180:183], v[124:127], a[116:119]
    v_add_f32 v218, v218, v212
    v_cvt_pk_bf16_f32 v106, v212, v213
    v_mfma_f32_16x16x32_bf16 a[24:27], a[184:187], v[112:115], a[24:27]
    v_exp_f32 v214, v38
    v_mfma_f32_16x16x32_bf16 a[56:59], a[184:187], v[116:119], a[56:59]
    s_add_u32 s35, s38, 256000
    buffer_load_dwordx4 v128, s[44:47], s35 offen offset:2048 lds
    v_add_f32 v218, v218, v213
    v_mfma_f32_16x16x32_bf16 a[88:91], a[184:187], v[120:123], a[88:91]
    v_exp_f32 v215, v39
    v_mfma_f32_16x16x32_bf16 a[120:123], a[184:187], v[124:127], a[120:123]
    v_add_f32 v218, v218, v214
    v_cvt_pk_bf16_f32 v107, v214, v215
    v_mfma_f32_16x16x32_bf16 a[28:31], a[188:191], v[112:115], a[28:31]
    v_exp_f32 v208, v40
    v_mfma_f32_16x16x32_bf16 a[60:63], a[188:191], v[116:119], a[60:63]
    s_add_u32 s35, s38, 269312
    buffer_load_dwordx4 v129, s[44:47], s35 offen offset:3072 lds
    v_add_f32 v218, v218, v215
    v_mfma_f32_16x16x32_bf16 a[92:95], a[188:191], v[120:123], a[92:95]
    s_add_u32 s29, s29, 16384
    v_exp_f32 v209, v41
    v_mfma_f32_16x16x32_bf16 a[124:127], a[188:191], v[124:127], a[124:127]
    s_waitcnt vmcnt(16) lgkmcnt(0)
    s_barrier
    v_mfma_f32_16x16x32_bf16 v[48:51], a[128:131], v[144:147], v[80:83]
    v_cvt_pk_bf16_f32 v108, v208, v209
    v_exp_f32 v210, v42
    v_mfma_f32_16x16x32_bf16 v[48:51], a[132:135], v[148:151], v[48:51]
    ds_read_b64_tr_b16 a[160:161], v242 offset:32768
    v_add_f32 v219, v208, v209
    v_mfma_f32_16x16x32_bf16 v[48:51], a[136:139], v[152:155], v[48:51]
    v_exp_f32 v211, v43
    v_mfma_f32_16x16x32_bf16 v[48:51], a[140:143], v[156:159], v[48:51]
    ds_read_b64_tr_b16 a[162:163], v242 offset:36864
    v_add_f32 v219, v219, v210
    v_cvt_pk_bf16_f32 v109, v210, v211
    v_mfma_f32_16x16x32_bf16 v[52:55], a[144:147], v[144:147], v[80:83]
    v_exp_f32 v212, v44
    v_mfma_f32_16x16x32_bf16 v[52:55], a[148:151], v[148:151], v[52:55]
    ds_read_b64_tr_b16 a[164:165], v243 offset:32768
    v_add_f32 v219, v219, v211
    v_mfma_f32_16x16x32_bf16 v[52:55], a[152:155], v[152:155], v[52:55]
    v_exp_f32 v213, v45
    v_mfma_f32_16x16x32_bf16 v[52:55], a[156:159], v[156:159], v[52:55]
    ds_read_b64_tr_b16 a[166:167], v243 offset:36864
    v_add_f32 v219, v219, v212
    v_cvt_pk_bf16_f32 v110, v212, v213
    v_mfma_f32_16x16x32_bf16 v[56:59], a[128:131], v[160:163], v[84:87]
    v_exp_f32 v214, v46
    v_mfma_f32_16x16x32_bf16 v[56:59], a[132:135], v[164:167], v[56:59]
    ds_read_b64_tr_b16 a[168:169], v244 offset:32768
    v_add_f32 v219, v219, v213
    v_mfma_f32_16x16x32_bf16 v[56:59], a[136:139], v[168:171], v[56:59]
    v_exp_f32 v215, v47
    v_mfma_f32_16x16x32_bf16 v[56:59], a[140:143], v[172:175], v[56:59]
    ds_read_b64_tr_b16 a[170:171], v244 offset:36864
    v_add_f32 v219, v219, v214
    v_cvt_pk_bf16_f32 v111, v214, v215
    v_mfma_f32_16x16x32_bf16 v[60:63], a[144:147], v[160:163], v[84:87]
    v_exp_f32 v208, v48
    v_mfma_f32_16x16x32_bf16 v[60:63], a[148:151], v[164:167], v[60:63]
    ds_read_b64_tr_b16 a[172:173], v245 offset:32768
    v_add_f32 v219, v219, v215
    v_mfma_f32_16x16x32_bf16 v[60:63], a[152:155], v[168:171], v[60:63]
    v_exp_f32 v209, v49
    v_max3_f32 v228, v216, v217, v218
    v_mfma_f32_16x16x32_bf16 v[60:63], a[156:159], v[172:175], v[60:63]
    ds_read_b64_tr_b16 a[174:175], v245 offset:36864
    v_cvt_pk_bf16_f32 v112, v208, v209
    v_max_f32 v228, v228, v219
    v_mfma_f32_16x16x32_bf16 v[64:67], a[128:131], v[176:179], v[88:91]
    v_exp_f32 v210, v50
    v_mfma_f32_16x16x32_bf16 v[64:67], a[132:135], v[180:183], v[64:67]
    ds_read_b64_tr_b16 a[176:177], v246 offset:32768
    v_add_f32 v220, v208, v209
    v_cmp_nle_f32 vcc, v228, v229
    v_mfma_f32_16x16x32_bf16 v[64:67], a[136:139], v[184:187], v[64:67]
    v_exp_f32 v211, v51
    v_mfma_f32_16x16x32_bf16 v[64:67], a[140:143], v[188:191], v[64:67]
    ds_read_b64_tr_b16 a[178:179], v246 offset:36864
    v_add_f32 v220, v220, v210
    v_cvt_pk_bf16_f32 v113, v210, v211
    v_mfma_f32_16x16x32_bf16 v[68:71], a[144:147], v[176:179], v[88:91]
    v_exp_f32 v212, v52
    v_mfma_f32_16x16x32_bf16 v[68:71], a[148:151], v[180:183], v[68:71]
    ds_read_b64_tr_b16 a[180:181], v247 offset:32768
    v_add_f32 v220, v220, v211
    v_mfma_f32_16x16x32_bf16 v[68:71], a[152:155], v[184:187], v[68:71]
    v_exp_f32 v213, v53
    v_mfma_f32_16x16x32_bf16 v[68:71], a[156:159], v[188:191], v[68:71]
    ds_read_b64_tr_b16 a[182:183], v247 offset:36864
    v_add_f32 v220, v220, v212
    v_cvt_pk_bf16_f32 v114, v212, v213
    s_cbranch_vccnz L_tramp_25
L_back_26:
    v_mfma_f32_16x16x32_bf16 v[72:75], a[128:131], v[192:195], v[92:95]
    v_exp_f32 v214, v54
    v_mfma_f32_16x16x32_bf16 v[72:75], a[132:135], v[196:199], v[72:75]
    ds_read_b64_tr_b16 a[184:185], v248 offset:32768
    v_add_f32 v220, v220, v213
    v_add_f32 v224, v224, v216
    v_mfma_f32_16x16x32_bf16 v[72:75], a[136:139], v[200:203], v[72:75]
    v_exp_f32 v215, v55
    v_mfma_f32_16x16x32_bf16 v[72:75], a[140:143], v[204:207], v[72:75]
    ds_read_b64_tr_b16 a[186:187], v248 offset:36864
    v_add_f32 v220, v220, v214
    v_cvt_pk_bf16_f32 v115, v214, v215
    v_add_f32 v225, v225, v217
    v_mfma_f32_16x16x32_bf16 v[76:79], a[144:147], v[192:195], v[92:95]
    v_exp_f32 v208, v56
    v_mfma_f32_16x16x32_bf16 v[76:79], a[148:151], v[196:199], v[76:79]
    ds_read_b64_tr_b16 a[188:189], v249 offset:32768
    v_add_f32 v220, v220, v215
    v_add_f32 v226, v226, v218
    v_mfma_f32_16x16x32_bf16 v[76:79], a[152:155], v[200:203], v[76:79]
    v_exp_f32 v209, v57
    v_mfma_f32_16x16x32_bf16 v[76:79], a[156:159], v[204:207], v[76:79]
    ds_read_b64_tr_b16 a[190:191], v249 offset:36864
    s_waitcnt lgkmcnt(8)
    v_cvt_pk_bf16_f32 v116, v208, v209
    v_add_f32 v227, v227, v219
    v_mfma_f32_16x16x32_bf16 a[0:3], a[160:163], v[96:99], a[0:3]
    v_exp_f32 v210, v58
    v_mfma_f32_16x16x32_bf16 a[32:35], a[160:163], v[100:103], a[32:35]
    ds_read_b128 a[128:131], v238 offset:49152
    v_add_f32 v221, v208, v209
    v_mfma_f32_16x16x32_bf16 a[64:67], a[160:163], v[104:107], a[64:67]
    s_add_u32 s64, s61, 6295552
    buffer_load_dwordx4 a[224:227], v14, s[20:23], s64 offen offset:0 sc1
    v_exp_f32 v211, v59
    v_mfma_f32_16x16x32_bf16 a[96:99], a[160:163], v[108:111], a[96:99]
    ds_read_b128 a[132:135], v239 offset:49152
    v_add_f32 v221, v221, v210
    v_cvt_pk_bf16_f32 v117, v210, v211
    v_mfma_f32_16x16x32_bf16 a[4:7], a[164:167], v[96:99], a[4:7]
    v_exp_f32 v212, v60
    v_mfma_f32_16x16x32_bf16 a[36:39], a[164:167], v[100:103], a[36:39]
    ds_read_b128 a[136:139], v240 offset:49152
    v_add_f32 v221, v221, v211
    v_mfma_f32_16x16x32_bf16 a[68:71], a[164:167], v[104:107], a[68:71]
    s_add_u32 s64, s61, 6311936
    buffer_load_dwordx4 a[228:231], v14, s[20:23], s64 offen offset:0 sc1
    v_exp_f32 v213, v61
    v_mfma_f32_16x16x32_bf16 a[100:103], a[164:167], v[108:111], a[100:103]
    ds_read_b128 a[140:143], v241 offset:49152
    v_add_f32 v221, v221, v212
    v_cvt_pk_bf16_f32 v118, v212, v213
    v_mfma_f32_16x16x32_bf16 a[8:11], a[168:171], v[96:99], a[8:11]
    v_exp_f32 v214, v62
    v_mfma_f32_16x16x32_bf16 a[40:43], a[168:171], v[100:103], a[40:43]
    ds_read_b128 a[144:147], v238 offset:53248
    v_add_f32 v221, v221, v213
    v_mfma_f32_16x16x32_bf16 a[72:75], a[168:171], v[104:107], a[72:75]
    s_add_u32 s64, s61, 6295552
    buffer_load_dwordx4 a[232:235], v14, s[20:23], s64 offen offset:1024 sc1
    v_exp_f32 v215, v63
    v_mfma_f32_16x16x32_bf16 a[104:107], a[168:171], v[108:111], a[104:107]
    ds_read_b128 a[148:151], v239 offset:53248
    v_add_f32 v221, v221, v214
    v_cvt_pk_bf16_f32 v119, v214, v215
    v_mfma_f32_16x16x32_bf16 a[12:15], a[172:175], v[96:99], a[12:15]
    v_exp_f32 v208, v64
    v_mfma_f32_16x16x32_bf16 a[44:47], a[172:175], v[100:103], a[44:47]
    ds_read_b128 a[152:155], v240 offset:53248
    v_add_f32 v221, v221, v215
    v_mfma_f32_16x16x32_bf16 a[76:79], a[172:175], v[104:107], a[76:79]
    s_add_u32 s64, s61, 6311936
    buffer_load_dwordx4 a[236:239], v14, s[20:23], s64 offen offset:1024 sc1
    v_exp_f32 v209, v65
    v_mfma_f32_16x16x32_bf16 a[108:111], a[172:175], v[108:111], a[108:111]
    ds_read_b128 a[156:159], v241 offset:53248
    s_waitcnt lgkmcnt(8)
    v_cvt_pk_bf16_f32 v120, v208, v209
    v_mfma_f32_16x16x32_bf16 a[16:19], a[176:179], v[96:99], a[16:19]
    s_add_u32 m0, s33, 16384
    v_exp_f32 v210, v66
    v_mfma_f32_16x16x32_bf16 a[48:51], a[176:179], v[100:103], a[48:51]
    s_add_u32 s35, s38, 458752
    buffer_load_dwordx4 v128, s[44:47], s35 offen offset:0 lds
    v_add_f32 v222, v208, v209
    v_mfma_f32_16x16x32_bf16 a[80:83], a[176:179], v[104:107], a[80:83]
    v_exp_f32 v211, v67
    v_mfma_f32_16x16x32_bf16 a[112:115], a[176:179], v[108:111], a[112:115]
    v_add_f32 v222, v222, v210
    v_cvt_pk_bf16_f32 v121, v210, v211
    v_mfma_f32_16x16x32_bf16 a[20:23], a[180:183], v[96:99], a[20:23]
    v_exp_f32 v212, v68
    v_mfma_f32_16x16x32_bf16 a[52:55], a[180:183], v[100:103], a[52:55]
    s_add_u32 s35, s38, 472064
    buffer_load_dwordx4 v129, s[44:47], s35 offen offset:1024 lds
    v_add_f32 v222, v222, v211
    v_mfma_f32_16x16x32_bf16 a[84:87], a[180:183], v[104:107], a[84:87]
    v_exp_f32 v213, v69
    v_mfma_f32_16x16x32_bf16 a[116:119], a[180:183], v[108:111], a[116:119]
    v_add_f32 v222, v222, v212
    v_cvt_pk_bf16_f32 v122, v212, v213
    v_mfma_f32_16x16x32_bf16 a[24:27], a[184:187], v[96:99], a[24:27]
    v_exp_f32 v214, v70
    v_mfma_f32_16x16x32_bf16 a[56:59], a[184:187], v[100:103], a[56:59]
    s_add_u32 s35, s38, 485376
    buffer_load_dwordx4 v128, s[44:47], s35 offen offset:2048 lds
    v_add_f32 v222, v222, v213
    v_mfma_f32_16x16x32_bf16 a[88:91], a[184:187], v[104:107], a[88:91]
    v_exp_f32 v215, v71
    v_mfma_f32_16x16x32_bf16 a[120:123], a[184:187], v[108:111], a[120:123]
    v_add_f32 v222, v222, v214
    v_cvt_pk_bf16_f32 v123, v214, v215
    v_mfma_f32_16x16x32_bf16 a[28:31], a[188:191], v[96:99], a[28:31]
    v_exp_f32 v208, v72
    v_mfma_f32_16x16x32_bf16 a[60:63], a[188:191], v[100:103], a[60:63]
    s_add_u32 s35, s38, 498688
    buffer_load_dwordx4 v129, s[44:47], s35 offen offset:3072 lds
    v_add_f32 v222, v222, v215
    v_mfma_f32_16x16x32_bf16 a[92:95], a[188:191], v[104:107], a[92:95]
    s_add_u32 s28, s28, 16384
    v_exp_f32 v209, v73
    v_mfma_f32_16x16x32_bf16 a[124:127], a[188:191], v[108:111], a[124:127]
    s_waitcnt lgkmcnt(0)
    v_cvt_pk_bf16_f32 v124, v208, v209
    v_mfma_f32_16x16x32_bf16 v[16:19], a[128:131], v[144:147], v[80:83]
    v_exp_f32 v210, v74
    v_mfma_f32_16x16x32_bf16 v[16:19], a[132:135], v[148:151], v[16:19]
    ds_read_b64_tr_b16 a[160:161], v242 offset:40960
    v_add_f32 v223, v208, v209
    v_mfma_f32_16x16x32_bf16 v[16:19], a[136:139], v[152:155], v[16:19]
    v_exp_f32 v211, v75
    v_mfma_f32_16x16x32_bf16 v[16:19], a[140:143], v[156:159], v[16:19]
    ds_read_b64_tr_b16 a[162:163], v242 offset:45056
    v_add_f32 v223, v223, v210
    v_cvt_pk_bf16_f32 v125, v210, v211
    v_mfma_f32_16x16x32_bf16 v[20:23], a[144:147], v[144:147], v[80:83]
    v_exp_f32 v212, v76
    v_mfma_f32_16x16x32_bf16 v[20:23], a[148:151], v[148:151], v[20:23]
    ds_read_b64_tr_b16 a[164:165], v243 offset:40960
    v_add_f32 v223, v223, v211
    v_mfma_f32_16x16x32_bf16 v[20:23], a[152:155], v[152:155], v[20:23]
    v_exp_f32 v213, v77
    v_mfma_f32_16x16x32_bf16 v[20:23], a[156:159], v[156:159], v[20:23]
    ds_read_b64_tr_b16 a[166:167], v243 offset:45056
    v_add_f32 v223, v223, v212
    v_cvt_pk_bf16_f32 v126, v212, v213
    v_mfma_f32_16x16x32_bf16 v[24:27], a[128:131], v[160:163], v[84:87]
    v_exp_f32 v214, v78
    v_mfma_f32_16x16x32_bf16 v[24:27], a[132:135], v[164:167], v[24:27]
    ds_read_b64_tr_b16 a[168:169], v244 offset:40960
    v_add_f32 v223, v223, v213
    v_mfma_f32_16x16x32_bf16 v[24:27], a[136:139], v[168:171], v[24:27]
    v_exp_f32 v215, v79
    v_mfma_f32_16x16x32_bf16 v[24:27], a[140:143], v[172:175], v[24:27]
    ds_read_b64_tr_b16 a[170:171], v244 offset:45056
    v_add_f32 v223, v223, v214
    v_cvt_pk_bf16_f32 v127, v214, v215
    v_mfma_f32_16x16x32_bf16 v[28:31], a[144:147], v[160:163], v[84:87]
    v_exp_f32 v208, v16
    v_mfma_f32_16x16x32_bf16 v[28:31], a[148:151], v[164:167], v[28:31]
    ds_read_b64_tr_b16 a[172:173], v245 offset:40960
    v_add_f32 v223, v223, v215
    v_mfma_f32_16x16x32_bf16 v[28:31], a[152:155], v[168:171], v[28:31]
    v_exp_f32 v209, v17
    v_max3_f32 v228, v220, v221, v222
    v_mfma_f32_16x16x32_bf16 v[28:31], a[156:159], v[172:175], v[28:31]
    ds_read_b64_tr_b16 a[174:175], v245 offset:45056
    v_cvt_pk_bf16_f32 v96, v208, v209
    v_max_f32 v228, v228, v223
    v_mfma_f32_16x16x32_bf16 v[32:35], a[128:131], v[176:179], v[88:91]
    v_exp_f32 v210, v18
    v_mfma_f32_16x16x32_bf16 v[32:35], a[132:135], v[180:183], v[32:35]
    ds_read_b64_tr_b16 a[176:177], v246 offset:40960
    v_add_f32 v216, v208, v209
    v_cmp_nle_f32 vcc, v228, v229
    v_mfma_f32_16x16x32_bf16 v[32:35], a[136:139], v[184:187], v[32:35]
    v_exp_f32 v211, v19
    v_mfma_f32_16x16x32_bf16 v[32:35], a[140:143], v[188:191], v[32:35]
    ds_read_b64_tr_b16 a[178:179], v246 offset:45056
    v_add_f32 v216, v216, v210
    v_cvt_pk_bf16_f32 v97, v210, v211
    v_mfma_f32_16x16x32_bf16 v[36:39], a[144:147], v[176:179], v[88:91]
    v_exp_f32 v212, v20
    v_mfma_f32_16x16x32_bf16 v[36:39], a[148:151], v[180:183], v[36:39]
    ds_read_b64_tr_b16 a[180:181], v247 offset:40960
    v_add_f32 v216, v216, v211
    v_mfma_f32_16x16x32_bf16 v[36:39], a[152:155], v[184:187], v[36:39]
    v_exp_f32 v213, v21
    v_mfma_f32_16x16x32_bf16 v[36:39], a[156:159], v[188:191], v[36:39]
    ds_read_b64_tr_b16 a[182:183], v247 offset:45056
    v_add_f32 v216, v216, v212
    v_cvt_pk_bf16_f32 v98, v212, v213
    s_cbranch_vccnz L_tramp_27
L_back_28:
    v_mfma_f32_16x16x32_bf16 v[40:43], a[128:131], v[192:195], v[92:95]
    v_exp_f32 v214, v22
    v_mfma_f32_16x16x32_bf16 v[40:43], a[132:135], v[196:199], v[40:43]
    ds_read_b64_tr_b16 a[184:185], v248 offset:40960
    v_add_f32 v216, v216, v213
    v_add_f32 v224, v224, v220
    v_mfma_f32_16x16x32_bf16 v[40:43], a[136:139], v[200:203], v[40:43]
    v_exp_f32 v215, v23
    v_mfma_f32_16x16x32_bf16 v[40:43], a[140:143], v[204:207], v[40:43]
    ds_read_b64_tr_b16 a[186:187], v248 offset:45056
    v_add_f32 v216, v216, v214
    v_cvt_pk_bf16_f32 v99, v214, v215
    v_add_f32 v225, v225, v221
    v_mfma_f32_16x16x32_bf16 v[44:47], a[144:147], v[192:195], v[92:95]
    v_exp_f32 v208, v24
    v_mfma_f32_16x16x32_bf16 v[44:47], a[148:151], v[196:199], v[44:47]
    ds_read_b64_tr_b16 a[188:189], v249 offset:40960
    v_add_f32 v216, v216, v215
    v_add_f32 v226, v226, v222
    v_mfma_f32_16x16x32_bf16 v[44:47], a[152:155], v[200:203], v[44:47]
    v_exp_f32 v209, v25
    v_mfma_f32_16x16x32_bf16 v[44:47], a[156:159], v[204:207], v[44:47]
    ds_read_b64_tr_b16 a[190:191], v249 offset:45056
    s_waitcnt lgkmcnt(8)
    v_cvt_pk_bf16_f32 v100, v208, v209
    v_add_f32 v227, v227, v223
    v_mfma_f32_16x16x32_bf16 a[0:3], a[160:163], v[112:115], a[0:3]
    v_exp_f32 v210, v26
    v_mfma_f32_16x16x32_bf16 a[32:35], a[160:163], v[116:119], a[32:35]
    ds_read_b128 a[128:131], v238 offset:57344
    v_add_f32 v217, v208, v209
    v_mfma_f32_16x16x32_bf16 a[64:67], a[160:163], v[120:123], a[64:67]
    s_add_u32 s64, s61, 6295552
    buffer_load_dwordx4 a[240:243], v14, s[20:23], s64 offen offset:2048 sc1
    v_exp_f32 v211, v27
    v_mfma_f32_16x16x32_bf16 a[96:99], a[160:163], v[124:127], a[96:99]
    ds_read_b128 a[132:135], v239 offset:57344
    v_add_f32 v217, v217, v210
    v_cvt_pk_bf16_f32 v101, v210, v211
    v_mfma_f32_16x16x32_bf16 a[4:7], a[164:167], v[112:115], a[4:7]
    v_exp_f32 v212, v28
    v_mfma_f32_16x16x32_bf16 a[36:39], a[164:167], v[116:119], a[36:39]
    ds_read_b128 a[136:139], v240 offset:57344
    v_add_f32 v217, v217, v211
    v_mfma_f32_16x16x32_bf16 a[68:71], a[164:167], v[120:123], a[68:71]
    s_add_u32 s64, s61, 6311936
    buffer_load_dwordx4 a[244:247], v14, s[20:23], s64 offen offset:2048 sc1
    v_exp_f32 v213, v29
    v_mfma_f32_16x16x32_bf16 a[100:103], a[164:167], v[124:127], a[100:103]
    ds_read_b128 a[140:143], v241 offset:57344
    v_add_f32 v217, v217, v212
    v_cvt_pk_bf16_f32 v102, v212, v213
    v_mfma_f32_16x16x32_bf16 a[8:11], a[168:171], v[112:115], a[8:11]
    v_exp_f32 v214, v30
    v_mfma_f32_16x16x32_bf16 a[40:43], a[168:171], v[116:119], a[40:43]
    ds_read_b128 a[144:147], v238 offset:61440
    v_add_f32 v217, v217, v213
    v_mfma_f32_16x16x32_bf16 a[72:75], a[168:171], v[120:123], a[72:75]
    s_add_u32 s64, s61, 6295552
    buffer_load_dwordx4 a[248:251], v14, s[20:23], s64 offen offset:3072 sc1
    v_exp_f32 v215, v31
    v_mfma_f32_16x16x32_bf16 a[104:107], a[168:171], v[124:127], a[104:107]
    ds_read_b128 a[148:151], v239 offset:61440
    v_add_f32 v217, v217, v214
    v_cvt_pk_bf16_f32 v103, v214, v215
    v_mfma_f32_16x16x32_bf16 a[12:15], a[172:175], v[112:115], a[12:15]
    v_exp_f32 v208, v32
    v_mfma_f32_16x16x32_bf16 a[44:47], a[172:175], v[116:119], a[44:47]
    ds_read_b128 a[152:155], v240 offset:61440
    v_add_f32 v217, v217, v215
    v_mfma_f32_16x16x32_bf16 a[76:79], a[172:175], v[120:123], a[76:79]
    s_add_u32 s64, s61, 6311936
    buffer_load_dwordx4 a[252:255], v14, s[20:23], s64 offen offset:3072 sc1
    v_exp_f32 v209, v33
    v_mfma_f32_16x16x32_bf16 a[108:111], a[172:175], v[124:127], a[108:111]
    ds_read_b128 a[156:159], v241 offset:61440
    s_waitcnt lgkmcnt(8)
    v_cvt_pk_bf16_f32 v104, v208, v209
    v_mfma_f32_16x16x32_bf16 a[16:19], a[176:179], v[112:115], a[16:19]
    s_add_u32 m0, s34, 16384
    v_exp_f32 v210, v34
    v_mfma_f32_16x16x32_bf16 a[48:51], a[176:179], v[116:119], a[48:51]
    s_add_u32 s35, s38, 688128
    buffer_load_dwordx4 v128, s[44:47], s35 offen offset:0 lds
    v_add_f32 v218, v208, v209
    v_mfma_f32_16x16x32_bf16 a[80:83], a[176:179], v[120:123], a[80:83]
    v_exp_f32 v211, v35
    v_mfma_f32_16x16x32_bf16 a[112:115], a[176:179], v[124:127], a[112:115]
    v_add_f32 v218, v218, v210
    v_cvt_pk_bf16_f32 v105, v210, v211
    v_mfma_f32_16x16x32_bf16 a[20:23], a[180:183], v[112:115], a[20:23]
    v_exp_f32 v212, v36
    v_mfma_f32_16x16x32_bf16 a[52:55], a[180:183], v[116:119], a[52:55]
    s_add_u32 s35, s38, 701440
    buffer_load_dwordx4 v129, s[44:47], s35 offen offset:1024 lds
    v_add_f32 v218, v218, v211
    v_mfma_f32_16x16x32_bf16 a[84:87], a[180:183], v[120:123], a[84:87]
    v_exp_f32 v213, v37
    v_mfma_f32_16x16x32_bf16 a[116:119], a[180:183], v[124:127], a[116:119]
    v_add_f32 v218, v218, v212
    v_cvt_pk_bf16_f32 v106, v212, v213
    v_mfma_f32_16x16x32_bf16 a[24:27], a[184:187], v[112:115], a[24:27]
    v_exp_f32 v214, v38
    v_mfma_f32_16x16x32_bf16 a[56:59], a[184:187], v[116:119], a[56:59]
    s_add_u32 s35, s38, 714752
    buffer_load_dwordx4 v128, s[44:47], s35 offen offset:2048 lds
    v_add_f32 v218, v218, v213
    v_mfma_f32_16x16x32_bf16 a[88:91], a[184:187], v[120:123], a[88:91]
    v_exp_f32 v215, v39
    v_mfma_f32_16x16x32_bf16 a[120:123], a[184:187], v[124:127], a[120:123]
    v_add_f32 v218, v218, v214
    v_cvt_pk_bf16_f32 v107, v214, v215
    v_mfma_f32_16x16x32_bf16 a[28:31], a[188:191], v[112:115], a[28:31]
    v_exp_f32 v208, v40
    v_mfma_f32_16x16x32_bf16 a[60:63], a[188:191], v[116:119], a[60:63]
    s_add_u32 s35, s38, 728064
    buffer_load_dwordx4 v129, s[44:47], s35 offen offset:3072 lds
    v_add_f32 v218, v218, v215
    v_mfma_f32_16x16x32_bf16 a[92:95], a[188:191], v[120:123], a[92:95]
    s_add_u32 s29, s29, 16384
    v_exp_f32 v209, v41
    v_mfma_f32_16x16x32_bf16 a[124:127], a[188:191], v[124:127], a[124:127]
    s_waitcnt vmcnt(16) lgkmcnt(0)
    s_barrier
    v_mfma_f32_16x16x32_bf16 v[48:51], a[128:131], v[144:147], v[80:83]
    v_cvt_pk_bf16_f32 v108, v208, v209
    v_exp_f32 v210, v42
    v_mfma_f32_16x16x32_bf16 v[48:51], a[132:135], v[148:151], v[48:51]
    ds_read_b64_tr_b16 a[160:161], v242 offset:49152
    v_add_f32 v219, v208, v209
    v_mfma_f32_16x16x32_bf16 v[48:51], a[136:139], v[152:155], v[48:51]
    v_exp_f32 v211, v43
    v_mfma_f32_16x16x32_bf16 v[48:51], a[140:143], v[156:159], v[48:51]
    ds_read_b64_tr_b16 a[162:163], v242 offset:53248
    v_add_f32 v219, v219, v210
    v_cvt_pk_bf16_f32 v109, v210, v211
    v_mfma_f32_16x16x32_bf16 v[52:55], a[144:147], v[144:147], v[80:83]
    v_exp_f32 v212, v44
    v_mfma_f32_16x16x32_bf16 v[52:55], a[148:151], v[148:151], v[52:55]
    ds_read_b64_tr_b16 a[164:165], v243 offset:49152
    v_add_f32 v219, v219, v211
    v_mfma_f32_16x16x32_bf16 v[52:55], a[152:155], v[152:155], v[52:55]
    v_exp_f32 v213, v45
    v_mfma_f32_16x16x32_bf16 v[52:55], a[156:159], v[156:159], v[52:55]
    ds_read_b64_tr_b16 a[166:167], v243 offset:53248
    v_add_f32 v219, v219, v212
    v_cvt_pk_bf16_f32 v110, v212, v213
    v_mfma_f32_16x16x32_bf16 v[56:59], a[128:131], v[160:163], v[84:87]
    v_exp_f32 v214, v46
    v_mfma_f32_16x16x32_bf16 v[56:59], a[132:135], v[164:167], v[56:59]
    ds_read_b64_tr_b16 a[168:169], v244 offset:49152
    v_add_f32 v219, v219, v213
    v_mfma_f32_16x16x32_bf16 v[56:59], a[136:139], v[168:171], v[56:59]
    v_exp_f32 v215, v47
    v_mfma_f32_16x16x32_bf16 v[56:59], a[140:143], v[172:175], v[56:59]
    ds_read_b64_tr_b16 a[170:171], v244 offset:53248
    v_add_f32 v219, v219, v214
    v_cvt_pk_bf16_f32 v111, v214, v215
    v_mfma_f32_16x16x32_bf16 v[60:63], a[144:147], v[160:163], v[84:87]
    v_exp_f32 v208, v48
    v_mfma_f32_16x16x32_bf16 v[60:63], a[148:151], v[164:167], v[60:63]
    ds_read_b64_tr_b16 a[172:173], v245 offset:49152
    v_add_f32 v219, v219, v215
    v_mfma_f32_16x16x32_bf16 v[60:63], a[152:155], v[168:171], v[60:63]
    v_exp_f32 v209, v49
    v_max3_f32 v228, v216, v217, v218
    v_mfma_f32_16x16x32_bf16 v[60:63], a[156:159], v[172:175], v[60:63]
    ds_read_b64_tr_b16 a[174:175], v245 offset:53248
    v_cvt_pk_bf16_f32 v112, v208, v209
    v_max_f32 v228, v228, v219
    v_mfma_f32_16x16x32_bf16 v[64:67], a[128:131], v[176:179], v[88:91]
    v_exp_f32 v210, v50
    v_mfma_f32_16x16x32_bf16 v[64:67], a[132:135], v[180:183], v[64:67]
    ds_read_b64_tr_b16 a[176:177], v246 offset:49152
    v_add_f32 v220, v208, v209
    v_cmp_nle_f32 vcc, v228, v229
    v_mfma_f32_16x16x32_bf16 v[64:67], a[136:139], v[184:187], v[64:67]
    v_exp_f32 v211, v51
    v_mfma_f32_16x16x32_bf16 v[64:67], a[140:143], v[188:191], v[64:67]
    ds_read_b64_tr_b16 a[178:179], v246 offset:53248
    v_add_f32 v220, v220, v210
    v_cvt_pk_bf16_f32 v113, v210, v211
    v_mfma_f32_16x16x32_bf16 v[68:71], a[144:147], v[176:179], v[88:91]
    v_exp_f32 v212, v52
    v_mfma_f32_16x16x32_bf16 v[68:71], a[148:151], v[180:183], v[68:71]
    ds_read_b64_tr_b16 a[180:181], v247 offset:49152
    v_add_f32 v220, v220, v211
    v_mfma_f32_16x16x32_bf16 v[68:71], a[152:155], v[184:187], v[68:71]
    v_exp_f32 v213, v53
    v_mfma_f32_16x16x32_bf16 v[68:71], a[156:159], v[188:191], v[68:71]
    ds_read_b64_tr_b16 a[182:183], v247 offset:53248
    v_add_f32 v220, v220, v212
    v_cvt_pk_bf16_f32 v114, v212, v213
    s_cbranch_vccnz L_tramp_29
L_back_30:
    v_mfma_f32_16x16x32_bf16 v[72:75], a[128:131], v[192:195], v[92:95]
    v_exp_f32 v214, v54
    v_mfma_f32_16x16x32_bf16 v[72:75], a[132:135], v[196:199], v[72:75]
    ds_read_b64_tr_b16 a[184:185], v248 offset:49152
    v_add_f32 v220, v220, v213
    v_add_f32 v224, v224, v216
    v_mfma_f32_16x16x32_bf16 v[72:75], a[136:139], v[200:203], v[72:75]
    v_exp_f32 v215, v55
    v_mfma_f32_16x16x32_bf16 v[72:75], a[140:143], v[204:207], v[72:75]
    ds_read_b64_tr_b16 a[186:187], v248 offset:53248
    v_add_f32 v220, v220, v214
    v_cvt_pk_bf16_f32 v115, v214, v215
    v_add_f32 v225, v225, v217
    v_mfma_f32_16x16x32_bf16 v[76:79], a[144:147], v[192:195], v[92:95]
    v_exp_f32 v208, v56
    v_mfma_f32_16x16x32_bf16 v[76:79], a[148:151], v[196:199], v[76:79]
    ds_read_b64_tr_b16 a[188:189], v249 offset:49152
    v_add_f32 v220, v220, v215
    v_add_f32 v226, v226, v218
    v_mfma_f32_16x16x32_bf16 v[76:79], a[152:155], v[200:203], v[76:79]
    v_exp_f32 v209, v57
    v_mfma_f32_16x16x32_bf16 v[76:79], a[156:159], v[204:207], v[76:79]
    ds_read_b64_tr_b16 a[190:191], v249 offset:53248
    s_waitcnt lgkmcnt(8)
    v_cvt_pk_bf16_f32 v116, v208, v209
    v_add_f32 v227, v227, v219
    v_mfma_f32_16x16x32_bf16 a[0:3], a[160:163], v[96:99], a[0:3]
    v_exp_f32 v210, v58
    v_mfma_f32_16x16x32_bf16 a[32:35], a[160:163], v[100:103], a[32:35]
    v_add_f32 v221, v208, v209
    v_mfma_f32_16x16x32_bf16 a[64:67], a[160:163], v[104:107], a[64:67]
    v_exp_f32 v211, v59
    v_mfma_f32_16x16x32_bf16 a[96:99], a[160:163], v[108:111], a[96:99]
    v_add_f32 v221, v221, v210
    v_cvt_pk_bf16_f32 v117, v210, v211
    v_mfma_f32_16x16x32_bf16 a[4:7], a[164:167], v[96:99], a[4:7]
    v_exp_f32 v212, v60
    v_mfma_f32_16x16x32_bf16 a[36:39], a[164:167], v[100:103], a[36:39]
    v_add_f32 v221, v221, v211
    v_mfma_f32_16x16x32_bf16 a[68:71], a[164:167], v[104:107], a[68:71]
    v_exp_f32 v213, v61
    v_mfma_f32_16x16x32_bf16 a[100:103], a[164:167], v[108:111], a[100:103]
    v_add_f32 v221, v221, v212
    v_cvt_pk_bf16_f32 v118, v212, v213
    v_mfma_f32_16x16x32_bf16 a[8:11], a[168:171], v[96:99], a[8:11]
    v_exp_f32 v214, v62
    v_mfma_f32_16x16x32_bf16 a[40:43], a[168:171], v[100:103], a[40:43]
    v_add_f32 v221, v221, v213
    v_mfma_f32_16x16x32_bf16 a[72:75], a[168:171], v[104:107], a[72:75]
    v_exp_f32 v215, v63
    v_mfma_f32_16x16x32_bf16 a[104:107], a[168:171], v[108:111], a[104:107]
    v_add_f32 v221, v221, v214
    v_cvt_pk_bf16_f32 v119, v214, v215
    v_mfma_f32_16x16x32_bf16 a[12:15], a[172:175], v[96:99], a[12:15]
    v_exp_f32 v208, v64
    v_mfma_f32_16x16x32_bf16 a[44:47], a[172:175], v[100:103], a[44:47]
    v_add_f32 v221, v221, v215
    v_mfma_f32_16x16x32_bf16 a[76:79], a[172:175], v[104:107], a[76:79]
    v_exp_f32 v209, v65
    v_mfma_f32_16x16x32_bf16 a[108:111], a[172:175], v[108:111], a[108:111]
    s_waitcnt lgkmcnt(0)
    v_cvt_pk_bf16_f32 v120, v208, v209
    v_mfma_f32_16x16x32_bf16 a[16:19], a[176:179], v[96:99], a[16:19]
    s_add_u32 m0, s33, 32768
    v_exp_f32 v210, v66
    v_mfma_f32_16x16x32_bf16 a[48:51], a[176:179], v[100:103], a[48:51]
    s_add_u32 s35, s38, 917504
    buffer_load_dwordx4 v128, s[44:47], s35 offen offset:0 lds
    v_add_f32 v222, v208, v209
    v_mfma_f32_16x16x32_bf16 a[80:83], a[176:179], v[104:107], a[80:83]
    v_exp_f32 v211, v67
    v_mfma_f32_16x16x32_bf16 a[112:115], a[176:179], v[108:111], a[112:115]
    v_add_f32 v222, v222, v210
    v_cvt_pk_bf16_f32 v121, v210, v211
    v_mfma_f32_16x16x32_bf16 a[20:23], a[180:183], v[96:99], a[20:23]
    v_exp_f32 v212, v68
    v_mfma_f32_16x16x32_bf16 a[52:55], a[180:183], v[100:103], a[52:55]
    s_add_u32 s35, s38, 930816
    buffer_load_dwordx4 v129, s[44:47], s35 offen offset:1024 lds
    v_add_f32 v222, v222, v211
    v_mfma_f32_16x16x32_bf16 a[84:87], a[180:183], v[104:107], a[84:87]
    v_exp_f32 v213, v69
    v_mfma_f32_16x16x32_bf16 a[116:119], a[180:183], v[108:111], a[116:119]
    v_add_f32 v222, v222, v212
    v_cvt_pk_bf16_f32 v122, v212, v213
    v_mfma_f32_16x16x32_bf16 a[24:27], a[184:187], v[96:99], a[24:27]
    v_exp_f32 v214, v70
    v_mfma_f32_16x16x32_bf16 a[56:59], a[184:187], v[100:103], a[56:59]
    s_add_u32 s35, s38, 944128
    buffer_load_dwordx4 v128, s[44:47], s35 offen offset:2048 lds
    v_add_f32 v222, v222, v213
    v_mfma_f32_16x16x32_bf16 a[88:91], a[184:187], v[104:107], a[88:91]
    v_exp_f32 v215, v71
    v_mfma_f32_16x16x32_bf16 a[120:123], a[184:187], v[108:111], a[120:123]
    v_add_f32 v222, v222, v214
    v_cvt_pk_bf16_f32 v123, v214, v215
    v_mfma_f32_16x16x32_bf16 a[28:31], a[188:191], v[96:99], a[28:31]
    v_exp_f32 v208, v72
    v_mfma_f32_16x16x32_bf16 a[60:63], a[188:191], v[100:103], a[60:63]
    s_add_u32 s35, s38, 957440
    buffer_load_dwordx4 v129, s[44:47], s35 offen offset:3072 lds
    v_add_f32 v222, v222, v215
    v_mfma_f32_16x16x32_bf16 a[92:95], a[188:191], v[104:107], a[92:95]
    s_add_u32 s28, s28, 16384
    v_exp_f32 v209, v73
    v_mfma_f32_16x16x32_bf16 a[124:127], a[188:191], v[108:111], a[124:127]
    s_waitcnt lgkmcnt(0)
    v_cvt_pk_bf16_f32 v124, v208, v209
    v_exp_f32 v210, v74
    ds_read_b64_tr_b16 a[160:161], v242 offset:57344
    v_add_f32 v223, v208, v209
    v_exp_f32 v211, v75
    ds_read_b64_tr_b16 a[162:163], v242 offset:61440
    v_add_f32 v223, v223, v210
    v_cvt_pk_bf16_f32 v125, v210, v211
    v_exp_f32 v212, v76
    ds_read_b64_tr_b16 a[164:165], v243 offset:57344
    v_add_f32 v223, v223, v211
    v_exp_f32 v213, v77
    ds_read_b64_tr_b16 a[166:167], v243 offset:61440
    v_add_f32 v223, v223, v212
    v_cvt_pk_bf16_f32 v126, v212, v213
    v_exp_f32 v214, v78
    ds_read_b64_tr_b16 a[168:169], v244 offset:57344
    v_add_f32 v223, v223, v213
    v_exp_f32 v215, v79
    ds_read_b64_tr_b16 a[170:171], v244 offset:61440
    v_add_f32 v223, v223, v214
    v_cvt_pk_bf16_f32 v127, v214, v215
    ds_read_b64_tr_b16 a[172:173], v245 offset:57344
    v_add_f32 v223, v223, v215
    v_max3_f32 v228, v220, v221, v222
    ds_read_b64_tr_b16 a[174:175], v245 offset:61440
    v_max_f32 v228, v228, v223
    ds_read_b64_tr_b16 a[176:177], v246 offset:57344
    v_cmp_nle_f32 vcc, v228, v229
    ds_read_b64_tr_b16 a[178:179], v246 offset:61440
    ds_read_b64_tr_b16 a[180:181], v247 offset:57344
    ds_read_b64_tr_b16 a[182:183], v247 offset:61440
    s_cbranch_vccnz L_tramp_31
L_back_32:
    ds_read_b64_tr_b16 a[184:185], v248 offset:57344
    v_add_f32 v224, v224, v220
    ds_read_b64_tr_b16 a[186:187], v248 offset:61440
    v_add_f32 v225, v225, v221
    ds_read_b64_tr_b16 a[188:189], v249 offset:57344
    v_add_f32 v226, v226, v222
    ds_read_b64_tr_b16 a[190:191], v249 offset:61440
    s_waitcnt lgkmcnt(8)
    v_add_f32 v227, v227, v223
    v_mfma_f32_16x16x32_bf16 a[0:3], a[160:163], v[112:115], a[0:3]
    v_mfma_f32_16x16x32_bf16 a[32:35], a[160:163], v[116:119], a[32:35]
    v_mfma_f32_16x16x32_bf16 a[64:67], a[160:163], v[120:123], a[64:67]
    v_mfma_f32_16x16x32_bf16 a[96:99], a[160:163], v[124:127], a[96:99]
    v_mfma_f32_16x16x32_bf16 a[4:7], a[164:167], v[112:115], a[4:7]
    v_mfma_f32_16x16x32_bf16 a[36:39], a[164:167], v[116:119], a[36:39]
    v_mfma_f32_16x16x32_bf16 a[68:71], a[164:167], v[120:123], a[68:71]
    v_mfma_f32_16x16x32_bf16 a[100:103], a[164:167], v[124:127], a[100:103]
    v_mfma_f32_16x16x32_bf16 a[8:11], a[168:171], v[112:115], a[8:11]
    v_mfma_f32_16x16x32_bf16 a[40:43], a[168:171], v[116:119], a[40:43]
    v_mfma_f32_16x16x32_bf16 a[72:75], a[168:171], v[120:123], a[72:75]
    v_mfma_f32_16x16x32_bf16 a[104:107], a[168:171], v[124:127], a[104:107]
    v_mfma_f32_16x16x32_bf16 a[12:15], a[172:175], v[112:115], a[12:15]
    v_mfma_f32_16x16x32_bf16 a[44:47], a[172:175], v[116:119], a[44:47]
    v_mfma_f32_16x16x32_bf16 a[76:79], a[172:175], v[120:123], a[76:79]
    v_mfma_f32_16x16x32_bf16 a[108:111], a[172:175], v[124:127], a[108:111]
    s_waitcnt lgkmcnt(0)
    v_mfma_f32_16x16x32_bf16 a[16:19], a[176:179], v[112:115], a[16:19]
    s_add_u32 m0, s34, 32768
    v_mfma_f32_16x16x32_bf16 a[48:51], a[176:179], v[116:119], a[48:51]
    s_add_u32 s35, s38, 1146880
    buffer_load_dwordx4 v128, s[44:47], s35 offen offset:0 lds
    v_mfma_f32_16x16x32_bf16 a[80:83], a[176:179], v[120:123], a[80:83]
    v_mfma_f32_16x16x32_bf16 a[112:115], a[176:179], v[124:127], a[112:115]
    v_mfma_f32_16x16x32_bf16 a[20:23], a[180:183], v[112:115], a[20:23]
    v_mfma_f32_16x16x32_bf16 a[52:55], a[180:183], v[116:119], a[52:55]
    s_add_u32 s35, s38, 1160192
    buffer_load_dwordx4 v129, s[44:47], s35 offen offset:1024 lds
    v_mfma_f32_16x16x32_bf16 a[84:87], a[180:183], v[120:123], a[84:87]
    v_mfma_f32_16x16x32_bf16 a[116:119], a[180:183], v[124:127], a[116:119]
    v_mfma_f32_16x16x32_bf16 a[24:27], a[184:187], v[112:115], a[24:27]
    v_mfma_f32_16x16x32_bf16 a[56:59], a[184:187], v[116:119], a[56:59]
    s_add_u32 s35, s38, 1173504
    buffer_load_dwordx4 v128, s[44:47], s35 offen offset:2048 lds
    v_mfma_f32_16x16x32_bf16 a[88:91], a[184:187], v[120:123], a[88:91]
    v_mfma_f32_16x16x32_bf16 a[120:123], a[184:187], v[124:127], a[120:123]
    v_mfma_f32_16x16x32_bf16 a[28:31], a[188:191], v[112:115], a[28:31]
    v_mfma_f32_16x16x32_bf16 a[60:63], a[188:191], v[116:119], a[60:63]
    s_add_u32 s35, s38, 1186816
    buffer_load_dwordx4 v129, s[44:47], s35 offen offset:3072 lds
    v_mfma_f32_16x16x32_bf16 a[92:95], a[188:191], v[120:123], a[92:95]
    s_add_u32 s29, s29, 16384
    v_mfma_f32_16x16x32_bf16 a[124:127], a[188:191], v[124:127], a[124:127]
    s_waitcnt lgkmcnt(0)
    s_waitcnt lgkmcnt(0)
L_j3:
    v_subrev_u32 v130, 65536, v242
    v_subrev_u32 v131, 65536, v243
    v_subrev_u32 v132, 65536, v244
    v_subrev_u32 v133, 65536, v245
    v_subrev_u32 v134, 65536, v246
    v_subrev_u32 v135, 65536, v247
    v_subrev_u32 v136, 65536, v248
    s_lshl_b32 s35, s24, 6
    v_xor_b32 v140, s35, v242
    v_subrev_u32 v142, 65536, v140
    v_xor_b32 v141, s35, v243
    v_subrev_u32 v143, 65536, v141
    v_mov_b32 v10, 0x3f803f80
    v_mov_b32 v11, 0x3f803f80
    v_mov_b32 v12, 0x3f803f80
    v_mov_b32 v13, 0x3f803f80
    s_waitcnt vmcnt(8)
    s_barrier
    ds_read_b64_tr_b16 a[128:129], v130 offset:0
    ds_read_b64_tr_b16 a[130:131], v130 offset:4096
    ds_read_b64_tr_b16 a[132:133], v131 offset:0
    ds_read_b64_tr_b16 a[134:135], v131 offset:4096
    ds_read_b64_tr_b16 a[136:137], v132 offset:0
    ds_read_b64_tr_b16 a[138:139], v132 offset:4096
    ds_read_b64_tr_b16 a[140:141], v133 offset:0
    ds_read_b64_tr_b16 a[142:143], v133 offset:4096
    ds_read_b64_tr_b16 a[144:145], v134 offset:0
    ds_read_b64_tr_b16 a[146:147], v134 offset:4096
    ds_read_b64_tr_b16 a[148:149], v135 offset:0
    ds_read_b64_tr_b16 a[150:151], v135 offset:4096
    ds_read_b64_tr_b16 a[152:153], v136 offset:0
    ds_read_b64_tr_b16 a[154:155], v136 offset:4096
    ds_read_b64_tr_b16 a[156:157], v142 offset:0
    ds_read_b64_tr_b16 a[158:159], v142 offset:4096
    ds_read_b64_tr_b16 a[160:161], v143 offset:0
    ds_read_b64_tr_b16 a[162:163], v143 offset:4096
    s_waitcnt lgkmcnt(12)
    v_mfma_f32_16x16x32_bf16 v[144:147], a[128:131], a[192:195], 0
    ds_read_b64_tr_b16 a[164:165], v130 offset:8192
    ds_read_b64_tr_b16 a[166:167], v130 offset:12288
    v_mfma_f32_16x16x32_bf16 v[172:175], a[128:131], a[196:199], 0
    v_mfma_f32_16x16x32_bf16 v[148:151], a[132:135], a[192:195], 0
    ds_read_b64_tr_b16 a[168:169], v131 offset:8192
    ds_read_b64_tr_b16 a[170:171], v131 offset:12288
    v_mfma_f32_16x16x32_bf16 v[176:179], a[132:135], a[196:199], 0
    s_add_u32 m0, s33, 49152
    s_add_u32 s35, s38, 1376256
    buffer_load_dwordx4 v128, s[44:47], s35 offen offset:0 lds
    v_mfma_f32_16x16x32_bf16 v[152:155], a[136:139], a[192:195], 0
    ds_read_b64_tr_b16 a[172:173], v132 offset:8192
    ds_read_b64_tr_b16 a[174:175], v132 offset:12288
    v_mov_b32 v230, v224
    v_mfma_f32_16x16x32_bf16 v[180:183], a[136:139], a[196:199], 0
    s_nop 1
    v_permlane16_swap_b32 v224, v230
    s_waitcnt lgkmcnt(12)
    v_mfma_f32_16x16x32_bf16 v[156:159], a[140:143], a[192:195], 0
    ds_read_b64_tr_b16 a[176:177], v133 offset:8192
    ds_read_b64_tr_b16 a[178:179], v133 offset:12288
    s_nop 0
    v_add_f32 v224, v224, v230
    v_mfma_f32_16x16x32_bf16 v[184:187], a[140:143], a[196:199], 0
    s_add_u32 m0, s33, 49152
    s_add_u32 s35, s38, 1389568
    buffer_load_dwordx4 v129, s[44:47], s35 offen offset:1024 lds
    v_mov_b32 v230, v224
    v_mfma_f32_16x16x32_bf16 v[160:163], a[144:147], a[192:195], 0
    ds_read_b64_tr_b16 a[180:181], v134 offset:8192
    ds_read_b64_tr_b16 a[182:183], v134 offset:12288
    s_nop 1
    v_permlane32_swap_b32 v224, v230
    v_mfma_f32_16x16x32_bf16 v[188:191], a[144:147], a[196:199], 0
    s_nop 0
    v_add_f32 v224, v224, v230
    v_mfma_f32_16x16x32_bf16 v[164:167], a[148:151], a[192:195], 0
    ds_read_b64_tr_b16 a[184:185], v135 offset:8192
    ds_read_b64_tr_b16 a[186:187], v135 offset:12288
    v_mov_b32 v231, v225
    v_mfma_f32_16x16x32_bf16 v[192:195], a[148:151], a[196:199], 0
    s_add_u32 m0, s33, 49152
    s_add_u32 s35, s38, 1402880
    buffer_load_dwordx4 v128, s[44:47], s35 offen offset:2048 lds
    s_nop 1
    v_permlane16_swap_b32 v225, v231
    s_waitcnt lgkmcnt(12)
    v_mfma_f32_16x16x32_bf16 v[168:171], a[152:155], a[192:195], 0
    ds_read_b64_tr_b16 a[188:189], v136 offset:8192
    ds_read_b64_tr_b16 a[190:191], v136 offset:12288
    s_nop 0
    v_add_f32 v225, v225, v231
    v_mfma_f32_16x16x32_bf16 v[196:199], a[152:155], a[196:199], 0
    v_mov_b32 v231, v225
    v_mfma_f32_16x16x32_bf16 v[200:203], a[156:159], v[10:13], 0
    ds_read_b64_tr_b16 a[128:129], v142 offset:8192
    ds_read_b64_tr_b16 a[130:131], v142 offset:12288
    s_nop 1
    v_permlane32_swap_b32 v225, v231
    v_mfma_f32_16x16x32_bf16 v[204:207], a[160:163], v[10:13], 0
    ds_read_b64_tr_b16 a[132:133], v143 offset:8192
    ds_read_b64_tr_b16 a[134:135], v143 offset:12288
    s_nop 0
    v_add_f32 v225, v225, v231
    s_waitcnt lgkmcnt(12)
    v_mfma_f32_16x16x32_bf16 v[144:147], a[164:167], a[200:203], v[144:147]
    ds_read_b64_tr_b16 a[136:137], v242 offset:0
    ds_read_b64_tr_b16 a[138:139], v242 offset:4096
    v_mov_b32 v232, v226
    v_mfma_f32_16x16x32_bf16 v[172:175], a[164:167], a[204:207], v[172:175]
    s_nop 1
    v_permlane16_swap_b32 v226, v232
    v_mfma_f32_16x16x32_bf16 v[148:151], a[168:171], a[200:203], v[148:151]
    ds_read_b64_tr_b16 a[140:141], v243 offset:0
    ds_read_b64_tr_b16 a[142:143], v243 offset:4096
    s_nop 0
    v_add_f32 v226, v226, v232
    v_mfma_f32_16x16x32_bf16 v[176:179], a[168:171], a[204:207], v[176:179]
    s_add_u32 m0, s33, 49152
    s_add_u32 s35, s38, 1416192
    buffer_load_dwordx4 v129, s[44:47], s35 offen offset:3072 lds
    v_mov_b32 v232, v226
    v_mfma_f32_16x16x32_bf16 v[152:155], a[172:175], a[200:203], v[152:155]
    ds_read_b64_tr_b16 a[144:145], v244 offset:0
    ds_read_b64_tr_b16 a[146:147], v244 offset:4096
    s_nop 1
    v_permlane32_swap_b32 v226, v232
    v_mfma_f32_16x16x32_bf16 v[180:183], a[172:175], a[204:207], v[180:183]
    s_nop 0
    v_add_f32 v226, v226, v232
    s_waitcnt lgkmcnt(12)
    v_mfma_f32_16x16x32_bf16 v[156:159], a[176:179], a[200:203], v[156:159]
    ds_read_b64_tr_b16 a[148:149], v245 offset:0
    ds_read_b64_tr_b16 a[150:151], v245 offset:4096
    v_mov_b32 v233, v227
    v_mfma_f32_16x16x32_bf16 v[184:187], a[176:179], a[204:207], v[184:187]
    s_add_u32 m0, s34, 49152
    s_add_u32 s35, s38, 1605632
    buffer_load_dwordx4 v128, s[44:47], s35 offen offset:0 lds
    s_nop 1
    v_permlane16_swap_b32 v227, v233
    v_mfma_f32_16x16x32_bf16 v[160:163], a[180:183], a[200:203], v[160:163]
    ds_read_b64_tr_b16 a[152:153], v246 offset:0
    ds_read_b64_tr_b16 a[154:155], v246 offset:4096
    s_nop 0
    v_add_f32 v227, v227, v233
    v_mfma_f32_16x16x32_bf16 v[188:191], a[180:183], a[204:207], v[188:191]
    v_mov_b32 v233, v227
    v_mfma_f32_16x16x32_bf16 v[164:167], a[184:187], a[200:203], v[164:167]
    ds_read_b64_tr_b16 a[156:157], v247 offset:0
    ds_read_b64_tr_b16 a[158:159], v247 offset:4096
    s_nop 1
    v_permlane32_swap_b32 v227, v233
    v_mfma_f32_16x16x32_bf16 v[192:195], a[184:187], a[204:207], v[192:195]
    s_add_u32 m0, s34, 49152
    s_add_u32 s35, s38, 1618944
    buffer_load_dwordx4 v129, s[44:47], s35 offen offset:1024 lds
    s_nop 0
    v_add_f32 v227, v227, v233
    s_waitcnt lgkmcnt(12)
    v_mfma_f32_16x16x32_bf16 v[168:171], a[188:191], a[200:203], v[168:171]
    ds_read_b64_tr_b16 a[160:161], v248 offset:0
    ds_read_b64_tr_b16 a[162:163], v248 offset:4096
    v_rcp_f32 v224, v224
    v_mfma_f32_16x16x32_bf16 v[196:199], a[188:191], a[204:207], v[196:199]
    v_rcp_f32 v225, v225
    v_mfma_f32_16x16x32_bf16 v[200:203], a[128:131], v[10:13], v[200:203]
    ds_read_b64_tr_b16 a[164:165], v140 offset:0
    ds_read_b64_tr_b16 a[166:167], v140 offset:4096
    v_rcp_f32 v226, v226
    v_mfma_f32_16x16x32_bf16 v[204:207], a[132:135], v[10:13], v[204:207]
    ds_read_b64_tr_b16 a[168:169], v141 offset:0
    ds_read_b64_tr_b16 a[170:171], v141 offset:4096
    v_rcp_f32 v227, v227
    s_waitcnt lgkmcnt(12)
    v_mfma_f32_16x16x32_bf16 v[144:147], a[136:139], a[208:211], v[144:147]
    ds_read_b64_tr_b16 a[172:173], v242 offset:8192
    ds_read_b64_tr_b16 a[174:175], v242 offset:12288
    s_lshl_b32 s39, s25, 12
    s_add_u32 s39, s39, 16777216
    s_mul_i32 s68, s43, 132096
    s_add_u32 s39, s39, s68
    v_accvgpr_read_b32 v80, a0
    v_mfma_f32_16x16x32_bf16 v[172:175], a[136:139], a[212:215], v[172:175]
    v_accvgpr_read_b32 v81, a1
    v_mfma_f32_16x16x32_bf16 v[148:151], a[140:143], a[208:211], v[148:151]
    ds_read_b64_tr_b16 a[176:177], v243 offset:8192
    ds_read_b64_tr_b16 a[178:179], v243 offset:12288
    v_accvgpr_read_b32 v82, a2
    v_mfma_f32_16x16x32_bf16 v[176:179], a[140:143], a[212:215], v[176:179]
    s_add_u32 m0, s34, 49152
    s_add_u32 s35, s38, 1632256
    buffer_load_dwordx4 v128, s[44:47], s35 offen offset:2048 lds
    v_accvgpr_read_b32 v83, a3
    v_mfma_f32_16x16x32_bf16 v[152:155], a[144:147], a[208:211], v[152:155]
    ds_read_b64_tr_b16 a[180:181], v244 offset:8192
    ds_read_b64_tr_b16 a[182:183], v244 offset:12288
    v_accvgpr_read_b32 v84, a4
    v_mfma_f32_16x16x32_bf16 v[180:183], a[144:147], a[212:215], v[180:183]
    v_accvgpr_read_b32 v85, a5
    s_waitcnt lgkmcnt(12)
    v_mfma_f32_16x16x32_bf16 v[156:159], a[148:151], a[208:211], v[156:159]
    ds_read_b64_tr_b16 a[184:185], v245 offset:8192
    ds_read_b64_tr_b16 a[186:187], v245 offset:12288
    v_accvgpr_read_b32 v86, a6
    v_mfma_f32_16x16x32_bf16 v[184:187], a[148:151], a[212:215], v[184:187]
    s_add_u32 m0, s34, 49152
    s_add_u32 s35, s38, 1645568
    buffer_load_dwordx4 v129, s[44:47], s35 offen offset:3072 lds
    v_accvgpr_read_b32 v87, a7
    v_mfma_f32_16x16x32_bf16 v[160:163], a[152:155], a[208:211], v[160:163]
    ds_read_b64_tr_b16 a[188:189], v246 offset:8192
    ds_read_b64_tr_b16 a[190:191], v246 offset:12288
    v_mul_f32 v80, v80, v224
    v_mfma_f32_16x16x32_bf16 v[188:191], a[152:155], a[212:215], v[188:191]
    v_mul_f32 v81, v81, v224
    v_mfma_f32_16x16x32_bf16 v[164:167], a[156:159], a[208:211], v[164:167]
    ds_read_b64_tr_b16 a[128:129], v247 offset:8192
    ds_read_b64_tr_b16 a[130:131], v247 offset:12288
    v_mul_f32 v82, v82, v224
    v_mfma_f32_16x16x32_bf16 v[192:195], a[156:159], a[212:215], v[192:195]
    s_add_u32 s64, s61, 6299648
    buffer_load_dwordx4 v[16:19], v14, s[20:23], s64 offen offset:0 sc1
    v_mul_f32 v83, v83, v224
    s_waitcnt lgkmcnt(12)
    v_mfma_f32_16x16x32_bf16 v[168:171], a[160:163], a[208:211], v[168:171]
    ds_read_b64_tr_b16 a[132:133], v248 offset:8192
    ds_read_b64_tr_b16 a[134:135], v248 offset:12288
    v_mul_f32 v84, v84, v224
    v_mfma_f32_16x16x32_bf16 v[196:199], a[160:163], a[212:215], v[196:199]
    v_mul_f32 v85, v85, v224
    v_mfma_f32_16x16x32_bf16 v[200:203], a[164:167], v[10:13], v[200:203]
    ds_read_b64_tr_b16 a[136:137], v140 offset:8192
    ds_read_b64_tr_b16 a[138:139], v140 offset:12288
    v_mul_f32 v86, v86, v224
    v_mfma_f32_16x16x32_bf16 v[204:207], a[168:171], v[10:13], v[204:207]
    ds_read_b64_tr_b16 a[140:141], v141 offset:8192
    ds_read_b64_tr_b16 a[142:143], v141 offset:12288
    v_mul_f32 v87, v87, v224
    s_waitcnt lgkmcnt(12)
    v_mfma_f32_16x16x32_bf16 v[144:147], a[172:175], a[216:219], v[144:147]
    ds_read_b64_tr_b16 a[144:145], v130 offset:16384
    ds_read_b64_tr_b16 a[146:147], v130 offset:20480
    v_cvt_pk_bf16_f32 v88, v80, v81
    v_mfma_f32_16x16x32_bf16 v[172:175], a[172:175], a[220:223], v[172:175]
    v_cvt_pk_bf16_f32 v89, v82, v83
    v_mfma_f32_16x16x32_bf16 v[148:151], a[176:179], a[216:219], v[148:151]
    ds_read_b64_tr_b16 a[148:149], v131 offset:16384
    ds_read_b64_tr_b16 a[150:151], v131 offset:20480
    v_cvt_pk_bf16_f32 v90, v84, v85
    v_mfma_f32_16x16x32_bf16 v[176:179], a[176:179], a[220:223], v[176:179]
    s_add_u32 s64, s61, 6316032
    buffer_load_dwordx4 v[20:23], v14, s[20:23], s64 offen offset:0 sc1
    v_cvt_pk_bf16_f32 v91, v86, v87
    v_mfma_f32_16x16x32_bf16 v[152:155], a[180:183], a[216:219], v[152:155]
    ds_read_b64_tr_b16 a[152:153], v132 offset:16384
    ds_read_b64_tr_b16 a[154:155], v132 offset:20480
    buffer_store_dwordx4 v[88:91], v14, s[20:23], s39 offen offset:0 sc1
    v_mfma_f32_16x16x32_bf16 v[180:183], a[180:183], a[220:223], v[180:183]
    v_accvgpr_read_b32 v92, a8
    s_waitcnt lgkmcnt(12)
    v_mfma_f32_16x16x32_bf16 v[156:159], a[184:187], a[216:219], v[156:159]
    ds_read_b64_tr_b16 a[156:157], v133 offset:16384
    ds_read_b64_tr_b16 a[158:159], v133 offset:20480
    v_accvgpr_read_b32 v93, a9
    v_mfma_f32_16x16x32_bf16 v[184:187], a[184:187], a[220:223], v[184:187]
    s_add_u32 s64, s61, 6299648
    buffer_load_dwordx4 v[24:27], v14, s[20:23], s64 offen offset:1024 sc1
    v_accvgpr_read_b32 v94, a10
    v_mfma_f32_16x16x32_bf16 v[160:163], a[188:191], a[216:219], v[160:163]
    ds_read_b64_tr_b16 a[160:161], v134 offset:16384
    ds_read_b64_tr_b16 a[162:163], v134 offset:20480
    v_accvgpr_read_b32 v95, a11
    v_mfma_f32_16x16x32_bf16 v[188:191], a[188:191], a[220:223], v[188:191]
    v_accvgpr_read_b32 v96, a12
    v_mfma_f32_16x16x32_bf16 v[164:167], a[128:131], a[216:219], v[164:167]
    ds_read_b64_tr_b16 a[164:165], v135 offset:16384
    ds_read_b64_tr_b16 a[166:167], v135 offset:20480
    v_accvgpr_read_b32 v97, a13
    v_mfma_f32_16x16x32_bf16 v[192:195], a[128:131], a[220:223], v[192:195]
    s_add_u32 s64, s61, 6316032
    buffer_load_dwordx4 v[28:31], v14, s[20:23], s64 offen offset:1024 sc1
    v_accvgpr_read_b32 v98, a14
    s_waitcnt lgkmcnt(12)
    v_mfma_f32_16x16x32_bf16 v[168:171], a[132:135], a[216:219], v[168:171]
    ds_read_b64_tr_b16 a[168:169], v136 offset:16384
    ds_read_b64_tr_b16 a[170:171], v136 offset:20480
    v_accvgpr_read_b32 v99, a15
    v_mfma_f32_16x16x32_bf16 v[196:199], a[132:135], a[220:223], v[196:199]
    v_mul_f32 v92, v92, v224
    v_mfma_f32_16x16x32_bf16 v[200:203], a[136:139], v[10:13], v[200:203]
    ds_read_b64_tr_b16 a[172:173], v142 offset:16384
    ds_read_b64_tr_b16 a[174:175], v142 offset:20480
    v_mul_f32 v93, v93, v224
    v_mfma_f32_16x16x32_bf16 v[204:207], a[140:143], v[10:13], v[204:207]
    ds_read_b64_tr_b16 a[176:177], v143 offset:16384
    ds_read_b64_tr_b16 a[178:179], v143 offset:20480
    v_mul_f32 v94, v94, v224
    s_waitcnt lgkmcnt(12)
    v_mfma_f32_16x16x32_bf16 v[144:147], a[144:147], a[224:227], v[144:147]
    ds_read_b64_tr_b16 a[180:181], v130 offset:24576
    ds_read_b64_tr_b16 a[182:183], v130 offset:28672
    v_mul_f32 v95, v95, v224
    v_mfma_f32_16x16x32_bf16 v[172:175], a[144:147], a[228:231], v[172:175]
    v_mul_f32 v96, v96, v224
    v_mfma_f32_16x16x32_bf16 v[148:151], a[148:151], a[224:227], v[148:151]
    ds_read_b64_tr_b16 a[184:185], v131 offset:24576
    ds_read_b64_tr_b16 a[186:187], v131 offset:28672
    v_mul_f32 v97, v97, v224
    v_mfma_f32_16x16x32_bf16 v[176:179], a[148:151], a[228:231], v[176:179]
    s_add_u32 s64, s61, 6299648
    buffer_load_dwordx4 v[32:35], v14, s[20:23], s64 offen offset:2048 sc1
    v_mul_f32 v98, v98, v224
    v_mfma_f32_16x16x32_bf16 v[152:155], a[152:155], a[224:227], v[152:155]
    ds_read_b64_tr_b16 a[188:189], v132 offset:24576
    ds_read_b64_tr_b16 a[190:191], v132 offset:28672
    v_mul_f32 v99, v99, v224
    v_mfma_f32_16x16x32_bf16 v[180:183], a[152:155], a[228:231], v[180:183]
    v_cvt_pk_bf16_f32 v100, v92, v93
    s_waitcnt lgkmcnt(12)
    v_mfma_f32_16x16x32_bf16 v[156:159], a[156:159], a[224:227], v[156:159]
    ds_read_b64_tr_b16 a[128:129], v133 offset:24576
    ds_read_b64_tr_b16 a[130:131], v133 offset:28672
    v_cvt_pk_bf16_f32 v101, v94, v95
    v_mfma_f32_16x16x32_bf16 v[184:187], a[156:159], a[228:231], v[184:187]
    s_add_u32 s64, s61, 6316032
    buffer_load_dwordx4 v[36:39], v14, s[20:23], s64 offen offset:2048 sc1
    v_cvt_pk_bf16_f32 v102, v96, v97
    v_mfma_f32_16x16x32_bf16 v[160:163], a[160:163], a[224:227], v[160:163]
    ds_read_b64_tr_b16 a[132:133], v134 offset:24576
    ds_read_b64_tr_b16 a[134:135], v134 offset:28672
    v_cvt_pk_bf16_f32 v103, v98, v99
    v_mfma_f32_16x16x32_bf16 v[188:191], a[160:163], a[228:231], v[188:191]
    buffer_store_dwordx4 v[100:103], v14, s[20:23], s39 offen offset:1024 sc1
    v_mfma_f32_16x16x32_bf16 v[164:167], a[164:167], a[224:227], v[164:167]
    ds_read_b64_tr_b16 a[136:137], v135 offset:24576
    ds_read_b64_tr_b16 a[138:139], v135 offset:28672
    v_accvgpr_read_b32 v104, a16
    v_mfma_f32_16x16x32_bf16 v[192:195], a[164:167], a[228:231], v[192:195]
    s_add_u32 s64, s61, 6299648
    buffer_load_dwordx4 v[40:43], v14, s[20:23], s64 offen offset:3072 sc1
    v_accvgpr_read_b32 v105, a17
    s_waitcnt lgkmcnt(12)
    v_mfma_f32_16x16x32_bf16 v[168:171], a[168:171], a[224:227], v[168:171]
    ds_read_b64_tr_b16 a[140:141], v136 offset:24576
    ds_read_b64_tr_b16 a[142:143], v136 offset:28672
    v_accvgpr_read_b32 v106, a18
    v_mfma_f32_16x16x32_bf16 v[196:199], a[168:171], a[228:231], v[196:199]
    v_accvgpr_read_b32 v107, a19
    v_mfma_f32_16x16x32_bf16 v[200:203], a[172:175], v[10:13], v[200:203]
    ds_read_b64_tr_b16 a[144:145], v142 offset:24576
    ds_read_b64_tr_b16 a[146:147], v142 offset:28672
    v_accvgpr_read_b32 v108, a20
    v_mfma_f32_16x16x32_bf16 v[204:207], a[176:179], v[10:13], v[204:207]
    ds_read_b64_tr_b16 a[148:149], v143 offset:24576
    ds_read_b64_tr_b16 a[150:151], v143 offset:28672
    v_accvgpr_read_b32 v109, a21
    s_waitcnt lgkmcnt(12)
    v_mfma_f32_16x16x32_bf16 v[144:147], a[180:183], a[232:235], v[144:147]
    ds_read_b64_tr_b16 a[152:153], v242 offset:16384
    ds_read_b64_tr_b16 a[154:155], v242 offset:20480
    v_accvgpr_read_b32 v110, a22
    v_mfma_f32_16x16x32_bf16 v[172:175], a[180:183], a[236:239], v[172:175]
    v_accvgpr_read_b32 v111, a23
    v_mfma_f32_16x16x32_bf16 v[148:151], a[184:187], a[232:235], v[148:151]
    ds_read_b64_tr_b16 a[156:157], v243 offset:16384
    ds_read_b64_tr_b16 a[158:159], v243 offset:20480
    v_mul_f32 v104, v104, v224
    v_mfma_f32_16x16x32_bf16 v[176:179], a[184:187], a[236:239], v[176:179]
    s_add_u32 s64, s61, 6316032
    buffer_load_dwordx4 v[44:47], v14, s[20:23], s64 offen offset:3072 sc1
    v_mul_f32 v105, v105, v224
    v_mfma_f32_16x16x32_bf16 v[152:155], a[188:191], a[232:235], v[152:155]
    ds_read_b64_tr_b16 a[160:161], v244 offset:16384
    ds_read_b64_tr_b16 a[162:163], v244 offset:20480
    v_mul_f32 v106, v106, v224
    v_mfma_f32_16x16x32_bf16 v[180:183], a[188:191], a[236:239], v[180:183]
    v_mul_f32 v107, v107, v224
    s_waitcnt lgkmcnt(12)
    v_mfma_f32_16x16x32_bf16 v[156:159], a[128:131], a[232:235], v[156:159]
    ds_read_b64_tr_b16 a[164:165], v245 offset:16384
    ds_read_b64_tr_b16 a[166:167], v245 offset:20480
    v_mul_f32 v108, v108, v224
    v_mfma_f32_16x16x32_bf16 v[184:187], a[128:131], a[236:239], v[184:187]
    s_add_u32 s64, s61, 6303744
    buffer_load_dwordx4 v[48:51], v14, s[20:23], s64 offen offset:0 sc1
    v_mul_f32 v109, v109, v224
    v_mfma_f32_16x16x32_bf16 v[160:163], a[132:135], a[232:235], v[160:163]
    ds_read_b64_tr_b16 a[168:169], v246 offset:16384
    ds_read_b64_tr_b16 a[170:171], v246 offset:20480
    v_mul_f32 v110, v110, v224
    v_mfma_f32_16x16x32_bf16 v[188:191], a[132:135], a[236:239], v[188:191]
    v_mul_f32 v111, v111, v224
    v_mfma_f32_16x16x32_bf16 v[164:167], a[136:139], a[232:235], v[164:167]
    ds_read_b64_tr_b16 a[172:173], v247 offset:16384
    ds_read_b64_tr_b16 a[174:175], v247 offset:20480
    v_cvt_pk_bf16_f32 v112, v104, v105
    v_mfma_f32_16x16x32_bf16 v[192:195], a[136:139], a[236:239], v[192:195]
    s_add_u32 s64, s61, 6320128
    buffer_load_dwordx4 v[52:55], v14, s[20:23], s64 offen offset:0 sc1
    v_cvt_pk_bf16_f32 v113, v106, v107
    s_waitcnt lgkmcnt(12)
    v_mfma_f32_16x16x32_bf16 v[168:171], a[140:143], a[232:235], v[168:171]
    ds_read_b64_tr_b16 a[176:177], v248 offset:16384
    ds_read_b64_tr_b16 a[178:179], v248 offset:20480
    v_cvt_pk_bf16_f32 v114, v108, v109
    v_mfma_f32_16x16x32_bf16 v[196:199], a[140:143], a[236:239], v[196:199]
    v_cvt_pk_bf16_f32 v115, v110, v111
    v_mfma_f32_16x16x32_bf16 v[200:203], a[144:147], v[10:13], v[200:203]
    ds_read_b64_tr_b16 a[180:181], v140 offset:16384
    ds_read_b64_tr_b16 a[182:183], v140 offset:20480
    buffer_store_dwordx4 v[112:115], v14, s[20:23], s39 offen offset:2048 sc1
    v_mfma_f32_16x16x32_bf16 v[204:207], a[148:151], v[10:13], v[204:207]
    ds_read_b64_tr_b16 a[184:185], v141 offset:16384
    ds_read_b64_tr_b16 a[186:187], v141 offset:20480
    v_accvgpr_read_b32 v116, a24
    s_waitcnt lgkmcnt(12)
    v_mfma_f32_16x16x32_bf16 v[144:147], a[152:155], a[240:243], v[144:147]
    ds_read_b64_tr_b16 a[188:189], v242 offset:24576
    ds_read_b64_tr_b16 a[190:191], v242 offset:28672
    v_accvgpr_read_b32 v117, a25
    v_mfma_f32_16x16x32_bf16 v[172:175], a[152:155], a[244:247], v[172:175]
    v_accvgpr_read_b32 v118, a26
    v_mfma_f32_16x16x32_bf16 v[148:151], a[156:159], a[240:243], v[148:151]
    ds_read_b64_tr_b16 a[128:129], v243 offset:24576
    ds_read_b64_tr_b16 a[130:131], v243 offset:28672
    v_accvgpr_read_b32 v119, a27
    v_mfma_f32_16x16x32_bf16 v[176:179], a[156:159], a[244:247], v[176:179]
    s_add_u32 s64, s61, 6303744
    buffer_load_dwordx4 v[56:59], v14, s[20:23], s64 offen offset:1024 sc1
    v_accvgpr_read_b32 v120, a28
    v_mfma_f32_16x16x32_bf16 v[152:155], a[160:163], a[240:243], v[152:155]
    ds_read_b64_tr_b16 a[132:133], v244 offset:24576
    ds_read_b64_tr_b16 a[134:135], v244 offset:28672
    v_accvgpr_read_b32 v121, a29
    v_mfma_f32_16x16x32_bf16 v[180:183], a[160:163], a[244:247], v[180:183]
    v_accvgpr_read_b32 v122, a30
    s_waitcnt lgkmcnt(12)
    v_mfma_f32_16x16x32_bf16 v[156:159], a[164:167], a[240:243], v[156:159]
    ds_read_b64_tr_b16 a[136:137], v245 offset:24576
    ds_read_b64_tr_b16 a[138:139], v245 offset:28672
    v_accvgpr_read_b32 v123, a31
    v_mfma_f32_16x16x32_bf16 v[184:187], a[164:167], a[244:247], v[184:187]
    s_add_u32 s64, s61, 6320128
    buffer_load_dwordx4 v[60:63], v14, s[20:23], s64 offen offset:1024 sc1
    v_mul_f32 v116, v116, v224
    v_mfma_f32_16x16x32_bf16 v[160:163], a[168:171], a[240:243], v[160:163]
    ds_read_b64_tr_b16 a[140:141], v246 offset:24576
    ds_read_b64_tr_b16 a[142:143], v246 offset:28672
    v_mul_f32 v117, v117, v224
    v_mfma_f32_16x16x32_bf16 v[188:191], a[168:171], a[244:247], v[188:191]
    v_mul_f32 v118, v118, v224
    v_mfma_f32_16x16x32_bf16 v[164:167], a[172:175], a[240:243], v[164:167]
    ds_read_b64_tr_b16 a[144:145], v247 offset:24576
    ds_read_b64_tr_b16 a[146:147], v247 offset:28672
    v_mul_f32 v119, v119, v224
    v_mfma_f32_16x16x32_bf16 v[192:195], a[172:175], a[244:247], v[192:195]
    s_add_u32 s64, s61, 6303744
    buffer_load_dwordx4 v[64:67], v14, s[20:23], s64 offen offset:2048 sc1
    v_mul_f32 v120, v120, v224
    s_waitcnt lgkmcnt(12)
    v_mfma_f32_16x16x32_bf16 v[168:171], a[176:179], a[240:243], v[168:171]
    ds_read_b64_tr_b16 a[148:149], v248 offset:24576
    ds_read_b64_tr_b16 a[150:151], v248 offset:28672
    v_mul_f32 v121, v121, v224
    v_mfma_f32_16x16x32_bf16 v[196:199], a[176:179], a[244:247], v[196:199]
    v_mul_f32 v122, v122, v224
    v_mfma_f32_16x16x32_bf16 v[200:203], a[180:183], v[10:13], v[200:203]
    ds_read_b64_tr_b16 a[152:153], v140 offset:24576
    ds_read_b64_tr_b16 a[154:155], v140 offset:28672
    v_mul_f32 v123, v123, v224
    v_mfma_f32_16x16x32_bf16 v[204:207], a[184:187], v[10:13], v[204:207]
    ds_read_b64_tr_b16 a[156:157], v141 offset:24576
    ds_read_b64_tr_b16 a[158:159], v141 offset:28672
    v_cvt_pk_bf16_f32 v124, v116, v117
    s_waitcnt lgkmcnt(12)
    v_mfma_f32_16x16x32_bf16 v[144:147], a[188:191], a[248:251], v[144:147]
    s_waitcnt vmcnt(24)
    s_barrier
    ds_read_b64_tr_b16 a[160:161], v130 offset:32768
    ds_read_b64_tr_b16 a[162:163], v130 offset:36864
    v_cvt_pk_bf16_f32 v125, v118, v119
    v_mfma_f32_16x16x32_bf16 v[172:175], a[188:191], a[252:255], v[172:175]
    v_cvt_pk_bf16_f32 v126, v120, v121
    v_mfma_f32_16x16x32_bf16 v[148:151], a[128:131], a[248:251], v[148:151]
    ds_read_b64_tr_b16 a[164:165], v131 offset:32768
    ds_read_b64_tr_b16 a[166:167], v131 offset:36864
    v_cvt_pk_bf16_f32 v127, v122, v123
    v_mfma_f32_16x16x32_bf16 v[176:179], a[128:131], a[252:255], v[176:179]
    s_add_u32 s64, s61, 6320128
    buffer_load_dwordx4 v[68:71], v14, s[20:23], s64 offen offset:2048 sc1
    buffer_store_dwordx4 v[124:127], v14, s[20:23], s39 offen offset:3072 sc1
    v_mfma_f32_16x16x32_bf16 v[152:155], a[132:135], a[248:251], v[152:155]
    ds_read_b64_tr_b16 a[168:169], v132 offset:32768
    ds_read_b64_tr_b16 a[170:171], v132 offset:36864
    s_lshl_b32 s39, s25, 12
    s_add_u32 s39, s39, 16909312
    s_mul_i32 s68, s43, 132096
    s_add_u32 s39, s39, s68
    v_accvgpr_read_b32 v80, a32
    v_mfma_f32_16x16x32_bf16 v[180:183], a[132:135], a[252:255], v[180:183]
    v_accvgpr_read_b32 v81, a33
    s_waitcnt lgkmcnt(12)
    v_mfma_f32_16x16x32_bf16 v[156:159], a[136:139], a[248:251], v[156:159]
    ds_read_b64_tr_b16 a[172:173], v133 offset:32768
    ds_read_b64_tr_b16 a[174:175], v133 offset:36864
    v_accvgpr_read_b32 v82, a34
    v_mfma_f32_16x16x32_bf16 v[184:187], a[136:139], a[252:255], v[184:187]
    s_add_u32 s64, s61, 6303744
    buffer_load_dwordx4 v[72:75], v14, s[20:23], s64 offen offset:3072 sc1
    v_accvgpr_read_b32 v83, a35
    v_mfma_f32_16x16x32_bf16 v[160:163], a[140:143], a[248:251], v[160:163]
    ds_read_b64_tr_b16 a[176:177], v134 offset:32768
    ds_read_b64_tr_b16 a[178:179], v134 offset:36864
    v_accvgpr_read_b32 v84, a36
    v_mfma_f32_16x16x32_bf16 v[188:191], a[140:143], a[252:255], v[188:191]
    v_accvgpr_read_b32 v85, a37
    v_mfma_f32_16x16x32_bf16 v[164:167], a[144:147], a[248:251], v[164:167]
    ds_read_b64_tr_b16 a[180:181], v135 offset:32768
    ds_read_b64_tr_b16 a[182:183], v135 offset:36864
    v_accvgpr_read_b32 v86, a38
    v_mfma_f32_16x16x32_bf16 v[192:195], a[144:147], a[252:255], v[192:195]
    s_add_u32 s64, s61, 6320128
    buffer_load_dwordx4 v[76:79], v14, s[20:23], s64 offen offset:3072 sc1
    v_accvgpr_read_b32 v87, a39
    s_waitcnt lgkmcnt(12)
    v_mfma_f32_16x16x32_bf16 v[168:171], a[148:151], a[248:251], v[168:171]
    ds_read_b64_tr_b16 a[184:185], v136 offset:32768
    ds_read_b64_tr_b16 a[186:187], v136 offset:36864
    v_mul_f32 v80, v80, v225
    v_mfma_f32_16x16x32_bf16 v[196:199], a[148:151], a[252:255], v[196:199]
    v_mul_f32 v81, v81, v225
    v_mfma_f32_16x16x32_bf16 v[200:203], a[152:155], v[10:13], v[200:203]
    ds_read_b64_tr_b16 a[188:189], v142 offset:32768
    ds_read_b64_tr_b16 a[190:191], v142 offset:36864
    v_mul_f32 v82, v82, v225
    v_mfma_f32_16x16x32_bf16 v[204:207], a[156:159], v[10:13], v[204:207]
    ds_read_b64_tr_b16 a[128:129], v143 offset:32768
    ds_read_b64_tr_b16 a[130:131], v143 offset:36864
    v_mul_f32 v83, v83, v225
    s_waitcnt vmcnt(15)
    s_waitcnt lgkmcnt(12)
    v_mfma_f32_16x16x32_bf16 v[144:147], a[160:163], v[16:19], v[144:147]
    ds_read_b64_tr_b16 a[132:133], v130 offset:40960
    ds_read_b64_tr_b16 a[134:135], v130 offset:45056
    v_mul_f32 v84, v84, v225
    v_mfma_f32_16x16x32_bf16 v[172:175], a[160:163], v[20:23], v[172:175]
    v_mul_f32 v85, v85, v225
    v_mfma_f32_16x16x32_bf16 v[148:151], a[164:167], v[16:19], v[148:151]
    ds_read_b64_tr_b16 a[136:137], v131 offset:40960
    ds_read_b64_tr_b16 a[138:139], v131 offset:45056
    v_mul_f32 v86, v86, v225
    v_mfma_f32_16x16x32_bf16 v[176:179], a[164:167], v[20:23], v[176:179]
    v_lshrrev_b32 v1, 4, v14
    v_and_b32 v2, 15, v1
    v_lshrrev_b32 v5, 4, v1
    v_lshlrev_b32 v2, 3, v2
    v_lshl_add_u32 v2, v5, 16, v2
    s_lshl_b32 s63, s43, 7
    s_add_u32 s63, s63, 36700160
    buffer_load_dwordx2 v[208:209], v2, s[20:23], s63 offen offset:0 sc1
    v_mul_f32 v87, v87, v225
    v_mfma_f32_16x16x32_bf16 v[152:155], a[168:171], v[16:19], v[152:155]
    ds_read_b64_tr_b16 a[140:141], v132 offset:40960
    ds_read_b64_tr_b16 a[142:143], v132 offset:45056
    v_cvt_pk_bf16_f32 v88, v80, v81
    v_mfma_f32_16x16x32_bf16 v[180:183], a[168:171], v[20:23], v[180:183]
    v_cvt_pk_bf16_f32 v89, v82, v83
    s_waitcnt lgkmcnt(12)
    v_mfma_f32_16x16x32_bf16 v[156:159], a[172:175], v[16:19], v[156:159]
    ds_read_b64_tr_b16 a[144:145], v133 offset:40960
    ds_read_b64_tr_b16 a[146:147], v133 offset:45056
    v_cvt_pk_bf16_f32 v90, v84, v85
    v_mfma_f32_16x16x32_bf16 v[184:187], a[172:175], v[20:23], v[184:187]
    s_lshl_b32 s63, s43, 7
    s_add_u32 s63, s63, 36700160
    buffer_load_dwordx2 v[216:217], v2, s[20:23], s63 offen offset:128 sc1
    v_cvt_pk_bf16_f32 v91, v86, v87
    v_mfma_f32_16x16x32_bf16 v[160:163], a[176:179], v[16:19], v[160:163]
    ds_read_b64_tr_b16 a[148:149], v134 offset:40960
    ds_read_b64_tr_b16 a[150:151], v134 offset:45056
    buffer_store_dwordx4 v[88:91], v14, s[20:23], s39 offen offset:0 sc1
    v_mfma_f32_16x16x32_bf16 v[188:191], a[176:179], v[20:23], v[188:191]
    v_accvgpr_read_b32 v92, a40
    v_mfma_f32_16x16x32_bf16 v[164:167], a[180:183], v[16:19], v[164:167]
    ds_read_b64_tr_b16 a[152:153], v135 offset:40960
    ds_read_b64_tr_b16 a[154:155], v135 offset:45056
    v_accvgpr_read_b32 v93, a41
    v_mfma_f32_16x16x32_bf16 v[192:195], a[180:183], v[20:23], v[192:195]
    s_lshl_b32 s63, s43, 7
    s_add_u32 s63, s63, 36716544
    buffer_load_dwordx2 v[210:211], v2, s[20:23], s63 offen offset:0 sc1
    v_accvgpr_read_b32 v94, a42
    s_waitcnt lgkmcnt(12)
    v_mfma_f32_16x16x32_bf16 v[168:171], a[184:187], v[16:19], v[168:171]
    ds_read_b64_tr_b16 a[156:157], v136 offset:40960
    ds_read_b64_tr_b16 a[158:159], v136 offset:45056
    v_accvgpr_read_b32 v95, a43
    v_mfma_f32_16x16x32_bf16 v[196:199], a[184:187], v[20:23], v[196:199]
    v_accvgpr_read_b32 v96, a44
    v_mfma_f32_16x16x32_bf16 v[200:203], a[188:191], v[10:13], v[200:203]
    ds_read_b64_tr_b16 a[160:161], v142 offset:40960
    ds_read_b64_tr_b16 a[162:163], v142 offset:45056
    v_accvgpr_read_b32 v97, a45
    v_mfma_f32_16x16x32_bf16 v[204:207], a[128:131], v[10:13], v[204:207]
    ds_read_b64_tr_b16 a[164:165], v143 offset:40960
    ds_read_b64_tr_b16 a[166:167], v143 offset:45056
    v_accvgpr_read_b32 v98, a46
    s_waitcnt lgkmcnt(12)
    v_mfma_f32_16x16x32_bf16 v[144:147], a[132:135], v[24:27], v[144:147]
    ds_read_b64_tr_b16 a[168:169], v242 offset:32768
    ds_read_b64_tr_b16 a[170:171], v242 offset:36864
    v_accvgpr_read_b32 v99, a47
    v_mfma_f32_16x16x32_bf16 v[172:175], a[132:135], v[28:31], v[172:175]
    v_mul_f32 v92, v92, v225
    v_mfma_f32_16x16x32_bf16 v[148:151], a[136:139], v[24:27], v[148:151]
    ds_read_b64_tr_b16 a[172:173], v243 offset:32768
    ds_read_b64_tr_b16 a[174:175], v243 offset:36864
    v_mul_f32 v93, v93, v225
    v_mfma_f32_16x16x32_bf16 v[176:179], a[136:139], v[28:31], v[176:179]
    s_lshl_b32 s63, s43, 7
    s_add_u32 s63, s63, 36716544
    buffer_load_dwordx2 v[218:219], v2, s[20:23], s63 offen offset:128 sc1
    v_mul_f32 v94, v94, v225
    v_mfma_f32_16x16x32_bf16 v[152:155], a[140:143], v[24:27], v[152:155]
    ds_read_b64_tr_b16 a[176:177], v244 offset:32768
    ds_read_b64_tr_b16 a[178:179], v244 offset:36864
    v_mul_f32 v95, v95, v225
    v_mfma_f32_16x16x32_bf16 v[180:183], a[140:143], v[28:31], v[180:183]
    v_mul_f32 v96, v96, v225
    s_waitcnt lgkmcnt(12)
    v_mfma_f32_16x16x32_bf16 v[156:159], a[144:147], v[24:27], v[156:159]
    ds_read_b64_tr_b16 a[180:181], v245 offset:32768
    ds_read_b64_tr_b16 a[182:183], v245 offset:36864
    v_mul_f32 v97, v97, v225
    v_mfma_f32_16x16x32_bf16 v[184:187], a[144:147], v[28:31], v[184:187]
    s_lshl_b32 s63, s43, 7
    s_add_u32 s63, s63, 36732928
    buffer_load_dwordx2 v[212:213], v2, s[20:23], s63 offen offset:0 sc1
    v_mul_f32 v98, v98, v225
    v_mfma_f32_16x16x32_bf16 v[160:163], a[148:151], v[24:27], v[160:163]
    ds_read_b64_tr_b16 a[184:185], v246 offset:32768
    ds_read_b64_tr_b16 a[186:187], v246 offset:36864
    v_mul_f32 v99, v99, v225
    v_mfma_f32_16x16x32_bf16 v[188:191], a[148:151], v[28:31], v[188:191]
    v_cvt_pk_bf16_f32 v100, v92, v93
    v_mfma_f32_16x16x32_bf16 v[164:167], a[152:155], v[24:27], v[164:167]
    ds_read_b64_tr_b16 a[188:189], v247 offset:32768
    ds_read_b64_tr_b16 a[190:191], v247 offset:36864
    v_cvt_pk_bf16_f32 v101, v94, v95
    v_mfma_f32_16x16x32_bf16 v[192:195], a[152:155], v[28:31], v[192:195]
    s_lshl_b32 s63, s43, 7
    s_add_u32 s63, s63, 36732928
    buffer_load_dwordx2 v[220:221], v2, s[20:23], s63 offen offset:128 sc1
    v_cvt_pk_bf16_f32 v102, v96, v97
    s_waitcnt lgkmcnt(12)
    v_mfma_f32_16x16x32_bf16 v[168:171], a[156:159], v[24:27], v[168:171]
    ds_read_b64_tr_b16 a[128:129], v248 offset:32768
    ds_read_b64_tr_b16 a[130:131], v248 offset:36864
    v_cvt_pk_bf16_f32 v103, v98, v99
    v_mfma_f32_16x16x32_bf16 v[196:199], a[156:159], v[28:31], v[196:199]
    buffer_store_dwordx4 v[100:103], v14, s[20:23], s39 offen offset:1024 sc1
    v_mfma_f32_16x16x32_bf16 v[200:203], a[160:163], v[10:13], v[200:203]
    ds_read_b64_tr_b16 a[132:133], v140 offset:32768
    ds_read_b64_tr_b16 a[134:135], v140 offset:36864
    v_accvgpr_read_b32 v104, a48
    v_mfma_f32_16x16x32_bf16 v[204:207], a[164:167], v[10:13], v[204:207]
    ds_read_b64_tr_b16 a[136:137], v141 offset:32768
    ds_read_b64_tr_b16 a[138:139], v141 offset:36864
    v_accvgpr_read_b32 v105, a49
    s_waitcnt vmcnt(18)
    s_waitcnt lgkmcnt(12)
    v_mfma_f32_16x16x32_bf16 v[144:147], a[168:171], v[32:35], v[144:147]
    ds_read_b64_tr_b16 a[140:141], v242 offset:40960
    ds_read_b64_tr_b16 a[142:143], v242 offset:45056
    v_accvgpr_read_b32 v106, a50
    v_mfma_f32_16x16x32_bf16 v[172:175], a[168:171], v[36:39], v[172:175]
    v_accvgpr_read_b32 v107, a51
    v_mfma_f32_16x16x32_bf16 v[148:151], a[172:175], v[32:35], v[148:151]
    ds_read_b64_tr_b16 a[144:145], v243 offset:40960
    ds_read_b64_tr_b16 a[146:147], v243 offset:45056
    v_accvgpr_read_b32 v108, a52
    v_mfma_f32_16x16x32_bf16 v[176:179], a[172:175], v[36:39], v[176:179]
    s_lshl_b32 s63, s43, 7
    s_add_u32 s63, s63, 36749312
    buffer_load_dwordx2 v[214:215], v2, s[20:23], s63 offen offset:0 sc1
    v_accvgpr_read_b32 v109, a53
    v_mfma_f32_16x16x32_bf16 v[152:155], a[176:179], v[32:35], v[152:155]
    ds_read_b64_tr_b16 a[148:149], v244 offset:40960
    ds_read_b64_tr_b16 a[150:151], v244 offset:45056
    v_accvgpr_read_b32 v110, a54
    v_mfma_f32_16x16x32_bf16 v[180:183], a[176:179], v[36:39], v[180:183]
    v_accvgpr_read_b32 v111, a55
    s_waitcnt lgkmcnt(12)
    v_mfma_f32_16x16x32_bf16 v[156:159], a[180:183], v[32:35], v[156:159]
    ds_read_b64_tr_b16 a[152:153], v245 offset:40960
    ds_read_b64_tr_b16 a[154:155], v245 offset:45056
    v_mul_f32 v104, v104, v225
    v_mfma_f32_16x16x32_bf16 v[184:187], a[180:183], v[36:39], v[184:187]
    s_lshl_b32 s63, s43, 7
    s_add_u32 s63, s63, 36749312
    buffer_load_dwordx2 v[222:223], v2, s[20:23], s63 offen offset:128 sc1
    v_mul_f32 v105, v105, v225
    v_mfma_f32_16x16x32_bf16 v[160:163], a[184:187], v[32:35], v[160:163]
    ds_read_b64_tr_b16 a[156:157], v246 offset:40960
    ds_read_b64_tr_b16 a[158:159], v246 offset:45056
    v_mul_f32 v106, v106, v225
    v_mfma_f32_16x16x32_bf16 v[188:191], a[184:187], v[36:39], v[188:191]
    v_mul_f32 v107, v107, v225
    v_mfma_f32_16x16x32_bf16 v[164:167], a[188:191], v[32:35], v[164:167]
    ds_read_b64_tr_b16 a[160:161], v247 offset:40960
    ds_read_b64_tr_b16 a[162:163], v247 offset:45056
    v_mul_f32 v108, v108, v225
    v_mfma_f32_16x16x32_bf16 v[192:195], a[188:191], v[36:39], v[192:195]
    v_mul_f32 v109, v109, v225
    s_waitcnt lgkmcnt(12)
    v_mfma_f32_16x16x32_bf16 v[168:171], a[128:131], v[32:35], v[168:171]
    ds_read_b64_tr_b16 a[164:165], v248 offset:40960
    ds_read_b64_tr_b16 a[166:167], v248 offset:45056
    v_mul_f32 v110, v110, v225
    v_mfma_f32_16x16x32_bf16 v[196:199], a[128:131], v[36:39], v[196:199]
    v_mul_f32 v111, v111, v225
    v_mfma_f32_16x16x32_bf16 v[200:203], a[132:135], v[10:13], v[200:203]
    ds_read_b64_tr_b16 a[168:169], v140 offset:40960
    ds_read_b64_tr_b16 a[170:171], v140 offset:45056
    v_cvt_pk_bf16_f32 v112, v104, v105
    v_mfma_f32_16x16x32_bf16 v[204:207], a[136:139], v[10:13], v[204:207]
    ds_read_b64_tr_b16 a[172:173], v141 offset:40960
    ds_read_b64_tr_b16 a[174:175], v141 offset:45056
    v_cvt_pk_bf16_f32 v113, v106, v107
    s_waitcnt lgkmcnt(12)
    v_mfma_f32_16x16x32_bf16 v[144:147], a[140:143], v[40:43], v[144:147]
    s_barrier
    ds_read_b64_tr_b16 a[176:177], v130 offset:49152
    ds_read_b64_tr_b16 a[178:179], v130 offset:53248
    v_cvt_pk_bf16_f32 v114, v108, v109
    v_mfma_f32_16x16x32_bf16 v[172:175], a[140:143], v[44:47], v[172:175]
    v_cvt_pk_bf16_f32 v115, v110, v111
    v_mfma_f32_16x16x32_bf16 v[148:151], a[144:147], v[40:43], v[148:151]
    ds_read_b64_tr_b16 a[180:181], v131 offset:49152
    ds_read_b64_tr_b16 a[182:183], v131 offset:53248
    buffer_store_dwordx4 v[112:115], v14, s[20:23], s39 offen offset:2048 sc1
    v_mfma_f32_16x16x32_bf16 v[176:179], a[144:147], v[44:47], v[176:179]
    v_accvgpr_read_b32 v116, a56
    v_mfma_f32_16x16x32_bf16 v[152:155], a[148:151], v[40:43], v[152:155]
    ds_read_b64_tr_b16 a[184:185], v132 offset:49152
    ds_read_b64_tr_b16 a[186:187], v132 offset:53248
    v_accvgpr_read_b32 v117, a57
    v_mfma_f32_16x16x32_bf16 v[180:183], a[148:151], v[44:47], v[180:183]
    v_accvgpr_read_b32 v118, a58
    s_waitcnt lgkmcnt(12)
    v_mfma_f32_16x16x32_bf16 v[156:159], a[152:155], v[40:43], v[156:159]
    ds_read_b64_tr_b16 a[188:189], v133 offset:49152
    ds_read_b64_tr_b16 a[190:191], v133 offset:53248
    v_accvgpr_read_b32 v119, a59
    v_mfma_f32_16x16x32_bf16 v[184:187], a[152:155], v[44:47], v[184:187]
    v_accvgpr_read_b32 v120, a60
    v_mfma_f32_16x16x32_bf16 v[160:163], a[156:159], v[40:43], v[160:163]
    ds_read_b64_tr_b16 a[128:129], v134 offset:49152
    ds_read_b64_tr_b16 a[130:131], v134 offset:53248
    v_accvgpr_read_b32 v121, a61
    v_mfma_f32_16x16x32_bf16 v[188:191], a[156:159], v[44:47], v[188:191]
    v_accvgpr_read_b32 v122, a62
    v_mfma_f32_16x16x32_bf16 v[164:167], a[160:163], v[40:43], v[164:167]
    ds_read_b64_tr_b16 a[132:133], v135 offset:49152
    ds_read_b64_tr_b16 a[134:135], v135 offset:53248
    v_accvgpr_read_b32 v123, a63
    v_mfma_f32_16x16x32_bf16 v[192:195], a[160:163], v[44:47], v[192:195]
    v_mul_f32 v116, v116, v225
    s_waitcnt lgkmcnt(12)
    v_mfma_f32_16x16x32_bf16 v[168:171], a[164:167], v[40:43], v[168:171]
    ds_read_b64_tr_b16 a[136:137], v136 offset:49152
    ds_read_b64_tr_b16 a[138:139], v136 offset:53248
    v_mul_f32 v117, v117, v225
    v_mfma_f32_16x16x32_bf16 v[196:199], a[164:167], v[44:47], v[196:199]
    v_mul_f32 v118, v118, v225
    v_mfma_f32_16x16x32_bf16 v[200:203], a[168:171], v[10:13], v[200:203]
    ds_read_b64_tr_b16 a[140:141], v142 offset:49152
    ds_read_b64_tr_b16 a[142:143], v142 offset:53248
    v_mul_f32 v119, v119, v225
    v_mfma_f32_16x16x32_bf16 v[204:207], a[172:175], v[10:13], v[204:207]
    ds_read_b64_tr_b16 a[144:145], v143 offset:49152
    ds_read_b64_tr_b16 a[146:147], v143 offset:53248
    v_mul_f32 v120, v120, v225
    s_waitcnt vmcnt(16)
    s_waitcnt lgkmcnt(12)
    v_mfma_f32_16x16x32_bf16 v[144:147], a[176:179], v[48:51], v[144:147]
    ds_read_b64_tr_b16 a[148:149], v130 offset:57344
    ds_read_b64_tr_b16 a[150:151], v130 offset:61440
    v_mul_f32 v121, v121, v225
    v_mfma_f32_16x16x32_bf16 v[172:175], a[176:179], v[52:55], v[172:175]
    v_mul_f32 v122, v122, v225
    v_mfma_f32_16x16x32_bf16 v[148:151], a[180:183], v[48:51], v[148:151]
    ds_read_b64_tr_b16 a[152:153], v131 offset:57344
    ds_read_b64_tr_b16 a[154:155], v131 offset:61440
    v_mul_f32 v123, v123, v225
    v_mfma_f32_16x16x32_bf16 v[176:179], a[180:183], v[52:55], v[176:179]
    v_cvt_pk_bf16_f32 v124, v116, v117
    v_mfma_f32_16x16x32_bf16 v[152:155], a[184:187], v[48:51], v[152:155]
    ds_read_b64_tr_b16 a[156:157], v132 offset:57344
    ds_read_b64_tr_b16 a[158:159], v132 offset:61440
    v_cvt_pk_bf16_f32 v125, v118, v119
    v_mfma_f32_16x16x32_bf16 v[180:183], a[184:187], v[52:55], v[180:183]
    v_cvt_pk_bf16_f32 v126, v120, v121
    s_waitcnt lgkmcnt(12)
    v_mfma_f32_16x16x32_bf16 v[156:159], a[188:191], v[48:51], v[156:159]
    ds_read_b64_tr_b16 a[160:161], v133 offset:57344
    ds_read_b64_tr_b16 a[162:163], v133 offset:61440
    v_cvt_pk_bf16_f32 v127, v122, v123
    v_mfma_f32_16x16x32_bf16 v[184:187], a[188:191], v[52:55], v[184:187]
    buffer_store_dwordx4 v[124:127], v14, s[20:23], s39 offen offset:3072 sc1
    v_mfma_f32_16x16x32_bf16 v[160:163], a[128:131], v[48:51], v[160:163]
    ds_read_b64_tr_b16 a[164:165], v134 offset:57344
    ds_read_b64_tr_b16 a[166:167], v134 offset:61440
    s_lshl_b32 s39, s25, 12
    s_add_u32 s39, s39, 16777216
    s_mul_i32 s68, s60, 132096
    s_add_u32 s39, s39, s68
    v_accvgpr_read_b32 v80, a64
    v_mfma_f32_16x16x32_bf16 v[188:191], a[128:131], v[52:55], v[188:191]
    v_accvgpr_read_b32 v81, a65
    v_mfma_f32_16x16x32_bf16 v[164:167], a[132:135], v[48:51], v[164:167]
    ds_read_b64_tr_b16 a[168:169], v135 offset:57344
    ds_read_b64_tr_b16 a[170:171], v135 offset:61440
    v_accvgpr_read_b32 v82, a66
    v_mfma_f32_16x16x32_bf16 v[192:195], a[132:135], v[52:55], v[192:195]
    v_accvgpr_read_b32 v83, a67
    s_waitcnt lgkmcnt(12)
    v_mfma_f32_16x16x32_bf16 v[168:171], a[136:139], v[48:51], v[168:171]
    ds_read_b64_tr_b16 a[172:173], v136 offset:57344
    ds_read_b64_tr_b16 a[174:175], v136 offset:61440
    v_accvgpr_read_b32 v84, a68
    v_mfma_f32_16x16x32_bf16 v[196:199], a[136:139], v[52:55], v[196:199]
    v_accvgpr_read_b32 v85, a69
    v_mfma_f32_16x16x32_bf16 v[200:203], a[140:143], v[10:13], v[200:203]
    ds_read_b64_tr_b16 a[176:177], v142 offset:57344
    ds_read_b64_tr_b16 a[178:179], v142 offset:61440
    v_accvgpr_read_b32 v86, a70
    v_mfma_f32_16x16x32_bf16 v[204:207], a[144:147], v[10:13], v[204:207]
    ds_read_b64_tr_b16 a[180:181], v143 offset:57344
    ds_read_b64_tr_b16 a[182:183], v143 offset:61440
    v_accvgpr_read_b32 v87, a71
    s_waitcnt lgkmcnt(12)
    v_mfma_f32_16x16x32_bf16 v[144:147], a[148:151], v[56:59], v[144:147]
    ds_read_b64_tr_b16 a[184:185], v242 offset:49152
    ds_read_b64_tr_b16 a[186:187], v242 offset:53248
    v_mul_f32 v80, v80, v226
    v_mfma_f32_16x16x32_bf16 v[172:175], a[148:151], v[60:63], v[172:175]
    v_mul_f32 v81, v81, v226
    v_mfma_f32_16x16x32_bf16 v[148:151], a[152:155], v[56:59], v[148:151]
    ds_read_b64_tr_b16 a[188:189], v243 offset:49152
    ds_read_b64_tr_b16 a[190:191], v243 offset:53248
    v_mul_f32 v82, v82, v226
    v_mfma_f32_16x16x32_bf16 v[176:179], a[152:155], v[60:63], v[176:179]
    v_mul_f32 v83, v83, v226
    v_mfma_f32_16x16x32_bf16 v[152:155], a[156:159], v[56:59], v[152:155]
    ds_read_b64_tr_b16 a[128:129], v244 offset:49152
    ds_read_b64_tr_b16 a[130:131], v244 offset:53248
    v_mul_f32 v84, v84, v226
    v_mfma_f32_16x16x32_bf16 v[180:183], a[156:159], v[60:63], v[180:183]
    v_mul_f32 v85, v85, v226
    s_waitcnt lgkmcnt(12)
    v_mfma_f32_16x16x32_bf16 v[156:159], a[160:163], v[56:59], v[156:159]
    ds_read_b64_tr_b16 a[132:133], v245 offset:49152
    ds_read_b64_tr_b16 a[134:135], v245 offset:53248
    v_mul_f32 v86, v86, v226
    v_mfma_f32_16x16x32_bf16 v[184:187], a[160:163], v[60:63], v[184:187]
    v_mul_f32 v87, v87, v226
    v_mfma_f32_16x16x32_bf16 v[160:163], a[164:167], v[56:59], v[160:163]
    ds_read_b64_tr_b16 a[136:137], v246 offset:49152
    ds_read_b64_tr_b16 a[138:139], v246 offset:53248
    v_cvt_pk_bf16_f32 v88, v80, v81
    v_mfma_f32_16x16x32_bf16 v[188:191], a[164:167], v[60:63], v[188:191]
    v_cvt_pk_bf16_f32 v89, v82, v83
    v_mfma_f32_16x16x32_bf16 v[164:167], a[168:171], v[56:59], v[164:167]
    ds_read_b64_tr_b16 a[140:141], v247 offset:49152
    ds_read_b64_tr_b16 a[142:143], v247 offset:53248
    v_cvt_pk_bf16_f32 v90, v84, v85
    v_mfma_f32_16x16x32_bf16 v[192:195], a[168:171], v[60:63], v[192:195]
    v_cvt_pk_bf16_f32 v91, v86, v87
    s_waitcnt lgkmcnt(12)
    v_mfma_f32_16x16x32_bf16 v[168:171], a[172:175], v[56:59], v[168:171]
    ds_read_b64_tr_b16 a[144:145], v248 offset:49152
    ds_read_b64_tr_b16 a[146:147], v248 offset:53248
    buffer_store_dwordx4 v[88:91], v14, s[20:23], s39 offen offset:0 sc1
    v_mfma_f32_16x16x32_bf16 v[196:199], a[172:175], v[60:63], v[196:199]
    v_accvgpr_read_b32 v92, a72
    v_mfma_f32_16x16x32_bf16 v[200:203], a[176:179], v[10:13], v[200:203]
    ds_read_b64_tr_b16 a[148:149], v140 offset:49152
    ds_read_b64_tr_b16 a[150:151], v140 offset:53248
    v_accvgpr_read_b32 v93, a73
    v_mfma_f32_16x16x32_bf16 v[204:207], a[180:183], v[10:13], v[204:207]
    ds_read_b64_tr_b16 a[152:153], v141 offset:49152
    ds_read_b64_tr_b16 a[154:155], v141 offset:53248
    v_accvgpr_read_b32 v94, a74
    s_waitcnt vmcnt(13)
    s_waitcnt lgkmcnt(12)
    v_mfma_f32_16x16x32_bf16 v[144:147], a[184:187], v[64:67], v[144:147]
    ds_read_b64_tr_b16 a[156:157], v242 offset:57344
    ds_read_b64_tr_b16 a[158:159], v242 offset:61440
    v_accvgpr_read_b32 v95, a75
    v_mfma_f32_16x16x32_bf16 v[172:175], a[184:187], v[68:71], v[172:175]
    v_accvgpr_read_b32 v96, a76
    v_mfma_f32_16x16x32_bf16 v[148:151], a[188:191], v[64:67], v[148:151]
    ds_read_b64_tr_b16 a[160:161], v243 offset:57344
    ds_read_b64_tr_b16 a[162:163], v243 offset:61440
    v_accvgpr_read_b32 v97, a77
    v_mfma_f32_16x16x32_bf16 v[176:179], a[188:191], v[68:71], v[176:179]
    v_accvgpr_read_b32 v98, a78
    v_mfma_f32_16x16x32_bf16 v[152:155], a[128:131], v[64:67], v[152:155]
    ds_read_b64_tr_b16 a[164:165], v244 offset:57344
    ds_read_b64_tr_b16 a[166:167], v244 offset:61440
    v_accvgpr_read_b32 v99, a79
    v_mfma_f32_16x16x32_bf16 v[180:183], a[128:131], v[68:71], v[180:183]
    v_mul_f32 v92, v92, v226
    s_waitcnt lgkmcnt(12)
    v_mfma_f32_16x16x32_bf16 v[156:159], a[132:135], v[64:67], v[156:159]
    ds_read_b64_tr_b16 a[168:169], v245 offset:57344
    ds_read_b64_tr_b16 a[170:171], v245 offset:61440
    v_mul_f32 v93, v93, v226
    v_mfma_f32_16x16x32_bf16 v[184:187], a[132:135], v[68:71], v[184:187]
    v_mul_f32 v94, v94, v226
    v_mfma_f32_16x16x32_bf16 v[160:163], a[136:139], v[64:67], v[160:163]
    ds_read_b64_tr_b16 a[172:173], v246 offset:57344
    ds_read_b64_tr_b16 a[174:175], v246 offset:61440
    v_mul_f32 v95, v95, v226
    v_mfma_f32_16x16x32_bf16 v[188:191], a[136:139], v[68:71], v[188:191]
    v_mul_f32 v96, v96, v226
    v_mfma_f32_16x16x32_bf16 v[164:167], a[140:143], v[64:67], v[164:167]
    ds_read_b64_tr_b16 a[176:177], v247 offset:57344
    ds_read_b64_tr_b16 a[178:179], v247 offset:61440
    v_mul_f32 v97, v97, v226
    v_mfma_f32_16x16x32_bf16 v[192:195], a[140:143], v[68:71], v[192:195]
    v_mul_f32 v98, v98, v226
    s_waitcnt lgkmcnt(12)
    v_mfma_f32_16x16x32_bf16 v[168:171], a[144:147], v[64:67], v[168:171]
    ds_read_b64_tr_b16 a[180:181], v248 offset:57344
    ds_read_b64_tr_b16 a[182:183], v248 offset:61440
    v_mul_f32 v99, v99, v226
    v_mfma_f32_16x16x32_bf16 v[196:199], a[144:147], v[68:71], v[196:199]
    v_cvt_pk_bf16_f32 v100, v92, v93
    v_mfma_f32_16x16x32_bf16 v[200:203], a[148:151], v[10:13], v[200:203]
    ds_read_b64_tr_b16 a[184:185], v140 offset:57344
    ds_read_b64_tr_b16 a[186:187], v140 offset:61440
    v_cvt_pk_bf16_f32 v101, v94, v95
    v_mfma_f32_16x16x32_bf16 v[204:207], a[152:155], v[10:13], v[204:207]
    ds_read_b64_tr_b16 a[188:189], v141 offset:57344
    ds_read_b64_tr_b16 a[190:191], v141 offset:61440
    v_cvt_pk_bf16_f32 v102, v96, v97
    s_waitcnt lgkmcnt(12)
    v_mfma_f32_16x16x32_bf16 v[144:147], a[156:159], v[72:75], v[144:147]
    v_cvt_pk_bf16_f32 v103, v98, v99
    v_mfma_f32_16x16x32_bf16 v[172:175], a[156:159], v[76:79], v[172:175]
    buffer_store_dwordx4 v[100:103], v14, s[20:23], s39 offen offset:1024 sc1
    v_mfma_f32_16x16x32_bf16 v[148:151], a[160:163], v[72:75], v[148:151]
    v_accvgpr_read_b32 v104, a80
    v_mfma_f32_16x16x32_bf16 v[176:179], a[160:163], v[76:79], v[176:179]
    v_accvgpr_read_b32 v105, a81
    v_mfma_f32_16x16x32_bf16 v[152:155], a[164:167], v[72:75], v[152:155]
    v_accvgpr_read_b32 v106, a82
    v_mfma_f32_16x16x32_bf16 v[180:183], a[164:167], v[76:79], v[180:183]
    v_accvgpr_read_b32 v107, a83
    s_waitcnt lgkmcnt(6)
    v_mfma_f32_16x16x32_bf16 v[156:159], a[168:171], v[72:75], v[156:159]
    v_accvgpr_read_b32 v108, a84
    v_mfma_f32_16x16x32_bf16 v[184:187], a[168:171], v[76:79], v[184:187]
    v_accvgpr_read_b32 v109, a85
    v_mfma_f32_16x16x32_bf16 v[160:163], a[172:175], v[72:75], v[160:163]
    v_accvgpr_read_b32 v110, a86
    v_mfma_f32_16x16x32_bf16 v[188:191], a[172:175], v[76:79], v[188:191]
    v_accvgpr_read_b32 v111, a87
    v_mfma_f32_16x16x32_bf16 v[164:167], a[176:179], v[72:75], v[164:167]
    v_mul_f32 v104, v104, v226
    v_mfma_f32_16x16x32_bf16 v[192:195], a[176:179], v[76:79], v[192:195]
    v_mul_f32 v105, v105, v226
    s_waitcnt lgkmcnt(0)
    v_mfma_f32_16x16x32_bf16 v[168:171], a[180:183], v[72:75], v[168:171]
    v_mul_f32 v106, v106, v226
    v_mfma_f32_16x16x32_bf16 v[196:199], a[180:183], v[76:79], v[196:199]
    v_mul_f32 v107, v107, v226
    v_mfma_f32_16x16x32_bf16 v[200:203], a[184:187], v[10:13], v[200:203]
    v_mul_f32 v108, v108, v226
    v_mfma_f32_16x16x32_bf16 v[204:207], a[188:191], v[10:13], v[204:207]
    v_mul_f32 v109, v109, v226
    v_mul_f32 v110, v110, v226
    v_mul_f32 v111, v111, v226
    v_cvt_pk_bf16_f32 v112, v104, v105
    v_cvt_pk_bf16_f32 v113, v106, v107
    v_cvt_pk_bf16_f32 v114, v108, v109
    v_cvt_pk_bf16_f32 v115, v110, v111
    buffer_store_dwordx4 v[112:115], v14, s[20:23], s39 offen offset:2048 sc1
    v_accvgpr_read_b32 v116, a88
    v_accvgpr_read_b32 v117, a89
    v_accvgpr_read_b32 v118, a90
    v_accvgpr_read_b32 v119, a91
    v_accvgpr_read_b32 v120, a92
    v_accvgpr_read_b32 v121, a93
    v_accvgpr_read_b32 v122, a94
    v_accvgpr_read_b32 v123, a95
    v_mul_f32 v116, v116, v226
    v_mul_f32 v117, v117, v226
    v_mul_f32 v118, v118, v226
    v_mul_f32 v119, v119, v226
    v_mul_f32 v120, v120, v226
    v_mul_f32 v121, v121, v226
    v_mul_f32 v122, v122, v226
    v_mul_f32 v123, v123, v226
    v_cvt_pk_bf16_f32 v124, v116, v117
    v_cvt_pk_bf16_f32 v125, v118, v119
    v_cvt_pk_bf16_f32 v126, v120, v121
    v_cvt_pk_bf16_f32 v127, v122, v123
    buffer_store_dwordx4 v[124:127], v14, s[20:23], s39 offen offset:3072 sc1
    s_lshl_b32 s39, s25, 12
    s_add_u32 s39, s39, 16909312
    s_mul_i32 s68, s60, 132096
    s_add_u32 s39, s39, s68
    v_accvgpr_read_b32 v80, a96
    v_accvgpr_read_b32 v81, a97
    v_accvgpr_read_b32 v82, a98
    v_accvgpr_read_b32 v83, a99
    v_accvgpr_read_b32 v84, a100
    v_accvgpr_read_b32 v85, a101
    v_accvgpr_read_b32 v86, a102
    v_accvgpr_read_b32 v87, a103
    v_mul_f32 v80, v80, v227
    v_mul_f32 v81, v81, v227
    v_mul_f32 v82, v82, v227
    v_mul_f32 v83, v83, v227
    v_mul_f32 v84, v84, v227
    v_mul_f32 v85, v85, v227
    v_mul_f32 v86, v86, v227
    v_mul_f32 v87, v87, v227
    v_cvt_pk_bf16_f32 v88, v80, v81
    v_cvt_pk_bf16_f32 v89, v82, v83
    v_cvt_pk_bf16_f32 v90, v84, v85
    v_cvt_pk_bf16_f32 v91, v86, v87
    buffer_store_dwordx4 v[88:91], v14, s[20:23], s39 offen offset:0 sc1
    v_accvgpr_read_b32 v92, a104
    v_accvgpr_read_b32 v93, a105
    v_accvgpr_read_b32 v94, a106
    v_accvgpr_read_b32 v95, a107
    v_accvgpr_read_b32 v96, a108
    v_accvgpr_read_b32 v97, a109
    v_accvgpr_read_b32 v98, a110
    v_accvgpr_read_b32 v99, a111
    v_mul_f32 v92, v92, v227
    v_mul_f32 v93, v93, v227
    v_mul_f32 v94, v94, v227
    v_mul_f32 v95, v95, v227
    v_mul_f32 v96, v96, v227
    v_mul_f32 v97, v97, v227
    v_mul_f32 v98, v98, v227
    v_mul_f32 v99, v99, v227
    v_cvt_pk_bf16_f32 v100, v92, v93
    v_cvt_pk_bf16_f32 v101, v94, v95
    v_cvt_pk_bf16_f32 v102, v96, v97
    v_cvt_pk_bf16_f32 v103, v98, v99
    buffer_store_dwordx4 v[100:103], v14, s[20:23], s39 offen offset:1024 sc1
    v_accvgpr_read_b32 v104, a112
    v_accvgpr_read_b32 v105, a113
    v_accvgpr_read_b32 v106, a114
    v_accvgpr_read_b32 v107, a115
    v_accvgpr_read_b32 v108, a116
    v_accvgpr_read_b32 v109, a117
    v_accvgpr_read_b32 v110, a118
    v_accvgpr_read_b32 v111, a119
    v_mul_f32 v104, v104, v227
    v_mul_f32 v105, v105, v227
    v_mul_f32 v106, v106, v227
    v_mul_f32 v107, v107, v227
    v_mul_f32 v108, v108, v227
    v_mul_f32 v109, v109, v227
    v_mul_f32 v110, v110, v227
    v_mul_f32 v111, v111, v227
    v_cvt_pk_bf16_f32 v112, v104, v105
    v_cvt_pk_bf16_f32 v113, v106, v107
    v_cvt_pk_bf16_f32 v114, v108, v109
    v_cvt_pk_bf16_f32 v115, v110, v111
    buffer_store_dwordx4 v[112:115], v14, s[20:23], s39 offen offset:2048 sc1
    v_accvgpr_read_b32 v116, a120
    v_accvgpr_read_b32 v117, a121
    v_accvgpr_read_b32 v118, a122
    v_accvgpr_read_b32 v119, a123
    v_accvgpr_read_b32 v120, a124
    v_accvgpr_read_b32 v121, a125
    v_accvgpr_read_b32 v122, a126
    v_accvgpr_read_b32 v123, a127
    v_mul_f32 v116, v116, v227
    v_mul_f32 v117, v117, v227
    v_mul_f32 v118, v118, v227
    v_mul_f32 v119, v119, v227
    v_mul_f32 v120, v120, v227
    v_mul_f32 v121, v121, v227
    v_mul_f32 v122, v122, v227
    v_mul_f32 v123, v123, v227
    v_cvt_pk_bf16_f32 v124, v116, v117
    v_cvt_pk_bf16_f32 v125, v118, v119
    v_cvt_pk_bf16_f32 v126, v120, v121
    v_cvt_pk_bf16_f32 v127, v122, v123
    buffer_store_dwordx4 v[124:127], v14, s[20:23], s39 offen offset:3072 sc1
    s_waitcnt vmcnt(10)
    v_add_f32 v208, v208, v210
    v_add_f32 v212, v212, v214
    v_add_f32 v208, v208, v212
    v_mov_b32 v0, v208
    s_nop 1
    v_permlane16_swap_b32 v208, v0
    s_nop 0
    v_add_f32 v208, v208, v0
    v_mov_b32 v0, v208
    s_nop 1
    v_permlane32_swap_b32 v208, v0
    s_nop 0
    v_add_f32 v208, v208, v0
    v_add_f32 v209, v209, v211
    v_add_f32 v213, v213, v215
    v_add_f32 v209, v209, v213
    v_mov_b32 v0, v209
    s_nop 1
    v_permlane16_swap_b32 v209, v0
    s_nop 0
    v_add_f32 v209, v209, v0
    v_mov_b32 v0, v209
    s_nop 1
    v_permlane32_swap_b32 v209, v0
    s_nop 0
    v_add_f32 v209, v209, v0
    v_mul_f32 v208, 0xbb000000, v208
    v_mul_f32 v209, 0x3b000000, v209
    v_fma_f32 v209, -v208, v208, v209
    v_max_f32 v209, 0, v209
    v_add_f32 v209, 0x3727c5ac, v209
    v_rsq_f32 v209, v209
    s_nop 0
    v_mul_f32 v214, v209, v209
    v_rcp_f32 v212, v209
    v_mul_f32 v214, v214, v209
    v_mul_f32 v210, 0xc0135761, v209
    v_mul_f32 v214, 0xbdd2d3e8, v214
    v_add_f32 v216, v216, v218
    v_add_f32 v220, v220, v222
    v_add_f32 v216, v216, v220
    v_mov_b32 v0, v216
    s_nop 1
    v_permlane16_swap_b32 v216, v0
    s_nop 0
    v_add_f32 v216, v216, v0
    v_mov_b32 v0, v216
    s_nop 1
    v_permlane32_swap_b32 v216, v0
    s_nop 0
    v_add_f32 v216, v216, v0
    v_add_f32 v217, v217, v219
    v_add_f32 v221, v221, v223
    v_add_f32 v217, v217, v221
    v_mov_b32 v0, v217
    s_nop 1
    v_permlane16_swap_b32 v217, v0
    s_nop 0
    v_add_f32 v217, v217, v0
    v_mov_b32 v0, v217
    s_nop 1
    v_permlane32_swap_b32 v217, v0
    s_nop 0
    v_add_f32 v217, v217, v0
    v_mul_f32 v216, 0xbb000000, v216
    v_mul_f32 v217, 0x3b000000, v217
    v_fma_f32 v217, -v216, v216, v217
    v_max_f32 v217, 0, v217
    v_add_f32 v217, 0x3727c5ac, v217
    v_rsq_f32 v217, v217
    s_nop 0
    v_mul_f32 v222, v217, v217
    v_rcp_f32 v220, v217
    v_mul_f32 v222, v222, v217
    v_mul_f32 v218, 0xc0135761, v217
    v_mul_f32 v222, 0xbdd2d3e8, v222
    s_lshl_b32 s35, s24, 11
    s_add_u32 s35, s35, 131072
    v_add_u32 v0, s35, v14
    v_add_u32 v1, 131072, v14
    ds_write_b128 v0, v[200:203] offset:0
    ds_write_b128 v0, v[204:207] offset:1024
    s_waitcnt lgkmcnt(0)
    s_barrier
    ds_read_b128 v[16:19], v1 offset:0
    ds_read_b128 v[20:23], v1 offset:1024
    ds_read_b128 v[24:27], v1 offset:2048
    ds_read_b128 v[28:31], v1 offset:3072
    ds_read_b128 v[32:35], v1 offset:4096
    ds_read_b128 v[36:39], v1 offset:5120
    ds_read_b128 v[40:43], v1 offset:6144
    s_mul_i32 s39, s43, 57344
    s_add_u32 s39, s39, 8388608
    s_mul_i32 s64, s42, 7
    s_add_u32 s63, s64, 0
    s_lshr_b32 s35, s63, 1
    s_lshl_b32 s35, s35, 10
    s_and_b32 s63, s63, 1
    s_lshl_b32 s63, s63, 3
    s_add_u32 s35, s35, s63
    s_add_u32 s35, s35, s39
    s_add_u32 s63, s64, 1
    s_lshr_b32 s36, s63, 1
    s_lshl_b32 s36, s36, 10
    s_and_b32 s63, s63, 1
    s_lshl_b32 s63, s63, 3
    s_add_u32 s36, s36, s63
    s_add_u32 s36, s36, s39
    s_waitcnt lgkmcnt(0)
    v_pk_fma_f32 v[144:145], v[208:209], v[16:17], v[144:145] op_sel:[0,0,0] op_sel_hi:[0,1,1]
    v_pk_fma_f32 v[146:147], v[208:209], v[18:19], v[146:147] op_sel:[0,0,0] op_sel_hi:[0,1,1]
    v_pk_fma_f32 v[148:149], v[208:209], v[20:21], v[148:149] op_sel:[0,0,0] op_sel_hi:[0,1,1]
    v_pk_fma_f32 v[150:151], v[208:209], v[22:23], v[150:151] op_sel:[0,0,0] op_sel_hi:[0,1,1]
    v_pk_fma_f32 v[152:153], v[208:209], v[24:25], v[152:153] op_sel:[0,0,0] op_sel_hi:[0,1,1]
    v_pk_fma_f32 v[154:155], v[208:209], v[26:27], v[154:155] op_sel:[0,0,0] op_sel_hi:[0,1,1]
    v_pk_fma_f32 v[156:157], v[208:209], v[28:29], v[156:157] op_sel:[0,0,0] op_sel_hi:[0,1,1]
    v_pk_fma_f32 v[158:159], v[208:209], v[30:31], v[158:159] op_sel:[0,0,0] op_sel_hi:[0,1,1]
    v_pk_mul_f32 v[48:49], v[144:145], v[144:145] op_sel:[0,0] op_sel_hi:[1,1]
    v_pk_mul_f32 v[50:51], v[146:147], v[146:147] op_sel:[0,0] op_sel_hi:[1,1]
    v_pk_mul_f32 v[52:53], v[148:149], v[148:149] op_sel:[0,0] op_sel_hi:[1,1]
    v_pk_mul_f32 v[54:55], v[150:151], v[150:151] op_sel:[0,0] op_sel_hi:[1,1]
    v_pk_mul_f32 v[56:57], v[152:153], v[152:153] op_sel:[0,0] op_sel_hi:[1,1]
    v_pk_mul_f32 v[58:59], v[154:155], v[154:155] op_sel:[0,0] op_sel_hi:[1,1]
    v_pk_mul_f32 v[60:61], v[156:157], v[156:157] op_sel:[0,0] op_sel_hi:[1,1]
    v_pk_mul_f32 v[62:63], v[158:159], v[158:159] op_sel:[0,0] op_sel_hi:[1,1]
    v_pk_fma_f32 v[48:49], v[48:49], v[214:215], v[210:211] op_sel:[0,0,0] op_sel_hi:[1,0,0]
    v_pk_fma_f32 v[50:51], v[50:51], v[214:215], v[210:211] op_sel:[0,0,0] op_sel_hi:[1,0,0]
    v_pk_fma_f32 v[52:53], v[52:53], v[214:215], v[210:211] op_sel:[0,0,0] op_sel_hi:[1,0,0]
    v_pk_fma_f32 v[54:55], v[54:55], v[214:215], v[210:211] op_sel:[0,0,0] op_sel_hi:[1,0,0]
    v_pk_fma_f32 v[56:57], v[56:57], v[214:215], v[210:211] op_sel:[0,0,0] op_sel_hi:[1,0,0]
    v_pk_fma_f32 v[58:59], v[58:59], v[214:215], v[210:211] op_sel:[0,0,0] op_sel_hi:[1,0,0]
    v_pk_fma_f32 v[60:61], v[60:61], v[214:215], v[210:211] op_sel:[0,0,0] op_sel_hi:[1,0,0]
    v_pk_fma_f32 v[62:63], v[62:63], v[214:215], v[210:211] op_sel:[0,0,0] op_sel_hi:[1,0,0]
    v_pk_mul_f32 v[48:49], v[48:49], v[144:145] op_sel:[0,0] op_sel_hi:[1,1]
    v_pk_mul_f32 v[50:51], v[50:51], v[146:147] op_sel:[0,0] op_sel_hi:[1,1]
    v_pk_mul_f32 v[52:53], v[52:53], v[148:149] op_sel:[0,0] op_sel_hi:[1,1]
    v_pk_mul_f32 v[54:55], v[54:55], v[150:151] op_sel:[0,0] op_sel_hi:[1,1]
    v_pk_mul_f32 v[56:57], v[56:57], v[152:153] op_sel:[0,0] op_sel_hi:[1,1]
    v_pk_mul_f32 v[58:59], v[58:59], v[154:155] op_sel:[0,0] op_sel_hi:[1,1]
    v_pk_mul_f32 v[60:61], v[60:61], v[156:157] op_sel:[0,0] op_sel_hi:[1,1]
    v_pk_mul_f32 v[62:63], v[62:63], v[158:159] op_sel:[0,0] op_sel_hi:[1,1]
    v_exp_f32 v48, v48
    v_exp_f32 v50, v50
    v_exp_f32 v52, v52
    v_exp_f32 v54, v54
    v_exp_f32 v56, v56
    v_exp_f32 v58, v58
    v_exp_f32 v60, v60
    v_exp_f32 v62, v62
    v_exp_f32 v49, v49
    v_exp_f32 v51, v51
    v_exp_f32 v53, v53
    v_exp_f32 v55, v55
    v_exp_f32 v57, v57
    v_exp_f32 v59, v59
    v_exp_f32 v61, v61
    v_exp_f32 v63, v63
    v_pk_fma_f32 v[48:49], v[48:49], v[212:213], v[212:213] op_sel:[0,0,0] op_sel_hi:[1,0,0]
    v_pk_fma_f32 v[50:51], v[50:51], v[212:213], v[212:213] op_sel:[0,0,0] op_sel_hi:[1,0,0]
    v_pk_fma_f32 v[52:53], v[52:53], v[212:213], v[212:213] op_sel:[0,0,0] op_sel_hi:[1,0,0]
    v_pk_fma_f32 v[54:55], v[54:55], v[212:213], v[212:213] op_sel:[0,0,0] op_sel_hi:[1,0,0]
    v_pk_fma_f32 v[56:57], v[56:57], v[212:213], v[212:213] op_sel:[0,0,0] op_sel_hi:[1,0,0]
    v_pk_fma_f32 v[58:59], v[58:59], v[212:213], v[212:213] op_sel:[0,0,0] op_sel_hi:[1,0,0]
    v_pk_fma_f32 v[60:61], v[60:61], v[212:213], v[212:213] op_sel:[0,0,0] op_sel_hi:[1,0,0]
    v_pk_fma_f32 v[62:63], v[62:63], v[212:213], v[212:213] op_sel:[0,0,0] op_sel_hi:[1,0,0]
    v_rcp_f32 v48, v48
    v_rcp_f32 v50, v50
    v_rcp_f32 v52, v52
    v_rcp_f32 v54, v54
    v_rcp_f32 v56, v56
    v_rcp_f32 v58, v58
    v_rcp_f32 v60, v60
    v_rcp_f32 v62, v62
    v_rcp_f32 v49, v49
    v_rcp_f32 v51, v51
    v_rcp_f32 v53, v53
    v_rcp_f32 v55, v55
    v_rcp_f32 v57, v57
    v_rcp_f32 v59, v59
    v_rcp_f32 v61, v61
    v_rcp_f32 v63, v63
    v_pk_mul_f32 v[144:145], v[144:145], v[48:49] op_sel:[0,0] op_sel_hi:[1,1]
    v_pk_mul_f32 v[146:147], v[146:147], v[50:51] op_sel:[0,0] op_sel_hi:[1,1]
    v_pk_mul_f32 v[148:149], v[148:149], v[52:53] op_sel:[0,0] op_sel_hi:[1,1]
    v_pk_mul_f32 v[150:151], v[150:151], v[54:55] op_sel:[0,0] op_sel_hi:[1,1]
    v_pk_mul_f32 v[152:153], v[152:153], v[56:57] op_sel:[0,0] op_sel_hi:[1,1]
    v_pk_mul_f32 v[154:155], v[154:155], v[58:59] op_sel:[0,0] op_sel_hi:[1,1]
    v_pk_mul_f32 v[156:157], v[156:157], v[60:61] op_sel:[0,0] op_sel_hi:[1,1]
    v_pk_mul_f32 v[158:159], v[158:159], v[62:63] op_sel:[0,0] op_sel_hi:[1,1]
    v_cvt_pk_bf16_f32 v104, v144, v145
    v_cvt_pk_bf16_f32 v105, v146, v147
    v_cvt_pk_bf16_f32 v106, v148, v149
    v_cvt_pk_bf16_f32 v107, v150, v151
    v_cvt_pk_bf16_f32 v108, v152, v153
    v_cvt_pk_bf16_f32 v109, v154, v155
    v_cvt_pk_bf16_f32 v110, v156, v157
    v_cvt_pk_bf16_f32 v111, v158, v159
    v_pk_fma_f32 v[160:161], v[208:209], v[32:33], v[160:161] op_sel:[0,0,0] op_sel_hi:[0,1,1]
    v_pk_fma_f32 v[162:163], v[208:209], v[34:35], v[162:163] op_sel:[0,0,0] op_sel_hi:[0,1,1]
    v_pk_fma_f32 v[164:165], v[208:209], v[36:37], v[164:165] op_sel:[0,0,0] op_sel_hi:[0,1,1]
    v_pk_fma_f32 v[166:167], v[208:209], v[38:39], v[166:167] op_sel:[0,0,0] op_sel_hi:[0,1,1]
    v_pk_fma_f32 v[168:169], v[208:209], v[40:41], v[168:169] op_sel:[0,0,0] op_sel_hi:[0,1,1]
    v_pk_fma_f32 v[170:171], v[208:209], v[42:43], v[170:171] op_sel:[0,0,0] op_sel_hi:[0,1,1]
    v_pk_mul_f32 v[64:65], v[160:161], v[160:161] op_sel:[0,0] op_sel_hi:[1,1]
    v_pk_mul_f32 v[66:67], v[162:163], v[162:163] op_sel:[0,0] op_sel_hi:[1,1]
    v_pk_mul_f32 v[68:69], v[164:165], v[164:165] op_sel:[0,0] op_sel_hi:[1,1]
    v_pk_mul_f32 v[70:71], v[166:167], v[166:167] op_sel:[0,0] op_sel_hi:[1,1]
    v_pk_mul_f32 v[72:73], v[168:169], v[168:169] op_sel:[0,0] op_sel_hi:[1,1]
    v_pk_mul_f32 v[74:75], v[170:171], v[170:171] op_sel:[0,0] op_sel_hi:[1,1]
    v_pk_fma_f32 v[64:65], v[64:65], v[214:215], v[210:211] op_sel:[0,0,0] op_sel_hi:[1,0,0]
    v_pk_fma_f32 v[66:67], v[66:67], v[214:215], v[210:211] op_sel:[0,0,0] op_sel_hi:[1,0,0]
    v_pk_fma_f32 v[68:69], v[68:69], v[214:215], v[210:211] op_sel:[0,0,0] op_sel_hi:[1,0,0]
    v_pk_fma_f32 v[70:71], v[70:71], v[214:215], v[210:211] op_sel:[0,0,0] op_sel_hi:[1,0,0]
    v_pk_fma_f32 v[72:73], v[72:73], v[214:215], v[210:211] op_sel:[0,0,0] op_sel_hi:[1,0,0]
    v_pk_fma_f32 v[74:75], v[74:75], v[214:215], v[210:211] op_sel:[0,0,0] op_sel_hi:[1,0,0]
    v_pk_mul_f32 v[64:65], v[64:65], v[160:161] op_sel:[0,0] op_sel_hi:[1,1]
    v_pk_mul_f32 v[66:67], v[66:67], v[162:163] op_sel:[0,0] op_sel_hi:[1,1]
    v_pk_mul_f32 v[68:69], v[68:69], v[164:165] op_sel:[0,0] op_sel_hi:[1,1]
    v_pk_mul_f32 v[70:71], v[70:71], v[166:167] op_sel:[0,0] op_sel_hi:[1,1]
    v_pk_mul_f32 v[72:73], v[72:73], v[168:169] op_sel:[0,0] op_sel_hi:[1,1]
    v_pk_mul_f32 v[74:75], v[74:75], v[170:171] op_sel:[0,0] op_sel_hi:[1,1]
    v_exp_f32 v64, v64
    v_exp_f32 v66, v66
    v_exp_f32 v68, v68
    v_exp_f32 v70, v70
    v_exp_f32 v72, v72
    v_exp_f32 v74, v74
    v_exp_f32 v65, v65
    v_exp_f32 v67, v67
    v_exp_f32 v69, v69
    v_exp_f32 v71, v71
    v_exp_f32 v73, v73
    v_exp_f32 v75, v75
    v_pk_fma_f32 v[64:65], v[64:65], v[212:213], v[212:213] op_sel:[0,0,0] op_sel_hi:[1,0,0]
    v_pk_fma_f32 v[66:67], v[66:67], v[212:213], v[212:213] op_sel:[0,0,0] op_sel_hi:[1,0,0]
    v_pk_fma_f32 v[68:69], v[68:69], v[212:213], v[212:213] op_sel:[0,0,0] op_sel_hi:[1,0,0]
    v_pk_fma_f32 v[70:71], v[70:71], v[212:213], v[212:213] op_sel:[0,0,0] op_sel_hi:[1,0,0]
    v_pk_fma_f32 v[72:73], v[72:73], v[212:213], v[212:213] op_sel:[0,0,0] op_sel_hi:[1,0,0]
    v_pk_fma_f32 v[74:75], v[74:75], v[212:213], v[212:213] op_sel:[0,0,0] op_sel_hi:[1,0,0]
    v_rcp_f32 v64, v64
    v_rcp_f32 v66, v66
    v_rcp_f32 v68, v68
    v_rcp_f32 v70, v70
    v_rcp_f32 v72, v72
    v_rcp_f32 v74, v74
    v_rcp_f32 v65, v65
    v_rcp_f32 v67, v67
    v_rcp_f32 v69, v69
    v_rcp_f32 v71, v71
    v_rcp_f32 v73, v73
    v_rcp_f32 v75, v75
    v_pk_mul_f32 v[160:161], v[160:161], v[64:65] op_sel:[0,0] op_sel_hi:[1,1]
    v_pk_mul_f32 v[162:163], v[162:163], v[66:67] op_sel:[0,0] op_sel_hi:[1,1]
    v_pk_mul_f32 v[164:165], v[164:165], v[68:69] op_sel:[0,0] op_sel_hi:[1,1]
    v_pk_mul_f32 v[166:167], v[166:167], v[70:71] op_sel:[0,0] op_sel_hi:[1,1]
    v_pk_mul_f32 v[168:169], v[168:169], v[72:73] op_sel:[0,0] op_sel_hi:[1,1]
    v_pk_mul_f32 v[170:171], v[170:171], v[74:75] op_sel:[0,0] op_sel_hi:[1,1]
    v_cvt_pk_bf16_f32 v112, v160, v161
    v_cvt_pk_bf16_f32 v113, v162, v163
    v_cvt_pk_bf16_f32 v114, v164, v165
    v_cvt_pk_bf16_f32 v115, v166, v167
    v_cvt_pk_bf16_f32 v116, v168, v169
    v_cvt_pk_bf16_f32 v117, v170, v171
    s_bitcmp1_b32 s42, 0
    s_cbranch_scc1 L_h2odd0
    buffer_store_dwordx4 v[104:107], v14, s[20:23], s35 offen offset:0 sc1
    buffer_store_dwordx4 v[108:111], v14, s[20:23], s35 offen offset:1024 sc1
    buffer_store_dwordx4 v[112:115], v14, s[20:23], s35 offen offset:2048 sc1
    buffer_store_dwordx2 v[116:117], v14, s[20:23], s35 offen offset:3072 sc1
    s_branch L_h2done0
L_h2odd0:
    buffer_store_dwordx2 v[104:105], v14, s[20:23], s35 offen sc1
    buffer_store_dwordx4 v[106:109], v14, s[20:23], s36 offen offset:0 sc1
    buffer_store_dwordx4 v[110:113], v14, s[20:23], s36 offen offset:1024 sc1
    buffer_store_dwordx4 v[114:117], v14, s[20:23], s36 offen offset:2048 sc1
L_h2done0:
    s_add_u32 s35, s35, 57344
    s_add_u32 s36, s36, 57344
    v_pk_fma_f32 v[172:173], v[216:217], v[16:17], v[172:173] op_sel:[0,0,0] op_sel_hi:[0,1,1]
    v_pk_fma_f32 v[174:175], v[216:217], v[18:19], v[174:175] op_sel:[0,0,0] op_sel_hi:[0,1,1]
    v_pk_fma_f32 v[176:177], v[216:217], v[20:21], v[176:177] op_sel:[0,0,0] op_sel_hi:[0,1,1]
    v_pk_fma_f32 v[178:179], v[216:217], v[22:23], v[178:179] op_sel:[0,0,0] op_sel_hi:[0,1,1]
    v_pk_fma_f32 v[180:181], v[216:217], v[24:25], v[180:181] op_sel:[0,0,0] op_sel_hi:[0,1,1]
    v_pk_fma_f32 v[182:183], v[216:217], v[26:27], v[182:183] op_sel:[0,0,0] op_sel_hi:[0,1,1]
    v_pk_fma_f32 v[184:185], v[216:217], v[28:29], v[184:185] op_sel:[0,0,0] op_sel_hi:[0,1,1]
    v_pk_fma_f32 v[186:187], v[216:217], v[30:31], v[186:187] op_sel:[0,0,0] op_sel_hi:[0,1,1]
    v_pk_mul_f32 v[76:77], v[172:173], v[172:173] op_sel:[0,0] op_sel_hi:[1,1]
    v_pk_mul_f32 v[78:79], v[174:175], v[174:175] op_sel:[0,0] op_sel_hi:[1,1]
    v_pk_mul_f32 v[80:81], v[176:177], v[176:177] op_sel:[0,0] op_sel_hi:[1,1]
    v_pk_mul_f32 v[82:83], v[178:179], v[178:179] op_sel:[0,0] op_sel_hi:[1,1]
    v_pk_mul_f32 v[84:85], v[180:181], v[180:181] op_sel:[0,0] op_sel_hi:[1,1]
    v_pk_mul_f32 v[86:87], v[182:183], v[182:183] op_sel:[0,0] op_sel_hi:[1,1]
    v_pk_mul_f32 v[88:89], v[184:185], v[184:185] op_sel:[0,0] op_sel_hi:[1,1]
    v_pk_mul_f32 v[90:91], v[186:187], v[186:187] op_sel:[0,0] op_sel_hi:[1,1]
    v_pk_fma_f32 v[76:77], v[76:77], v[222:223], v[218:219] op_sel:[0,0,0] op_sel_hi:[1,0,0]
    v_pk_fma_f32 v[78:79], v[78:79], v[222:223], v[218:219] op_sel:[0,0,0] op_sel_hi:[1,0,0]
    v_pk_fma_f32 v[80:81], v[80:81], v[222:223], v[218:219] op_sel:[0,0,0] op_sel_hi:[1,0,0]
    v_pk_fma_f32 v[82:83], v[82:83], v[222:223], v[218:219] op_sel:[0,0,0] op_sel_hi:[1,0,0]
    v_pk_fma_f32 v[84:85], v[84:85], v[222:223], v[218:219] op_sel:[0,0,0] op_sel_hi:[1,0,0]
    v_pk_fma_f32 v[86:87], v[86:87], v[222:223], v[218:219] op_sel:[0,0,0] op_sel_hi:[1,0,0]
    v_pk_fma_f32 v[88:89], v[88:89], v[222:223], v[218:219] op_sel:[0,0,0] op_sel_hi:[1,0,0]
    v_pk_fma_f32 v[90:91], v[90:91], v[222:223], v[218:219] op_sel:[0,0,0] op_sel_hi:[1,0,0]
    v_pk_mul_f32 v[76:77], v[76:77], v[172:173] op_sel:[0,0] op_sel_hi:[1,1]
    v_pk_mul_f32 v[78:79], v[78:79], v[174:175] op_sel:[0,0] op_sel_hi:[1,1]
    v_pk_mul_f32 v[80:81], v[80:81], v[176:177] op_sel:[0,0] op_sel_hi:[1,1]
    v_pk_mul_f32 v[82:83], v[82:83], v[178:179] op_sel:[0,0] op_sel_hi:[1,1]
    v_pk_mul_f32 v[84:85], v[84:85], v[180:181] op_sel:[0,0] op_sel_hi:[1,1]
    v_pk_mul_f32 v[86:87], v[86:87], v[182:183] op_sel:[0,0] op_sel_hi:[1,1]
    v_pk_mul_f32 v[88:89], v[88:89], v[184:185] op_sel:[0,0] op_sel_hi:[1,1]
    v_pk_mul_f32 v[90:91], v[90:91], v[186:187] op_sel:[0,0] op_sel_hi:[1,1]
    v_exp_f32 v76, v76
    v_exp_f32 v78, v78
    v_exp_f32 v80, v80
    v_exp_f32 v82, v82
    v_exp_f32 v84, v84
    v_exp_f32 v86, v86
    v_exp_f32 v88, v88
    v_exp_f32 v90, v90
    v_exp_f32 v77, v77
    v_exp_f32 v79, v79
    v_exp_f32 v81, v81
    v_exp_f32 v83, v83
    v_exp_f32 v85, v85
    v_exp_f32 v87, v87
    v_exp_f32 v89, v89
    v_exp_f32 v91, v91
    v_pk_fma_f32 v[76:77], v[76:77], v[220:221], v[220:221] op_sel:[0,0,0] op_sel_hi:[1,0,0]
    v_pk_fma_f32 v[78:79], v[78:79], v[220:221], v[220:221] op_sel:[0,0,0] op_sel_hi:[1,0,0]
    v_pk_fma_f32 v[80:81], v[80:81], v[220:221], v[220:221] op_sel:[0,0,0] op_sel_hi:[1,0,0]
    v_pk_fma_f32 v[82:83], v[82:83], v[220:221], v[220:221] op_sel:[0,0,0] op_sel_hi:[1,0,0]
    v_pk_fma_f32 v[84:85], v[84:85], v[220:221], v[220:221] op_sel:[0,0,0] op_sel_hi:[1,0,0]
    v_pk_fma_f32 v[86:87], v[86:87], v[220:221], v[220:221] op_sel:[0,0,0] op_sel_hi:[1,0,0]
    v_pk_fma_f32 v[88:89], v[88:89], v[220:221], v[220:221] op_sel:[0,0,0] op_sel_hi:[1,0,0]
    v_pk_fma_f32 v[90:91], v[90:91], v[220:221], v[220:221] op_sel:[0,0,0] op_sel_hi:[1,0,0]
    v_rcp_f32 v76, v76
    v_rcp_f32 v78, v78
    v_rcp_f32 v80, v80
    v_rcp_f32 v82, v82
    v_rcp_f32 v84, v84
    v_rcp_f32 v86, v86
    v_rcp_f32 v88, v88
    v_rcp_f32 v90, v90
    v_rcp_f32 v77, v77
    v_rcp_f32 v79, v79
    v_rcp_f32 v81, v81
    v_rcp_f32 v83, v83
    v_rcp_f32 v85, v85
    v_rcp_f32 v87, v87
    v_rcp_f32 v89, v89
    v_rcp_f32 v91, v91
    v_pk_mul_f32 v[172:173], v[172:173], v[76:77] op_sel:[0,0] op_sel_hi:[1,1]
    v_pk_mul_f32 v[174:175], v[174:175], v[78:79] op_sel:[0,0] op_sel_hi:[1,1]
    v_pk_mul_f32 v[176:177], v[176:177], v[80:81] op_sel:[0,0] op_sel_hi:[1,1]
    v_pk_mul_f32 v[178:179], v[178:179], v[82:83] op_sel:[0,0] op_sel_hi:[1,1]
    v_pk_mul_f32 v[180:181], v[180:181], v[84:85] op_sel:[0,0] op_sel_hi:[1,1]
    v_pk_mul_f32 v[182:183], v[182:183], v[86:87] op_sel:[0,0] op_sel_hi:[1,1]
    v_pk_mul_f32 v[184:185], v[184:185], v[88:89] op_sel:[0,0] op_sel_hi:[1,1]
    v_pk_mul_f32 v[186:187], v[186:187], v[90:91] op_sel:[0,0] op_sel_hi:[1,1]
    v_cvt_pk_bf16_f32 v118, v172, v173
    v_cvt_pk_bf16_f32 v119, v174, v175
    v_cvt_pk_bf16_f32 v120, v176, v177
    v_cvt_pk_bf16_f32 v121, v178, v179
    v_cvt_pk_bf16_f32 v122, v180, v181
    v_cvt_pk_bf16_f32 v123, v182, v183
    v_cvt_pk_bf16_f32 v124, v184, v185
    v_cvt_pk_bf16_f32 v125, v186, v187
    v_pk_fma_f32 v[188:189], v[216:217], v[32:33], v[188:189] op_sel:[0,0,0] op_sel_hi:[0,1,1]
    v_pk_fma_f32 v[190:191], v[216:217], v[34:35], v[190:191] op_sel:[0,0,0] op_sel_hi:[0,1,1]
    v_pk_fma_f32 v[192:193], v[216:217], v[36:37], v[192:193] op_sel:[0,0,0] op_sel_hi:[0,1,1]
    v_pk_fma_f32 v[194:195], v[216:217], v[38:39], v[194:195] op_sel:[0,0,0] op_sel_hi:[0,1,1]
    v_pk_fma_f32 v[196:197], v[216:217], v[40:41], v[196:197] op_sel:[0,0,0] op_sel_hi:[0,1,1]
    v_pk_fma_f32 v[198:199], v[216:217], v[42:43], v[198:199] op_sel:[0,0,0] op_sel_hi:[0,1,1]
    v_pk_mul_f32 v[92:93], v[188:189], v[188:189] op_sel:[0,0] op_sel_hi:[1,1]
    v_pk_mul_f32 v[94:95], v[190:191], v[190:191] op_sel:[0,0] op_sel_hi:[1,1]
    v_pk_mul_f32 v[96:97], v[192:193], v[192:193] op_sel:[0,0] op_sel_hi:[1,1]
    v_pk_mul_f32 v[98:99], v[194:195], v[194:195] op_sel:[0,0] op_sel_hi:[1,1]
    v_pk_mul_f32 v[100:101], v[196:197], v[196:197] op_sel:[0,0] op_sel_hi:[1,1]
    v_pk_mul_f32 v[102:103], v[198:199], v[198:199] op_sel:[0,0] op_sel_hi:[1,1]
    v_pk_fma_f32 v[92:93], v[92:93], v[222:223], v[218:219] op_sel:[0,0,0] op_sel_hi:[1,0,0]
    v_pk_fma_f32 v[94:95], v[94:95], v[222:223], v[218:219] op_sel:[0,0,0] op_sel_hi:[1,0,0]
    v_pk_fma_f32 v[96:97], v[96:97], v[222:223], v[218:219] op_sel:[0,0,0] op_sel_hi:[1,0,0]
    v_pk_fma_f32 v[98:99], v[98:99], v[222:223], v[218:219] op_sel:[0,0,0] op_sel_hi:[1,0,0]
    v_pk_fma_f32 v[100:101], v[100:101], v[222:223], v[218:219] op_sel:[0,0,0] op_sel_hi:[1,0,0]
    v_pk_fma_f32 v[102:103], v[102:103], v[222:223], v[218:219] op_sel:[0,0,0] op_sel_hi:[1,0,0]
    v_pk_mul_f32 v[92:93], v[92:93], v[188:189] op_sel:[0,0] op_sel_hi:[1,1]
    v_pk_mul_f32 v[94:95], v[94:95], v[190:191] op_sel:[0,0] op_sel_hi:[1,1]
    v_pk_mul_f32 v[96:97], v[96:97], v[192:193] op_sel:[0,0] op_sel_hi:[1,1]
    v_pk_mul_f32 v[98:99], v[98:99], v[194:195] op_sel:[0,0] op_sel_hi:[1,1]
    v_pk_mul_f32 v[100:101], v[100:101], v[196:197] op_sel:[0,0] op_sel_hi:[1,1]
    v_pk_mul_f32 v[102:103], v[102:103], v[198:199] op_sel:[0,0] op_sel_hi:[1,1]
    v_exp_f32 v92, v92
    v_exp_f32 v94, v94
    v_exp_f32 v96, v96
    v_exp_f32 v98, v98
    v_exp_f32 v100, v100
    v_exp_f32 v102, v102
    v_exp_f32 v93, v93
    v_exp_f32 v95, v95
    v_exp_f32 v97, v97
    v_exp_f32 v99, v99
    v_exp_f32 v101, v101
    v_exp_f32 v103, v103
    v_pk_fma_f32 v[92:93], v[92:93], v[220:221], v[220:221] op_sel:[0,0,0] op_sel_hi:[1,0,0]
    v_pk_fma_f32 v[94:95], v[94:95], v[220:221], v[220:221] op_sel:[0,0,0] op_sel_hi:[1,0,0]
    v_pk_fma_f32 v[96:97], v[96:97], v[220:221], v[220:221] op_sel:[0,0,0] op_sel_hi:[1,0,0]
    v_pk_fma_f32 v[98:99], v[98:99], v[220:221], v[220:221] op_sel:[0,0,0] op_sel_hi:[1,0,0]
    v_pk_fma_f32 v[100:101], v[100:101], v[220:221], v[220:221] op_sel:[0,0,0] op_sel_hi:[1,0,0]
    v_pk_fma_f32 v[102:103], v[102:103], v[220:221], v[220:221] op_sel:[0,0,0] op_sel_hi:[1,0,0]
    v_rcp_f32 v92, v92
    v_rcp_f32 v94, v94
    v_rcp_f32 v96, v96
    v_rcp_f32 v98, v98
    v_rcp_f32 v100, v100
    v_rcp_f32 v102, v102
    v_rcp_f32 v93, v93
    v_rcp_f32 v95, v95
    v_rcp_f32 v97, v97
    v_rcp_f32 v99, v99
    v_rcp_f32 v101, v101
    v_rcp_f32 v103, v103
    v_pk_mul_f32 v[188:189], v[188:189], v[92:93] op_sel:[0,0] op_sel_hi:[1,1]
    v_pk_mul_f32 v[190:191], v[190:191], v[94:95] op_sel:[0,0] op_sel_hi:[1,1]
    v_pk_mul_f32 v[192:193], v[192:193], v[96:97] op_sel:[0,0] op_sel_hi:[1,1]
    v_pk_mul_f32 v[194:195], v[194:195], v[98:99] op_sel:[0,0] op_sel_hi:[1,1]
    v_pk_mul_f32 v[196:197], v[196:197], v[100:101] op_sel:[0,0] op_sel_hi:[1,1]
    v_pk_mul_f32 v[198:199], v[198:199], v[102:103] op_sel:[0,0] op_sel_hi:[1,1]
    v_cvt_pk_bf16_f32 v126, v188, v189
    v_cvt_pk_bf16_f32 v127, v190, v191
    v_cvt_pk_bf16_f32 v128, v192, v193
    v_cvt_pk_bf16_f32 v129, v194, v195
    v_cvt_pk_bf16_f32 v130, v196, v197
    v_cvt_pk_bf16_f32 v131, v198, v199
    s_bitcmp1_b32 s42, 0
    s_cbranch_scc1 L_h2odd1
    buffer_store_dwordx4 v[118:121], v14, s[20:23], s35 offen offset:0 sc1
    buffer_store_dwordx4 v[122:125], v14, s[20:23], s35 offen offset:1024 sc1
    buffer_store_dwordx4 v[126:129], v14, s[20:23], s35 offen offset:2048 sc1
    buffer_store_dwordx2 v[130:131], v14, s[20:23], s35 offen offset:3072 sc1
    s_branch L_h2done1
L_h2odd1:
    buffer_store_dwordx2 v[118:119], v14, s[20:23], s35 offen sc1
    buffer_store_dwordx4 v[120:123], v14, s[20:23], s36 offen offset:0 sc1
    buffer_store_dwordx4 v[124:127], v14, s[20:23], s36 offen offset:1024 sc1
    buffer_store_dwordx4 v[128:131], v14, s[20:23], s36 offen offset:2048 sc1
L_h2done1:
L_a_end:
    s_endpgm
L_tramp_1:
    s_call_b64 s[30:31], L_rare_0
    s_branch L_back_2
L_tramp_3:
    s_call_b64 s[30:31], L_rare_1
    s_branch L_back_4
L_tramp_5:
    s_call_b64 s[30:31], L_rare_0
    s_branch L_back_6
L_tramp_7:
    s_call_b64 s[30:31], L_rare_1
    s_branch L_back_8
L_tramp_9:
    s_call_b64 s[30:31], L_rare_0
    s_branch L_back_10
L_tramp_11:
    s_call_b64 s[30:31], L_rare_1
    s_branch L_back_12
L_tramp_13:
    s_call_b64 s[30:31], L_rare_0
    s_branch L_back_14
L_tramp_15:
    s_call_b64 s[30:31], L_rare_1
    s_branch L_back_16
L_tramp_17:
    s_call_b64 s[30:31], L_rare_0
    s_branch L_back_18
L_tramp_19:
    s_call_b64 s[30:31], L_rare_1
    s_branch L_back_20
L_tramp_21:
    s_call_b64 s[30:31], L_rare_0
    s_branch L_back_22
L_tramp_23:
    s_call_b64 s[30:31], L_rare_1
    s_branch L_back_24
L_tramp_25:
    s_call_b64 s[30:31], L_rare_0
    s_branch L_back_26
L_tramp_27:
    s_call_b64 s[30:31], L_rare_1
    s_branch L_back_28
L_tramp_29:
    s_call_b64 s[30:31], L_rare_0
    s_branch L_back_30
L_tramp_31:
    s_call_b64 s[30:31], L_rare_2
    s_branch L_back_32
L_rare_0:
    s_nop 15
    v_max3_f32 v230, v16, v17, v18
    v_max3_f32 v230, v230, v19, v20
    v_max3_f32 v230, v230, v21, v22
    v_max_f32 v230, v230, v23
    v_mov_b32 v231, v230
    s_nop 1
    v_permlane16_swap_b32 v230, v231
    s_nop 0
    v_max_f32 v230, v230, v231
    v_mov_b32 v231, v230
    s_nop 1
    v_permlane32_swap_b32 v230, v231
    s_nop 0
    v_max_f32 v230, v230, v231
    v_max_f32 v232, 0, v230
    v_exp_f32 v233, -v232
    v_sub_f32 v16, v16, v232
    v_sub_f32 v17, v17, v232
    v_sub_f32 v18, v18, v232
    v_sub_f32 v19, v19, v232
    v_sub_f32 v20, v20, v232
    v_sub_f32 v21, v21, v232
    v_sub_f32 v22, v22, v232
    v_sub_f32 v23, v23, v232
    v_sub_f32 v80, v80, v232
    v_sub_f32 v81, v81, v232
    v_sub_f32 v82, v82, v232
    v_sub_f32 v83, v83, v232
    v_sub_f32 v48, v48, v232
    v_sub_f32 v49, v49, v232
    v_sub_f32 v50, v50, v232
    v_sub_f32 v51, v51, v232
    v_sub_f32 v52, v52, v232
    v_sub_f32 v53, v53, v232
    v_sub_f32 v54, v54, v232
    v_sub_f32 v55, v55, v232
    v_mul_f32 v224, v224, v233
    v_accvgpr_read_b32 v234, a0
    v_accvgpr_read_b32 v235, a1
    v_accvgpr_read_b32 v236, a2
    v_accvgpr_read_b32 v237, a3
    v_mul_f32 v234, v234, v233
    v_mul_f32 v235, v235, v233
    v_mul_f32 v236, v236, v233
    v_mul_f32 v237, v237, v233
    v_accvgpr_write_b32 a0, v234
    v_accvgpr_write_b32 a1, v235
    v_accvgpr_write_b32 a2, v236
    v_accvgpr_write_b32 a3, v237
    v_accvgpr_read_b32 v234, a4
    v_accvgpr_read_b32 v235, a5
    v_accvgpr_read_b32 v236, a6
    v_accvgpr_read_b32 v237, a7
    v_mul_f32 v234, v234, v233
    v_mul_f32 v235, v235, v233
    v_mul_f32 v236, v236, v233
    v_mul_f32 v237, v237, v233
    v_accvgpr_write_b32 a4, v234
    v_accvgpr_write_b32 a5, v235
    v_accvgpr_write_b32 a6, v236
    v_accvgpr_write_b32 a7, v237
    v_accvgpr_read_b32 v234, a8
    v_accvgpr_read_b32 v235, a9
    v_accvgpr_read_b32 v236, a10
    v_accvgpr_read_b32 v237, a11
    v_mul_f32 v234, v234, v233
    v_mul_f32 v235, v235, v233
    v_mul_f32 v236, v236, v233
    v_mul_f32 v237, v237, v233
    v_accvgpr_write_b32 a8, v234
    v_accvgpr_write_b32 a9, v235
    v_accvgpr_write_b32 a10, v236
    v_accvgpr_write_b32 a11, v237
    v_accvgpr_read_b32 v234, a12
    v_accvgpr_read_b32 v235, a13
    v_accvgpr_read_b32 v236, a14
    v_accvgpr_read_b32 v237, a15
    v_mul_f32 v234, v234, v233
    v_mul_f32 v235, v235, v233
    v_mul_f32 v236, v236, v233
    v_mul_f32 v237, v237, v233
    v_accvgpr_write_b32 a12, v234
    v_accvgpr_write_b32 a13, v235
    v_accvgpr_write_b32 a14, v236
    v_accvgpr_write_b32 a15, v237
    v_accvgpr_read_b32 v234, a16
    v_accvgpr_read_b32 v235, a17
    v_accvgpr_read_b32 v236, a18
    v_accvgpr_read_b32 v237, a19
    v_mul_f32 v234, v234, v233
    v_mul_f32 v235, v235, v233
    v_mul_f32 v236, v236, v233
    v_mul_f32 v237, v237, v233
    v_accvgpr_write_b32 a16, v234
    v_accvgpr_write_b32 a17, v235
    v_accvgpr_write_b32 a18, v236
    v_accvgpr_write_b32 a19, v237
    v_accvgpr_read_b32 v234, a20
    v_accvgpr_read_b32 v235, a21
    v_accvgpr_read_b32 v236, a22
    v_accvgpr_read_b32 v237, a23
    v_mul_f32 v234, v234, v233
    v_mul_f32 v235, v235, v233
    v_mul_f32 v236, v236, v233
    v_mul_f32 v237, v237, v233
    v_accvgpr_write_b32 a20, v234
    v_accvgpr_write_b32 a21, v235
    v_accvgpr_write_b32 a22, v236
    v_accvgpr_write_b32 a23, v237
    v_accvgpr_read_b32 v234, a24
    v_accvgpr_read_b32 v235, a25
    v_accvgpr_read_b32 v236, a26
    v_accvgpr_read_b32 v237, a27
    v_mul_f32 v234, v234, v233
    v_mul_f32 v235, v235, v233
    v_mul_f32 v236, v236, v233
    v_mul_f32 v237, v237, v233
    v_accvgpr_write_b32 a24, v234
    v_accvgpr_write_b32 a25, v235
    v_accvgpr_write_b32 a26, v236
    v_accvgpr_write_b32 a27, v237
    v_accvgpr_read_b32 v234, a28
    v_accvgpr_read_b32 v235, a29
    v_accvgpr_read_b32 v236, a30
    v_accvgpr_read_b32 v237, a31
    v_mul_f32 v234, v234, v233
    v_mul_f32 v235, v235, v233
    v_mul_f32 v236, v236, v233
    v_mul_f32 v237, v237, v233
    v_accvgpr_write_b32 a28, v234
    v_accvgpr_write_b32 a29, v235
    v_accvgpr_write_b32 a30, v236
    v_accvgpr_write_b32 a31, v237
    v_max3_f32 v230, v24, v25, v26
    v_max3_f32 v230, v230, v27, v28
    v_max3_f32 v230, v230, v29, v30
    v_max_f32 v230, v230, v31
    v_mov_b32 v231, v230
    s_nop 1
    v_permlane16_swap_b32 v230, v231
    s_nop 0
    v_max_f32 v230, v230, v231
    v_mov_b32 v231, v230
    s_nop 1
    v_permlane32_swap_b32 v230, v231
    s_nop 0
    v_max_f32 v230, v230, v231
    v_max_f32 v232, 0, v230
    v_exp_f32 v233, -v232
    v_sub_f32 v24, v24, v232
    v_sub_f32 v25, v25, v232
    v_sub_f32 v26, v26, v232
    v_sub_f32 v27, v27, v232
    v_sub_f32 v28, v28, v232
    v_sub_f32 v29, v29, v232
    v_sub_f32 v30, v30, v232
    v_sub_f32 v31, v31, v232
    v_sub_f32 v84, v84, v232
    v_sub_f32 v85, v85, v232
    v_sub_f32 v86, v86, v232
    v_sub_f32 v87, v87, v232
    v_sub_f32 v56, v56, v232
    v_sub_f32 v57, v57, v232
    v_sub_f32 v58, v58, v232
    v_sub_f32 v59, v59, v232
    v_sub_f32 v60, v60, v232
    v_sub_f32 v61, v61, v232
    v_sub_f32 v62, v62, v232
    v_sub_f32 v63, v63, v232
    v_mul_f32 v225, v225, v233
    v_accvgpr_read_b32 v234, a32
    v_accvgpr_read_b32 v235, a33
    v_accvgpr_read_b32 v236, a34
    v_accvgpr_read_b32 v237, a35
    v_mul_f32 v234, v234, v233
    v_mul_f32 v235, v235, v233
    v_mul_f32 v236, v236, v233
    v_mul_f32 v237, v237, v233
    v_accvgpr_write_b32 a32, v234
    v_accvgpr_write_b32 a33, v235
    v_accvgpr_write_b32 a34, v236
    v_accvgpr_write_b32 a35, v237
    v_accvgpr_read_b32 v234, a36
    v_accvgpr_read_b32 v235, a37
    v_accvgpr_read_b32 v236, a38
    v_accvgpr_read_b32 v237, a39
    v_mul_f32 v234, v234, v233
    v_mul_f32 v235, v235, v233
    v_mul_f32 v236, v236, v233
    v_mul_f32 v237, v237, v233
    v_accvgpr_write_b32 a36, v234
    v_accvgpr_write_b32 a37, v235
    v_accvgpr_write_b32 a38, v236
    v_accvgpr_write_b32 a39, v237
    v_accvgpr_read_b32 v234, a40
    v_accvgpr_read_b32 v235, a41
    v_accvgpr_read_b32 v236, a42
    v_accvgpr_read_b32 v237, a43
    v_mul_f32 v234, v234, v233
    v_mul_f32 v235, v235, v233
    v_mul_f32 v236, v236, v233
    v_mul_f32 v237, v237, v233
    v_accvgpr_write_b32 a40, v234
    v_accvgpr_write_b32 a41, v235
    v_accvgpr_write_b32 a42, v236
    v_accvgpr_write_b32 a43, v237
    v_accvgpr_read_b32 v234, a44
    v_accvgpr_read_b32 v235, a45
    v_accvgpr_read_b32 v236, a46
    v_accvgpr_read_b32 v237, a47
    v_mul_f32 v234, v234, v233
    v_mul_f32 v235, v235, v233
    v_mul_f32 v236, v236, v233
    v_mul_f32 v237, v237, v233
    v_accvgpr_write_b32 a44, v234
    v_accvgpr_write_b32 a45, v235
    v_accvgpr_write_b32 a46, v236
    v_accvgpr_write_b32 a47, v237
    v_accvgpr_read_b32 v234, a48
    v_accvgpr_read_b32 v235, a49
    v_accvgpr_read_b32 v236, a50
    v_accvgpr_read_b32 v237, a51
    v_mul_f32 v234, v234, v233
    v_mul_f32 v235, v235, v233
    v_mul_f32 v236, v236, v233
    v_mul_f32 v237, v237, v233
    v_accvgpr_write_b32 a48, v234
    v_accvgpr_write_b32 a49, v235
    v_accvgpr_write_b32 a50, v236
    v_accvgpr_write_b32 a51, v237
    v_accvgpr_read_b32 v234, a52
    v_accvgpr_read_b32 v235, a53
    v_accvgpr_read_b32 v236, a54
    v_accvgpr_read_b32 v237, a55
    v_mul_f32 v234, v234, v233
    v_mul_f32 v235, v235, v233
    v_mul_f32 v236, v236, v233
    v_mul_f32 v237, v237, v233
    v_accvgpr_write_b32 a52, v234
    v_accvgpr_write_b32 a53, v235
    v_accvgpr_write_b32 a54, v236
    v_accvgpr_write_b32 a55, v237
    v_accvgpr_read_b32 v234, a56
    v_accvgpr_read_b32 v235, a57
    v_accvgpr_read_b32 v236, a58
    v_accvgpr_read_b32 v237, a59
    v_mul_f32 v234, v234, v233
    v_mul_f32 v235, v235, v233
    v_mul_f32 v236, v236, v233
    v_mul_f32 v237, v237, v233
    v_accvgpr_write_b32 a56, v234
    v_accvgpr_write_b32 a57, v235
    v_accvgpr_write_b32 a58, v236
    v_accvgpr_write_b32 a59, v237
    v_accvgpr_read_b32 v234, a60
    v_accvgpr_read_b32 v235, a61
    v_accvgpr_read_b32 v236, a62
    v_accvgpr_read_b32 v237, a63
    v_mul_f32 v234, v234, v233
    v_mul_f32 v235, v235, v233
    v_mul_f32 v236, v236, v233
    v_mul_f32 v237, v237, v233
    v_accvgpr_write_b32 a60, v234
    v_accvgpr_write_b32 a61, v235
    v_accvgpr_write_b32 a62, v236
    v_accvgpr_write_b32 a63, v237
    v_max3_f32 v230, v32, v33, v34
    v_max3_f32 v230, v230, v35, v36
    v_max3_f32 v230, v230, v37, v38
    v_max_f32 v230, v230, v39
    v_mov_b32 v231, v230
    s_nop 1
    v_permlane16_swap_b32 v230, v231
    s_nop 0
    v_max_f32 v230, v230, v231
    v_mov_b32 v231, v230
    s_nop 1
    v_permlane32_swap_b32 v230, v231
    s_nop 0
    v_max_f32 v230, v230, v231
    v_max_f32 v232, 0, v230
    v_exp_f32 v233, -v232
    v_sub_f32 v32, v32, v232
    v_sub_f32 v33, v33, v232
    v_sub_f32 v34, v34, v232
    v_sub_f32 v35, v35, v232
    v_sub_f32 v36, v36, v232
    v_sub_f32 v37, v37, v232
    v_sub_f32 v38, v38, v232
    v_sub_f32 v39, v39, v232
    v_sub_f32 v88, v88, v232
    v_sub_f32 v89, v89, v232
    v_sub_f32 v90, v90, v232
    v_sub_f32 v91, v91, v232
    v_sub_f32 v64, v64, v232
    v_sub_f32 v65, v65, v232
    v_sub_f32 v66, v66, v232
    v_sub_f32 v67, v67, v232
    v_sub_f32 v68, v68, v232
    v_sub_f32 v69, v69, v232
    v_sub_f32 v70, v70, v232
    v_sub_f32 v71, v71, v232
    v_mul_f32 v226, v226, v233
    v_accvgpr_read_b32 v234, a64
    v_accvgpr_read_b32 v235, a65
    v_accvgpr_read_b32 v236, a66
    v_accvgpr_read_b32 v237, a67
    v_mul_f32 v234, v234, v233
    v_mul_f32 v235, v235, v233
    v_mul_f32 v236, v236, v233
    v_mul_f32 v237, v237, v233
    v_accvgpr_write_b32 a64, v234
    v_accvgpr_write_b32 a65, v235
    v_accvgpr_write_b32 a66, v236
    v_accvgpr_write_b32 a67, v237
    v_accvgpr_read_b32 v234, a68
    v_accvgpr_read_b32 v235, a69
    v_accvgpr_read_b32 v236, a70
    v_accvgpr_read_b32 v237, a71
    v_mul_f32 v234, v234, v233
    v_mul_f32 v235, v235, v233
    v_mul_f32 v236, v236, v233
    v_mul_f32 v237, v237, v233
    v_accvgpr_write_b32 a68, v234
    v_accvgpr_write_b32 a69, v235
    v_accvgpr_write_b32 a70, v236
    v_accvgpr_write_b32 a71, v237
    v_accvgpr_read_b32 v234, a72
    v_accvgpr_read_b32 v235, a73
    v_accvgpr_read_b32 v236, a74
    v_accvgpr_read_b32 v237, a75
    v_mul_f32 v234, v234, v233
    v_mul_f32 v235, v235, v233
    v_mul_f32 v236, v236, v233
    v_mul_f32 v237, v237, v233
    v_accvgpr_write_b32 a72, v234
    v_accvgpr_write_b32 a73, v235
    v_accvgpr_write_b32 a74, v236
    v_accvgpr_write_b32 a75, v237
    v_accvgpr_read_b32 v234, a76
    v_accvgpr_read_b32 v235, a77
    v_accvgpr_read_b32 v236, a78
    v_accvgpr_read_b32 v237, a79
    v_mul_f32 v234, v234, v233
    v_mul_f32 v235, v235, v233
    v_mul_f32 v236, v236, v233
    v_mul_f32 v237, v237, v233
    v_accvgpr_write_b32 a76, v234
    v_accvgpr_write_b32 a77, v235
    v_accvgpr_write_b32 a78, v236
    v_accvgpr_write_b32 a79, v237
    v_accvgpr_read_b32 v234, a80
    v_accvgpr_read_b32 v235, a81
    v_accvgpr_read_b32 v236, a82
    v_accvgpr_read_b32 v237, a83
    v_mul_f32 v234, v234, v233
    v_mul_f32 v235, v235, v233
    v_mul_f32 v236, v236, v233
    v_mul_f32 v237, v237, v233
    v_accvgpr_write_b32 a80, v234
    v_accvgpr_write_b32 a81, v235
    v_accvgpr_write_b32 a82, v236
    v_accvgpr_write_b32 a83, v237
    v_accvgpr_read_b32 v234, a84
    v_accvgpr_read_b32 v235, a85
    v_accvgpr_read_b32 v236, a86
    v_accvgpr_read_b32 v237, a87
    v_mul_f32 v234, v234, v233
    v_mul_f32 v235, v235, v233
    v_mul_f32 v236, v236, v233
    v_mul_f32 v237, v237, v233
    v_accvgpr_write_b32 a84, v234
    v_accvgpr_write_b32 a85, v235
    v_accvgpr_write_b32 a86, v236
    v_accvgpr_write_b32 a87, v237
    v_accvgpr_read_b32 v234, a88
    v_accvgpr_read_b32 v235, a89
    v_accvgpr_read_b32 v236, a90
    v_accvgpr_read_b32 v237, a91
    v_mul_f32 v234, v234, v233
    v_mul_f32 v235, v235, v233
    v_mul_f32 v236, v236, v233
    v_mul_f32 v237, v237, v233
    v_accvgpr_write_b32 a88, v234
    v_accvgpr_write_b32 a89, v235
    v_accvgpr_write_b32 a90, v236
    v_accvgpr_write_b32 a91, v237
    v_accvgpr_read_b32 v234, a92
    v_accvgpr_read_b32 v235, a93
    v_accvgpr_read_b32 v236, a94
    v_accvgpr_read_b32 v237, a95
    v_mul_f32 v234, v234, v233
    v_mul_f32 v235, v235, v233
    v_mul_f32 v236, v236, v233
    v_mul_f32 v237, v237, v233
    v_accvgpr_write_b32 a92, v234
    v_accvgpr_write_b32 a93, v235
    v_accvgpr_write_b32 a94, v236
    v_accvgpr_write_b32 a95, v237
    v_max3_f32 v230, v40, v41, v42
    v_max3_f32 v230, v230, v43, v44
    v_max3_f32 v230, v230, v45, v46
    v_max_f32 v230, v230, v47
    v_mov_b32 v231, v230
    s_nop 1
    v_permlane16_swap_b32 v230, v231
    s_nop 0
    v_max_f32 v230, v230, v231
    v_mov_b32 v231, v230
    s_nop 1
    v_permlane32_swap_b32 v230, v231
    s_nop 0
    v_max_f32 v230, v230, v231
    v_max_f32 v232, 0, v230
    v_exp_f32 v233, -v232
    v_sub_f32 v40, v40, v232
    v_sub_f32 v41, v41, v232
    v_sub_f32 v42, v42, v232
    v_sub_f32 v43, v43, v232
    v_sub_f32 v44, v44, v232
    v_sub_f32 v45, v45, v232
    v_sub_f32 v46, v46, v232
    v_sub_f32 v47, v47, v232
    v_sub_f32 v92, v92, v232
    v_sub_f32 v93, v93, v232
    v_sub_f32 v94, v94, v232
    v_sub_f32 v95, v95, v232
    v_mul_f32 v227, v227, v233
    v_accvgpr_read_b32 v234, a96
    v_accvgpr_read_b32 v235, a97
    v_accvgpr_read_b32 v236, a98
    v_accvgpr_read_b32 v237, a99
    v_mul_f32 v234, v234, v233
    v_mul_f32 v235, v235, v233
    v_mul_f32 v236, v236, v233
    v_mul_f32 v237, v237, v233
    v_accvgpr_write_b32 a96, v234
    v_accvgpr_write_b32 a97, v235
    v_accvgpr_write_b32 a98, v236
    v_accvgpr_write_b32 a99, v237
    v_accvgpr_read_b32 v234, a100
    v_accvgpr_read_b32 v235, a101
    v_accvgpr_read_b32 v236, a102
    v_accvgpr_read_b32 v237, a103
    v_mul_f32 v234, v234, v233
    v_mul_f32 v235, v235, v233
    v_mul_f32 v236, v236, v233
    v_mul_f32 v237, v237, v233
    v_accvgpr_write_b32 a100, v234
    v_accvgpr_write_b32 a101, v235
    v_accvgpr_write_b32 a102, v236
    v_accvgpr_write_b32 a103, v237
    v_accvgpr_read_b32 v234, a104
    v_accvgpr_read_b32 v235, a105
    v_accvgpr_read_b32 v236, a106
    v_accvgpr_read_b32 v237, a107
    v_mul_f32 v234, v234, v233
    v_mul_f32 v235, v235, v233
    v_mul_f32 v236, v236, v233
    v_mul_f32 v237, v237, v233
    v_accvgpr_write_b32 a104, v234
    v_accvgpr_write_b32 a105, v235
    v_accvgpr_write_b32 a106, v236
    v_accvgpr_write_b32 a107, v237
    v_accvgpr_read_b32 v234, a108
    v_accvgpr_read_b32 v235, a109
    v_accvgpr_read_b32 v236, a110
    v_accvgpr_read_b32 v237, a111
    v_mul_f32 v234, v234, v233
    v_mul_f32 v235, v235, v233
    v_mul_f32 v236, v236, v233
    v_mul_f32 v237, v237, v233
    v_accvgpr_write_b32 a108, v234
    v_accvgpr_write_b32 a109, v235
    v_accvgpr_write_b32 a110, v236
    v_accvgpr_write_b32 a111, v237
    v_accvgpr_read_b32 v234, a112
    v_accvgpr_read_b32 v235, a113
    v_accvgpr_read_b32 v236, a114
    v_accvgpr_read_b32 v237, a115
    v_mul_f32 v234, v234, v233
    v_mul_f32 v235, v235, v233
    v_mul_f32 v236, v236, v233
    v_mul_f32 v237, v237, v233
    v_accvgpr_write_b32 a112, v234
    v_accvgpr_write_b32 a113, v235
    v_accvgpr_write_b32 a114, v236
    v_accvgpr_write_b32 a115, v237
    v_accvgpr_read_b32 v234, a116
    v_accvgpr_read_b32 v235, a117
    v_accvgpr_read_b32 v236, a118
    v_accvgpr_read_b32 v237, a119
    v_mul_f32 v234, v234, v233
    v_mul_f32 v235, v235, v233
    v_mul_f32 v236, v236, v233
    v_mul_f32 v237, v237, v233
    v_accvgpr_write_b32 a116, v234
    v_accvgpr_write_b32 a117, v235
    v_accvgpr_write_b32 a118, v236
    v_accvgpr_write_b32 a119, v237
    v_accvgpr_read_b32 v234, a120
    v_accvgpr_read_b32 v235, a121
    v_accvgpr_read_b32 v236, a122
    v_accvgpr_read_b32 v237, a123
    v_mul_f32 v234, v234, v233
    v_mul_f32 v235, v235, v233
    v_mul_f32 v236, v236, v233
    v_mul_f32 v237, v237, v233
    v_accvgpr_write_b32 a120, v234
    v_accvgpr_write_b32 a121, v235
    v_accvgpr_write_b32 a122, v236
    v_accvgpr_write_b32 a123, v237
    v_accvgpr_read_b32 v234, a124
    v_accvgpr_read_b32 v235, a125
    v_accvgpr_read_b32 v236, a126
    v_accvgpr_read_b32 v237, a127
    v_mul_f32 v234, v234, v233
    v_mul_f32 v235, v235, v233
    v_mul_f32 v236, v236, v233
    v_mul_f32 v237, v237, v233
    v_accvgpr_write_b32 a124, v234
    v_accvgpr_write_b32 a125, v235
    v_accvgpr_write_b32 a126, v236
    v_accvgpr_write_b32 a127, v237
    v_exp_f32 v208, v16
    v_exp_f32 v209, v17
    s_nop 0
    v_cvt_pk_bf16_f32 v96, v208, v209
    v_exp_f32 v210, v18
    v_add_f32 v216, v208, v209
    v_exp_f32 v211, v19
    v_add_f32 v216, v216, v210
    v_cvt_pk_bf16_f32 v97, v210, v211
    v_exp_f32 v212, v20
    v_add_f32 v216, v216, v211
    v_exp_f32 v213, v21
    v_add_f32 v216, v216, v212
    v_cvt_pk_bf16_f32 v98, v212, v213
    v_exp_f32 v214, v22
    v_add_f32 v216, v216, v213
    v_exp_f32 v215, v23
    v_add_f32 v216, v216, v214
    v_cvt_pk_bf16_f32 v99, v214, v215
    v_exp_f32 v208, v24
    v_add_f32 v216, v216, v215
    v_exp_f32 v209, v25
    s_nop 0
    v_cvt_pk_bf16_f32 v100, v208, v209
    v_exp_f32 v210, v26
    v_add_f32 v217, v208, v209
    v_exp_f32 v211, v27
    v_add_f32 v217, v217, v210
    v_cvt_pk_bf16_f32 v101, v210, v211
    v_exp_f32 v212, v28
    v_add_f32 v217, v217, v211
    v_exp_f32 v213, v29
    v_add_f32 v217, v217, v212
    v_cvt_pk_bf16_f32 v102, v212, v213
    v_exp_f32 v214, v30
    v_add_f32 v217, v217, v213
    v_exp_f32 v215, v31
    v_add_f32 v217, v217, v214
    v_cvt_pk_bf16_f32 v103, v214, v215
    v_exp_f32 v208, v32
    v_add_f32 v217, v217, v215
    v_exp_f32 v209, v33
    s_nop 0
    v_cvt_pk_bf16_f32 v104, v208, v209
    v_exp_f32 v210, v34
    v_add_f32 v218, v208, v209
    v_exp_f32 v211, v35
    v_add_f32 v218, v218, v210
    v_cvt_pk_bf16_f32 v105, v210, v211
    v_exp_f32 v212, v36
    v_add_f32 v218, v218, v211
    v_exp_f32 v213, v37
    v_add_f32 v218, v218, v212
    v_cvt_pk_bf16_f32 v106, v212, v213
    v_exp_f32 v214, v38
    v_add_f32 v218, v218, v213
    v_exp_f32 v215, v39
    v_add_f32 v218, v218, v214
    v_cvt_pk_bf16_f32 v107, v214, v215
    v_exp_f32 v208, v40
    v_add_f32 v218, v218, v215
    v_exp_f32 v209, v41
    s_nop 0
    v_cvt_pk_bf16_f32 v108, v208, v209
    v_exp_f32 v210, v42
    v_add_f32 v219, v208, v209
    v_exp_f32 v211, v43
    v_add_f32 v219, v219, v210
    v_cvt_pk_bf16_f32 v109, v210, v211
    v_exp_f32 v212, v44
    v_add_f32 v219, v219, v211
    v_exp_f32 v213, v45
    v_add_f32 v219, v219, v212
    v_cvt_pk_bf16_f32 v110, v212, v213
    v_exp_f32 v214, v46
    v_add_f32 v219, v219, v213
    v_exp_f32 v215, v47
    v_add_f32 v219, v219, v214
    v_cvt_pk_bf16_f32 v111, v214, v215
    v_exp_f32 v208, v48
    v_add_f32 v219, v219, v215
    v_exp_f32 v209, v49
    s_nop 0
    v_cvt_pk_bf16_f32 v112, v208, v209
    v_exp_f32 v210, v50
    v_add_f32 v220, v208, v209
    v_exp_f32 v211, v51
    v_add_f32 v220, v220, v210
    v_cvt_pk_bf16_f32 v113, v210, v211
    v_exp_f32 v212, v52
    v_add_f32 v220, v220, v211
    v_exp_f32 v213, v53
    v_add_f32 v220, v220, v212
    v_cvt_pk_bf16_f32 v114, v212, v213
    s_nop 1
    s_setpc_b64 s[30:31]
L_rare_1:
    s_nop 15
    v_max3_f32 v230, v48, v49, v50
    v_max3_f32 v230, v230, v51, v52
    v_max3_f32 v230, v230, v53, v54
    v_max_f32 v230, v230, v55
    v_mov_b32 v231, v230
    s_nop 1
    v_permlane16_swap_b32 v230, v231
    s_nop 0
    v_max_f32 v230, v230, v231
    v_mov_b32 v231, v230
    s_nop 1
    v_permlane32_swap_b32 v230, v231
    s_nop 0
    v_max_f32 v230, v230, v231
    v_max_f32 v232, 0, v230
    v_exp_f32 v233, -v232
    v_sub_f32 v48, v48, v232
    v_sub_f32 v49, v49, v232
    v_sub_f32 v50, v50, v232
    v_sub_f32 v51, v51, v232
    v_sub_f32 v52, v52, v232
    v_sub_f32 v53, v53, v232
    v_sub_f32 v54, v54, v232
    v_sub_f32 v55, v55, v232
    v_sub_f32 v80, v80, v232
    v_sub_f32 v81, v81, v232
    v_sub_f32 v82, v82, v232
    v_sub_f32 v83, v83, v232
    v_sub_f32 v16, v16, v232
    v_sub_f32 v17, v17, v232
    v_sub_f32 v18, v18, v232
    v_sub_f32 v19, v19, v232
    v_sub_f32 v20, v20, v232
    v_sub_f32 v21, v21, v232
    v_sub_f32 v22, v22, v232
    v_sub_f32 v23, v23, v232
    v_mul_f32 v224, v224, v233
    v_accvgpr_read_b32 v234, a0
    v_accvgpr_read_b32 v235, a1
    v_accvgpr_read_b32 v236, a2
    v_accvgpr_read_b32 v237, a3
    v_mul_f32 v234, v234, v233
    v_mul_f32 v235, v235, v233
    v_mul_f32 v236, v236, v233
    v_mul_f32 v237, v237, v233
    v_accvgpr_write_b32 a0, v234
    v_accvgpr_write_b32 a1, v235
    v_accvgpr_write_b32 a2, v236
    v_accvgpr_write_b32 a3, v237
    v_accvgpr_read_b32 v234, a4
    v_accvgpr_read_b32 v235, a5
    v_accvgpr_read_b32 v236, a6
    v_accvgpr_read_b32 v237, a7
    v_mul_f32 v234, v234, v233
    v_mul_f32 v235, v235, v233
    v_mul_f32 v236, v236, v233
    v_mul_f32 v237, v237, v233
    v_accvgpr_write_b32 a4, v234
    v_accvgpr_write_b32 a5, v235
    v_accvgpr_write_b32 a6, v236
    v_accvgpr_write_b32 a7, v237
    v_accvgpr_read_b32 v234, a8
    v_accvgpr_read_b32 v235, a9
    v_accvgpr_read_b32 v236, a10
    v_accvgpr_read_b32 v237, a11
    v_mul_f32 v234, v234, v233
    v_mul_f32 v235, v235, v233
    v_mul_f32 v236, v236, v233
    v_mul_f32 v237, v237, v233
    v_accvgpr_write_b32 a8, v234
    v_accvgpr_write_b32 a9, v235
    v_accvgpr_write_b32 a10, v236
    v_accvgpr_write_b32 a11, v237
    v_accvgpr_read_b32 v234, a12
    v_accvgpr_read_b32 v235, a13
    v_accvgpr_read_b32 v236, a14
    v_accvgpr_read_b32 v237, a15
    v_mul_f32 v234, v234, v233
    v_mul_f32 v235, v235, v233
    v_mul_f32 v236, v236, v233
    v_mul_f32 v237, v237, v233
    v_accvgpr_write_b32 a12, v234
    v_accvgpr_write_b32 a13, v235
    v_accvgpr_write_b32 a14, v236
    v_accvgpr_write_b32 a15, v237
    v_accvgpr_read_b32 v234, a16
    v_accvgpr_read_b32 v235, a17
    v_accvgpr_read_b32 v236, a18
    v_accvgpr_read_b32 v237, a19
    v_mul_f32 v234, v234, v233
    v_mul_f32 v235, v235, v233
    v_mul_f32 v236, v236, v233
    v_mul_f32 v237, v237, v233
    v_accvgpr_write_b32 a16, v234
    v_accvgpr_write_b32 a17, v235
    v_accvgpr_write_b32 a18, v236
    v_accvgpr_write_b32 a19, v237
    v_accvgpr_read_b32 v234, a20
    v_accvgpr_read_b32 v235, a21
    v_accvgpr_read_b32 v236, a22
    v_accvgpr_read_b32 v237, a23
    v_mul_f32 v234, v234, v233
    v_mul_f32 v235, v235, v233
    v_mul_f32 v236, v236, v233
    v_mul_f32 v237, v237, v233
    v_accvgpr_write_b32 a20, v234
    v_accvgpr_write_b32 a21, v235
    v_accvgpr_write_b32 a22, v236
    v_accvgpr_write_b32 a23, v237
    v_accvgpr_read_b32 v234, a24
    v_accvgpr_read_b32 v235, a25
    v_accvgpr_read_b32 v236, a26
    v_accvgpr_read_b32 v237, a27
    v_mul_f32 v234, v234, v233
    v_mul_f32 v235, v235, v233
    v_mul_f32 v236, v236, v233
    v_mul_f32 v237, v237, v233
    v_accvgpr_write_b32 a24, v234
    v_accvgpr_write_b32 a25, v235
    v_accvgpr_write_b32 a26, v236
    v_accvgpr_write_b32 a27, v237
    v_accvgpr_read_b32 v234, a28
    v_accvgpr_read_b32 v235, a29
    v_accvgpr_read_b32 v236, a30
    v_accvgpr_read_b32 v237, a31
    v_mul_f32 v234, v234, v233
    v_mul_f32 v235, v235, v233
    v_mul_f32 v236, v236, v233
    v_mul_f32 v237, v237, v233
    v_accvgpr_write_b32 a28, v234
    v_accvgpr_write_b32 a29, v235
    v_accvgpr_write_b32 a30, v236
    v_accvgpr_write_b32 a31, v237
    v_max3_f32 v230, v56, v57, v58
    v_max3_f32 v230, v230, v59, v60
    v_max3_f32 v230, v230, v61, v62
    v_max_f32 v230, v230, v63
    v_mov_b32 v231, v230
    s_nop 1
    v_permlane16_swap_b32 v230, v231
    s_nop 0
    v_max_f32 v230, v230, v231
    v_mov_b32 v231, v230
    s_nop 1
    v_permlane32_swap_b32 v230, v231
    s_nop 0
    v_max_f32 v230, v230, v231
    v_max_f32 v232, 0, v230
    v_exp_f32 v233, -v232
    v_sub_f32 v56, v56, v232
    v_sub_f32 v57, v57, v232
    v_sub_f32 v58, v58, v232
    v_sub_f32 v59, v59, v232
    v_sub_f32 v60, v60, v232
    v_sub_f32 v61, v61, v232
    v_sub_f32 v62, v62, v232
    v_sub_f32 v63, v63, v232
    v_sub_f32 v84, v84, v232
    v_sub_f32 v85, v85, v232
    v_sub_f32 v86, v86, v232
    v_sub_f32 v87, v87, v232
    v_sub_f32 v24, v24, v232
    v_sub_f32 v25, v25, v232
    v_sub_f32 v26, v26, v232
    v_sub_f32 v27, v27, v232
    v_sub_f32 v28, v28, v232
    v_sub_f32 v29, v29, v232
    v_sub_f32 v30, v30, v232
    v_sub_f32 v31, v31, v232
    v_mul_f32 v225, v225, v233
    v_accvgpr_read_b32 v234, a32
    v_accvgpr_read_b32 v235, a33
    v_accvgpr_read_b32 v236, a34
    v_accvgpr_read_b32 v237, a35
    v_mul_f32 v234, v234, v233
    v_mul_f32 v235, v235, v233
    v_mul_f32 v236, v236, v233
    v_mul_f32 v237, v237, v233
    v_accvgpr_write_b32 a32, v234
    v_accvgpr_write_b32 a33, v235
    v_accvgpr_write_b32 a34, v236
    v_accvgpr_write_b32 a35, v237
    v_accvgpr_read_b32 v234, a36
    v_accvgpr_read_b32 v235, a37
    v_accvgpr_read_b32 v236, a38
    v_accvgpr_read_b32 v237, a39
    v_mul_f32 v234, v234, v233
    v_mul_f32 v235, v235, v233
    v_mul_f32 v236, v236, v233
    v_mul_f32 v237, v237, v233
    v_accvgpr_write_b32 a36, v234
    v_accvgpr_write_b32 a37, v235
    v_accvgpr_write_b32 a38, v236
    v_accvgpr_write_b32 a39, v237
    v_accvgpr_read_b32 v234, a40
    v_accvgpr_read_b32 v235, a41
    v_accvgpr_read_b32 v236, a42
    v_accvgpr_read_b32 v237, a43
    v_mul_f32 v234, v234, v233
    v_mul_f32 v235, v235, v233
    v_mul_f32 v236, v236, v233
    v_mul_f32 v237, v237, v233
    v_accvgpr_write_b32 a40, v234
    v_accvgpr_write_b32 a41, v235
    v_accvgpr_write_b32 a42, v236
    v_accvgpr_write_b32 a43, v237
    v_accvgpr_read_b32 v234, a44
    v_accvgpr_read_b32 v235, a45
    v_accvgpr_read_b32 v236, a46
    v_accvgpr_read_b32 v237, a47
    v_mul_f32 v234, v234, v233
    v_mul_f32 v235, v235, v233
    v_mul_f32 v236, v236, v233
    v_mul_f32 v237, v237, v233
    v_accvgpr_write_b32 a44, v234
    v_accvgpr_write_b32 a45, v235
    v_accvgpr_write_b32 a46, v236
    v_accvgpr_write_b32 a47, v237
    v_accvgpr_read_b32 v234, a48
    v_accvgpr_read_b32 v235, a49
    v_accvgpr_read_b32 v236, a50
    v_accvgpr_read_b32 v237, a51
    v_mul_f32 v234, v234, v233
    v_mul_f32 v235, v235, v233
    v_mul_f32 v236, v236, v233
    v_mul_f32 v237, v237, v233
    v_accvgpr_write_b32 a48, v234
    v_accvgpr_write_b32 a49, v235
    v_accvgpr_write_b32 a50, v236
    v_accvgpr_write_b32 a51, v237
    v_accvgpr_read_b32 v234, a52
    v_accvgpr_read_b32 v235, a53
    v_accvgpr_read_b32 v236, a54
    v_accvgpr_read_b32 v237, a55
    v_mul_f32 v234, v234, v233
    v_mul_f32 v235, v235, v233
    v_mul_f32 v236, v236, v233
    v_mul_f32 v237, v237, v233
    v_accvgpr_write_b32 a52, v234
    v_accvgpr_write_b32 a53, v235
    v_accvgpr_write_b32 a54, v236
    v_accvgpr_write_b32 a55, v237
    v_accvgpr_read_b32 v234, a56
    v_accvgpr_read_b32 v235, a57
    v_accvgpr_read_b32 v236, a58
    v_accvgpr_read_b32 v237, a59
    v_mul_f32 v234, v234, v233
    v_mul_f32 v235, v235, v233
    v_mul_f32 v236, v236, v233
    v_mul_f32 v237, v237, v233
    v_accvgpr_write_b32 a56, v234
    v_accvgpr_write_b32 a57, v235
    v_accvgpr_write_b32 a58, v236
    v_accvgpr_write_b32 a59, v237
    v_accvgpr_read_b32 v234, a60
    v_accvgpr_read_b32 v235, a61
    v_accvgpr_read_b32 v236, a62
    v_accvgpr_read_b32 v237, a63
    v_mul_f32 v234, v234, v233
    v_mul_f32 v235, v235, v233
    v_mul_f32 v236, v236, v233
    v_mul_f32 v237, v237, v233
    v_accvgpr_write_b32 a60, v234
    v_accvgpr_write_b32 a61, v235
    v_accvgpr_write_b32 a62, v236
    v_accvgpr_write_b32 a63, v237
    v_max3_f32 v230, v64, v65, v66
    v_max3_f32 v230, v230, v67, v68
    v_max3_f32 v230, v230, v69, v70
    v_max_f32 v230, v230, v71
    v_mov_b32 v231, v230
    s_nop 1
    v_permlane16_swap_b32 v230, v231
    s_nop 0
    v_max_f32 v230, v230, v231
    v_mov_b32 v231, v230
    s_nop 1
    v_permlane32_swap_b32 v230, v231
    s_nop 0
    v_max_f32 v230, v230, v231
    v_max_f32 v232, 0, v230
    v_exp_f32 v233, -v232
    v_sub_f32 v64, v64, v232
    v_sub_f32 v65, v65, v232
    v_sub_f32 v66, v66, v232
    v_sub_f32 v67, v67, v232
    v_sub_f32 v68, v68, v232
    v_sub_f32 v69, v69, v232
    v_sub_f32 v70, v70, v232
    v_sub_f32 v71, v71, v232
    v_sub_f32 v88, v88, v232
    v_sub_f32 v89, v89, v232
    v_sub_f32 v90, v90, v232
    v_sub_f32 v91, v91, v232
    v_sub_f32 v32, v32, v232
    v_sub_f32 v33, v33, v232
    v_sub_f32 v34, v34, v232
    v_sub_f32 v35, v35, v232
    v_sub_f32 v36, v36, v232
    v_sub_f32 v37, v37, v232
    v_sub_f32 v38, v38, v232
    v_sub_f32 v39, v39, v232
    v_mul_f32 v226, v226, v233
    v_accvgpr_read_b32 v234, a64
    v_accvgpr_read_b32 v235, a65
    v_accvgpr_read_b32 v236, a66
    v_accvgpr_read_b32 v237, a67
    v_mul_f32 v234, v234, v233
    v_mul_f32 v235, v235, v233
    v_mul_f32 v236, v236, v233
    v_mul_f32 v237, v237, v233
    v_accvgpr_write_b32 a64, v234
    v_accvgpr_write_b32 a65, v235
    v_accvgpr_write_b32 a66, v236
    v_accvgpr_write_b32 a67, v237
    v_accvgpr_read_b32 v234, a68
    v_accvgpr_read_b32 v235, a69
    v_accvgpr_read_b32 v236, a70
    v_accvgpr_read_b32 v237, a71
    v_mul_f32 v234, v234, v233
    v_mul_f32 v235, v235, v233
    v_mul_f32 v236, v236, v233
    v_mul_f32 v237, v237, v233
    v_accvgpr_write_b32 a68, v234
    v_accvgpr_write_b32 a69, v235
    v_accvgpr_write_b32 a70, v236
    v_accvgpr_write_b32 a71, v237
    v_accvgpr_read_b32 v234, a72
    v_accvgpr_read_b32 v235, a73
    v_accvgpr_read_b32 v236, a74
    v_accvgpr_read_b32 v237, a75
    v_mul_f32 v234, v234, v233
    v_mul_f32 v235, v235, v233
    v_mul_f32 v236, v236, v233
    v_mul_f32 v237, v237, v233
    v_accvgpr_write_b32 a72, v234
    v_accvgpr_write_b32 a73, v235
    v_accvgpr_write_b32 a74, v236
    v_accvgpr_write_b32 a75, v237
    v_accvgpr_read_b32 v234, a76
    v_accvgpr_read_b32 v235, a77
    v_accvgpr_read_b32 v236, a78
    v_accvgpr_read_b32 v237, a79
    v_mul_f32 v234, v234, v233
    v_mul_f32 v235, v235, v233
    v_mul_f32 v236, v236, v233
    v_mul_f32 v237, v237, v233
    v_accvgpr_write_b32 a76, v234
    v_accvgpr_write_b32 a77, v235
    v_accvgpr_write_b32 a78, v236
    v_accvgpr_write_b32 a79, v237
    v_accvgpr_read_b32 v234, a80
    v_accvgpr_read_b32 v235, a81
    v_accvgpr_read_b32 v236, a82
    v_accvgpr_read_b32 v237, a83
    v_mul_f32 v234, v234, v233
    v_mul_f32 v235, v235, v233
    v_mul_f32 v236, v236, v233
    v_mul_f32 v237, v237, v233
    v_accvgpr_write_b32 a80, v234
    v_accvgpr_write_b32 a81, v235
    v_accvgpr_write_b32 a82, v236
    v_accvgpr_write_b32 a83, v237
    v_accvgpr_read_b32 v234, a84
    v_accvgpr_read_b32 v235, a85
    v_accvgpr_read_b32 v236, a86
    v_accvgpr_read_b32 v237, a87
    v_mul_f32 v234, v234, v233
    v_mul_f32 v235, v235, v233
    v_mul_f32 v236, v236, v233
    v_mul_f32 v237, v237, v233
    v_accvgpr_write_b32 a84, v234
    v_accvgpr_write_b32 a85, v235
    v_accvgpr_write_b32 a86, v236
    v_accvgpr_write_b32 a87, v237
    v_accvgpr_read_b32 v234, a88
    v_accvgpr_read_b32 v235, a89
    v_accvgpr_read_b32 v236, a90
    v_accvgpr_read_b32 v237, a91
    v_mul_f32 v234, v234, v233
    v_mul_f32 v235, v235, v233
    v_mul_f32 v236, v236, v233
    v_mul_f32 v237, v237, v233
    v_accvgpr_write_b32 a88, v234
    v_accvgpr_write_b32 a89, v235
    v_accvgpr_write_b32 a90, v236
    v_accvgpr_write_b32 a91, v237
    v_accvgpr_read_b32 v234, a92
    v_accvgpr_read_b32 v235, a93
    v_accvgpr_read_b32 v236, a94
    v_accvgpr_read_b32 v237, a95
    v_mul_f32 v234, v234, v233
    v_mul_f32 v235, v235, v233
    v_mul_f32 v236, v236, v233
    v_mul_f32 v237, v237, v233
    v_accvgpr_write_b32 a92, v234
    v_accvgpr_write_b32 a93, v235
    v_accvgpr_write_b32 a94, v236
    v_accvgpr_write_b32 a95, v237
    v_max3_f32 v230, v72, v73, v74
    v_max3_f32 v230, v230, v75, v76
    v_max3_f32 v230, v230, v77, v78
    v_max_f32 v230, v230, v79
    v_mov_b32 v231, v230
    s_nop 1
    v_permlane16_swap_b32 v230, v231
    s_nop 0
    v_max_f32 v230, v230, v231
    v_mov_b32 v231, v230
    s_nop 1
    v_permlane32_swap_b32 v230, v231
    s_nop 0
    v_max_f32 v230, v230, v231
    v_max_f32 v232, 0, v230
    v_exp_f32 v233, -v232
    v_sub_f32 v72, v72, v232
    v_sub_f32 v73, v73, v232
    v_sub_f32 v74, v74, v232
    v_sub_f32 v75, v75, v232
    v_sub_f32 v76, v76, v232
    v_sub_f32 v77, v77, v232
    v_sub_f32 v78, v78, v232
    v_sub_f32 v79, v79, v232
    v_sub_f32 v92, v92, v232
    v_sub_f32 v93, v93, v232
    v_sub_f32 v94, v94, v232
    v_sub_f32 v95, v95, v232
    v_mul_f32 v227, v227, v233
    v_accvgpr_read_b32 v234, a96
    v_accvgpr_read_b32 v235, a97
    v_accvgpr_read_b32 v236, a98
    v_accvgpr_read_b32 v237, a99
    v_mul_f32 v234, v234, v233
    v_mul_f32 v235, v235, v233
    v_mul_f32 v236, v236, v233
    v_mul_f32 v237, v237, v233
    v_accvgpr_write_b32 a96, v234
    v_accvgpr_write_b32 a97, v235
    v_accvgpr_write_b32 a98, v236
    v_accvgpr_write_b32 a99, v237
    v_accvgpr_read_b32 v234, a100
    v_accvgpr_read_b32 v235, a101
    v_accvgpr_read_b32 v236, a102
    v_accvgpr_read_b32 v237, a103
    v_mul_f32 v234, v234, v233
    v_mul_f32 v235, v235, v233
    v_mul_f32 v236, v236, v233
    v_mul_f32 v237, v237, v233
    v_accvgpr_write_b32 a100, v234
    v_accvgpr_write_b32 a101, v235
    v_accvgpr_write_b32 a102, v236
    v_accvgpr_write_b32 a103, v237
    v_accvgpr_read_b32 v234, a104
    v_accvgpr_read_b32 v235, a105
    v_accvgpr_read_b32 v236, a106
    v_accvgpr_read_b32 v237, a107
    v_mul_f32 v234, v234, v233
    v_mul_f32 v235, v235, v233
    v_mul_f32 v236, v236, v233
    v_mul_f32 v237, v237, v233
    v_accvgpr_write_b32 a104, v234
    v_accvgpr_write_b32 a105, v235
    v_accvgpr_write_b32 a106, v236
    v_accvgpr_write_b32 a107, v237
    v_accvgpr_read_b32 v234, a108
    v_accvgpr_read_b32 v235, a109
    v_accvgpr_read_b32 v236, a110
    v_accvgpr_read_b32 v237, a111
    v_mul_f32 v234, v234, v233
    v_mul_f32 v235, v235, v233
    v_mul_f32 v236, v236, v233
    v_mul_f32 v237, v237, v233
    v_accvgpr_write_b32 a108, v234
    v_accvgpr_write_b32 a109, v235
    v_accvgpr_write_b32 a110, v236
    v_accvgpr_write_b32 a111, v237
    v_accvgpr_read_b32 v234, a112
    v_accvgpr_read_b32 v235, a113
    v_accvgpr_read_b32 v236, a114
    v_accvgpr_read_b32 v237, a115
    v_mul_f32 v234, v234, v233
    v_mul_f32 v235, v235, v233
    v_mul_f32 v236, v236, v233
    v_mul_f32 v237, v237, v233
    v_accvgpr_write_b32 a112, v234
    v_accvgpr_write_b32 a113, v235
    v_accvgpr_write_b32 a114, v236
    v_accvgpr_write_b32 a115, v237
    v_accvgpr_read_b32 v234, a116
    v_accvgpr_read_b32 v235, a117
    v_accvgpr_read_b32 v236, a118
    v_accvgpr_read_b32 v237, a119
    v_mul_f32 v234, v234, v233
    v_mul_f32 v235, v235, v233
    v_mul_f32 v236, v236, v233
    v_mul_f32 v237, v237, v233
    v_accvgpr_write_b32 a116, v234
    v_accvgpr_write_b32 a117, v235
    v_accvgpr_write_b32 a118, v236
    v_accvgpr_write_b32 a119, v237
    v_accvgpr_read_b32 v234, a120
    v_accvgpr_read_b32 v235, a121
    v_accvgpr_read_b32 v236, a122
    v_accvgpr_read_b32 v237, a123
    v_mul_f32 v234, v234, v233
    v_mul_f32 v235, v235, v233
    v_mul_f32 v236, v236, v233
    v_mul_f32 v237, v237, v233
    v_accvgpr_write_b32 a120, v234
    v_accvgpr_write_b32 a121, v235
    v_accvgpr_write_b32 a122, v236
    v_accvgpr_write_b32 a123, v237
    v_accvgpr_read_b32 v234, a124
    v_accvgpr_read_b32 v235, a125
    v_accvgpr_read_b32 v236, a126
    v_accvgpr_read_b32 v237, a127
    v_mul_f32 v234, v234, v233
    v_mul_f32 v235, v235, v233
    v_mul_f32 v236, v236, v233
    v_mul_f32 v237, v237, v233
    v_accvgpr_write_b32 a124, v234
    v_accvgpr_write_b32 a125, v235
    v_accvgpr_write_b32 a126, v236
    v_accvgpr_write_b32 a127, v237
    v_exp_f32 v208, v48
    v_exp_f32 v209, v49
    s_nop 0
    v_cvt_pk_bf16_f32 v112, v208, v209
    v_exp_f32 v210, v50
    v_add_f32 v220, v208, v209
    v_exp_f32 v211, v51
    v_add_f32 v220, v220, v210
    v_cvt_pk_bf16_f32 v113, v210, v211
    v_exp_f32 v212, v52
    v_add_f32 v220, v220, v211
    v_exp_f32 v213, v53
    v_add_f32 v220, v220, v212
    v_cvt_pk_bf16_f32 v114, v212, v213
    v_exp_f32 v214, v54
    v_add_f32 v220, v220, v213
    v_exp_f32 v215, v55
    v_add_f32 v220, v220, v214
    v_cvt_pk_bf16_f32 v115, v214, v215
    v_exp_f32 v208, v56
    v_add_f32 v220, v220, v215
    v_exp_f32 v209, v57
    s_nop 0
    v_cvt_pk_bf16_f32 v116, v208, v209
    v_exp_f32 v210, v58
    v_add_f32 v221, v208, v209
    v_exp_f32 v211, v59
    v_add_f32 v221, v221, v210
    v_cvt_pk_bf16_f32 v117, v210, v211
    v_exp_f32 v212, v60
    v_add_f32 v221, v221, v211
    v_exp_f32 v213, v61
    v_add_f32 v221, v221, v212
    v_cvt_pk_bf16_f32 v118, v212, v213
    v_exp_f32 v214, v62
    v_add_f32 v221, v221, v213
    v_exp_f32 v215, v63
    v_add_f32 v221, v221, v214
    v_cvt_pk_bf16_f32 v119, v214, v215
    v_exp_f32 v208, v64
    v_add_f32 v221, v221, v215
    v_exp_f32 v209, v65
    s_nop 0
    v_cvt_pk_bf16_f32 v120, v208, v209
    v_exp_f32 v210, v66
    v_add_f32 v222, v208, v209
    v_exp_f32 v211, v67
    v_add_f32 v222, v222, v210
    v_cvt_pk_bf16_f32 v121, v210, v211
    v_exp_f32 v212, v68
    v_add_f32 v222, v222, v211
    v_exp_f32 v213, v69
    v_add_f32 v222, v222, v212
    v_cvt_pk_bf16_f32 v122, v212, v213
    v_exp_f32 v214, v70
    v_add_f32 v222, v222, v213
    v_exp_f32 v215, v71
    v_add_f32 v222, v222, v214
    v_cvt_pk_bf16_f32 v123, v214, v215
    v_exp_f32 v208, v72
    v_add_f32 v222, v222, v215
    v_exp_f32 v209, v73
    s_nop 0
    v_cvt_pk_bf16_f32 v124, v208, v209
    v_exp_f32 v210, v74
    v_add_f32 v223, v208, v209
    v_exp_f32 v211, v75
    v_add_f32 v223, v223, v210
    v_cvt_pk_bf16_f32 v125, v210, v211
    v_exp_f32 v212, v76
    v_add_f32 v223, v223, v211
    v_exp_f32 v213, v77
    v_add_f32 v223, v223, v212
    v_cvt_pk_bf16_f32 v126, v212, v213
    v_exp_f32 v214, v78
    v_add_f32 v223, v223, v213
    v_exp_f32 v215, v79
    v_add_f32 v223, v223, v214
    v_cvt_pk_bf16_f32 v127, v214, v215
    v_exp_f32 v208, v16
    v_add_f32 v223, v223, v215
    v_exp_f32 v209, v17
    s_nop 0
    v_cvt_pk_bf16_f32 v96, v208, v209
    v_exp_f32 v210, v18
    v_add_f32 v216, v208, v209
    v_exp_f32 v211, v19
    v_add_f32 v216, v216, v210
    v_cvt_pk_bf16_f32 v97, v210, v211
    v_exp_f32 v212, v20
    v_add_f32 v216, v216, v211
    v_exp_f32 v213, v21
    v_add_f32 v216, v216, v212
    v_cvt_pk_bf16_f32 v98, v212, v213
    s_nop 1
    s_setpc_b64 s[30:31]
L_rare_2:
    s_nop 15
    v_max3_f32 v230, v48, v49, v50
    v_max3_f32 v230, v230, v51, v52
    v_max3_f32 v230, v230, v53, v54
    v_max_f32 v230, v230, v55
    v_mov_b32 v231, v230
    s_nop 1
    v_permlane16_swap_b32 v230, v231
    s_nop 0
    v_max_f32 v230, v230, v231
    v_mov_b32 v231, v230
    s_nop 1
    v_permlane32_swap_b32 v230, v231
    s_nop 0
    v_max_f32 v230, v230, v231
    v_max_f32 v232, 0, v230
    v_exp_f32 v233, -v232
    v_sub_f32 v48, v48, v232
    v_sub_f32 v49, v49, v232
    v_sub_f32 v50, v50, v232
    v_sub_f32 v51, v51, v232
    v_sub_f32 v52, v52, v232
    v_sub_f32 v53, v53, v232
    v_sub_f32 v54, v54, v232
    v_sub_f32 v55, v55, v232
    v_sub_f32 v80, v80, v232
    v_sub_f32 v81, v81, v232
    v_sub_f32 v82, v82, v232
    v_sub_f32 v83, v83, v232
    v_mul_f32 v224, v224, v233
    v_accvgpr_read_b32 v234, a0
    v_accvgpr_read_b32 v235, a1
    v_accvgpr_read_b32 v236, a2
    v_accvgpr_read_b32 v237, a3
    v_mul_f32 v234, v234, v233
    v_mul_f32 v235, v235, v233
    v_mul_f32 v236, v236, v233
    v_mul_f32 v237, v237, v233
    v_accvgpr_write_b32 a0, v234
    v_accvgpr_write_b32 a1, v235
    v_accvgpr_write_b32 a2, v236
    v_accvgpr_write_b32 a3, v237
    v_accvgpr_read_b32 v234, a4
    v_accvgpr_read_b32 v235, a5
    v_accvgpr_read_b32 v236, a6
    v_accvgpr_read_b32 v237, a7
    v_mul_f32 v234, v234, v233
    v_mul_f32 v235, v235, v233
    v_mul_f32 v236, v236, v233
    v_mul_f32 v237, v237, v233
    v_accvgpr_write_b32 a4, v234
    v_accvgpr_write_b32 a5, v235
    v_accvgpr_write_b32 a6, v236
    v_accvgpr_write_b32 a7, v237
    v_accvgpr_read_b32 v234, a8
    v_accvgpr_read_b32 v235, a9
    v_accvgpr_read_b32 v236, a10
    v_accvgpr_read_b32 v237, a11
    v_mul_f32 v234, v234, v233
    v_mul_f32 v235, v235, v233
    v_mul_f32 v236, v236, v233
    v_mul_f32 v237, v237, v233
    v_accvgpr_write_b32 a8, v234
    v_accvgpr_write_b32 a9, v235
    v_accvgpr_write_b32 a10, v236
    v_accvgpr_write_b32 a11, v237
    v_accvgpr_read_b32 v234, a12
    v_accvgpr_read_b32 v235, a13
    v_accvgpr_read_b32 v236, a14
    v_accvgpr_read_b32 v237, a15
    v_mul_f32 v234, v234, v233
    v_mul_f32 v235, v235, v233
    v_mul_f32 v236, v236, v233
    v_mul_f32 v237, v237, v233
    v_accvgpr_write_b32 a12, v234
    v_accvgpr_write_b32 a13, v235
    v_accvgpr_write_b32 a14, v236
    v_accvgpr_write_b32 a15, v237
    v_accvgpr_read_b32 v234, a16
    v_accvgpr_read_b32 v235, a17
    v_accvgpr_read_b32 v236, a18
    v_accvgpr_read_b32 v237, a19
    v_mul_f32 v234, v234, v233
    v_mul_f32 v235, v235, v233
    v_mul_f32 v236, v236, v233
    v_mul_f32 v237, v237, v233
    v_accvgpr_write_b32 a16, v234
    v_accvgpr_write_b32 a17, v235
    v_accvgpr_write_b32 a18, v236
    v_accvgpr_write_b32 a19, v237
    v_accvgpr_read_b32 v234, a20
    v_accvgpr_read_b32 v235, a21
    v_accvgpr_read_b32 v236, a22
    v_accvgpr_read_b32 v237, a23
    v_mul_f32 v234, v234, v233
    v_mul_f32 v235, v235, v233
    v_mul_f32 v236, v236, v233
    v_mul_f32 v237, v237, v233
    v_accvgpr_write_b32 a20, v234
    v_accvgpr_write_b32 a21, v235
    v_accvgpr_write_b32 a22, v236
    v_accvgpr_write_b32 a23, v237
    v_accvgpr_read_b32 v234, a24
    v_accvgpr_read_b32 v235, a25
    v_accvgpr_read_b32 v236, a26
    v_accvgpr_read_b32 v237, a27
    v_mul_f32 v234, v234, v233
    v_mul_f32 v235, v235, v233
    v_mul_f32 v236, v236, v233
    v_mul_f32 v237, v237, v233
    v_accvgpr_write_b32 a24, v234
    v_accvgpr_write_b32 a25, v235
    v_accvgpr_write_b32 a26, v236
    v_accvgpr_write_b32 a27, v237
    v_accvgpr_read_b32 v234, a28
    v_accvgpr_read_b32 v235, a29
    v_accvgpr_read_b32 v236, a30
    v_accvgpr_read_b32 v237, a31
    v_mul_f32 v234, v234, v233
    v_mul_f32 v235, v235, v233
    v_mul_f32 v236, v236, v233
    v_mul_f32 v237, v237, v233
    v_accvgpr_write_b32 a28, v234
    v_accvgpr_write_b32 a29, v235
    v_accvgpr_write_b32 a30, v236
    v_accvgpr_write_b32 a31, v237
    v_max3_f32 v230, v56, v57, v58
    v_max3_f32 v230, v230, v59, v60
    v_max3_f32 v230, v230, v61, v62
    v_max_f32 v230, v230, v63
    v_mov_b32 v231, v230
    s_nop 1
    v_permlane16_swap_b32 v230, v231
    s_nop 0
    v_max_f32 v230, v230, v231
    v_mov_b32 v231, v230
    s_nop 1
    v_permlane32_swap_b32 v230, v231
    s_nop 0
    v_max_f32 v230, v230, v231
    v_max_f32 v232, 0, v230
    v_exp_f32 v233, -v232
    v_sub_f32 v56, v56, v232
    v_sub_f32 v57, v57, v232
    v_sub_f32 v58, v58, v232
    v_sub_f32 v59, v59, v232
    v_sub_f32 v60, v60, v232
    v_sub_f32 v61, v61, v232
    v_sub_f32 v62, v62, v232
    v_sub_f32 v63, v63, v232
    v_sub_f32 v84, v84, v232
    v_sub_f32 v85, v85, v232
    v_sub_f32 v86, v86, v232
    v_sub_f32 v87, v87, v232
    v_mul_f32 v225, v225, v233
    v_accvgpr_read_b32 v234, a32
    v_accvgpr_read_b32 v235, a33
    v_accvgpr_read_b32 v236, a34
    v_accvgpr_read_b32 v237, a35
    v_mul_f32 v234, v234, v233
    v_mul_f32 v235, v235, v233
    v_mul_f32 v236, v236, v233
    v_mul_f32 v237, v237, v233
    v_accvgpr_write_b32 a32, v234
    v_accvgpr_write_b32 a33, v235
    v_accvgpr_write_b32 a34, v236
    v_accvgpr_write_b32 a35, v237
    v_accvgpr_read_b32 v234, a36
    v_accvgpr_read_b32 v235, a37
    v_accvgpr_read_b32 v236, a38
    v_accvgpr_read_b32 v237, a39
    v_mul_f32 v234, v234, v233
    v_mul_f32 v235, v235, v233
    v_mul_f32 v236, v236, v233
    v_mul_f32 v237, v237, v233
    v_accvgpr_write_b32 a36, v234
    v_accvgpr_write_b32 a37, v235
    v_accvgpr_write_b32 a38, v236
    v_accvgpr_write_b32 a39, v237
    v_accvgpr_read_b32 v234, a40
    v_accvgpr_read_b32 v235, a41
    v_accvgpr_read_b32 v236, a42
    v_accvgpr_read_b32 v237, a43
    v_mul_f32 v234, v234, v233
    v_mul_f32 v235, v235, v233
    v_mul_f32 v236, v236, v233
    v_mul_f32 v237, v237, v233
    v_accvgpr_write_b32 a40, v234
    v_accvgpr_write_b32 a41, v235
    v_accvgpr_write_b32 a42, v236
    v_accvgpr_write_b32 a43, v237
    v_accvgpr_read_b32 v234, a44
    v_accvgpr_read_b32 v235, a45
    v_accvgpr_read_b32 v236, a46
    v_accvgpr_read_b32 v237, a47
    v_mul_f32 v234, v234, v233
    v_mul_f32 v235, v235, v233
    v_mul_f32 v236, v236, v233
    v_mul_f32 v237, v237, v233
    v_accvgpr_write_b32 a44, v234
    v_accvgpr_write_b32 a45, v235
    v_accvgpr_write_b32 a46, v236
    v_accvgpr_write_b32 a47, v237
    v_accvgpr_read_b32 v234, a48
    v_accvgpr_read_b32 v235, a49
    v_accvgpr_read_b32 v236, a50
    v_accvgpr_read_b32 v237, a51
    v_mul_f32 v234, v234, v233
    v_mul_f32 v235, v235, v233
    v_mul_f32 v236, v236, v233
    v_mul_f32 v237, v237, v233
    v_accvgpr_write_b32 a48, v234
    v_accvgpr_write_b32 a49, v235
    v_accvgpr_write_b32 a50, v236
    v_accvgpr_write_b32 a51, v237
    v_accvgpr_read_b32 v234, a52
    v_accvgpr_read_b32 v235, a53
    v_accvgpr_read_b32 v236, a54
    v_accvgpr_read_b32 v237, a55
    v_mul_f32 v234, v234, v233
    v_mul_f32 v235, v235, v233
    v_mul_f32 v236, v236, v233
    v_mul_f32 v237, v237, v233
    v_accvgpr_write_b32 a52, v234
    v_accvgpr_write_b32 a53, v235
    v_accvgpr_write_b32 a54, v236
    v_accvgpr_write_b32 a55, v237
    v_accvgpr_read_b32 v234, a56
    v_accvgpr_read_b32 v235, a57
    v_accvgpr_read_b32 v236, a58
    v_accvgpr_read_b32 v237, a59
    v_mul_f32 v234, v234, v233
    v_mul_f32 v235, v235, v233
    v_mul_f32 v236, v236, v233
    v_mul_f32 v237, v237, v233
    v_accvgpr_write_b32 a56, v234
    v_accvgpr_write_b32 a57, v235
    v_accvgpr_write_b32 a58, v236
    v_accvgpr_write_b32 a59, v237
    v_accvgpr_read_b32 v234, a60
    v_accvgpr_read_b32 v235, a61
    v_accvgpr_read_b32 v236, a62
    v_accvgpr_read_b32 v237, a63
    v_mul_f32 v234, v234, v233
    v_mul_f32 v235, v235, v233
    v_mul_f32 v236, v236, v233
    v_mul_f32 v237, v237, v233
    v_accvgpr_write_b32 a60, v234
    v_accvgpr_write_b32 a61, v235
    v_accvgpr_write_b32 a62, v236
    v_accvgpr_write_b32 a63, v237
    v_max3_f32 v230, v64, v65, v66
    v_max3_f32 v230, v230, v67, v68
    v_max3_f32 v230, v230, v69, v70
    v_max_f32 v230, v230, v71
    v_mov_b32 v231, v230
    s_nop 1
    v_permlane16_swap_b32 v230, v231
    s_nop 0
    v_max_f32 v230, v230, v231
    v_mov_b32 v231, v230
    s_nop 1
    v_permlane32_swap_b32 v230, v231
    s_nop 0
    v_max_f32 v230, v230, v231
    v_max_f32 v232, 0, v230
    v_exp_f32 v233, -v232
    v_sub_f32 v64, v64, v232
    v_sub_f32 v65, v65, v232
    v_sub_f32 v66, v66, v232
    v_sub_f32 v67, v67, v232
    v_sub_f32 v68, v68, v232
    v_sub_f32 v69, v69, v232
    v_sub_f32 v70, v70, v232
    v_sub_f32 v71, v71, v232
    v_sub_f32 v88, v88, v232
    v_sub_f32 v89, v89, v232
    v_sub_f32 v90, v90, v232
    v_sub_f32 v91, v91, v232
    v_mul_f32 v226, v226, v233
    v_accvgpr_read_b32 v234, a64
    v_accvgpr_read_b32 v235, a65
    v_accvgpr_read_b32 v236, a66
    v_accvgpr_read_b32 v237, a67
    v_mul_f32 v234, v234, v233
    v_mul_f32 v235, v235, v233
    v_mul_f32 v236, v236, v233
    v_mul_f32 v237, v237, v233
    v_accvgpr_write_b32 a64, v234
    v_accvgpr_write_b32 a65, v235
    v_accvgpr_write_b32 a66, v236
    v_accvgpr_write_b32 a67, v237
    v_accvgpr_read_b32 v234, a68
    v_accvgpr_read_b32 v235, a69
    v_accvgpr_read_b32 v236, a70
    v_accvgpr_read_b32 v237, a71
    v_mul_f32 v234, v234, v233
    v_mul_f32 v235, v235, v233
    v_mul_f32 v236, v236, v233
    v_mul_f32 v237, v237, v233
    v_accvgpr_write_b32 a68, v234
    v_accvgpr_write_b32 a69, v235
    v_accvgpr_write_b32 a70, v236
    v_accvgpr_write_b32 a71, v237
    v_accvgpr_read_b32 v234, a72
    v_accvgpr_read_b32 v235, a73
    v_accvgpr_read_b32 v236, a74
    v_accvgpr_read_b32 v237, a75
    v_mul_f32 v234, v234, v233
    v_mul_f32 v235, v235, v233
    v_mul_f32 v236, v236, v233
    v_mul_f32 v237, v237, v233
    v_accvgpr_write_b32 a72, v234
    v_accvgpr_write_b32 a73, v235
    v_accvgpr_write_b32 a74, v236
    v_accvgpr_write_b32 a75, v237
    v_accvgpr_read_b32 v234, a76
    v_accvgpr_read_b32 v235, a77
    v_accvgpr_read_b32 v236, a78
    v_accvgpr_read_b32 v237, a79
    v_mul_f32 v234, v234, v233
    v_mul_f32 v235, v235, v233
    v_mul_f32 v236, v236, v233
    v_mul_f32 v237, v237, v233
    v_accvgpr_write_b32 a76, v234
    v_accvgpr_write_b32 a77, v235
    v_accvgpr_write_b32 a78, v236
    v_accvgpr_write_b32 a79, v237
    v_accvgpr_read_b32 v234, a80
    v_accvgpr_read_b32 v235, a81
    v_accvgpr_read_b32 v236, a82
    v_accvgpr_read_b32 v237, a83
    v_mul_f32 v234, v234, v233
    v_mul_f32 v235, v235, v233
    v_mul_f32 v236, v236, v233
    v_mul_f32 v237, v237, v233
    v_accvgpr_write_b32 a80, v234
    v_accvgpr_write_b32 a81, v235
    v_accvgpr_write_b32 a82, v236
    v_accvgpr_write_b32 a83, v237
    v_accvgpr_read_b32 v234, a84
    v_accvgpr_read_b32 v235, a85
    v_accvgpr_read_b32 v236, a86
    v_accvgpr_read_b32 v237, a87
    v_mul_f32 v234, v234, v233
    v_mul_f32 v235, v235, v233
    v_mul_f32 v236, v236, v233
    v_mul_f32 v237, v237, v233
    v_accvgpr_write_b32 a84, v234
    v_accvgpr_write_b32 a85, v235
    v_accvgpr_write_b32 a86, v236
    v_accvgpr_write_b32 a87, v237
    v_accvgpr_read_b32 v234, a88
    v_accvgpr_read_b32 v235, a89
    v_accvgpr_read_b32 v236, a90
    v_accvgpr_read_b32 v237, a91
    v_mul_f32 v234, v234, v233
    v_mul_f32 v235, v235, v233
    v_mul_f32 v236, v236, v233
    v_mul_f32 v237, v237, v233
    v_accvgpr_write_b32 a88, v234
    v_accvgpr_write_b32 a89, v235
    v_accvgpr_write_b32 a90, v236
    v_accvgpr_write_b32 a91, v237
    v_accvgpr_read_b32 v234, a92
    v_accvgpr_read_b32 v235, a93
    v_accvgpr_read_b32 v236, a94
    v_accvgpr_read_b32 v237, a95
    v_mul_f32 v234, v234, v233
    v_mul_f32 v235, v235, v233
    v_mul_f32 v236, v236, v233
    v_mul_f32 v237, v237, v233
    v_accvgpr_write_b32 a92, v234
    v_accvgpr_write_b32 a93, v235
    v_accvgpr_write_b32 a94, v236
    v_accvgpr_write_b32 a95, v237
    v_max3_f32 v230, v72, v73, v74
    v_max3_f32 v230, v230, v75, v76
    v_max3_f32 v230, v230, v77, v78
    v_max_f32 v230, v230, v79
    v_mov_b32 v231, v230
    s_nop 1
    v_permlane16_swap_b32 v230, v231
    s_nop 0
    v_max_f32 v230, v230, v231
    v_mov_b32 v231, v230
    s_nop 1
    v_permlane32_swap_b32 v230, v231
    s_nop 0
    v_max_f32 v230, v230, v231
    v_max_f32 v232, 0, v230
    v_exp_f32 v233, -v232
    v_sub_f32 v72, v72, v232
    v_sub_f32 v73, v73, v232
    v_sub_f32 v74, v74, v232
    v_sub_f32 v75, v75, v232
    v_sub_f32 v76, v76, v232
    v_sub_f32 v77, v77, v232
    v_sub_f32 v78, v78, v232
    v_sub_f32 v79, v79, v232
    v_sub_f32 v92, v92, v232
    v_sub_f32 v93, v93, v232
    v_sub_f32 v94, v94, v232
    v_sub_f32 v95, v95, v232
    v_mul_f32 v227, v227, v233
    v_accvgpr_read_b32 v234, a96
    v_accvgpr_read_b32 v235, a97
    v_accvgpr_read_b32 v236, a98
    v_accvgpr_read_b32 v237, a99
    v_mul_f32 v234, v234, v233
    v_mul_f32 v235, v235, v233
    v_mul_f32 v236, v236, v233
    v_mul_f32 v237, v237, v233
    v_accvgpr_write_b32 a96, v234
    v_accvgpr_write_b32 a97, v235
    v_accvgpr_write_b32 a98, v236
    v_accvgpr_write_b32 a99, v237
    v_accvgpr_read_b32 v234, a100
    v_accvgpr_read_b32 v235, a101
    v_accvgpr_read_b32 v236, a102
    v_accvgpr_read_b32 v237, a103
    v_mul_f32 v234, v234, v233
    v_mul_f32 v235, v235, v233
    v_mul_f32 v236, v236, v233
    v_mul_f32 v237, v237, v233
    v_accvgpr_write_b32 a100, v234
    v_accvgpr_write_b32 a101, v235
    v_accvgpr_write_b32 a102, v236
    v_accvgpr_write_b32 a103, v237
    v_accvgpr_read_b32 v234, a104
    v_accvgpr_read_b32 v235, a105
    v_accvgpr_read_b32 v236, a106
    v_accvgpr_read_b32 v237, a107
    v_mul_f32 v234, v234, v233
    v_mul_f32 v235, v235, v233
    v_mul_f32 v236, v236, v233
    v_mul_f32 v237, v237, v233
    v_accvgpr_write_b32 a104, v234
    v_accvgpr_write_b32 a105, v235
    v_accvgpr_write_b32 a106, v236
    v_accvgpr_write_b32 a107, v237
    v_accvgpr_read_b32 v234, a108
    v_accvgpr_read_b32 v235, a109
    v_accvgpr_read_b32 v236, a110
    v_accvgpr_read_b32 v237, a111
    v_mul_f32 v234, v234, v233
    v_mul_f32 v235, v235, v233
    v_mul_f32 v236, v236, v233
    v_mul_f32 v237, v237, v233
    v_accvgpr_write_b32 a108, v234
    v_accvgpr_write_b32 a109, v235
    v_accvgpr_write_b32 a110, v236
    v_accvgpr_write_b32 a111, v237
    v_accvgpr_read_b32 v234, a112
    v_accvgpr_read_b32 v235, a113
    v_accvgpr_read_b32 v236, a114
    v_accvgpr_read_b32 v237, a115
    v_mul_f32 v234, v234, v233
    v_mul_f32 v235, v235, v233
    v_mul_f32 v236, v236, v233
    v_mul_f32 v237, v237, v233
    v_accvgpr_write_b32 a112, v234
    v_accvgpr_write_b32 a113, v235
    v_accvgpr_write_b32 a114, v236
    v_accvgpr_write_b32 a115, v237
    v_accvgpr_read_b32 v234, a116
    v_accvgpr_read_b32 v235, a117
    v_accvgpr_read_b32 v236, a118
    v_accvgpr_read_b32 v237, a119
    v_mul_f32 v234, v234, v233
    v_mul_f32 v235, v235, v233
    v_mul_f32 v236, v236, v233
    v_mul_f32 v237, v237, v233
    v_accvgpr_write_b32 a116, v234
    v_accvgpr_write_b32 a117, v235
    v_accvgpr_write_b32 a118, v236
    v_accvgpr_write_b32 a119, v237
    v_accvgpr_read_b32 v234, a120
    v_accvgpr_read_b32 v235, a121
    v_accvgpr_read_b32 v236, a122
    v_accvgpr_read_b32 v237, a123
    v_mul_f32 v234, v234, v233
    v_mul_f32 v235, v235, v233
    v_mul_f32 v236, v236, v233
    v_mul_f32 v237, v237, v233
    v_accvgpr_write_b32 a120, v234
    v_accvgpr_write_b32 a121, v235
    v_accvgpr_write_b32 a122, v236
    v_accvgpr_write_b32 a123, v237
    v_accvgpr_read_b32 v234, a124
    v_accvgpr_read_b32 v235, a125
    v_accvgpr_read_b32 v236, a126
    v_accvgpr_read_b32 v237, a127
    v_mul_f32 v234, v234, v233
    v_mul_f32 v235, v235, v233
    v_mul_f32 v236, v236, v233
    v_mul_f32 v237, v237, v233
    v_accvgpr_write_b32 a124, v234
    v_accvgpr_write_b32 a125, v235
    v_accvgpr_write_b32 a126, v236
    v_accvgpr_write_b32 a127, v237
    v_exp_f32 v208, v48
    v_exp_f32 v209, v49
    s_nop 0
    v_cvt_pk_bf16_f32 v112, v208, v209
    v_exp_f32 v210, v50
    v_add_f32 v220, v208, v209
    v_exp_f32 v211, v51
    v_add_f32 v220, v220, v210
    v_cvt_pk_bf16_f32 v113, v210, v211
    v_exp_f32 v212, v52
    v_add_f32 v220, v220, v211
    v_exp_f32 v213, v53
    v_add_f32 v220, v220, v212
    v_cvt_pk_bf16_f32 v114, v212, v213
    v_exp_f32 v214, v54
    v_add_f32 v220, v220, v213
    v_exp_f32 v215, v55
    v_add_f32 v220, v220, v214
    v_cvt_pk_bf16_f32 v115, v214, v215
    v_exp_f32 v208, v56
    v_add_f32 v220, v220, v215
    v_exp_f32 v209, v57
    s_nop 0
    v_cvt_pk_bf16_f32 v116, v208, v209
    v_exp_f32 v210, v58
    v_add_f32 v221, v208, v209
    v_exp_f32 v211, v59
    v_add_f32 v221, v221, v210
    v_cvt_pk_bf16_f32 v117, v210, v211
    v_exp_f32 v212, v60
    v_add_f32 v221, v221, v211
    v_exp_f32 v213, v61
    v_add_f32 v221, v221, v212
    v_cvt_pk_bf16_f32 v118, v212, v213
    v_exp_f32 v214, v62
    v_add_f32 v221, v221, v213
    v_exp_f32 v215, v63
    v_add_f32 v221, v221, v214
    v_cvt_pk_bf16_f32 v119, v214, v215
    v_exp_f32 v208, v64
    v_add_f32 v221, v221, v215
    v_exp_f32 v209, v65
    s_nop 0
    v_cvt_pk_bf16_f32 v120, v208, v209
    v_exp_f32 v210, v66
    v_add_f32 v222, v208, v209
    v_exp_f32 v211, v67
    v_add_f32 v222, v222, v210
    v_cvt_pk_bf16_f32 v121, v210, v211
    v_exp_f32 v212, v68
    v_add_f32 v222, v222, v211
    v_exp_f32 v213, v69
    v_add_f32 v222, v222, v212
    v_cvt_pk_bf16_f32 v122, v212, v213
    v_exp_f32 v214, v70
    v_add_f32 v222, v222, v213
    v_exp_f32 v215, v71
    v_add_f32 v222, v222, v214
    v_cvt_pk_bf16_f32 v123, v214, v215
    v_exp_f32 v208, v72
    v_add_f32 v222, v222, v215
    v_exp_f32 v209, v73
    s_nop 0
    v_cvt_pk_bf16_f32 v124, v208, v209
    v_exp_f32 v210, v74
    v_add_f32 v223, v208, v209
    v_exp_f32 v211, v75
    v_add_f32 v223, v223, v210
    v_cvt_pk_bf16_f32 v125, v210, v211
    v_exp_f32 v212, v76
    v_add_f32 v223, v223, v211
    v_exp_f32 v213, v77
    v_add_f32 v223, v223, v212
    v_cvt_pk_bf16_f32 v126, v212, v213
    v_exp_f32 v214, v78
    v_add_f32 v223, v223, v213
    v_exp_f32 v215, v79
    v_add_f32 v223, v223, v214
    v_cvt_pk_bf16_f32 v127, v214, v215
    v_add_f32 v223, v223, v215
    s_nop 1
    s_setpc_b64 s[30:31]
.globl final_kernel
.p2align 8
.type final_kernel,@function
final_kernel:
    s_cmp_ge_u32 s2, 256
    s_cbranch_scc1 L_final_kernel_end
    s_load_dwordx2 s[4:5], s[0:1], 72
    s_load_dwordx2 s[12:13], s[0:1], 32
    s_load_dwordx2 s[8:9], s[0:1], 96
    s_load_dwordx2 s[24:25], s[0:1], 0
    s_load_dwordx2 s[28:29], s[0:1], 80
    v_lshrrev_b32 v1, 6, v0
    s_nop 0
    v_readfirstlane_b32 s32, v1
    v_and_b32 v1, 63, v0
    v_lshlrev_b32 v14, 4, v1
    s_and_b32 s33, s2, 7
    s_lshr_b32 s34, s2, 3
    s_and_b32 s43, s34, 7
    s_lshr_b32 s34, s34, 3
    s_lshl_b32 s33, s33, 2
    s_add_u32 s42, s33, s34
    v_and_b32 v2, 15, v1
    v_lshrrev_b32 v5, 4, v1
    v_lshrrev_b32 v6, 2, v1
    v_and_b32 v6, 3, v6
    v_lshl_add_u32 v7, v5, 2, v6
    v_lshrrev_b32 v8, 1, v7
    v_and_b32 v8, 3, v8
    v_and_b32 v9, 3, v1
    v_lshlrev_b32 v10, 7, v7
    v_lshl_add_u32 v10, v8, 5, v10
    v_lshl_add_u32 v10, v9, 3, v10
    s_and_b32 s33, s32, 1
    s_lshl_b32 s33, s33, 1
    s_add_u32 s34, s33, 0
    s_lshl_b32 s34, s34, 5
    v_xor_b32 v16, s34, v10
    s_add_u32 s34, s33, 1
    s_lshl_b32 s34, s34, 5
    v_xor_b32 v17, s34, v10
    s_lshr_b32 s33, s32, 1
    s_lshl_b32 s33, s33, 12
    s_add_u32 s33, s33, 8192
    v_add_u32 v18, s33, v14
    v_lshrrev_b32 v6, 3, v1
    v_and_b32 v7, 7, v1
    v_lshrrev_b32 v8, 1, v6
    v_lshlrev_b32 v8, 1, v8
    v_xor_b32 v8, v8, v7
    v_lshlrev_b32 v8, 4, v8
    v_lshl_add_u32 v19, v6, 10, v8
    s_waitcnt lgkmcnt(0)
    s_add_u32 s16, s8, 16777216
    s_addc_u32 s17, s9, 0
    s_mov_b32 s18, 18874368
    s_mov_b32 s19, 0x20000
    s_add_u32 s20, s8, 6291456
    s_addc_u32 s21, s9, 0
    s_mov_b32 s22, 2097152
    s_mov_b32 s23, 0x20000
    s_add_u32 s8, s8, 8388608
    s_addc_u32 s9, s9, 0
    s_mov_b32 s10, 7340032
    s_mov_b32 s11, 0x20000
    s_mul_i32 s33, s43, 754688
    s_add_u32 s33, s33, 37748736
    s_add_u32 s4, s20, s33
    s_addc_u32 s5, s21, 0
    s_sub_u32 s4, s4, 6291456
    s_subb_u32 s5, s5, 0
    s_mov_b32 s6, 753664
    s_mov_b32 s7, 0x20000
    s_mov_b32 s26, 2097152
    s_mov_b32 s27, 0x20000
    s_mov_b32 s30, 2097152
    s_mov_b32 s31, 0x20000
    s_lshl_b32 s35, s32, 11
    s_mov_b32 s40, s35
    s_lshl_b32 s33, s42, 2
    s_add_u32 s33, s33, s32
    s_mul_i32 s36, s33, 57344
    s_mul_i32 s41, s33, 132096
    s_lshl_b32 s37, s32, 11
    s_mov_b32 s38, 0
    s_lshr_b32 s33, s32, 1
    s_lshl_b32 s33, s33, 1
    s_lshl_b32 s34, s42, 2
    s_add_u32 s33, s33, s34
    s_and_b32 s34, s32, 1
    s_lshl_b32 s44, s43, 1
    s_add_u32 s34, s34, s44
    s_lshl_b32 s45, s33, 14
    s_lshl_b32 s46, s34, 10
    s_add_u32 s45, s45, s46
    buffer_load_dwordx4 v[128:131], v14, s[20:23], s45 offen
    s_add_u32 s45, s45, 16384
    buffer_load_dwordx4 v[132:135], v14, s[20:23], s45 offen
    v_lshlrev_b32 v144, 10, v2
    v_lshl_add_u32 v144, v5, 3, v144
    s_lshl_b32 s45, s33, 14
    s_lshl_b32 s46, s34, 6
    s_add_u32 s45, s45, s46
    s_add_u32 s46, s45, 16384
    buffer_load_dwordx2 v[136:137], v144, s[24:27], s45 offen offset:0
    buffer_load_dwordx2 v[138:139], v144, s[24:27], s45 offen offset:32
    buffer_load_dwordx2 v[140:141], v144, s[24:27], s46 offen offset:0
    buffer_load_dwordx2 v[142:143], v144, s[24:27], s46 offen offset:32
    s_add_u32 m0, s37, 0
    s_nop 0
    buffer_load_dwordx4 v14, s[4:7], s35 offen lds
    buffer_load_dwordx4 v14, s[4:7], s35 offen offset:1024 lds
    s_add_u32 m0, s37, 8192
    s_add_u32 s35, s35, 8192
    buffer_load_dwordx4 v14, s[8:11], s36 offen lds
    buffer_load_dwordx4 v14, s[8:11], s36 offen offset:1024 lds
    s_add_u32 s36, s36, 2048
    s_add_u32 s38, s38, 1
    s_cmp_eq_u32 s38, 28
    s_cbranch_scc0 L_final_kernel_sw0
    s_mov_b32 s8, s16
    s_mov_b32 s9, s17
    s_mov_b32 s10, s18
    s_mov_b32 s11, s19
    s_mov_b32 s36, s41
L_final_kernel_sw0:
    s_add_u32 m0, s37, 16384
    s_nop 0
    buffer_load_dwordx4 v14, s[4:7], s35 offen lds
    buffer_load_dwordx4 v14, s[4:7], s35 offen offset:1024 lds
    s_add_u32 m0, s37, 24576
    s_add_u32 s35, s35, 8192
    buffer_load_dwordx4 v14, s[8:11], s36 offen lds
    buffer_load_dwordx4 v14, s[8:11], s36 offen offset:1024 lds
    s_add_u32 s36, s36, 2048
    s_add_u32 s38, s38, 1
    s_cmp_eq_u32 s38, 28
    s_cbranch_scc0 L_final_kernel_sw1
    s_mov_b32 s8, s16
    s_mov_b32 s9, s17
    s_mov_b32 s10, s18
    s_mov_b32 s11, s19
    s_mov_b32 s36, s41
L_final_kernel_sw1:
    s_add_u32 m0, s37, 32768
    s_nop 0
    buffer_load_dwordx4 v14, s[4:7], s35 offen lds
    buffer_load_dwordx4 v14, s[4:7], s35 offen offset:1024 lds
    s_add_u32 m0, s37, 40960
    s_add_u32 s35, s35, 8192
    buffer_load_dwordx4 v14, s[8:11], s36 offen lds
    buffer_load_dwordx4 v14, s[8:11], s36 offen offset:1024 lds
    s_add_u32 s36, s36, 2048
    s_add_u32 s38, s38, 1
    s_cmp_eq_u32 s38, 28
    s_cbranch_scc0 L_final_kernel_sw2
    s_mov_b32 s8, s16
    s_mov_b32 s9, s17
    s_mov_b32 s10, s18
    s_mov_b32 s11, s19
    s_mov_b32 s36, s41
L_final_kernel_sw2:
    s_add_u32 m0, s37, 49152
    s_nop 0
    buffer_load_dwordx4 v14, s[4:7], s35 offen lds
    buffer_load_dwordx4 v14, s[4:7], s35 offen offset:1024 lds
    s_add_u32 m0, s37, 57344
    s_add_u32 s35, s35, 8192
    buffer_load_dwordx4 v14, s[8:11], s36 offen lds
    buffer_load_dwordx4 v14, s[8:11], s36 offen offset:1024 lds
    s_add_u32 s36, s36, 2048
    s_add_u32 s38, s38, 1
    s_cmp_eq_u32 s38, 28
    s_cbranch_scc0 L_final_kernel_sw3
    s_mov_b32 s8, s16
    s_mov_b32 s9, s17
    s_mov_b32 s10, s18
    s_mov_b32 s11, s19
    s_mov_b32 s36, s41
L_final_kernel_sw3:
    s_xor_b32 s37, s37, 0x10000
    s_add_u32 m0, s37, 0
    s_nop 0
    buffer_load_dwordx4 v14, s[4:7], s35 offen lds
    buffer_load_dwordx4 v14, s[4:7], s35 offen offset:1024 lds
    s_add_u32 m0, s37, 8192
    s_add_u32 s35, s35, 8192
    buffer_load_dwordx4 v14, s[8:11], s36 offen lds
    buffer_load_dwordx4 v14, s[8:11], s36 offen offset:1024 lds
    s_add_u32 s36, s36, 2048
    s_add_u32 s38, s38, 1
    s_cmp_eq_u32 s38, 28
    s_cbranch_scc0 L_final_kernel_sw4
    s_mov_b32 s8, s16
    s_mov_b32 s9, s17
    s_mov_b32 s10, s18
    s_mov_b32 s11, s19
    s_mov_b32 s36, s41
L_final_kernel_sw4:
    s_waitcnt vmcnt(16)
    s_barrier
    ds_read_b64_tr_b16 v[32:33], v16 offset:0
    ds_read_b64_tr_b16 v[34:35], v16 offset:2048
    ds_read_b64_tr_b16 v[36:37], v17 offset:0
    ds_read_b64_tr_b16 v[38:39], v17 offset:2048
    ds_read_b128 v[64:67], v18 offset:0
    ds_read_b128 v[68:71], v18 offset:2048
    ds_read_b64_tr_b16 v[40:41], v16 offset:4096
    ds_read_b64_tr_b16 v[42:43], v16 offset:6144
    ds_read_b64_tr_b16 v[44:45], v17 offset:4096
    ds_read_b64_tr_b16 v[46:47], v17 offset:6144
    ds_read_b128 v[72:75], v18 offset:1024
    ds_read_b128 v[76:79], v18 offset:3072
    v_mov_b32 v96, 0
    v_mov_b32 v97, 0
    v_mov_b32 v98, 0
    v_mov_b32 v99, 0
    v_mov_b32 v100, 0
    v_mov_b32 v101, 0
    v_mov_b32 v102, 0
    v_mov_b32 v103, 0
    v_mov_b32 v104, 0
    v_mov_b32 v105, 0
    v_mov_b32 v106, 0
    v_mov_b32 v107, 0
    v_mov_b32 v108, 0
    v_mov_b32 v109, 0
    v_mov_b32 v110, 0
    v_mov_b32 v111, 0
    v_mov_b32 v112, 0
    v_mov_b32 v113, 0
    v_mov_b32 v114, 0
    v_mov_b32 v115, 0
    v_mov_b32 v116, 0
    v_mov_b32 v117, 0
    v_mov_b32 v118, 0
    v_mov_b32 v119, 0
    v_mov_b32 v120, 0
    v_mov_b32 v121, 0
    v_mov_b32 v122, 0
    v_mov_b32 v123, 0
    v_mov_b32 v124, 0
    v_mov_b32 v125, 0
    v_mov_b32 v126, 0
    v_mov_b32 v127, 0
    s_mov_b32 s39, 7
L_final_kernel_loopB:
    s_waitcnt vmcnt(12) lgkmcnt(0)
    s_barrier
    v_mfma_f32_16x16x32_bf16 v[96:99], v[32:35], v[64:67], v[96:99]
    ds_read_b64_tr_b16 v[48:49], v16 offset:16384
    ds_read_b64_tr_b16 v[50:51], v16 offset:18432
    v_mfma_f32_16x16x32_bf16 v[104:107], v[32:35], v[68:71], v[104:107]
    ds_read_b64_tr_b16 v[52:53], v17 offset:16384
    s_add_u32 m0, s37, 16384
    s_nop 0
    buffer_load_dwordx4 v14, s[4:7], s35 offen lds
    v_mfma_f32_16x16x32_bf16 v[100:103], v[36:39], v[64:67], v[100:103]
    ds_read_b64_tr_b16 v[54:55], v17 offset:18432
    ds_read_b128 v[80:83], v18 offset:16384
    v_mfma_f32_16x16x32_bf16 v[108:111], v[36:39], v[68:71], v[108:111]
    ds_read_b128 v[84:87], v18 offset:18432
    buffer_load_dwordx4 v14, s[4:7], s35 offen offset:1024 lds
    s_add_u32 m0, s37, 24576
    s_add_u32 s35, s35, 8192
    v_mfma_f32_16x16x32_bf16 v[96:99], v[40:43], v[72:75], v[96:99]
    ds_read_b64_tr_b16 v[56:57], v16 offset:20480
    ds_read_b64_tr_b16 v[58:59], v16 offset:22528
    v_mfma_f32_16x16x32_bf16 v[104:107], v[40:43], v[76:79], v[104:107]
    ds_read_b64_tr_b16 v[60:61], v17 offset:20480
    buffer_load_dwordx4 v14, s[8:11], s36 offen lds
    v_mfma_f32_16x16x32_bf16 v[100:103], v[44:47], v[72:75], v[100:103]
    ds_read_b64_tr_b16 v[62:63], v17 offset:22528
    ds_read_b128 v[88:91], v18 offset:17408
    v_mfma_f32_16x16x32_bf16 v[108:111], v[44:47], v[76:79], v[108:111]
    ds_read_b128 v[92:95], v18 offset:19456
    buffer_load_dwordx4 v14, s[8:11], s36 offen offset:1024 lds
    s_add_u32 s36, s36, 2048
    s_add_u32 s38, s38, 1
    s_cmp_eq_u32 s38, 28
    s_cbranch_scc0 L_final_kernel_sw5
    s_mov_b32 s8, s16
    s_mov_b32 s9, s17
    s_mov_b32 s10, s18
    s_mov_b32 s11, s19
    s_mov_b32 s36, s41
L_final_kernel_sw5:
    s_waitcnt vmcnt(12) lgkmcnt(0)
    s_barrier
    v_mfma_f32_16x16x32_bf16 v[96:99], v[48:51], v[80:83], v[96:99]
    ds_read_b64_tr_b16 v[32:33], v16 offset:32768
    ds_read_b64_tr_b16 v[34:35], v16 offset:34816
    v_mfma_f32_16x16x32_bf16 v[104:107], v[48:51], v[84:87], v[104:107]
    ds_read_b64_tr_b16 v[36:37], v17 offset:32768
    s_add_u32 m0, s37, 32768
    s_nop 0
    buffer_load_dwordx4 v14, s[4:7], s35 offen lds
    v_mfma_f32_16x16x32_bf16 v[100:103], v[52:55], v[80:83], v[100:103]
    ds_read_b64_tr_b16 v[38:39], v17 offset:34816
    ds_read_b128 v[64:67], v18 offset:32768
    v_mfma_f32_16x16x32_bf16 v[108:111], v[52:55], v[84:87], v[108:111]
    ds_read_b128 v[68:71], v18 offset:34816
    buffer_load_dwordx4 v14, s[4:7], s35 offen offset:1024 lds
    s_add_u32 m0, s37, 40960
    s_add_u32 s35, s35, 8192
    v_mfma_f32_16x16x32_bf16 v[96:99], v[56:59], v[88:91], v[96:99]
    ds_read_b64_tr_b16 v[40:41], v16 offset:36864
    ds_read_b64_tr_b16 v[42:43], v16 offset:38912
    v_mfma_f32_16x16x32_bf16 v[104:107], v[56:59], v[92:95], v[104:107]
    ds_read_b64_tr_b16 v[44:45], v17 offset:36864
    buffer_load_dwordx4 v14, s[8:11], s36 offen lds
    v_mfma_f32_16x16x32_bf16 v[100:103], v[60:63], v[88:91], v[100:103]
    ds_read_b64_tr_b16 v[46:47], v17 offset:38912
    ds_read_b128 v[72:75], v18 offset:33792
    v_mfma_f32_16x16x32_bf16 v[108:111], v[60:63], v[92:95], v[108:111]
    ds_read_b128 v[76:79], v18 offset:35840
    buffer_load_dwordx4 v14, s[8:11], s36 offen offset:1024 lds
    s_add_u32 s36, s36, 2048
    s_add_u32 s38, s38, 1
    s_cmp_eq_u32 s38, 28
    s_cbranch_scc0 L_final_kernel_sw6
    s_mov_b32 s8, s16
    s_mov_b32 s9, s17
    s_mov_b32 s10, s18
    s_mov_b32 s11, s19
    s_mov_b32 s36, s41
L_final_kernel_sw6:
    s_waitcnt vmcnt(12) lgkmcnt(0)
    s_barrier
    v_mfma_f32_16x16x32_bf16 v[96:99], v[32:35], v[64:67], v[96:99]
    ds_read_b64_tr_b16 v[48:49], v16 offset:49152
    ds_read_b64_tr_b16 v[50:51], v16 offset:51200
    v_mfma_f32_16x16x32_bf16 v[104:107], v[32:35], v[68:71], v[104:107]
    ds_read_b64_tr_b16 v[52:53], v17 offset:49152
    s_add_u32 m0, s37, 49152
    s_nop 0
    buffer_load_dwordx4 v14, s[4:7], s35 offen lds
    v_mfma_f32_16x16x32_bf16 v[100:103], v[36:39], v[64:67], v[100:103]
    ds_read_b64_tr_b16 v[54:55], v17 offset:51200
    ds_read_b128 v[80:83], v18 offset:49152
    v_mfma_f32_16x16x32_bf16 v[108:111], v[36:39], v[68:71], v[108:111]
    ds_read_b128 v[84:87], v18 offset:51200
    buffer_load_dwordx4 v14, s[4:7], s35 offen offset:1024 lds
    s_add_u32 m0, s37, 57344
    s_add_u32 s35, s35, 8192
    v_mfma_f32_16x16x32_bf16 v[96:99], v[40:43], v[72:75], v[96:99]
    ds_read_b64_tr_b16 v[56:57], v16 offset:53248
    ds_read_b64_tr_b16 v[58:59], v16 offset:55296
    v_mfma_f32_16x16x32_bf16 v[104:107], v[40:43], v[76:79], v[104:107]
    ds_read_b64_tr_b16 v[60:61], v17 offset:53248
    buffer_load_dwordx4 v14, s[8:11], s36 offen lds
    v_mfma_f32_16x16x32_bf16 v[100:103], v[44:47], v[72:75], v[100:103]
    ds_read_b64_tr_b16 v[62:63], v17 offset:55296
    ds_read_b128 v[88:91], v18 offset:50176
    v_mfma_f32_16x16x32_bf16 v[108:111], v[44:47], v[76:79], v[108:111]
    ds_read_b128 v[92:95], v18 offset:52224
    buffer_load_dwordx4 v14, s[8:11], s36 offen offset:1024 lds
    s_add_u32 s36, s36, 2048
    s_add_u32 s38, s38, 1
    s_cmp_eq_u32 s38, 28
    s_cbranch_scc0 L_final_kernel_sw7
    s_mov_b32 s8, s16
    s_mov_b32 s9, s17
    s_mov_b32 s10, s18
    s_mov_b32 s11, s19
    s_mov_b32 s36, s41
L_final_kernel_sw7:
    s_waitcnt vmcnt(12) lgkmcnt(0)
    s_barrier
    v_xor_b32 v16, 0x10000, v16
    v_xor_b32 v17, 0x10000, v17
    v_xor_b32 v18, 0x10000, v18
    v_mfma_f32_16x16x32_bf16 v[96:99], v[48:51], v[80:83], v[96:99]
    ds_read_b64_tr_b16 v[32:33], v16 offset:0
    ds_read_b64_tr_b16 v[34:35], v16 offset:2048
    v_mfma_f32_16x16x32_bf16 v[104:107], v[48:51], v[84:87], v[104:107]
    ds_read_b64_tr_b16 v[36:37], v17 offset:0
    s_xor_b32 s37, s37, 0x10000
    s_add_u32 m0, s37, 0
    s_nop 0
    buffer_load_dwordx4 v14, s[4:7], s35 offen lds
    v_mfma_f32_16x16x32_bf16 v[100:103], v[52:55], v[80:83], v[100:103]
    ds_read_b64_tr_b16 v[38:39], v17 offset:2048
    ds_read_b128 v[64:67], v18 offset:0
    v_mfma_f32_16x16x32_bf16 v[108:111], v[52:55], v[84:87], v[108:111]
    ds_read_b128 v[68:71], v18 offset:2048
    buffer_load_dwordx4 v14, s[4:7], s35 offen offset:1024 lds
    s_add_u32 m0, s37, 8192
    s_add_u32 s35, s35, 8192
    v_mfma_f32_16x16x32_bf16 v[96:99], v[56:59], v[88:91], v[96:99]
    ds_read_b64_tr_b16 v[40:41], v16 offset:4096
    ds_read_b64_tr_b16 v[42:43], v16 offset:6144
    v_mfma_f32_16x16x32_bf16 v[104:107], v[56:59], v[92:95], v[104:107]
    ds_read_b64_tr_b16 v[44:45], v17 offset:4096
    buffer_load_dwordx4 v14, s[8:11], s36 offen lds
    v_mfma_f32_16x16x32_bf16 v[100:103], v[60:63], v[88:91], v[100:103]
    ds_read_b64_tr_b16 v[46:47], v17 offset:6144
    ds_read_b128 v[72:75], v18 offset:1024
    v_mfma_f32_16x16x32_bf16 v[108:111], v[60:63], v[92:95], v[108:111]
    ds_read_b128 v[76:79], v18 offset:3072
    buffer_load_dwordx4 v14, s[8:11], s36 offen offset:1024 lds
    s_add_u32 s36, s36, 2048
    s_add_u32 s38, s38, 1
    s_cmp_eq_u32 s38, 28
    s_cbranch_scc0 L_final_kernel_sw8
    s_mov_b32 s8, s16
    s_mov_b32 s9, s17
    s_mov_b32 s10, s18
    s_mov_b32 s11, s19
    s_mov_b32 s36, s41
L_final_kernel_sw8:
    s_sub_u32 s39, s39, 1
    s_cmp_lg_u32 s39, 0
    s_cbranch_scc1 L_final_kernel_loopB
    s_mov_b32 s47, 0xbfb8aa3b
    s_waitcnt vmcnt(12) lgkmcnt(0)
    s_barrier
    v_mfma_f32_16x16x32_bf16 v[112:115], v[32:35], v[64:67], v[112:115]
    ds_read_b64_tr_b16 v[48:49], v16 offset:16384
    ds_read_b64_tr_b16 v[50:51], v16 offset:18432
    s_nop 0
    s_nop 0
    s_nop 0
    s_nop 0
    v_mfma_f32_16x16x32_bf16 v[120:123], v[32:35], v[68:71], v[120:123]
    ds_read_b64_tr_b16 v[52:53], v17 offset:16384
    s_add_u32 m0, s37, 16384
    s_nop 0
    buffer_load_dwordx4 v14, s[4:7], s35 offen lds
    s_nop 0
    s_nop 0
    s_nop 0
    s_nop 0
    v_mfma_f32_16x16x32_bf16 v[116:119], v[36:39], v[64:67], v[116:119]
    ds_read_b64_tr_b16 v[54:55], v17 offset:18432
    ds_read_b128 v[80:83], v18 offset:16384
    v_lshlrev_b32 v146, 16, v128
    v_and_b32 v147, 0xffff0000, v128
    v_lshlrev_b32 v148, 16, v129
    v_and_b32 v149, 0xffff0000, v129
    v_mfma_f32_16x16x32_bf16 v[124:127], v[36:39], v[68:71], v[124:127]
    ds_read_b128 v[84:87], v18 offset:18432
    buffer_load_dwordx4 v14, s[4:7], s35 offen offset:1024 lds
    s_add_u32 m0, s37, 24576
    s_add_u32 s35, s35, 8192
    v_lshlrev_b32 v150, 16, v130
    v_and_b32 v151, 0xffff0000, v130
    v_lshlrev_b32 v152, 16, v131
    v_and_b32 v153, 0xffff0000, v131
    v_mfma_f32_16x16x32_bf16 v[112:115], v[40:43], v[72:75], v[112:115]
    ds_read_b64_tr_b16 v[56:57], v16 offset:20480
    ds_read_b64_tr_b16 v[58:59], v16 offset:22528
    v_add_f32 v96, v96, v146
    v_add_f32 v97, v97, v147
    v_add_f32 v98, v98, v148
    v_add_f32 v99, v99, v149
    v_mfma_f32_16x16x32_bf16 v[120:123], v[40:43], v[76:79], v[120:123]
    ds_read_b64_tr_b16 v[60:61], v17 offset:20480
    buffer_load_dwordx4 v14, s[8:11], s36 offen lds
    v_add_f32 v100, v100, v150
    v_add_f32 v101, v101, v151
    v_add_f32 v102, v102, v152
    v_add_f32 v103, v103, v153
    v_mfma_f32_16x16x32_bf16 v[116:119], v[44:47], v[72:75], v[116:119]
    ds_read_b64_tr_b16 v[62:63], v17 offset:22528
    ds_read_b128 v[88:91], v18 offset:17408
    v_mul_f32 v146, s47, v96
    v_mul_f32 v147, s47, v97
    v_mul_f32 v148, s47, v98
    v_mul_f32 v149, s47, v99
    v_mfma_f32_16x16x32_bf16 v[124:127], v[44:47], v[76:79], v[124:127]
    ds_read_b128 v[92:95], v18 offset:19456
    buffer_load_dwordx4 v14, s[8:11], s36 offen offset:1024 lds
    s_add_u32 s36, s36, 2048
    s_add_u32 s38, s38, 1
    s_cmp_eq_u32 s38, 28
    s_cbranch_scc0 L_final_kernel_sw9
    s_mov_b32 s8, s16
    s_mov_b32 s9, s17
    s_mov_b32 s10, s18
    s_mov_b32 s11, s19
    s_mov_b32 s36, s41
L_final_kernel_sw9:
    v_mul_f32 v150, s47, v100
    v_mul_f32 v151, s47, v101
    v_mul_f32 v152, s47, v102
    v_mul_f32 v153, s47, v103
    s_waitcnt vmcnt(12) lgkmcnt(0)
    s_barrier
    v_mfma_f32_16x16x32_bf16 v[112:115], v[48:51], v[80:83], v[112:115]
    ds_read_b64_tr_b16 v[32:33], v16 offset:32768
    ds_read_b64_tr_b16 v[34:35], v16 offset:34816
    v_exp_f32 v146, v146
    v_exp_f32 v147, v147
    v_exp_f32 v148, v148
    v_exp_f32 v149, v149
    v_mfma_f32_16x16x32_bf16 v[120:123], v[48:51], v[84:87], v[120:123]
    ds_read_b64_tr_b16 v[36:37], v17 offset:32768
    s_add_u32 m0, s37, 32768
    s_nop 0
    buffer_load_dwordx4 v14, s[4:7], s35 offen lds
    v_exp_f32 v150, v150
    v_exp_f32 v151, v151
    v_exp_f32 v152, v152
    v_exp_f32 v153, v153
    v_mfma_f32_16x16x32_bf16 v[116:119], v[52:55], v[80:83], v[116:119]
    ds_read_b64_tr_b16 v[38:39], v17 offset:34816
    ds_read_b128 v[64:67], v18 offset:32768
    v_add_f32 v146, 1.0, v146
    v_add_f32 v147, 1.0, v147
    v_add_f32 v148, 1.0, v148
    v_add_f32 v149, 1.0, v149
    v_mfma_f32_16x16x32_bf16 v[124:127], v[52:55], v[84:87], v[124:127]
    ds_read_b128 v[68:71], v18 offset:34816
    buffer_load_dwordx4 v14, s[4:7], s35 offen offset:1024 lds
    s_add_u32 m0, s37, 40960
    s_add_u32 s35, s35, 8192
    v_add_f32 v150, 1.0, v150
    v_add_f32 v151, 1.0, v151
    v_add_f32 v152, 1.0, v152
    v_add_f32 v153, 1.0, v153
    v_mfma_f32_16x16x32_bf16 v[112:115], v[56:59], v[88:91], v[112:115]
    ds_read_b64_tr_b16 v[40:41], v16 offset:36864
    ds_read_b64_tr_b16 v[42:43], v16 offset:38912
    v_rcp_f32 v146, v146
    v_rcp_f32 v147, v147
    v_rcp_f32 v148, v148
    v_rcp_f32 v149, v149
    v_mfma_f32_16x16x32_bf16 v[120:123], v[56:59], v[92:95], v[120:123]
    ds_read_b64_tr_b16 v[44:45], v17 offset:36864
    buffer_load_dwordx4 v14, s[8:11], s36 offen lds
    v_rcp_f32 v150, v150
    v_rcp_f32 v151, v151
    v_rcp_f32 v152, v152
    v_rcp_f32 v153, v153
    v_mfma_f32_16x16x32_bf16 v[116:119], v[60:63], v[88:91], v[116:119]
    ds_read_b64_tr_b16 v[46:47], v17 offset:38912
    ds_read_b128 v[72:75], v18 offset:33792
    v_mul_f32 v96, v96, v146
    v_mul_f32 v97, v97, v147
    v_mul_f32 v98, v98, v148
    v_mul_f32 v99, v99, v149
    v_mfma_f32_16x16x32_bf16 v[124:127], v[60:63], v[92:95], v[124:127]
    ds_read_b128 v[76:79], v18 offset:35840
    buffer_load_dwordx4 v14, s[8:11], s36 offen offset:1024 lds
    s_add_u32 s36, s36, 2048
    s_add_u32 s38, s38, 1
    s_cmp_eq_u32 s38, 28
    s_cbranch_scc0 L_final_kernel_sw10
    s_mov_b32 s8, s16
    s_mov_b32 s9, s17
    s_mov_b32 s10, s18
    s_mov_b32 s11, s19
    s_mov_b32 s36, s41
L_final_kernel_sw10:
    v_mul_f32 v100, v100, v150
    v_mul_f32 v101, v101, v151
    v_mul_f32 v102, v102, v152
    v_mul_f32 v103, v103, v153
    s_waitcnt vmcnt(12) lgkmcnt(0)
    s_barrier
    v_mfma_f32_16x16x32_bf16 v[112:115], v[32:35], v[64:67], v[112:115]
    ds_read_b64_tr_b16 v[48:49], v16 offset:49152
    ds_read_b64_tr_b16 v[50:51], v16 offset:51200
    v_lshlrev_b32 v146, 16, v132
    v_and_b32 v147, 0xffff0000, v132
    v_lshlrev_b32 v148, 16, v133
    v_and_b32 v149, 0xffff0000, v133
    v_mfma_f32_16x16x32_bf16 v[120:123], v[32:35], v[68:71], v[120:123]
    ds_read_b64_tr_b16 v[52:53], v17 offset:49152
    s_add_u32 m0, s37, 49152
    s_nop 0
    buffer_load_dwordx4 v14, s[4:7], s35 offen lds
    v_lshlrev_b32 v150, 16, v134
    v_and_b32 v151, 0xffff0000, v134
    v_lshlrev_b32 v152, 16, v135
    v_and_b32 v153, 0xffff0000, v135
    v_mfma_f32_16x16x32_bf16 v[116:119], v[36:39], v[64:67], v[116:119]
    ds_read_b64_tr_b16 v[54:55], v17 offset:51200
    ds_read_b128 v[80:83], v18 offset:49152
    v_add_f32 v104, v104, v146
    v_add_f32 v105, v105, v147
    v_add_f32 v106, v106, v148
    v_add_f32 v107, v107, v149
    v_mfma_f32_16x16x32_bf16 v[124:127], v[36:39], v[68:71], v[124:127]
    ds_read_b128 v[84:87], v18 offset:51200
    buffer_load_dwordx4 v14, s[4:7], s35 offen offset:1024 lds
    s_add_u32 m0, s37, 57344
    s_add_u32 s35, s35, 8192
    v_add_f32 v108, v108, v150
    v_add_f32 v109, v109, v151
    v_add_f32 v110, v110, v152
    v_add_f32 v111, v111, v153
    v_mfma_f32_16x16x32_bf16 v[112:115], v[40:43], v[72:75], v[112:115]
    ds_read_b64_tr_b16 v[56:57], v16 offset:53248
    ds_read_b64_tr_b16 v[58:59], v16 offset:55296
    v_mul_f32 v146, s47, v104
    v_mul_f32 v147, s47, v105
    v_mul_f32 v148, s47, v106
    v_mul_f32 v149, s47, v107
    v_mfma_f32_16x16x32_bf16 v[120:123], v[40:43], v[76:79], v[120:123]
    ds_read_b64_tr_b16 v[60:61], v17 offset:53248
    buffer_load_dwordx4 v14, s[8:11], s36 offen lds
    v_mul_f32 v150, s47, v108
    v_mul_f32 v151, s47, v109
    v_mul_f32 v152, s47, v110
    v_mul_f32 v153, s47, v111
    v_mfma_f32_16x16x32_bf16 v[116:119], v[44:47], v[72:75], v[116:119]
    ds_read_b64_tr_b16 v[62:63], v17 offset:55296
    ds_read_b128 v[88:91], v18 offset:50176
    v_exp_f32 v146, v146
    v_exp_f32 v147, v147
    v_exp_f32 v148, v148
    v_exp_f32 v149, v149
    v_mfma_f32_16x16x32_bf16 v[124:127], v[44:47], v[76:79], v[124:127]
    ds_read_b128 v[92:95], v18 offset:52224
    buffer_load_dwordx4 v14, s[8:11], s36 offen offset:1024 lds
    s_add_u32 s36, s36, 2048
    s_add_u32 s38, s38, 1
    s_cmp_eq_u32 s38, 28
    s_cbranch_scc0 L_final_kernel_sw11
    s_mov_b32 s8, s16
    s_mov_b32 s9, s17
    s_mov_b32 s10, s18
    s_mov_b32 s11, s19
    s_mov_b32 s36, s41
L_final_kernel_sw11:
    v_exp_f32 v150, v150
    v_exp_f32 v151, v151
    v_exp_f32 v152, v152
    v_exp_f32 v153, v153
    s_waitcnt vmcnt(12) lgkmcnt(0)
    s_barrier
    v_xor_b32 v16, 0x10000, v16
    v_xor_b32 v17, 0x10000, v17
    v_xor_b32 v18, 0x10000, v18
    v_mfma_f32_16x16x32_bf16 v[112:115], v[48:51], v[80:83], v[112:115]
    ds_read_b64_tr_b16 v[32:33], v16 offset:0
    ds_read_b64_tr_b16 v[34:35], v16 offset:2048
    v_add_f32 v146, 1.0, v146
    v_add_f32 v147, 1.0, v147
    v_add_f32 v148, 1.0, v148
    v_add_f32 v149, 1.0, v149
    v_mfma_f32_16x16x32_bf16 v[120:123], v[48:51], v[84:87], v[120:123]
    ds_read_b64_tr_b16 v[36:37], v17 offset:0
    s_xor_b32 s37, s37, 0x10000
    s_add_u32 m0, s37, 0
    s_nop 0
    buffer_load_dwordx4 v14, s[4:7], s35 offen lds
    v_add_f32 v150, 1.0, v150
    v_add_f32 v151, 1.0, v151
    v_add_f32 v152, 1.0, v152
    v_add_f32 v153, 1.0, v153
    v_mfma_f32_16x16x32_bf16 v[116:119], v[52:55], v[80:83], v[116:119]
    ds_read_b64_tr_b16 v[38:39], v17 offset:2048
    ds_read_b128 v[64:67], v18 offset:0
    v_rcp_f32 v146, v146
    v_rcp_f32 v147, v147
    v_rcp_f32 v148, v148
    v_rcp_f32 v149, v149
    v_mfma_f32_16x16x32_bf16 v[124:127], v[52:55], v[84:87], v[124:127]
    ds_read_b128 v[68:71], v18 offset:2048
    buffer_load_dwordx4 v14, s[4:7], s35 offen offset:1024 lds
    s_add_u32 m0, s37, 8192
    s_add_u32 s35, s35, 8192
    v_rcp_f32 v150, v150
    v_rcp_f32 v151, v151
    v_rcp_f32 v152, v152
    v_rcp_f32 v153, v153
    v_mfma_f32_16x16x32_bf16 v[112:115], v[56:59], v[88:91], v[112:115]
    ds_read_b64_tr_b16 v[40:41], v16 offset:4096
    ds_read_b64_tr_b16 v[42:43], v16 offset:6144
    v_mul_f32 v104, v104, v146
    v_mul_f32 v105, v105, v147
    v_mul_f32 v106, v106, v148
    v_mul_f32 v107, v107, v149
    v_mfma_f32_16x16x32_bf16 v[120:123], v[56:59], v[92:95], v[120:123]
    ds_read_b64_tr_b16 v[44:45], v17 offset:4096
    buffer_load_dwordx4 v14, s[8:11], s36 offen lds
    v_mul_f32 v108, v108, v150
    v_mul_f32 v109, v109, v151
    v_mul_f32 v110, v110, v152
    v_mul_f32 v111, v111, v153
    v_mfma_f32_16x16x32_bf16 v[116:119], v[60:63], v[88:91], v[116:119]
    ds_read_b64_tr_b16 v[46:47], v17 offset:6144
    ds_read_b128 v[72:75], v18 offset:1024
    v_mfma_f32_16x16x32_bf16 v[124:127], v[60:63], v[92:95], v[124:127]
    ds_read_b128 v[76:79], v18 offset:3072
    buffer_load_dwordx4 v14, s[8:11], s36 offen offset:1024 lds
    s_add_u32 s36, s36, 2048
    s_add_u32 s38, s38, 1
    s_cmp_eq_u32 s38, 28
    s_cbranch_scc0 L_final_kernel_sw12
    s_mov_b32 s8, s16
    s_mov_b32 s9, s17
    s_mov_b32 s10, s18
    s_mov_b32 s11, s19
    s_mov_b32 s36, s41
L_final_kernel_sw12:
    s_mov_b32 s39, 15
L_final_kernel_loopS:
    s_waitcnt vmcnt(12) lgkmcnt(0)
    s_barrier
    v_mfma_f32_16x16x32_bf16 v[112:115], v[32:35], v[64:67], v[112:115]
    ds_read_b64_tr_b16 v[48:49], v16 offset:16384
    ds_read_b64_tr_b16 v[50:51], v16 offset:18432
    v_mfma_f32_16x16x32_bf16 v[120:123], v[32:35], v[68:71], v[120:123]
    ds_read_b64_tr_b16 v[52:53], v17 offset:16384
    s_add_u32 m0, s37, 16384
    s_nop 0
    buffer_load_dwordx4 v14, s[4:7], s35 offen lds
    v_mfma_f32_16x16x32_bf16 v[116:119], v[36:39], v[64:67], v[116:119]
    ds_read_b64_tr_b16 v[54:55], v17 offset:18432
    ds_read_b128 v[80:83], v18 offset:16384
    v_mfma_f32_16x16x32_bf16 v[124:127], v[36:39], v[68:71], v[124:127]
    ds_read_b128 v[84:87], v18 offset:18432
    buffer_load_dwordx4 v14, s[4:7], s35 offen offset:1024 lds
    s_add_u32 m0, s37, 24576
    s_add_u32 s35, s35, 8192
    v_mfma_f32_16x16x32_bf16 v[112:115], v[40:43], v[72:75], v[112:115]
    ds_read_b64_tr_b16 v[56:57], v16 offset:20480
    ds_read_b64_tr_b16 v[58:59], v16 offset:22528
    v_mfma_f32_16x16x32_bf16 v[120:123], v[40:43], v[76:79], v[120:123]
    ds_read_b64_tr_b16 v[60:61], v17 offset:20480
    buffer_load_dwordx4 v14, s[8:11], s36 offen lds
    v_mfma_f32_16x16x32_bf16 v[116:119], v[44:47], v[72:75], v[116:119]
    ds_read_b64_tr_b16 v[62:63], v17 offset:22528
    ds_read_b128 v[88:91], v18 offset:17408
    v_mfma_f32_16x16x32_bf16 v[124:127], v[44:47], v[76:79], v[124:127]
    ds_read_b128 v[92:95], v18 offset:19456
    buffer_load_dwordx4 v14, s[8:11], s36 offen offset:1024 lds
    s_add_u32 s36, s36, 2048
    s_add_u32 s38, s38, 1
    s_cmp_eq_u32 s38, 28
    s_cbranch_scc0 L_final_kernel_sw13
    s_mov_b32 s8, s16
    s_mov_b32 s9, s17
    s_mov_b32 s10, s18
    s_mov_b32 s11, s19
    s_mov_b32 s36, s41
L_final_kernel_sw13:
    s_waitcnt vmcnt(12) lgkmcnt(0)
    s_barrier
    v_mfma_f32_16x16x32_bf16 v[112:115], v[48:51], v[80:83], v[112:115]
    ds_read_b64_tr_b16 v[32:33], v16 offset:32768
    ds_read_b64_tr_b16 v[34:35], v16 offset:34816
    v_mfma_f32_16x16x32_bf16 v[120:123], v[48:51], v[84:87], v[120:123]
    ds_read_b64_tr_b16 v[36:37], v17 offset:32768
    s_add_u32 m0, s37, 32768
    s_nop 0
    buffer_load_dwordx4 v14, s[4:7], s35 offen lds
    v_mfma_f32_16x16x32_bf16 v[116:119], v[52:55], v[80:83], v[116:119]
    ds_read_b64_tr_b16 v[38:39], v17 offset:34816
    ds_read_b128 v[64:67], v18 offset:32768
    v_mfma_f32_16x16x32_bf16 v[124:127], v[52:55], v[84:87], v[124:127]
    ds_read_b128 v[68:71], v18 offset:34816
    buffer_load_dwordx4 v14, s[4:7], s35 offen offset:1024 lds
    s_add_u32 m0, s37, 40960
    s_add_u32 s35, s35, 8192
    v_mfma_f32_16x16x32_bf16 v[112:115], v[56:59], v[88:91], v[112:115]
    ds_read_b64_tr_b16 v[40:41], v16 offset:36864
    ds_read_b64_tr_b16 v[42:43], v16 offset:38912
    v_mfma_f32_16x16x32_bf16 v[120:123], v[56:59], v[92:95], v[120:123]
    ds_read_b64_tr_b16 v[44:45], v17 offset:36864
    buffer_load_dwordx4 v14, s[8:11], s36 offen lds
    v_mfma_f32_16x16x32_bf16 v[116:119], v[60:63], v[88:91], v[116:119]
    ds_read_b64_tr_b16 v[46:47], v17 offset:38912
    ds_read_b128 v[72:75], v18 offset:33792
    v_mfma_f32_16x16x32_bf16 v[124:127], v[60:63], v[92:95], v[124:127]
    ds_read_b128 v[76:79], v18 offset:35840
    buffer_load_dwordx4 v14, s[8:11], s36 offen offset:1024 lds
    s_add_u32 s36, s36, 2048
    s_add_u32 s38, s38, 1
    s_cmp_eq_u32 s38, 28
    s_cbranch_scc0 L_final_kernel_sw14
    s_mov_b32 s8, s16
    s_mov_b32 s9, s17
    s_mov_b32 s10, s18
    s_mov_b32 s11, s19
    s_mov_b32 s36, s41
L_final_kernel_sw14:
    s_waitcnt vmcnt(12) lgkmcnt(0)
    s_barrier
    v_mfma_f32_16x16x32_bf16 v[112:115], v[32:35], v[64:67], v[112:115]
    ds_read_b64_tr_b16 v[48:49], v16 offset:49152
    ds_read_b64_tr_b16 v[50:51], v16 offset:51200
    v_mfma_f32_16x16x32_bf16 v[120:123], v[32:35], v[68:71], v[120:123]
    ds_read_b64_tr_b16 v[52:53], v17 offset:49152
    s_add_u32 m0, s37, 49152
    s_nop 0
    buffer_load_dwordx4 v14, s[4:7], s35 offen lds
    v_mfma_f32_16x16x32_bf16 v[116:119], v[36:39], v[64:67], v[116:119]
    ds_read_b64_tr_b16 v[54:55], v17 offset:51200
    ds_read_b128 v[80:83], v18 offset:49152
    v_mfma_f32_16x16x32_bf16 v[124:127], v[36:39], v[68:71], v[124:127]
    ds_read_b128 v[84:87], v18 offset:51200
    buffer_load_dwordx4 v14, s[4:7], s35 offen offset:1024 lds
    s_add_u32 m0, s37, 57344
    s_add_u32 s35, s35, 8192
    v_mfma_f32_16x16x32_bf16 v[112:115], v[40:43], v[72:75], v[112:115]
    ds_read_b64_tr_b16 v[56:57], v16 offset:53248
    ds_read_b64_tr_b16 v[58:59], v16 offset:55296
    v_mfma_f32_16x16x32_bf16 v[120:123], v[40:43], v[76:79], v[120:123]
    ds_read_b64_tr_b16 v[60:61], v17 offset:53248
    buffer_load_dwordx4 v14, s[8:11], s36 offen lds
    v_mfma_f32_16x16x32_bf16 v[116:119], v[44:47], v[72:75], v[116:119]
    ds_read_b64_tr_b16 v[62:63], v17 offset:55296
    ds_read_b128 v[88:91], v18 offset:50176
    v_mfma_f32_16x16x32_bf16 v[124:127], v[44:47], v[76:79], v[124:127]
    ds_read_b128 v[92:95], v18 offset:52224
    buffer_load_dwordx4 v14, s[8:11], s36 offen offset:1024 lds
    s_add_u32 s36, s36, 2048
    s_add_u32 s38, s38, 1
    s_cmp_eq_u32 s38, 28
    s_cbranch_scc0 L_final_kernel_sw15
    s_mov_b32 s8, s16
    s_mov_b32 s9, s17
    s_mov_b32 s10, s18
    s_mov_b32 s11, s19
    s_mov_b32 s36, s41
L_final_kernel_sw15:
    s_waitcnt vmcnt(12) lgkmcnt(0)
    s_barrier
    v_xor_b32 v16, 0x10000, v16
    v_xor_b32 v17, 0x10000, v17
    v_xor_b32 v18, 0x10000, v18
    v_mfma_f32_16x16x32_bf16 v[112:115], v[48:51], v[80:83], v[112:115]
    ds_read_b64_tr_b16 v[32:33], v16 offset:0
    ds_read_b64_tr_b16 v[34:35], v16 offset:2048
    v_mfma_f32_16x16x32_bf16 v[120:123], v[48:51], v[84:87], v[120:123]
    ds_read_b64_tr_b16 v[36:37], v17 offset:0
    s_xor_b32 s37, s37, 0x10000
    s_add_u32 m0, s37, 0
    s_nop 0
    buffer_load_dwordx4 v14, s[4:7], s35 offen lds
    v_mfma_f32_16x16x32_bf16 v[116:119], v[52:55], v[80:83], v[116:119]
    ds_read_b64_tr_b16 v[38:39], v17 offset:2048
    ds_read_b128 v[64:67], v18 offset:0
    v_mfma_f32_16x16x32_bf16 v[124:127], v[52:55], v[84:87], v[124:127]
    ds_read_b128 v[68:71], v18 offset:2048
    buffer_load_dwordx4 v14, s[4:7], s35 offen offset:1024 lds
    s_add_u32 m0, s37, 8192
    s_add_u32 s35, s35, 8192
    v_mfma_f32_16x16x32_bf16 v[112:115], v[56:59], v[88:91], v[112:115]
    ds_read_b64_tr_b16 v[40:41], v16 offset:4096
    ds_read_b64_tr_b16 v[42:43], v16 offset:6144
    v_mfma_f32_16x16x32_bf16 v[120:123], v[56:59], v[92:95], v[120:123]
    ds_read_b64_tr_b16 v[44:45], v17 offset:4096
    buffer_load_dwordx4 v14, s[8:11], s36 offen lds
    v_mfma_f32_16x16x32_bf16 v[116:119], v[60:63], v[88:91], v[116:119]
    ds_read_b64_tr_b16 v[46:47], v17 offset:6144
    ds_read_b128 v[72:75], v18 offset:1024
    v_mfma_f32_16x16x32_bf16 v[124:127], v[60:63], v[92:95], v[124:127]
    ds_read_b128 v[76:79], v18 offset:3072
    buffer_load_dwordx4 v14, s[8:11], s36 offen offset:1024 lds
    s_add_u32 s36, s36, 2048
    s_add_u32 s38, s38, 1
    s_cmp_eq_u32 s38, 28
    s_cbranch_scc0 L_final_kernel_sw16
    s_mov_b32 s8, s16
    s_mov_b32 s9, s17
    s_mov_b32 s10, s18
    s_mov_b32 s11, s19
    s_mov_b32 s36, s41
L_final_kernel_sw16:
    s_sub_u32 s39, s39, 1
    s_cmp_lg_u32 s39, 0
    s_cbranch_scc1 L_final_kernel_loopS
    s_waitcnt lgkmcnt(0)
    s_nop 7
    v_lshlrev_b32 v56, 16, v136
    v_fma_f32 v112, v112, v96, v56
    v_and_b32 v57, 0xffff0000, v136
    v_fma_f32 v113, v113, v97, v57
    v_lshlrev_b32 v58, 16, v137
    v_fma_f32 v114, v114, v98, v58
    v_and_b32 v59, 0xffff0000, v137
    v_fma_f32 v115, v115, v99, v59
    v_cvt_pk_bf16_f32 v64, v112, v113
    v_cvt_pk_bf16_f32 v65, v114, v115
    buffer_store_dwordx2 v[64:65], v144, s[28:31], s45 offen offset:0
    v_lshlrev_b32 v56, 16, v138
    v_fma_f32 v116, v116, v100, v56
    v_and_b32 v57, 0xffff0000, v138
    v_fma_f32 v117, v117, v101, v57
    v_lshlrev_b32 v58, 16, v139
    v_fma_f32 v118, v118, v102, v58
    v_and_b32 v59, 0xffff0000, v139
    v_fma_f32 v119, v119, v103, v59
    v_cvt_pk_bf16_f32 v66, v116, v117
    v_cvt_pk_bf16_f32 v67, v118, v119
    buffer_store_dwordx2 v[66:67], v144, s[28:31], s45 offen offset:32
    v_lshlrev_b32 v56, 16, v140
    v_fma_f32 v120, v120, v104, v56
    v_and_b32 v57, 0xffff0000, v140
    v_fma_f32 v121, v121, v105, v57
    v_lshlrev_b32 v58, 16, v141
    v_fma_f32 v122, v122, v106, v58
    v_and_b32 v59, 0xffff0000, v141
    v_fma_f32 v123, v123, v107, v59
    v_cvt_pk_bf16_f32 v68, v120, v121
    v_cvt_pk_bf16_f32 v69, v122, v123
    buffer_store_dwordx2 v[68:69], v144, s[28:31], s46 offen offset:0
    v_lshlrev_b32 v56, 16, v142
    v_fma_f32 v124, v124, v108, v56
    v_and_b32 v57, 0xffff0000, v142
    v_fma_f32 v125, v125, v109, v57
    v_lshlrev_b32 v58, 16, v143
    v_fma_f32 v126, v126, v110, v58
    v_and_b32 v59, 0xffff0000, v143
    v_fma_f32 v127, v127, v111, v59
    v_cvt_pk_bf16_f32 v70, v124, v125
    v_cvt_pk_bf16_f32 v71, v126, v127
    buffer_store_dwordx2 v[70:71], v144, s[28:31], s46 offen offset:32
    s_waitcnt vmcnt(0)
L_final_kernel_end:
    s_endpgm
.section .rodata,"a"
.p2align 6
.amdhsa_kernel a_kernel
  .amdhsa_next_free_vgpr 512
  .amdhsa_next_free_sgpr 96
  .amdhsa_accum_offset 256
  .amdhsa_group_segment_fixed_size 0
  .amdhsa_kernarg_size 104
  .amdhsa_user_sgpr_count 2
  .amdhsa_user_sgpr_kernarg_segment_ptr 1
  .amdhsa_system_sgpr_workgroup_id_x 1
  .amdhsa_float_denorm_mode_32 3
  .amdhsa_ieee_mode 0
  .amdhsa_dx10_clamp 0
.end_amdhsa_kernel
.text
.section .rodata,"a"
.p2align 6
.amdhsa_kernel final_kernel
  .amdhsa_next_free_vgpr 160
  .amdhsa_next_free_sgpr 64
  .amdhsa_accum_offset 160
  .amdhsa_group_segment_fixed_size 0
  .amdhsa_kernarg_size 104
  .amdhsa_user_sgpr_count 2
  .amdhsa_user_sgpr_kernarg_segment_ptr 1
  .amdhsa_system_sgpr_workgroup_id_x 1
  .amdhsa_float_denorm_mode_32 3
  .amdhsa_ieee_mode 0
  .amdhsa_dx10_clamp 0
.end_amdhsa_kernel
.text
```
